```python
import torch

def _softmax(x, axis=-1):
    return torch.softmax(x, dim=axis)
def _gelu(x):
    return torch.nn.functional.gelu(x, approximate="tanh")
def _silu(x):
    return torch.nn.functional.silu(x)
def _sigmoid(x):
    return torch.sigmoid(x)
def _layernorm(x, axis=-1, eps=1e-5):
    m = x.mean(dim=axis, keepdim=True)
    v = x.var(dim=axis, keepdim=True, unbiased=False)
    return (x - m) / torch.sqrt(v + eps)
def _scatter_add(tgt, idx, src, axis=0):
    return tgt.clone().index_add_(axis, idx, src)
def _segment_sum(src, seg, n):
    out = torch.zeros((n,) + src.shape[1:], dtype=src.dtype)
    return out.index_add_(0, seg, src)
def _pad(x, pw):
    flat = tuple(v for pair in reversed(pw) for v in pair)
    return torch.nn.functional.pad(x, flat)

kernel_name = 'concat_heads__compressed_kv_cla__gqa_block_cached__decode'

def setup_inputs():

    _w = (lambda a: (lambda t: t.to(torch.bfloat16) if t.is_floating_point() else t)(torch.as_tensor(a)))
    def _A_setup():
        B, H, Sq, Sk, D, M = 2, 32, 1, 4096, 128, 512
        Dc = 4 * D
        return {
            "x": _w((lambda *s: torch.randn(*s, dtype=torch.bfloat16) * 3.2)(B, Sq, M)),
            "c_kv": _w((lambda *s: torch.randn(*s, dtype=torch.bfloat16) * 0.1)(B, Sk, Dc)),
            "w_q": _w((lambda *s: torch.randn(*s, dtype=torch.bfloat16) * 6.4)(M, H, D) * (M ** -0.5)),
            "w_uk": _w((lambda *s: torch.randn(*s, dtype=torch.bfloat16) * 6.4)(Dc, H, D) * (Dc ** -0.5)),
            "w_uv": _w((lambda *s: torch.randn(*s, dtype=torch.bfloat16) * 0.1)(Dc, H, D) * (Dc ** -0.5)),
            "w_o": _w((lambda *s: torch.randn(*s, dtype=torch.bfloat16) * 0.1)(H, D, M) * ((H * D) ** -0.5)),
        }
    _A_in = _A_setup()

    def _B_setup():
        B, Sq, D = 2, 1, 512
        Hq, Hkv, Sk, Dh = 32, 32, 4096, 128
        assert Hq % Hkv == 0, (Hq, Hkv)
        return {
            "x": _w((lambda *s: torch.randn(*s, dtype=torch.bfloat16) * 1.6)(B, Sq, D)),
            "k_cache": _w((lambda *s: torch.randn(*s, dtype=torch.bfloat16) * 1.6)(B, Hkv, Sk, Dh)),
            "v_cache": _w((lambda *s: torch.randn(*s, dtype=torch.bfloat16) * 0.05)(B, Hkv, Sk, Dh)),
            "wq": _w((lambda *s: torch.randn(*s, dtype=torch.bfloat16) * 1.6)(D, Hq * Dh) * (D ** -0.5)),
            "wo": _w((lambda *s: torch.randn(*s, dtype=torch.bfloat16) * 0.05)(Hq * Dh, D) * ((Hq * Dh) ** -0.5)),
        }
    _B_in = _B_setup()

    return {
        "A_x": _A_in["x"],
        "A_c_kv": _A_in["c_kv"],
        "A_w_q": _A_in["w_q"],
        "A_w_uk": _A_in["w_uk"],
        "A_w_uv": _A_in["w_uv"],
        "A_w_o": _A_in["w_o"],
        "B_x": _B_in["x"],
        "B_k_cache": _B_in["k_cache"],
        "B_v_cache": _B_in["v_cache"],
        "B_wq": _B_in["wq"],
        "B_wo": _B_in["wo"],
    }

def reference(A_x, A_c_kv, A_w_q, A_w_uk, A_w_uv, A_w_o, B_x, B_k_cache, B_v_cache, B_wq, B_wo):
    def _A_ref(x, c_kv, w_q, w_uk, w_uv, w_o):
        B, Sq, M = x.shape[0], x.shape[1], x.shape[2]
        Sk = c_kv.shape[1]
        H, D = w_q.shape[1], w_q.shape[2]
        q = torch.einsum("bqm,mhd->bhqd", x, w_q)
        k = torch.einsum("bkc,chd->bhkd", c_kv, w_uk)
        v = torch.einsum("bkc,chd->bhkd", c_kv, w_uv)
        scores = torch.einsum("bhqd,bhkd->bhqk", q, k) * (D ** -0.5)
        off = Sk - Sq
        qi = torch.arange(Sq)[:, None]
        kj = torch.arange(Sk)[None, :]
        cmask = kj <= (qi + off)
        scores = torch.where(cmask[None, None], scores, -1e9)
        p = _softmax(scores, axis=-1)
        ctx = torch.einsum("bhqk,bhkd->bhqd", p, v)
        return torch.einsum("bhqd,hdm->bqm", ctx, w_o)

    def _B_ref(x, k_cache, v_cache, wq, wo):
        B, Sq, D = x.shape
        Hq, Dh = 32, 128
        Hkv = k_cache.shape[1]
        rep = Hq // Hkv
        q = (lambda x, *d: x.permute(*d))((x @ wq).reshape(B, Sq, Hq, Dh), 0, 2, 1, 3)
        k = (lambda x, n, axis: torch.repeat_interleave(x, n, dim=axis))(k_cache, rep, axis=1)
        v = (lambda x, n, axis: torch.repeat_interleave(x, n, dim=axis))(v_cache, rep, axis=1)
        scores = torch.einsum("bhqd,bhkd->bhqk", q, k) * (Dh ** -0.5)
        p = _softmax(scores, axis=-1)
        o = torch.einsum("bhqk,bhkd->bhqd", p, v)
        return (lambda x, *d: x.permute(*d))(o, 0, 2, 1, 3).reshape(B, Sq, Hq * Dh) @ wo

    a = _A_ref(A_x, A_c_kv, A_w_q, A_w_uk, A_w_uv, A_w_o)
    b = _B_ref(B_x, B_k_cache, B_v_cache, B_wq, B_wo)
    return torch.concatenate([a, b], axis=-1)
```

```asm
; @launch grid=(256,1,1) block=(512,1,1) lds=163840
.amdgcn_target "amdgcn-amd-amdhsa--gfx950"
.text
.globl concat_heads__compressed_kv_cla__gqa_block_cached__decode_kernel
.p2align 8
.type concat_heads__compressed_kv_cla__gqa_block_cached__decode_kernel,@function
concat_heads__compressed_kv_cla__gqa_block_cached__decode_kernel:
    s_cmp_ge_u32 s2, 256
    s_cbranch_scc1 L_end
    s_load_dwordx16 s[4:19], s[0:1], 0
    s_load_dwordx8 s[20:27], s[0:1], 64
    s_load_dwordx4 s[28:31], s[0:1], 96
    v_lshrrev_b32 v1, 6, v0
    s_lshr_b32 s57, s2, 3
    v_readfirstlane_b32 s56, v1
    s_and_b32 s58, s2, 7
    s_waitcnt lgkmcnt(0)
    s_mov_b32 s32, s30
    s_mov_b32 s33, s31
    s_and_b32 s33, s33, 0xffff
    s_mov_b32 s34, 268435456
    s_mov_b32 s35, 0x00020000
    s_mov_b32 s52, s28
    s_mov_b32 s53, s29
    s_and_b32 s53, s53, 0xffff
    s_mov_b32 s54, 256
    s_mov_b32 s55, 0x00020000
    s_cmp_ge_u32 s2, 8
    s_cbranch_scc1 Lcq_1
    v_mov_b32 v40, -1
    v_mov_b32 v41, -1
    v_mov_b32 v42, -1
    v_mov_b32 v43, -1
    v_lshlrev_b32 v45, 4, v0
    s_lshl_b32 s61, s2, 13
    s_add_u32 s61, s61, 1310720
    buffer_store_dwordx4 v[40:43], v45, s[32:35], s61 offen sc0 sc1
    s_add_u32 s61, s61, 65536
    buffer_store_dwordx4 v[40:43], v45, s[32:35], s61 offen sc0 sc1
    s_waitcnt vmcnt(0)
    s_barrier
    s_cmp_lg_u32 s56, 7
    s_cbranch_scc1 Lcq_1
    v_mov_b32 v45, 1
    v_mov_b32 v46, 0
    s_lshl_b32 s61, s2, 2
    s_mov_b64 exec, 1
    buffer_atomic_add v45, v46, s[52:55], s61 offen offset:0 sc1
    s_mov_b64 exec, -1
Lcq_1:
    s_mov_b32 s65, s57
    s_and_b32 s59, s57, 7
    s_cmp_eq_u32 s58, s59
    s_cbranch_scc1 L_roleA1
    s_xor_b32 s60, s59, 5
    s_cmp_eq_u32 s58, s60
    s_cbranch_scc1 L_roleA2
    s_mov_b32 s67, s58
    s_cmp_gt_u32 s58, s59
    s_subb_u32 s67, s67, 0
    s_cmp_gt_u32 s58, s60
    s_subb_u32 s67, s67, 0
    s_mov_b32 s74, 0
    s_mov_b32 s59, s65
    s_and_b32 s60, s58, 1
    s_bfe_u32 s62, s58, 0x10001
    s_lshr_b32 s61, s58, 2
    s_lshl_b32 s3, s61, 5
    s_add_u32 s3, s3, s59
    s_lshl_b32 s3, s3, 2
    s_add_u32 s3, s3, s62
    s_lshl_b32 s3, s3, 1
    s_add_u32 s3, s3, s60
    s_lshl_b32 s3, s3, 8
    s_add_u32 s3, s3, 1310720
    s_and_b32 s91, s59, 0xfc
    s_cmp_eq_u32 s61, 0
    s_cselect_b32 s36, s8, s22
    s_cselect_b32 s37, s9, s23
    s_cselect_b32 s40, s4, s16
    s_cselect_b32 s41, s5, s17
    s_and_b32 s37, s37, 0xffff
    s_and_b32 s41, s41, 0xffff
    s_mov_b32 s38, 4194304
    s_mov_b32 s39, 0x00020000
    s_mov_b32 s42, 2048
    s_mov_b32 s43, 0x00020000
    v_and_b32 v228, 63, v0
    v_lshrrev_b32 v229, 3, v228
    v_and_b32 v230, 7, v228
    v_lshlrev_b32 v231, 3, v229
    s_lshl_b32 s61, s56, 6
    s_lshl_b32 s62, s62, 9
    s_add_u32 s61, s61, s62
    buffer_load_dwordx2 v[208:209], v231, s[40:43], s61 offen offset:0
    buffer_load_dwordx2 v[210:211], v231, s[40:43], s61 offen offset:1024
    v_lshlrev_b32 v231, 15, v229
    v_lshl_add_u32 v231, v230, 4, v231
    s_lshl_b32 s61, s61, 12
    s_lshl_b32 s59, s59, 8
    s_lshl_b32 s60, s60, 7
    s_add_u32 s61, s61, s59
    s_add_u32 s61, s61, s60
    buffer_load_dwordx4 v[192:195], v231, s[36:39], s61 offen
    s_add_u32 s61, s61, 8192
    buffer_load_dwordx4 v[196:199], v231, s[36:39], s61 offen
    s_add_u32 s61, s61, 8192
    buffer_load_dwordx4 v[200:203], v231, s[36:39], s61 offen
    s_add_u32 s61, s61, 8192
    buffer_load_dwordx4 v[204:207], v231, s[36:39], s61 offen
    s_mov_b32 s68, 0x05040100
    s_mov_b32 s69, 0x07060302
    s_barrier
    s_mul_i32 s80, s67, 43691
    s_add_u32 s78, s80, 43691
    s_lshr_b32 s80, s80, 10
    s_lshr_b32 s78, s78, 10
    s_sub_u32 s78, s78, s80
    s_add_u32 s79, s78, 26
    s_mul_i32 s81, s67, 26
    s_sub_u32 s81, s81, s78
    v_and_b32 v1, 63, v0
    v_lshrrev_b32 v2, 4, v1
    v_and_b32 v3, 15, v1
    s_lshl_b32 s61, s65, 20
    s_add_u32 s44, s18, s61
    s_addc_u32 s45, s19, 0
    s_and_b32 s45, s45, 0xffff
    s_mov_b32 s46, 34603008
    s_mov_b32 s47, 0x00020000
    s_add_u32 s48, s20, s61
    s_addc_u32 s49, s21, 0
    s_and_b32 s49, s49, 0xffff
    s_mov_b32 s50, 34603008
    s_mov_b32 s51, 0x00020000
    s_lshl_b32 s83, s65, 8
    s_add_u32 s83, s83, 1507328
    v_lshlrev_b32 v4, 4, v1
    s_mov_b32 s70, 1040356334
    v_mov_b32 v60, 0
    v_mov_b32 v10, 512
    s_mul_i32 s88, s65, 252
    s_and_b32 s88, s88, 255
    s_cmp_eq_u32 s56, 7
    s_cbranch_scc1 Lsvc_2
    s_add_u32 s62, s80, s56
    s_add_u32 s62, s62, s88
    s_mov_b32 s71, 0
    s_mov_b32 s72, 0
    s_mov_b32 s84, s62
    s_add_u32 s100, s84, 0
    s_and_b32 s100, s100, 255
    s_lshl_b32 s100, s100, 12
    buffer_load_dwordx4 v[64:67], v4, s[44:47], s100 offen offset:0 nt
    buffer_load_dwordx4 v[68:71], v4, s[44:47], s100 offen offset:1024 nt
    buffer_load_dwordx4 v[72:75], v4, s[44:47], s100 offen offset:2048 nt
    buffer_load_dwordx4 v[76:79], v4, s[44:47], s100 offen offset:3072 nt
    s_waitcnt vmcnt(4)
    v_perm_b32 v232, v196, v192, s68
    v_perm_b32 v233, v196, v192, s69
    v_perm_b32 v234, v197, v193, s68
    v_perm_b32 v235, v197, v193, s69
    v_perm_b32 v236, v198, v194, s68
    v_perm_b32 v237, v198, v194, s69
    v_perm_b32 v238, v199, v195, s68
    v_perm_b32 v239, v199, v195, s69
    v_dot2_f32_bf16 v212, v232, v208, 0
    v_dot2_f32_bf16 v213, v233, v208, 0
    v_dot2_f32_bf16 v214, v234, v208, 0
    v_dot2_f32_bf16 v215, v235, v208, 0
    v_dot2_f32_bf16 v216, v236, v208, 0
    v_dot2_f32_bf16 v217, v237, v208, 0
    v_dot2_f32_bf16 v218, v238, v208, 0
    v_dot2_f32_bf16 v219, v239, v208, 0
    v_dot2_f32_bf16 v220, v232, v210, 0
    v_dot2_f32_bf16 v221, v233, v210, 0
    v_dot2_f32_bf16 v222, v234, v210, 0
    v_dot2_f32_bf16 v223, v235, v210, 0
    v_dot2_f32_bf16 v224, v236, v210, 0
    v_dot2_f32_bf16 v225, v237, v210, 0
    v_dot2_f32_bf16 v226, v238, v210, 0
    v_dot2_f32_bf16 v227, v239, v210, 0
    v_perm_b32 v232, v204, v200, s68
    v_perm_b32 v233, v204, v200, s69
    v_perm_b32 v234, v205, v201, s68
    v_perm_b32 v235, v205, v201, s69
    v_perm_b32 v236, v206, v202, s68
    v_perm_b32 v237, v206, v202, s69
    v_perm_b32 v238, v207, v203, s68
    v_perm_b32 v239, v207, v203, s69
    v_dot2_f32_bf16 v212, v232, v209, v212
    v_dot2_f32_bf16 v213, v233, v209, v213
    v_dot2_f32_bf16 v214, v234, v209, v214
    v_dot2_f32_bf16 v215, v235, v209, v215
    v_dot2_f32_bf16 v216, v236, v209, v216
    v_dot2_f32_bf16 v217, v237, v209, v217
    v_dot2_f32_bf16 v218, v238, v209, v218
    v_dot2_f32_bf16 v219, v239, v209, v219
    v_dot2_f32_bf16 v220, v232, v211, v220
    v_dot2_f32_bf16 v221, v233, v211, v221
    v_dot2_f32_bf16 v222, v234, v211, v222
    v_dot2_f32_bf16 v223, v235, v211, v223
    v_dot2_f32_bf16 v224, v236, v211, v224
    v_dot2_f32_bf16 v225, v237, v211, v225
    v_dot2_f32_bf16 v226, v238, v211, v226
    v_dot2_f32_bf16 v227, v239, v211, v227
    s_nop 2
    v_permlane32_swap_b32 v212, v220
    v_permlane32_swap_b32 v213, v221
    v_permlane32_swap_b32 v214, v222
    v_permlane32_swap_b32 v215, v223
    v_permlane32_swap_b32 v216, v224
    v_permlane32_swap_b32 v217, v225
    v_permlane32_swap_b32 v218, v226
    v_permlane32_swap_b32 v219, v227
    s_nop 1
    v_add_f32 v212, v212, v220
    v_add_f32 v213, v213, v221
    v_add_f32 v214, v214, v222
    v_add_f32 v215, v215, v223
    v_add_f32 v216, v216, v224
    v_add_f32 v217, v217, v225
    v_add_f32 v218, v218, v226
    v_add_f32 v219, v219, v227
    s_nop 1
    v_permlane16_swap_b32 v212, v216
    v_permlane16_swap_b32 v213, v217
    v_permlane16_swap_b32 v214, v218
    v_permlane16_swap_b32 v215, v219
    s_nop 1
    v_add_f32 v212, v212, v216
    v_add_f32 v213, v213, v217
    v_add_f32 v214, v214, v218
    v_add_f32 v215, v215, v219
    s_nop 1
    v_add_f32_dpp v212, v212, v212 row_ror:8 row_mask:0xf bank_mask:0xf
    v_add_f32_dpp v213, v213, v213 row_ror:8 row_mask:0xf bank_mask:0xf
    v_add_f32_dpp v214, v214, v214 row_ror:8 row_mask:0xf bank_mask:0xf
    v_add_f32_dpp v215, v215, v215 row_ror:8 row_mask:0xf bank_mask:0xf
    v_lshrrev_b32 v232, 5, v228
    v_lshlrev_b32 v232, 8, v232
    v_bfe_u32 v233, v228, 4, 1
    v_lshl_add_u32 v232, v233, 4, v232
    v_lshl_add_u32 v232, v230, 5, v232
    s_lshl_b32 s61, s56, 9
    s_add_u32 s61, s61, 16384
    v_add_u32 v232, s61, v232
    ds_write_b128 v232, v[212:215]
    s_waitcnt lgkmcnt(0)
    s_barrier
    s_waitcnt vmcnt(3)
    buffer_load_dwordx4 v[80:83], v4, s[48:51], s100 offen offset:0 nt
    s_waitcnt vmcnt(3)
    buffer_load_dwordx4 v[84:87], v4, s[48:51], s100 offen offset:1024 nt
    s_waitcnt vmcnt(3)
    buffer_load_dwordx4 v[88:91], v4, s[48:51], s100 offen offset:2048 nt
    s_waitcnt vmcnt(3)
    buffer_load_dwordx4 v[92:95], v4, s[48:51], s100 offen offset:3072 nt
    s_add_u32 s100, s84, 7
    s_and_b32 s100, s100, 255
    s_lshl_b32 s100, s100, 12
    s_waitcnt vmcnt(3)
    buffer_load_dwordx4 v[96:99], v4, s[44:47], s100 offen offset:0 nt
    s_waitcnt vmcnt(3)
    buffer_load_dwordx4 v[100:103], v4, s[44:47], s100 offen offset:1024 nt
    s_waitcnt vmcnt(3)
    buffer_load_dwordx4 v[104:107], v4, s[44:47], s100 offen offset:2048 nt
    s_waitcnt vmcnt(3)
    buffer_load_dwordx4 v[108:111], v4, s[44:47], s100 offen offset:3072 nt
    s_waitcnt vmcnt(3)
    buffer_load_dwordx4 v[112:115], v4, s[48:51], s100 offen offset:0 nt
    s_waitcnt vmcnt(3)
    buffer_load_dwordx4 v[116:119], v4, s[48:51], s100 offen offset:1024 nt
    s_waitcnt vmcnt(3)
    buffer_load_dwordx4 v[120:123], v4, s[48:51], s100 offen offset:2048 nt
    s_waitcnt vmcnt(3)
    buffer_load_dwordx4 v[124:127], v4, s[48:51], s100 offen offset:3072 nt
    s_add_u32 s100, s84, 14
    s_and_b32 s100, s100, 255
    s_lshl_b32 s100, s100, 12
    s_waitcnt vmcnt(3)
    buffer_load_dwordx4 v[128:131], v4, s[44:47], s100 offen offset:0 nt
    s_waitcnt vmcnt(3)
    buffer_load_dwordx4 v[132:135], v4, s[44:47], s100 offen offset:1024 nt
    s_waitcnt vmcnt(3)
    buffer_load_dwordx4 v[136:139], v4, s[44:47], s100 offen offset:2048 nt
    s_waitcnt vmcnt(3)
    buffer_load_dwordx4 v[140:143], v4, s[44:47], s100 offen offset:3072 nt
    s_waitcnt vmcnt(3)
    buffer_load_dwordx4 v[144:147], v4, s[48:51], s100 offen offset:0 nt
    s_waitcnt vmcnt(3)
    buffer_load_dwordx4 v[148:151], v4, s[48:51], s100 offen offset:1024 nt
    s_waitcnt vmcnt(3)
    buffer_load_dwordx4 v[152:155], v4, s[48:51], s100 offen offset:2048 nt
    s_waitcnt vmcnt(3)
    buffer_load_dwordx4 v[156:159], v4, s[48:51], s100 offen offset:3072 nt
    s_add_u32 s100, s84, 21
    s_and_b32 s100, s100, 255
    s_lshl_b32 s100, s100, 12
    s_waitcnt vmcnt(3)
    buffer_load_dwordx4 v[160:163], v4, s[44:47], s100 offen offset:0 nt
    s_waitcnt vmcnt(3)
    buffer_load_dwordx4 v[164:167], v4, s[44:47], s100 offen offset:1024 nt
    s_waitcnt vmcnt(3)
    buffer_load_dwordx4 v[168:171], v4, s[44:47], s100 offen offset:2048 nt
    s_waitcnt vmcnt(3)
    buffer_load_dwordx4 v[172:175], v4, s[44:47], s100 offen offset:3072 nt
    s_waitcnt vmcnt(3)
    buffer_load_dwordx4 v[176:179], v4, s[48:51], s100 offen offset:0 nt
    s_waitcnt vmcnt(3)
    buffer_load_dwordx4 v[180:183], v4, s[48:51], s100 offen offset:1024 nt
    s_waitcnt vmcnt(3)
    buffer_load_dwordx4 v[184:187], v4, s[48:51], s100 offen offset:2048 nt
    s_waitcnt vmcnt(3)
    buffer_load_dwordx4 v[188:191], v4, s[48:51], s100 offen offset:3072 nt
    s_branch Lgo_3
Lsvc_2:
    s_setprio 3
    s_waitcnt vmcnt(0)
    v_perm_b32 v232, v196, v192, s68
    v_perm_b32 v233, v196, v192, s69
    v_perm_b32 v234, v197, v193, s68
    v_perm_b32 v235, v197, v193, s69
    v_perm_b32 v236, v198, v194, s68
    v_perm_b32 v237, v198, v194, s69
    v_perm_b32 v238, v199, v195, s68
    v_perm_b32 v239, v199, v195, s69
    v_dot2_f32_bf16 v212, v232, v208, 0
    v_dot2_f32_bf16 v213, v233, v208, 0
    v_dot2_f32_bf16 v214, v234, v208, 0
    v_dot2_f32_bf16 v215, v235, v208, 0
    v_dot2_f32_bf16 v216, v236, v208, 0
    v_dot2_f32_bf16 v217, v237, v208, 0
    v_dot2_f32_bf16 v218, v238, v208, 0
    v_dot2_f32_bf16 v219, v239, v208, 0
    v_dot2_f32_bf16 v220, v232, v210, 0
    v_dot2_f32_bf16 v221, v233, v210, 0
    v_dot2_f32_bf16 v222, v234, v210, 0
    v_dot2_f32_bf16 v223, v235, v210, 0
    v_dot2_f32_bf16 v224, v236, v210, 0
    v_dot2_f32_bf16 v225, v237, v210, 0
    v_dot2_f32_bf16 v226, v238, v210, 0
    v_dot2_f32_bf16 v227, v239, v210, 0
    v_perm_b32 v232, v204, v200, s68
    v_perm_b32 v233, v204, v200, s69
    v_perm_b32 v234, v205, v201, s68
    v_perm_b32 v235, v205, v201, s69
    v_perm_b32 v236, v206, v202, s68
    v_perm_b32 v237, v206, v202, s69
    v_perm_b32 v238, v207, v203, s68
    v_perm_b32 v239, v207, v203, s69
    v_dot2_f32_bf16 v212, v232, v209, v212
    v_dot2_f32_bf16 v213, v233, v209, v213
    v_dot2_f32_bf16 v214, v234, v209, v214
    v_dot2_f32_bf16 v215, v235, v209, v215
    v_dot2_f32_bf16 v216, v236, v209, v216
    v_dot2_f32_bf16 v217, v237, v209, v217
    v_dot2_f32_bf16 v218, v238, v209, v218
    v_dot2_f32_bf16 v219, v239, v209, v219
    v_dot2_f32_bf16 v220, v232, v211, v220
    v_dot2_f32_bf16 v221, v233, v211, v221
    v_dot2_f32_bf16 v222, v234, v211, v222
    v_dot2_f32_bf16 v223, v235, v211, v223
    v_dot2_f32_bf16 v224, v236, v211, v224
    v_dot2_f32_bf16 v225, v237, v211, v225
    v_dot2_f32_bf16 v226, v238, v211, v226
    v_dot2_f32_bf16 v227, v239, v211, v227
    s_nop 2
    v_permlane32_swap_b32 v212, v220
    v_permlane32_swap_b32 v213, v221
    v_permlane32_swap_b32 v214, v222
    v_permlane32_swap_b32 v215, v223
    v_permlane32_swap_b32 v216, v224
    v_permlane32_swap_b32 v217, v225
    v_permlane32_swap_b32 v218, v226
    v_permlane32_swap_b32 v219, v227
    s_nop 1
    v_add_f32 v212, v212, v220
    v_add_f32 v213, v213, v221
    v_add_f32 v214, v214, v222
    v_add_f32 v215, v215, v223
    v_add_f32 v216, v216, v224
    v_add_f32 v217, v217, v225
    v_add_f32 v218, v218, v226
    v_add_f32 v219, v219, v227
    s_nop 1
    v_permlane16_swap_b32 v212, v216
    v_permlane16_swap_b32 v213, v217
    v_permlane16_swap_b32 v214, v218
    v_permlane16_swap_b32 v215, v219
    s_nop 1
    v_add_f32 v212, v212, v216
    v_add_f32 v213, v213, v217
    v_add_f32 v214, v214, v218
    v_add_f32 v215, v215, v219
    s_nop 1
    v_add_f32_dpp v212, v212, v212 row_ror:8 row_mask:0xf bank_mask:0xf
    v_add_f32_dpp v213, v213, v213 row_ror:8 row_mask:0xf bank_mask:0xf
    v_add_f32_dpp v214, v214, v214 row_ror:8 row_mask:0xf bank_mask:0xf
    v_add_f32_dpp v215, v215, v215 row_ror:8 row_mask:0xf bank_mask:0xf
    v_lshrrev_b32 v232, 5, v228
    v_lshlrev_b32 v232, 8, v232
    v_bfe_u32 v233, v228, 4, 1
    v_lshl_add_u32 v232, v233, 4, v232
    v_lshl_add_u32 v232, v230, 5, v232
    s_lshl_b32 s61, s56, 9
    s_add_u32 s61, s61, 16384
    v_add_u32 v232, s61, v232
    ds_write_b128 v232, v[212:215]
    s_waitcnt lgkmcnt(0)
    s_barrier
    v_mov_b32 v234, 0
    buffer_load_dword v235, v234, s[52:55], s91 offen offset:0 sc0 sc1
    v_and_b32 v232, 31, v228
    v_lshlrev_b32 v233, 4, v232
    v_add_u32 v233, 16384, v233
    ds_read_b128 v[192:195], v233 offset:0
    ds_read_b128 v[196:199], v233 offset:512
    ds_read_b128 v[200:203], v233 offset:1024
    ds_read_b128 v[204:207], v233 offset:1536
    ds_read_b128 v[208:211], v233 offset:2048
    ds_read_b128 v[212:215], v233 offset:2560
    ds_read_b128 v[216:219], v233 offset:3072
    ds_read_b128 v[220:223], v233 offset:3584
    s_waitcnt lgkmcnt(6)
    v_add_f32 v192, v192, v196
    v_add_f32 v193, v193, v197
    v_add_f32 v194, v194, v198
    v_add_f32 v195, v195, v199
    s_waitcnt lgkmcnt(5)
    v_add_f32 v192, v192, v200
    v_add_f32 v193, v193, v201
    v_add_f32 v194, v194, v202
    v_add_f32 v195, v195, v203
    s_waitcnt lgkmcnt(4)
    v_add_f32 v192, v192, v204
    v_add_f32 v193, v193, v205
    v_add_f32 v194, v194, v206
    v_add_f32 v195, v195, v207
    s_waitcnt lgkmcnt(3)
    v_add_f32 v192, v192, v208
    v_add_f32 v193, v193, v209
    v_add_f32 v194, v194, v210
    v_add_f32 v195, v195, v211
    s_waitcnt lgkmcnt(2)
    v_add_f32 v192, v192, v212
    v_add_f32 v193, v193, v213
    v_add_f32 v194, v194, v214
    v_add_f32 v195, v195, v215
    s_waitcnt lgkmcnt(1)
    v_add_f32 v192, v192, v216
    v_add_f32 v193, v193, v217
    v_add_f32 v194, v194, v218
    v_add_f32 v195, v195, v219
    s_waitcnt lgkmcnt(0)
    v_add_f32 v192, v192, v220
    v_add_f32 v193, v193, v221
    v_add_f32 v194, v194, v222
    v_add_f32 v195, v195, v223
    v_lshrrev_b32 v233, 4, v232
    v_lshlrev_b32 v233, 10, v233
    v_and_b32 v232, 15, v232
    v_lshl_add_u32 v233, v232, 4, v233
    s_waitcnt vmcnt(0)
    s_mov_b32 s92, 0
Lcf_5:
    v_readfirstlane_b32 s57, v235
    s_nop 3
    s_cmp_lg_u32 s57, 0
    s_cbranch_scc1 Lcfd_6
    s_sleep 2
    buffer_load_dword v235, v234, s[52:55], s91 offen offset:0 sc0 sc1
    s_waitcnt vmcnt(0)
    s_add_u32 s92, s92, 1
    s_cmp_lt_u32 s92, 400000
    s_cbranch_scc1 Lcf_5
Lcfd_6:
    s_mov_b64 exec, 0xffffffff
    buffer_store_dwordx4 v[192:195], v233, s[32:35], s3 offen sc0 sc1
    s_mov_b64 exec, -1
L_svc_q:
    v_lshlrev_b32 v40, 4, v1
    s_lshl_b32 s61, s65, 11
    s_add_u32 s61, s61, 1376256
    s_mov_b32 s92, 0
Lpoll_7:
    buffer_load_dwordx4 v[48:51], v40, s[32:35], s61 offen offset:0 sc0 sc1
    buffer_load_dwordx4 v[56:59], v40, s[32:35], s61 offen offset:1024 sc0 sc1
    s_waitcnt vmcnt(0)
    v_mov_b32 v41, v48
    v_max3_u32 v41, v41, v49, v50
    v_max3_u32 v41, v41, v51, v56
    v_max3_u32 v41, v41, v57, v58
    v_max_u32 v41, v41, v59
    v_cmpx_eq_u32 vcc, -1, v41
    s_cbranch_execz Lpolld_8
    s_sleep 4
    s_add_u32 s92, s92, 1
    s_cmp_lt_u32 s92, 400000
    s_cbranch_scc1 Lpoll_7
Lpolld_8:
    s_mov_b64 exec, -1
    v_mov_b32 v52, v48
    v_mov_b32 v53, v49
    v_mov_b32 v54, v50
    v_mov_b32 v55, v51
    v_mov_b32 v60, v56
    v_mov_b32 v61, v57
    v_mov_b32 v62, v58
    v_mov_b32 v63, v59
    s_nop 1
    v_permlane32_swap_b32 v48, v52
    v_permlane32_swap_b32 v49, v53
    v_permlane32_swap_b32 v50, v54
    v_permlane32_swap_b32 v51, v55
    v_permlane32_swap_b32 v56, v60
    v_permlane32_swap_b32 v57, v61
    v_permlane32_swap_b32 v58, v62
    v_permlane32_swap_b32 v59, v63
    s_nop 1
    v_add_f32 v48, v48, v52
    v_add_f32 v49, v49, v53
    v_add_f32 v50, v50, v54
    v_add_f32 v51, v51, v55
    v_cvt_pk_bf16_f32 v48, v48, v49
    v_cvt_pk_bf16_f32 v49, v50, v51
    v_add_f32 v56, v56, v60
    v_add_f32 v57, v57, v61
    v_add_f32 v58, v58, v62
    v_add_f32 v59, v59, v63
    v_cvt_pk_bf16_f32 v56, v56, v57
    v_cvt_pk_bf16_f32 v57, v58, v59
    v_mov_b32 v60, 0
    v_and_b32 v42, 31, v1
    v_lshlrev_b32 v42, 3, v42
    ds_write_b64 v42, v[48:49] offset:0
    ds_write_b64 v42, v[56:57] offset:256
    v_add_u32 v40, 0, v1
    v_add_u32 v41, s80, v40
    v_add_u32 v41, s88, v41
    v_and_b32 v41, 255, v41
    v_lshlrev_b32 v41, 12, v41
    v_add_u32 v42, s81, v40
    v_add_u32 v42, s88, v42
    v_and_b32 v42, 255, v42
    v_lshlrev_b32 v42, 12, v42
    v_add_u32 v42, 33554432, v42
    v_cmp_gt_u32 vcc, s78, v40
    s_nop 1
    v_cndmask_b32 v41, v42, v41, vcc
    v_cmp_gt_u32 vcc, s79, v40
    v_mov_b32 v42, -1
    v_lshlrev_b32 v43, 2, v40
    v_cndmask_b32 v41, v42, v41, vcc
    ds_write_b32 v43, v41 offset:1024
    v_add_u32 v40, 64, v1
    v_add_u32 v41, s80, v40
    v_add_u32 v41, s88, v41
    v_and_b32 v41, 255, v41
    v_lshlrev_b32 v41, 12, v41
    v_add_u32 v42, s81, v40
    v_add_u32 v42, s88, v42
    v_and_b32 v42, 255, v42
    v_lshlrev_b32 v42, 12, v42
    v_add_u32 v42, 33554432, v42
    v_cmp_gt_u32 vcc, s78, v40
    s_nop 1
    v_cndmask_b32 v41, v42, v41, vcc
    v_cmp_gt_u32 vcc, s79, v40
    v_mov_b32 v42, -1
    v_lshlrev_b32 v43, 2, v40
    v_cndmask_b32 v41, v42, v41, vcc
    ds_write_b32 v43, v41 offset:1024
    v_add_u32 v40, 128, v1
    v_add_u32 v41, s80, v40
    v_add_u32 v41, s88, v41
    v_and_b32 v41, 255, v41
    v_lshlrev_b32 v41, 12, v41
    v_add_u32 v42, s81, v40
    v_add_u32 v42, s88, v42
    v_and_b32 v42, 255, v42
    v_lshlrev_b32 v42, 12, v42
    v_add_u32 v42, 33554432, v42
    v_cmp_gt_u32 vcc, s78, v40
    s_nop 1
    v_cndmask_b32 v41, v42, v41, vcc
    v_cmp_gt_u32 vcc, s79, v40
    v_mov_b32 v42, -1
    v_lshlrev_b32 v43, 2, v40
    v_cndmask_b32 v41, v42, v41, vcc
    ds_write_b32 v43, v41 offset:1024
    v_add_u32 v40, 192, v1
    v_add_u32 v41, s80, v40
    v_add_u32 v41, s88, v41
    v_and_b32 v41, 255, v41
    v_lshlrev_b32 v41, 12, v41
    v_add_u32 v42, s81, v40
    v_add_u32 v42, s88, v42
    v_and_b32 v42, 255, v42
    v_lshlrev_b32 v42, 12, v42
    v_add_u32 v42, 33554432, v42
    v_cmp_gt_u32 vcc, s78, v40
    s_nop 1
    v_cndmask_b32 v41, v42, v41, vcc
    v_cmp_gt_u32 vcc, s79, v40
    v_mov_b32 v42, -1
    v_lshlrev_b32 v43, 2, v40
    v_cndmask_b32 v41, v42, v41, vcc
    ds_write_b32 v43, v41 offset:1024
    v_add_u32 v40, 256, v1
    v_add_u32 v41, s80, v40
    v_add_u32 v41, s88, v41
    v_and_b32 v41, 255, v41
    v_lshlrev_b32 v41, 12, v41
    v_add_u32 v42, s81, v40
    v_add_u32 v42, s88, v42
    v_and_b32 v42, 255, v42
    v_lshlrev_b32 v42, 12, v42
    v_add_u32 v42, 33554432, v42
    v_cmp_gt_u32 vcc, s78, v40
    s_nop 1
    v_cndmask_b32 v41, v42, v41, vcc
    v_cmp_gt_u32 vcc, s79, v40
    v_mov_b32 v42, -1
    v_lshlrev_b32 v43, 2, v40
    v_cndmask_b32 v41, v42, v41, vcc
    ds_write_b32 v43, v41 offset:1024
    v_add_u32 v40, 320, v1
    v_add_u32 v41, s80, v40
    v_add_u32 v41, s88, v41
    v_and_b32 v41, 255, v41
    v_lshlrev_b32 v41, 12, v41
    v_add_u32 v42, s81, v40
    v_add_u32 v42, s88, v42
    v_and_b32 v42, 255, v42
    v_lshlrev_b32 v42, 12, v42
    v_add_u32 v42, 33554432, v42
    v_cmp_gt_u32 vcc, s78, v40
    s_nop 1
    v_cndmask_b32 v41, v42, v41, vcc
    v_cmp_gt_u32 vcc, s79, v40
    v_mov_b32 v42, -1
    v_lshlrev_b32 v43, 2, v40
    v_cndmask_b32 v41, v42, v41, vcc
    ds_write_b32 v43, v41 offset:1024
    v_add_u32 v40, 384, v1
    v_add_u32 v41, s80, v40
    v_add_u32 v41, s88, v41
    v_and_b32 v41, 255, v41
    v_lshlrev_b32 v41, 12, v41
    v_add_u32 v42, s81, v40
    v_add_u32 v42, s88, v42
    v_and_b32 v42, 255, v42
    v_lshlrev_b32 v42, 12, v42
    v_add_u32 v42, 33554432, v42
    v_cmp_gt_u32 vcc, s78, v40
    s_nop 1
    v_cndmask_b32 v41, v42, v41, vcc
    v_cmp_gt_u32 vcc, s79, v40
    v_mov_b32 v42, -1
    v_lshlrev_b32 v43, 2, v40
    v_cndmask_b32 v41, v42, v41, vcc
    ds_write_b32 v43, v41 offset:1024
    v_add_u32 v40, 448, v1
    v_add_u32 v41, s80, v40
    v_add_u32 v41, s88, v41
    v_and_b32 v41, 255, v41
    v_lshlrev_b32 v41, 12, v41
    v_add_u32 v42, s81, v40
    v_add_u32 v42, s88, v42
    v_and_b32 v42, 255, v42
    v_lshlrev_b32 v42, 12, v42
    v_add_u32 v42, 33554432, v42
    v_cmp_gt_u32 vcc, s78, v40
    s_nop 1
    v_cndmask_b32 v41, v42, v41, vcc
    v_cmp_gt_u32 vcc, s79, v40
    v_mov_b32 v42, -1
    v_lshlrev_b32 v43, 2, v40
    v_cndmask_b32 v41, v42, v41, vcc
    ds_write_b32 v43, v41 offset:1024
    v_mov_b32 v40, 0xff7fffff
    v_mov_b32 v41, 0
    v_mov_b32 v42, 56
    ds_write_b64 v42, v[40:41] offset:12288
    ds_write_b64 v42, v[40:41] offset:12352
    v_mov_b32 v40, 0
    v_lshlrev_b32 v42, 3, v1
    ds_write_b64 v42, v[40:41] offset:7680
    ds_write_b64 v42, v[40:41] offset:11776
    s_mov_b32 s82, s79
    s_cmp_eq_u32 s74, 0
    s_cselect_b32 s61, 28, 0
    v_mov_b32 v40, s61
    ds_write_b32 v10, v40
    s_mov_b32 s62, 0
    s_cbranch_scc1 Lnopre_9
    s_mov_b32 s61, 14
    v_mov_b32 v40, s61
    s_mov_b64 exec, 1
    buffer_atomic_add v40, v60, s[32:35], s83 offen sc0 sc1
    s_mov_b64 exec, -1
    s_waitcnt vmcnt(0)
    v_readfirstlane_b32 s62, v40
    s_nop 0
    s_add_u32 s62, s62, 4294902172
    v_add_u32 v40, s62, v1
    v_add_u32 v41, s88, v40
    v_and_b32 v41, 255, v41
    v_lshlrev_b32 v41, 12, v41
    v_add_u32 v41, 33554432, v41
    v_mov_b32 v42, 67108864
    v_cmp_gt_u32 vcc, 512, v40
    v_add_u32 v43, s82, v1
    v_lshlrev_b32 v43, 2, v43
    v_cndmask_b32 v41, v42, v41, vcc
    s_bfm_b64 exec, s61, 0
    ds_write_b32 v43, v41 offset:1024
    s_mov_b64 exec, -1
    s_add_u32 s82, s82, s61
    s_add_u32 s62, s62, s61
Lnopre_9:
    s_waitcnt lgkmcnt(0)
    s_barrier
    s_cmp_ge_u32 s62, 512
    s_cbranch_scc1 Lpoolend_11
    s_mov_b32 s92, 0
    s_mov_b32 s84, 0
    s_mov_b32 s87, s74
Lpool_10:
    ds_read_b32 v40, v10
    s_waitcnt lgkmcnt(0)
    v_readfirstlane_b32 s61, v40
    s_nop 0
    s_cmp_lg_u32 s87, 0
    s_cbranch_scc1 Lcfe_13
    s_cmp_lt_u32 s61, 30
    s_cbranch_scc1 Lcfe_13
    s_mov_b32 s87, s61
    v_mov_b32 v44, 0
    s_mov_b32 s92, 0
Lcf_14:
    buffer_load_dword v45, v44, s[52:55], 0 offen offset:128 sc0 sc1
    s_waitcnt vmcnt(0)
    v_readfirstlane_b32 s57, v45
    s_nop 3
    s_cmp_ge_u32 s57, 64
    s_cbranch_scc1 Lcfd_15
    s_sleep 16
    s_add_u32 s92, s92, 1
    s_cmp_lt_u32 s92, 400000
    s_cbranch_scc1 Lcf_14
Lcfd_15:
    s_mov_b32 s61, s87
Lcfe_13:
    s_add_u32 s61, s61, 4
    s_sub_i32 s61, s61, s82
    s_cmp_gt_i32 s61, 0
    s_cbranch_scc0 Lpoolslp_12
    s_min_i32 s61, s61, 7
    s_cmp_lg_u32 s87, 0
    s_cbranch_scc1 Lcfk_16
    s_mov_b32 s87, s61
    v_mov_b32 v44, 0
    s_mov_b32 s92, 0
Lcf_17:
    buffer_load_dword v45, v44, s[52:55], 0 offen offset:128 sc0 sc1
    s_waitcnt vmcnt(0)
    v_readfirstlane_b32 s57, v45
    s_nop 3
    s_cmp_ge_u32 s57, 64
    s_cbranch_scc1 Lcfd_18
    s_sleep 16
    s_add_u32 s92, s92, 1
    s_cmp_lt_u32 s92, 400000
    s_cbranch_scc1 Lcf_17
Lcfd_18:
    s_mov_b32 s61, s87
Lcfk_16:
    v_mov_b32 v40, s61
    s_mov_b64 exec, 1
    buffer_atomic_add v40, v60, s[32:35], s83 offen sc0 sc1
    s_mov_b64 exec, -1
    s_waitcnt vmcnt(0)
    v_readfirstlane_b32 s62, v40
    s_nop 0
    s_add_u32 s62, s62, 4294902172
    v_add_u32 v40, s62, v1
    v_add_u32 v41, s88, v40
    v_and_b32 v41, 255, v41
    v_lshlrev_b32 v41, 12, v41
    v_add_u32 v41, 33554432, v41
    v_mov_b32 v42, 67108864
    v_cmp_gt_u32 vcc, 512, v40
    v_add_u32 v43, s82, v1
    v_lshlrev_b32 v43, 2, v43
    v_cndmask_b32 v41, v42, v41, vcc
    s_bfm_b64 exec, s61, 0
    ds_write_b32 v43, v41 offset:1024
    s_mov_b64 exec, -1
    s_add_u32 s82, s82, s61
    s_add_u32 s62, s62, s61
    s_cmp_ge_u32 s62, 512
    s_cbranch_scc1 Lpoolend_11
Lpoolslp_12:
    s_sleep 2
    s_add_u32 s92, s92, 1
    s_cmp_lt_u32 s92, 400000
    s_cbranch_scc1 Lpool_10
Lpoolend_11:
    v_add_u32 v43, s82, v1
    v_min_u32 v43, 511, v43
    v_lshlrev_b32 v43, 2, v43
    v_mov_b32 v42, 67108864
    ds_write_b32 v43, v42 offset:1024
    s_waitcnt lgkmcnt(0)
    s_setprio 0
    s_branch L_bend
Lgo_3:
    s_barrier
    s_mov_b64 exec, 1
    v_mov_b32 v8, 1
    ds_add_rtn_u32 v8, v10, v8
    s_mov_b64 exec, -1
    v_lshlrev_b32 v40, 4, v3
    ds_read_b128 v[24:27], v40 offset:0
    v_mov_b32 v36, 0xff7fffff
    v_mov_b32 v37, 0
    v_mov_b32 v16, 0
    v_mov_b32 v17, 0
    v_mov_b32 v18, 0
    v_mov_b32 v19, 0
    v_mov_b32 v20, 0
    v_mov_b32 v21, 0
    v_mov_b32 v22, 0
    v_mov_b32 v23, 0
    v_lshlrev_b32 v6, 5, v3
    v_lshl_add_u32 v6, v2, 3, v6
    s_lshl_b32 s61, s56, 9
    v_add_u32 v7, s61, v6
    s_lshl_b32 s77, s56, 3
    s_mov_b32 s76, 33554432
    s_waitcnt lgkmcnt(0)
    v_readfirstlane_b32 s84, v8
    s_mov_b64 exec, 1
    v_lshlrev_b32 v8, 2, v8
    ds_read_b32 v9, v8 offset:1024
    s_mov_b64 exec, -1
    s_waitcnt lgkmcnt(0)
    v_readfirstlane_b32 s73, v9
    s_nop 0
    s_cmp_lg_u32 s73, -1
    s_cbranch_scc1 Lg_19
    s_mov_b32 s92, 0
Lgs_20:
    s_sleep 1
    s_mov_b64 exec, 1
    ds_read_b32 v9, v8 offset:1024
    s_mov_b64 exec, -1
    s_waitcnt lgkmcnt(0)
    v_readfirstlane_b32 s73, v9
    s_add_u32 s92, s92, 1
    s_cmp_lg_u32 s73, -1
    s_cbranch_scc1 Lg_19
    s_cmp_lt_u32 s92, 400000
    s_cbranch_scc1 Lgs_20
Lg_19:
    s_cmp_ge_u32 s73, 67108864
    s_cbranch_scc1 LBf0_28
    s_mov_b32 s100, s73
    s_mov_b32 s71, s73
    v_dot2_f32_bf16 v28, v64, v24, 0
    v_dot2_f32_bf16 v28, v65, v25, v28
    v_dot2_f32_bf16 v28, v66, v26, v28
    v_dot2_f32_bf16 v28, v67, v27, v28
    s_waitcnt vmcnt(7)
    buffer_load_dwordx4 v[64:67], v4, s[44:47], s100 offen offset:0 nt
    v_dot2_f32_bf16 v29, v68, v24, 0
    v_dot2_f32_bf16 v29, v69, v25, v29
    v_dot2_f32_bf16 v29, v70, v26, v29
    v_dot2_f32_bf16 v29, v71, v27, v29
    s_waitcnt vmcnt(7)
    buffer_load_dwordx4 v[68:71], v4, s[44:47], s100 offen offset:1024 nt
    v_dot2_f32_bf16 v30, v72, v24, 0
    v_dot2_f32_bf16 v30, v73, v25, v30
    v_dot2_f32_bf16 v30, v74, v26, v30
    v_dot2_f32_bf16 v30, v75, v27, v30
    s_waitcnt vmcnt(7)
    buffer_load_dwordx4 v[72:75], v4, s[44:47], s100 offen offset:2048 nt
    v_dot2_f32_bf16 v31, v76, v24, 0
    v_dot2_f32_bf16 v31, v77, v25, v31
    v_dot2_f32_bf16 v31, v78, v26, v31
    v_dot2_f32_bf16 v31, v79, v27, v31
    s_waitcnt vmcnt(7)
    buffer_load_dwordx4 v[76:79], v4, s[44:47], s100 offen offset:3072 nt
    s_nop 2
    v_add_f32_dpp v28, v28, v28 row_ror:8 row_mask:0xf bank_mask:0xf
    v_add_f32_dpp v29, v29, v29 row_ror:8 row_mask:0xf bank_mask:0xf
    v_add_f32_dpp v30, v30, v30 row_ror:8 row_mask:0xf bank_mask:0xf
    v_add_f32_dpp v31, v31, v31 row_ror:8 row_mask:0xf bank_mask:0xf
    v_add_f32_dpp v28, v28, v28 row_ror:4 row_mask:0xf bank_mask:0xf
    v_add_f32_dpp v29, v29, v29 row_ror:4 row_mask:0xf bank_mask:0xf
    v_add_f32_dpp v30, v30, v30 row_ror:4 row_mask:0xf bank_mask:0xf
    v_add_f32_dpp v31, v31, v31 row_ror:4 row_mask:0xf bank_mask:0xf
    v_add_f32_dpp v28, v28, v28 row_ror:2 row_mask:0xf bank_mask:0xf
    v_add_f32_dpp v29, v29, v29 row_ror:2 row_mask:0xf bank_mask:0xf
    v_add_f32_dpp v30, v30, v30 row_ror:2 row_mask:0xf bank_mask:0xf
    v_add_f32_dpp v31, v31, v31 row_ror:2 row_mask:0xf bank_mask:0xf
    v_add_f32_dpp v28, v28, v28 row_ror:1 row_mask:0xf bank_mask:0xf
    v_add_f32_dpp v29, v29, v29 row_ror:1 row_mask:0xf bank_mask:0xf
    v_add_f32_dpp v30, v30, v30 row_ror:1 row_mask:0xf bank_mask:0xf
    v_add_f32_dpp v31, v31, v31 row_ror:1 row_mask:0xf bank_mask:0xf
    v_max3_f32 v38, v36, v28, v29
    v_max3_f32 v38, v38, v30, v31
    v_sub_f32 v39, v36, v38
    v_mul_f32 v39, s70, v39
    v_exp_f32 v39, v39
    v_mul_f32 v56, s70, v38
    v_mov_b32 v36, v38
    v_fma_f32 v48, v28, s70, -v56
    v_fma_f32 v49, v29, s70, -v56
    v_fma_f32 v50, v30, s70, -v56
    v_fma_f32 v51, v31, s70, -v56
    v_exp_f32 v48, v48
    v_exp_f32 v49, v49
    v_exp_f32 v50, v50
    v_exp_f32 v51, v51
    v_mul_f32 v37, v37, v39
    v_mul_f32 v16, v16, v39
    v_mul_f32 v17, v17, v39
    v_mul_f32 v18, v18, v39
    v_mul_f32 v19, v19, v39
    v_mul_f32 v20, v20, v39
    v_mul_f32 v21, v21, v39
    v_mul_f32 v22, v22, v39
    v_mul_f32 v23, v23, v39
    v_add_f32 v37, v37, v48
    v_add_f32 v37, v37, v49
    v_add_f32 v37, v37, v50
    v_add_f32 v37, v37, v51
    v_lshlrev_b32 v40, 16, v80
    v_and_b32 v41, 0xffff0000, v80
    v_lshlrev_b32 v42, 16, v81
    v_and_b32 v43, 0xffff0000, v81
    v_lshlrev_b32 v44, 16, v82
    v_and_b32 v45, 0xffff0000, v82
    v_lshlrev_b32 v46, 16, v83
    v_and_b32 v47, 0xffff0000, v83
    s_waitcnt vmcnt(7)
    buffer_load_dwordx4 v[80:83], v4, s[48:51], s100 offen offset:0 nt
    v_fmac_f32 v16, v40, v48
    v_fmac_f32 v17, v41, v48
    v_fmac_f32 v18, v42, v48
    v_fmac_f32 v19, v43, v48
    v_fmac_f32 v20, v44, v48
    v_fmac_f32 v21, v45, v48
    v_fmac_f32 v22, v46, v48
    v_fmac_f32 v23, v47, v48
    v_lshlrev_b32 v40, 16, v84
    v_and_b32 v41, 0xffff0000, v84
    v_lshlrev_b32 v42, 16, v85
    v_and_b32 v43, 0xffff0000, v85
    v_lshlrev_b32 v44, 16, v86
    v_and_b32 v45, 0xffff0000, v86
    v_lshlrev_b32 v46, 16, v87
    v_and_b32 v47, 0xffff0000, v87
    s_waitcnt vmcnt(7)
    buffer_load_dwordx4 v[84:87], v4, s[48:51], s100 offen offset:1024 nt
    s_mov_b64 exec, 1
    v_mov_b32 v8, 1
    ds_add_rtn_u32 v8, v10, v8
    s_mov_b64 exec, -1
    v_fmac_f32 v16, v40, v49
    v_fmac_f32 v17, v41, v49
    v_fmac_f32 v18, v42, v49
    v_fmac_f32 v19, v43, v49
    v_fmac_f32 v20, v44, v49
    v_fmac_f32 v21, v45, v49
    v_fmac_f32 v22, v46, v49
    v_fmac_f32 v23, v47, v49
    v_lshlrev_b32 v40, 16, v88
    v_and_b32 v41, 0xffff0000, v88
    v_lshlrev_b32 v42, 16, v89
    v_and_b32 v43, 0xffff0000, v89
    v_lshlrev_b32 v44, 16, v90
    v_and_b32 v45, 0xffff0000, v90
    v_lshlrev_b32 v46, 16, v91
    v_and_b32 v47, 0xffff0000, v91
    s_waitcnt vmcnt(7)
    buffer_load_dwordx4 v[88:91], v4, s[48:51], s100 offen offset:2048 nt
    s_waitcnt lgkmcnt(0)
    v_readfirstlane_b32 s84, v8
    s_mov_b64 exec, 1
    v_lshlrev_b32 v8, 2, v8
    ds_read_b32 v9, v8 offset:1024
    s_mov_b64 exec, -1
    v_fmac_f32 v16, v40, v50
    v_fmac_f32 v17, v41, v50
    v_fmac_f32 v18, v42, v50
    v_fmac_f32 v19, v43, v50
    v_fmac_f32 v20, v44, v50
    v_fmac_f32 v21, v45, v50
    v_fmac_f32 v22, v46, v50
    v_fmac_f32 v23, v47, v50
    v_lshlrev_b32 v40, 16, v92
    v_and_b32 v41, 0xffff0000, v92
    v_lshlrev_b32 v42, 16, v93
    v_and_b32 v43, 0xffff0000, v93
    v_lshlrev_b32 v44, 16, v94
    v_and_b32 v45, 0xffff0000, v94
    v_lshlrev_b32 v46, 16, v95
    v_and_b32 v47, 0xffff0000, v95
    s_waitcnt vmcnt(7)
    buffer_load_dwordx4 v[92:95], v4, s[48:51], s100 offen offset:3072 nt
    v_fmac_f32 v16, v40, v51
    v_fmac_f32 v17, v41, v51
    v_fmac_f32 v18, v42, v51
    v_fmac_f32 v19, v43, v51
    v_fmac_f32 v20, v44, v51
    v_fmac_f32 v21, v45, v51
    v_fmac_f32 v22, v46, v51
    v_fmac_f32 v23, v47, v51
    s_waitcnt lgkmcnt(0)
    v_readfirstlane_b32 s73, v9
    s_nop 0
    s_cmp_lg_u32 s73, -1
    s_cbranch_scc1 Lg_30
    s_mov_b32 s92, 0
Lgs_31:
    s_sleep 1
    s_mov_b64 exec, 1
    ds_read_b32 v9, v8 offset:1024
    s_mov_b64 exec, -1
    s_waitcnt lgkmcnt(0)
    v_readfirstlane_b32 s73, v9
    s_add_u32 s92, s92, 1
    s_cmp_lg_u32 s73, -1
    s_cbranch_scc1 Lg_30
    s_cmp_lt_u32 s92, 400000
    s_cbranch_scc1 Lgs_31
Lg_30:
    v_dot2_f32_bf16 v28, v96, v24, 0
    v_dot2_f32_bf16 v28, v97, v25, v28
    v_dot2_f32_bf16 v28, v98, v26, v28
    v_dot2_f32_bf16 v28, v99, v27, v28
    v_dot2_f32_bf16 v29, v100, v24, 0
    v_dot2_f32_bf16 v29, v101, v25, v29
    v_dot2_f32_bf16 v29, v102, v26, v29
    v_dot2_f32_bf16 v29, v103, v27, v29
    v_dot2_f32_bf16 v30, v104, v24, 0
    v_dot2_f32_bf16 v30, v105, v25, v30
    v_dot2_f32_bf16 v30, v106, v26, v30
    v_dot2_f32_bf16 v30, v107, v27, v30
    v_dot2_f32_bf16 v31, v108, v24, 0
    v_dot2_f32_bf16 v31, v109, v25, v31
    v_dot2_f32_bf16 v31, v110, v26, v31
    v_dot2_f32_bf16 v31, v111, v27, v31
    s_nop 2
    v_add_f32_dpp v28, v28, v28 row_ror:8 row_mask:0xf bank_mask:0xf
    v_add_f32_dpp v29, v29, v29 row_ror:8 row_mask:0xf bank_mask:0xf
    v_add_f32_dpp v30, v30, v30 row_ror:8 row_mask:0xf bank_mask:0xf
    v_add_f32_dpp v31, v31, v31 row_ror:8 row_mask:0xf bank_mask:0xf
    v_add_f32_dpp v28, v28, v28 row_ror:4 row_mask:0xf bank_mask:0xf
    v_add_f32_dpp v29, v29, v29 row_ror:4 row_mask:0xf bank_mask:0xf
    v_add_f32_dpp v30, v30, v30 row_ror:4 row_mask:0xf bank_mask:0xf
    v_add_f32_dpp v31, v31, v31 row_ror:4 row_mask:0xf bank_mask:0xf
    v_add_f32_dpp v28, v28, v28 row_ror:2 row_mask:0xf bank_mask:0xf
    v_add_f32_dpp v29, v29, v29 row_ror:2 row_mask:0xf bank_mask:0xf
    v_add_f32_dpp v30, v30, v30 row_ror:2 row_mask:0xf bank_mask:0xf
    v_add_f32_dpp v31, v31, v31 row_ror:2 row_mask:0xf bank_mask:0xf
    v_add_f32_dpp v28, v28, v28 row_ror:1 row_mask:0xf bank_mask:0xf
    v_add_f32_dpp v29, v29, v29 row_ror:1 row_mask:0xf bank_mask:0xf
    v_add_f32_dpp v30, v30, v30 row_ror:1 row_mask:0xf bank_mask:0xf
    v_add_f32_dpp v31, v31, v31 row_ror:1 row_mask:0xf bank_mask:0xf
    v_max3_f32 v38, v36, v28, v29
    v_max3_f32 v38, v38, v30, v31
    v_sub_f32 v39, v36, v38
    v_mul_f32 v39, s70, v39
    v_exp_f32 v39, v39
    v_mul_f32 v56, s70, v38
    v_mov_b32 v36, v38
    v_fma_f32 v48, v28, s70, -v56
    v_fma_f32 v49, v29, s70, -v56
    v_fma_f32 v50, v30, s70, -v56
    v_fma_f32 v51, v31, s70, -v56
    v_exp_f32 v48, v48
    v_exp_f32 v49, v49
    v_exp_f32 v50, v50
    v_exp_f32 v51, v51
    v_mul_f32 v37, v37, v39
    v_mul_f32 v16, v16, v39
    v_mul_f32 v17, v17, v39
    v_mul_f32 v18, v18, v39
    v_mul_f32 v19, v19, v39
    v_mul_f32 v20, v20, v39
    v_mul_f32 v21, v21, v39
    v_mul_f32 v22, v22, v39
    v_mul_f32 v23, v23, v39
    v_add_f32 v37, v37, v48
    v_add_f32 v37, v37, v49
    v_add_f32 v37, v37, v50
    v_add_f32 v37, v37, v51
    v_lshlrev_b32 v40, 16, v112
    v_and_b32 v41, 0xffff0000, v112
    v_lshlrev_b32 v42, 16, v113
    v_and_b32 v43, 0xffff0000, v113
    v_lshlrev_b32 v44, 16, v114
    v_and_b32 v45, 0xffff0000, v114
    v_lshlrev_b32 v46, 16, v115
    v_and_b32 v47, 0xffff0000, v115
    v_fmac_f32 v16, v40, v48
    v_fmac_f32 v17, v41, v48
    v_fmac_f32 v18, v42, v48
    v_fmac_f32 v19, v43, v48
    v_fmac_f32 v20, v44, v48
    v_fmac_f32 v21, v45, v48
    v_fmac_f32 v22, v46, v48
    v_fmac_f32 v23, v47, v48
    v_lshlrev_b32 v40, 16, v116
    v_and_b32 v41, 0xffff0000, v116
    v_lshlrev_b32 v42, 16, v117
    v_and_b32 v43, 0xffff0000, v117
    v_lshlrev_b32 v44, 16, v118
    v_and_b32 v45, 0xffff0000, v118
    v_lshlrev_b32 v46, 16, v119
    v_and_b32 v47, 0xffff0000, v119
    v_fmac_f32 v16, v40, v49
    v_fmac_f32 v17, v41, v49
    v_fmac_f32 v18, v42, v49
    v_fmac_f32 v19, v43, v49
    v_fmac_f32 v20, v44, v49
    v_fmac_f32 v21, v45, v49
    v_fmac_f32 v22, v46, v49
    v_fmac_f32 v23, v47, v49
    v_lshlrev_b32 v40, 16, v120
    v_and_b32 v41, 0xffff0000, v120
    v_lshlrev_b32 v42, 16, v121
    v_and_b32 v43, 0xffff0000, v121
    v_lshlrev_b32 v44, 16, v122
    v_and_b32 v45, 0xffff0000, v122
    v_lshlrev_b32 v46, 16, v123
    v_and_b32 v47, 0xffff0000, v123
    v_fmac_f32 v16, v40, v50
    v_fmac_f32 v17, v41, v50
    v_fmac_f32 v18, v42, v50
    v_fmac_f32 v19, v43, v50
    v_fmac_f32 v20, v44, v50
    v_fmac_f32 v21, v45, v50
    v_fmac_f32 v22, v46, v50
    v_fmac_f32 v23, v47, v50
    v_lshlrev_b32 v40, 16, v124
    v_and_b32 v41, 0xffff0000, v124
    v_lshlrev_b32 v42, 16, v125
    v_and_b32 v43, 0xffff0000, v125
    v_lshlrev_b32 v44, 16, v126
    v_and_b32 v45, 0xffff0000, v126
    v_lshlrev_b32 v46, 16, v127
    v_and_b32 v47, 0xffff0000, v127
    v_fmac_f32 v16, v40, v51
    v_fmac_f32 v17, v41, v51
    v_fmac_f32 v18, v42, v51
    v_fmac_f32 v19, v43, v51
    v_fmac_f32 v20, v44, v51
    v_fmac_f32 v21, v45, v51
    v_fmac_f32 v22, v46, v51
    v_fmac_f32 v23, v47, v51
    v_dot2_f32_bf16 v28, v128, v24, 0
    v_dot2_f32_bf16 v28, v129, v25, v28
    v_dot2_f32_bf16 v28, v130, v26, v28
    v_dot2_f32_bf16 v28, v131, v27, v28
    v_dot2_f32_bf16 v29, v132, v24, 0
    v_dot2_f32_bf16 v29, v133, v25, v29
    v_dot2_f32_bf16 v29, v134, v26, v29
    v_dot2_f32_bf16 v29, v135, v27, v29
    v_dot2_f32_bf16 v30, v136, v24, 0
    v_dot2_f32_bf16 v30, v137, v25, v30
    v_dot2_f32_bf16 v30, v138, v26, v30
    v_dot2_f32_bf16 v30, v139, v27, v30
    v_dot2_f32_bf16 v31, v140, v24, 0
    v_dot2_f32_bf16 v31, v141, v25, v31
    v_dot2_f32_bf16 v31, v142, v26, v31
    v_dot2_f32_bf16 v31, v143, v27, v31
    s_nop 2
    v_add_f32_dpp v28, v28, v28 row_ror:8 row_mask:0xf bank_mask:0xf
    v_add_f32_dpp v29, v29, v29 row_ror:8 row_mask:0xf bank_mask:0xf
    v_add_f32_dpp v30, v30, v30 row_ror:8 row_mask:0xf bank_mask:0xf
    v_add_f32_dpp v31, v31, v31 row_ror:8 row_mask:0xf bank_mask:0xf
    v_add_f32_dpp v28, v28, v28 row_ror:4 row_mask:0xf bank_mask:0xf
    v_add_f32_dpp v29, v29, v29 row_ror:4 row_mask:0xf bank_mask:0xf
    v_add_f32_dpp v30, v30, v30 row_ror:4 row_mask:0xf bank_mask:0xf
    v_add_f32_dpp v31, v31, v31 row_ror:4 row_mask:0xf bank_mask:0xf
    v_add_f32_dpp v28, v28, v28 row_ror:2 row_mask:0xf bank_mask:0xf
    v_add_f32_dpp v29, v29, v29 row_ror:2 row_mask:0xf bank_mask:0xf
    v_add_f32_dpp v30, v30, v30 row_ror:2 row_mask:0xf bank_mask:0xf
    v_add_f32_dpp v31, v31, v31 row_ror:2 row_mask:0xf bank_mask:0xf
    v_add_f32_dpp v28, v28, v28 row_ror:1 row_mask:0xf bank_mask:0xf
    v_add_f32_dpp v29, v29, v29 row_ror:1 row_mask:0xf bank_mask:0xf
    v_add_f32_dpp v30, v30, v30 row_ror:1 row_mask:0xf bank_mask:0xf
    v_add_f32_dpp v31, v31, v31 row_ror:1 row_mask:0xf bank_mask:0xf
    v_max3_f32 v38, v36, v28, v29
    v_max3_f32 v38, v38, v30, v31
    v_sub_f32 v39, v36, v38
    v_mul_f32 v39, s70, v39
    v_exp_f32 v39, v39
    v_mul_f32 v56, s70, v38
    v_mov_b32 v36, v38
    v_fma_f32 v48, v28, s70, -v56
    v_fma_f32 v49, v29, s70, -v56
    v_fma_f32 v50, v30, s70, -v56
    v_fma_f32 v51, v31, s70, -v56
    v_exp_f32 v48, v48
    v_exp_f32 v49, v49
    v_exp_f32 v50, v50
    v_exp_f32 v51, v51
    v_mul_f32 v37, v37, v39
    v_mul_f32 v16, v16, v39
    v_mul_f32 v17, v17, v39
    v_mul_f32 v18, v18, v39
    v_mul_f32 v19, v19, v39
    v_mul_f32 v20, v20, v39
    v_mul_f32 v21, v21, v39
    v_mul_f32 v22, v22, v39
    v_mul_f32 v23, v23, v39
    v_add_f32 v37, v37, v48
    v_add_f32 v37, v37, v49
    v_add_f32 v37, v37, v50
    v_add_f32 v37, v37, v51
    v_lshlrev_b32 v40, 16, v144
    v_and_b32 v41, 0xffff0000, v144
    v_lshlrev_b32 v42, 16, v145
    v_and_b32 v43, 0xffff0000, v145
    v_lshlrev_b32 v44, 16, v146
    v_and_b32 v45, 0xffff0000, v146
    v_lshlrev_b32 v46, 16, v147
    v_and_b32 v47, 0xffff0000, v147
    v_fmac_f32 v16, v40, v48
    v_fmac_f32 v17, v41, v48
    v_fmac_f32 v18, v42, v48
    v_fmac_f32 v19, v43, v48
    v_fmac_f32 v20, v44, v48
    v_fmac_f32 v21, v45, v48
    v_fmac_f32 v22, v46, v48
    v_fmac_f32 v23, v47, v48
    v_lshlrev_b32 v40, 16, v148
    v_and_b32 v41, 0xffff0000, v148
    v_lshlrev_b32 v42, 16, v149
    v_and_b32 v43, 0xffff0000, v149
    v_lshlrev_b32 v44, 16, v150
    v_and_b32 v45, 0xffff0000, v150
    v_lshlrev_b32 v46, 16, v151
    v_and_b32 v47, 0xffff0000, v151
    v_fmac_f32 v16, v40, v49
    v_fmac_f32 v17, v41, v49
    v_fmac_f32 v18, v42, v49
    v_fmac_f32 v19, v43, v49
    v_fmac_f32 v20, v44, v49
    v_fmac_f32 v21, v45, v49
    v_fmac_f32 v22, v46, v49
    v_fmac_f32 v23, v47, v49
    v_lshlrev_b32 v40, 16, v152
    v_and_b32 v41, 0xffff0000, v152
    v_lshlrev_b32 v42, 16, v153
    v_and_b32 v43, 0xffff0000, v153
    v_lshlrev_b32 v44, 16, v154
    v_and_b32 v45, 0xffff0000, v154
    v_lshlrev_b32 v46, 16, v155
    v_and_b32 v47, 0xffff0000, v155
    v_fmac_f32 v16, v40, v50
    v_fmac_f32 v17, v41, v50
    v_fmac_f32 v18, v42, v50
    v_fmac_f32 v19, v43, v50
    v_fmac_f32 v20, v44, v50
    v_fmac_f32 v21, v45, v50
    v_fmac_f32 v22, v46, v50
    v_fmac_f32 v23, v47, v50
    v_lshlrev_b32 v40, 16, v156
    v_and_b32 v41, 0xffff0000, v156
    v_lshlrev_b32 v42, 16, v157
    v_and_b32 v43, 0xffff0000, v157
    v_lshlrev_b32 v44, 16, v158
    v_and_b32 v45, 0xffff0000, v158
    v_lshlrev_b32 v46, 16, v159
    v_and_b32 v47, 0xffff0000, v159
    v_fmac_f32 v16, v40, v51
    v_fmac_f32 v17, v41, v51
    v_fmac_f32 v18, v42, v51
    v_fmac_f32 v19, v43, v51
    v_fmac_f32 v20, v44, v51
    v_fmac_f32 v21, v45, v51
    v_fmac_f32 v22, v46, v51
    v_fmac_f32 v23, v47, v51
    s_waitcnt vmcnt(8)
    v_dot2_f32_bf16 v28, v160, v24, 0
    v_dot2_f32_bf16 v28, v161, v25, v28
    v_dot2_f32_bf16 v28, v162, v26, v28
    v_dot2_f32_bf16 v28, v163, v27, v28
    v_dot2_f32_bf16 v29, v164, v24, 0
    v_dot2_f32_bf16 v29, v165, v25, v29
    v_dot2_f32_bf16 v29, v166, v26, v29
    v_dot2_f32_bf16 v29, v167, v27, v29
    v_dot2_f32_bf16 v30, v168, v24, 0
    v_dot2_f32_bf16 v30, v169, v25, v30
    v_dot2_f32_bf16 v30, v170, v26, v30
    v_dot2_f32_bf16 v30, v171, v27, v30
    v_dot2_f32_bf16 v31, v172, v24, 0
    v_dot2_f32_bf16 v31, v173, v25, v31
    v_dot2_f32_bf16 v31, v174, v26, v31
    v_dot2_f32_bf16 v31, v175, v27, v31
    s_nop 2
    v_add_f32_dpp v28, v28, v28 row_ror:8 row_mask:0xf bank_mask:0xf
    v_add_f32_dpp v29, v29, v29 row_ror:8 row_mask:0xf bank_mask:0xf
    v_add_f32_dpp v30, v30, v30 row_ror:8 row_mask:0xf bank_mask:0xf
    v_add_f32_dpp v31, v31, v31 row_ror:8 row_mask:0xf bank_mask:0xf
    v_add_f32_dpp v28, v28, v28 row_ror:4 row_mask:0xf bank_mask:0xf
    v_add_f32_dpp v29, v29, v29 row_ror:4 row_mask:0xf bank_mask:0xf
    v_add_f32_dpp v30, v30, v30 row_ror:4 row_mask:0xf bank_mask:0xf
    v_add_f32_dpp v31, v31, v31 row_ror:4 row_mask:0xf bank_mask:0xf
    v_add_f32_dpp v28, v28, v28 row_ror:2 row_mask:0xf bank_mask:0xf
    v_add_f32_dpp v29, v29, v29 row_ror:2 row_mask:0xf bank_mask:0xf
    v_add_f32_dpp v30, v30, v30 row_ror:2 row_mask:0xf bank_mask:0xf
    v_add_f32_dpp v31, v31, v31 row_ror:2 row_mask:0xf bank_mask:0xf
    v_add_f32_dpp v28, v28, v28 row_ror:1 row_mask:0xf bank_mask:0xf
    v_add_f32_dpp v29, v29, v29 row_ror:1 row_mask:0xf bank_mask:0xf
    v_add_f32_dpp v30, v30, v30 row_ror:1 row_mask:0xf bank_mask:0xf
    v_add_f32_dpp v31, v31, v31 row_ror:1 row_mask:0xf bank_mask:0xf
    v_max3_f32 v38, v36, v28, v29
    v_max3_f32 v38, v38, v30, v31
    v_sub_f32 v39, v36, v38
    v_mul_f32 v39, s70, v39
    v_exp_f32 v39, v39
    v_mul_f32 v56, s70, v38
    v_mov_b32 v36, v38
    v_fma_f32 v48, v28, s70, -v56
    v_fma_f32 v49, v29, s70, -v56
    v_fma_f32 v50, v30, s70, -v56
    v_fma_f32 v51, v31, s70, -v56
    v_exp_f32 v48, v48
    v_exp_f32 v49, v49
    v_exp_f32 v50, v50
    v_exp_f32 v51, v51
    v_mul_f32 v37, v37, v39
    v_mul_f32 v16, v16, v39
    v_mul_f32 v17, v17, v39
    v_mul_f32 v18, v18, v39
    v_mul_f32 v19, v19, v39
    v_mul_f32 v20, v20, v39
    v_mul_f32 v21, v21, v39
    v_mul_f32 v22, v22, v39
    v_mul_f32 v23, v23, v39
    v_add_f32 v37, v37, v48
    v_add_f32 v37, v37, v49
    v_add_f32 v37, v37, v50
    v_add_f32 v37, v37, v51
    v_lshlrev_b32 v40, 16, v176
    v_and_b32 v41, 0xffff0000, v176
    v_lshlrev_b32 v42, 16, v177
    v_and_b32 v43, 0xffff0000, v177
    v_lshlrev_b32 v44, 16, v178
    v_and_b32 v45, 0xffff0000, v178
    v_lshlrev_b32 v46, 16, v179
    v_and_b32 v47, 0xffff0000, v179
    v_fmac_f32 v16, v40, v48
    v_fmac_f32 v17, v41, v48
    v_fmac_f32 v18, v42, v48
    v_fmac_f32 v19, v43, v48
    v_fmac_f32 v20, v44, v48
    v_fmac_f32 v21, v45, v48
    v_fmac_f32 v22, v46, v48
    v_fmac_f32 v23, v47, v48
    v_lshlrev_b32 v40, 16, v180
    v_and_b32 v41, 0xffff0000, v180
    v_lshlrev_b32 v42, 16, v181
    v_and_b32 v43, 0xffff0000, v181
    v_lshlrev_b32 v44, 16, v182
    v_and_b32 v45, 0xffff0000, v182
    v_lshlrev_b32 v46, 16, v183
    v_and_b32 v47, 0xffff0000, v183
    v_fmac_f32 v16, v40, v49
    v_fmac_f32 v17, v41, v49
    v_fmac_f32 v18, v42, v49
    v_fmac_f32 v19, v43, v49
    v_fmac_f32 v20, v44, v49
    v_fmac_f32 v21, v45, v49
    v_fmac_f32 v22, v46, v49
    v_fmac_f32 v23, v47, v49
    v_lshlrev_b32 v40, 16, v184
    v_and_b32 v41, 0xffff0000, v184
    v_lshlrev_b32 v42, 16, v185
    v_and_b32 v43, 0xffff0000, v185
    v_lshlrev_b32 v44, 16, v186
    v_and_b32 v45, 0xffff0000, v186
    v_lshlrev_b32 v46, 16, v187
    v_and_b32 v47, 0xffff0000, v187
    v_fmac_f32 v16, v40, v50
    v_fmac_f32 v17, v41, v50
    v_fmac_f32 v18, v42, v50
    v_fmac_f32 v19, v43, v50
    v_fmac_f32 v20, v44, v50
    v_fmac_f32 v21, v45, v50
    v_fmac_f32 v22, v46, v50
    v_fmac_f32 v23, v47, v50
    v_lshlrev_b32 v40, 16, v188
    v_and_b32 v41, 0xffff0000, v188
    v_lshlrev_b32 v42, 16, v189
    v_and_b32 v43, 0xffff0000, v189
    v_lshlrev_b32 v44, 16, v190
    v_and_b32 v45, 0xffff0000, v190
    v_lshlrev_b32 v46, 16, v191
    v_and_b32 v47, 0xffff0000, v191
    v_fmac_f32 v16, v40, v51
    v_fmac_f32 v17, v41, v51
    v_fmac_f32 v18, v42, v51
    v_fmac_f32 v19, v43, v51
    v_fmac_f32 v20, v44, v51
    v_fmac_f32 v21, v45, v51
    v_fmac_f32 v22, v46, v51
    v_fmac_f32 v23, v47, v51
LBloop_21:
    s_cmp_ge_u32 s73, 67108864
    s_cbranch_scc1 LBtail0_25
    s_cmp_ge_u32 s84, 42
    s_cbranch_scc1 LBloop2_23
    s_cmp_ge_u32 s71, s76
    s_cbranch_scc1 Lsw_32
Lswb_33:
    s_mov_b32 s100, s73
    s_mov_b32 s71, s73
    s_waitcnt vmcnt(7)
    v_dot2_f32_bf16 v28, v64, v24, 0
    v_dot2_f32_bf16 v28, v65, v25, v28
    v_dot2_f32_bf16 v28, v66, v26, v28
    v_dot2_f32_bf16 v28, v67, v27, v28
    s_waitcnt vmcnt(3)
    buffer_load_dwordx4 v[64:67], v4, s[44:47], s100 offen offset:0 nt
    s_waitcnt vmcnt(7)
    v_dot2_f32_bf16 v29, v68, v24, 0
    v_dot2_f32_bf16 v29, v69, v25, v29
    v_dot2_f32_bf16 v29, v70, v26, v29
    v_dot2_f32_bf16 v29, v71, v27, v29
    s_waitcnt vmcnt(3)
    buffer_load_dwordx4 v[68:71], v4, s[44:47], s100 offen offset:1024 nt
    s_waitcnt vmcnt(7)
    v_dot2_f32_bf16 v30, v72, v24, 0
    v_dot2_f32_bf16 v30, v73, v25, v30
    v_dot2_f32_bf16 v30, v74, v26, v30
    v_dot2_f32_bf16 v30, v75, v27, v30
    s_waitcnt vmcnt(3)
    buffer_load_dwordx4 v[72:75], v4, s[44:47], s100 offen offset:2048 nt
    s_waitcnt vmcnt(7)
    v_dot2_f32_bf16 v31, v76, v24, 0
    v_dot2_f32_bf16 v31, v77, v25, v31
    v_dot2_f32_bf16 v31, v78, v26, v31
    v_dot2_f32_bf16 v31, v79, v27, v31
    s_waitcnt vmcnt(3)
    buffer_load_dwordx4 v[76:79], v4, s[44:47], s100 offen offset:3072 nt
    s_nop 2
    v_add_f32_dpp v28, v28, v28 row_ror:8 row_mask:0xf bank_mask:0xf
    v_add_f32_dpp v29, v29, v29 row_ror:8 row_mask:0xf bank_mask:0xf
    v_add_f32_dpp v30, v30, v30 row_ror:8 row_mask:0xf bank_mask:0xf
    v_add_f32_dpp v31, v31, v31 row_ror:8 row_mask:0xf bank_mask:0xf
    v_add_f32_dpp v28, v28, v28 row_ror:4 row_mask:0xf bank_mask:0xf
    v_add_f32_dpp v29, v29, v29 row_ror:4 row_mask:0xf bank_mask:0xf
    v_add_f32_dpp v30, v30, v30 row_ror:4 row_mask:0xf bank_mask:0xf
    v_add_f32_dpp v31, v31, v31 row_ror:4 row_mask:0xf bank_mask:0xf
    v_add_f32_dpp v28, v28, v28 row_ror:2 row_mask:0xf bank_mask:0xf
    v_add_f32_dpp v29, v29, v29 row_ror:2 row_mask:0xf bank_mask:0xf
    v_add_f32_dpp v30, v30, v30 row_ror:2 row_mask:0xf bank_mask:0xf
    v_add_f32_dpp v31, v31, v31 row_ror:2 row_mask:0xf bank_mask:0xf
    v_add_f32_dpp v28, v28, v28 row_ror:1 row_mask:0xf bank_mask:0xf
    v_add_f32_dpp v29, v29, v29 row_ror:1 row_mask:0xf bank_mask:0xf
    v_add_f32_dpp v30, v30, v30 row_ror:1 row_mask:0xf bank_mask:0xf
    v_add_f32_dpp v31, v31, v31 row_ror:1 row_mask:0xf bank_mask:0xf
    v_max3_f32 v38, v36, v28, v29
    v_max3_f32 v38, v38, v30, v31
    v_sub_f32 v39, v36, v38
    v_mul_f32 v39, s70, v39
    v_exp_f32 v39, v39
    v_mul_f32 v56, s70, v38
    v_mov_b32 v36, v38
    v_fma_f32 v48, v28, s70, -v56
    v_fma_f32 v49, v29, s70, -v56
    v_fma_f32 v50, v30, s70, -v56
    v_fma_f32 v51, v31, s70, -v56
    v_exp_f32 v48, v48
    v_exp_f32 v49, v49
    v_exp_f32 v50, v50
    v_exp_f32 v51, v51
    v_mul_f32 v37, v37, v39
    v_mul_f32 v16, v16, v39
    v_mul_f32 v17, v17, v39
    v_mul_f32 v18, v18, v39
    v_mul_f32 v19, v19, v39
    v_mul_f32 v20, v20, v39
    v_mul_f32 v21, v21, v39
    v_mul_f32 v22, v22, v39
    v_mul_f32 v23, v23, v39
    v_add_f32 v37, v37, v48
    v_add_f32 v37, v37, v49
    v_add_f32 v37, v37, v50
    v_add_f32 v37, v37, v51
    s_waitcnt vmcnt(7)
    v_lshlrev_b32 v40, 16, v80
    v_and_b32 v41, 0xffff0000, v80
    v_lshlrev_b32 v42, 16, v81
    v_and_b32 v43, 0xffff0000, v81
    v_lshlrev_b32 v44, 16, v82
    v_and_b32 v45, 0xffff0000, v82
    v_lshlrev_b32 v46, 16, v83
    v_and_b32 v47, 0xffff0000, v83
    s_waitcnt vmcnt(3)
    buffer_load_dwordx4 v[80:83], v4, s[48:51], s100 offen offset:0 nt
    v_fmac_f32 v16, v40, v48
    v_fmac_f32 v17, v41, v48
    v_fmac_f32 v18, v42, v48
    v_fmac_f32 v19, v43, v48
    v_fmac_f32 v20, v44, v48
    v_fmac_f32 v21, v45, v48
    v_fmac_f32 v22, v46, v48
    v_fmac_f32 v23, v47, v48
    s_waitcnt vmcnt(7)
    v_lshlrev_b32 v40, 16, v84
    v_and_b32 v41, 0xffff0000, v84
    v_lshlrev_b32 v42, 16, v85
    v_and_b32 v43, 0xffff0000, v85
    v_lshlrev_b32 v44, 16, v86
    v_and_b32 v45, 0xffff0000, v86
    v_lshlrev_b32 v46, 16, v87
    v_and_b32 v47, 0xffff0000, v87
    s_waitcnt vmcnt(3)
    buffer_load_dwordx4 v[84:87], v4, s[48:51], s100 offen offset:1024 nt
    s_mov_b64 exec, 1
    v_mov_b32 v8, 1
    ds_add_rtn_u32 v8, v10, v8
    s_mov_b64 exec, -1
    v_fmac_f32 v16, v40, v49
    v_fmac_f32 v17, v41, v49
    v_fmac_f32 v18, v42, v49
    v_fmac_f32 v19, v43, v49
    v_fmac_f32 v20, v44, v49
    v_fmac_f32 v21, v45, v49
    v_fmac_f32 v22, v46, v49
    v_fmac_f32 v23, v47, v49
    s_waitcnt vmcnt(7)
    v_lshlrev_b32 v40, 16, v88
    v_and_b32 v41, 0xffff0000, v88
    v_lshlrev_b32 v42, 16, v89
    v_and_b32 v43, 0xffff0000, v89
    v_lshlrev_b32 v44, 16, v90
    v_and_b32 v45, 0xffff0000, v90
    v_lshlrev_b32 v46, 16, v91
    v_and_b32 v47, 0xffff0000, v91
    s_waitcnt vmcnt(3)
    buffer_load_dwordx4 v[88:91], v4, s[48:51], s100 offen offset:2048 nt
    s_waitcnt lgkmcnt(0)
    v_readfirstlane_b32 s84, v8
    s_mov_b64 exec, 1
    v_lshlrev_b32 v8, 2, v8
    ds_read_b32 v9, v8 offset:1024
    s_mov_b64 exec, -1
    v_fmac_f32 v16, v40, v50
    v_fmac_f32 v17, v41, v50
    v_fmac_f32 v18, v42, v50
    v_fmac_f32 v19, v43, v50
    v_fmac_f32 v20, v44, v50
    v_fmac_f32 v21, v45, v50
    v_fmac_f32 v22, v46, v50
    v_fmac_f32 v23, v47, v50
    s_waitcnt vmcnt(7)
    v_lshlrev_b32 v40, 16, v92
    v_and_b32 v41, 0xffff0000, v92
    v_lshlrev_b32 v42, 16, v93
    v_and_b32 v43, 0xffff0000, v93
    v_lshlrev_b32 v44, 16, v94
    v_and_b32 v45, 0xffff0000, v94
    v_lshlrev_b32 v46, 16, v95
    v_and_b32 v47, 0xffff0000, v95
    s_waitcnt vmcnt(3)
    buffer_load_dwordx4 v[92:95], v4, s[48:51], s100 offen offset:3072 nt
    v_fmac_f32 v16, v40, v51
    v_fmac_f32 v17, v41, v51
    v_fmac_f32 v18, v42, v51
    v_fmac_f32 v19, v43, v51
    v_fmac_f32 v20, v44, v51
    v_fmac_f32 v21, v45, v51
    v_fmac_f32 v22, v46, v51
    v_fmac_f32 v23, v47, v51
    s_waitcnt lgkmcnt(0)
    v_readfirstlane_b32 s73, v9
    s_nop 0
    s_cmp_lg_u32 s73, -1
    s_cbranch_scc1 Lg_34
    s_mov_b32 s92, 0
Lgs_35:
    s_sleep 1
    s_mov_b64 exec, 1
    ds_read_b32 v9, v8 offset:1024
    s_mov_b64 exec, -1
    s_waitcnt lgkmcnt(0)
    v_readfirstlane_b32 s73, v9
    s_add_u32 s92, s92, 1
    s_cmp_lg_u32 s73, -1
    s_cbranch_scc1 Lg_34
    s_cmp_lt_u32 s92, 400000
    s_cbranch_scc1 Lgs_35
Lg_34:
    s_branch LBloop_21
LBloop2_23:
    s_cmp_ge_u32 s73, 67108864
    s_cbranch_scc1 LBtail0_25
    s_cmp_ge_u32 s71, s76
    s_cbranch_scc1 Lsw_36
Lswb_37:
    s_mov_b32 s100, s73
    s_mov_b32 s71, s73
    s_waitcnt vmcnt(7)
    v_dot2_f32_bf16 v28, v64, v24, 0
    v_dot2_f32_bf16 v28, v65, v25, v28
    v_dot2_f32_bf16 v28, v66, v26, v28
    v_dot2_f32_bf16 v28, v67, v27, v28
    buffer_load_dwordx4 v[64:67], v4, s[44:47], s100 offen offset:0 nt
    s_waitcnt vmcnt(7)
    v_dot2_f32_bf16 v29, v68, v24, 0
    v_dot2_f32_bf16 v29, v69, v25, v29
    v_dot2_f32_bf16 v29, v70, v26, v29
    v_dot2_f32_bf16 v29, v71, v27, v29
    buffer_load_dwordx4 v[68:71], v4, s[44:47], s100 offen offset:1024 nt
    s_waitcnt vmcnt(7)
    v_dot2_f32_bf16 v30, v72, v24, 0
    v_dot2_f32_bf16 v30, v73, v25, v30
    v_dot2_f32_bf16 v30, v74, v26, v30
    v_dot2_f32_bf16 v30, v75, v27, v30
    buffer_load_dwordx4 v[72:75], v4, s[44:47], s100 offen offset:2048 nt
    s_waitcnt vmcnt(7)
    v_dot2_f32_bf16 v31, v76, v24, 0
    v_dot2_f32_bf16 v31, v77, v25, v31
    v_dot2_f32_bf16 v31, v78, v26, v31
    v_dot2_f32_bf16 v31, v79, v27, v31
    buffer_load_dwordx4 v[76:79], v4, s[44:47], s100 offen offset:3072 nt
    s_nop 2
    v_add_f32_dpp v28, v28, v28 row_ror:8 row_mask:0xf bank_mask:0xf
    v_add_f32_dpp v29, v29, v29 row_ror:8 row_mask:0xf bank_mask:0xf
    v_add_f32_dpp v30, v30, v30 row_ror:8 row_mask:0xf bank_mask:0xf
    v_add_f32_dpp v31, v31, v31 row_ror:8 row_mask:0xf bank_mask:0xf
    v_add_f32_dpp v28, v28, v28 row_ror:4 row_mask:0xf bank_mask:0xf
    v_add_f32_dpp v29, v29, v29 row_ror:4 row_mask:0xf bank_mask:0xf
    v_add_f32_dpp v30, v30, v30 row_ror:4 row_mask:0xf bank_mask:0xf
    v_add_f32_dpp v31, v31, v31 row_ror:4 row_mask:0xf bank_mask:0xf
    v_add_f32_dpp v28, v28, v28 row_ror:2 row_mask:0xf bank_mask:0xf
    v_add_f32_dpp v29, v29, v29 row_ror:2 row_mask:0xf bank_mask:0xf
    v_add_f32_dpp v30, v30, v30 row_ror:2 row_mask:0xf bank_mask:0xf
    v_add_f32_dpp v31, v31, v31 row_ror:2 row_mask:0xf bank_mask:0xf
    v_add_f32_dpp v28, v28, v28 row_ror:1 row_mask:0xf bank_mask:0xf
    v_add_f32_dpp v29, v29, v29 row_ror:1 row_mask:0xf bank_mask:0xf
    v_add_f32_dpp v30, v30, v30 row_ror:1 row_mask:0xf bank_mask:0xf
    v_add_f32_dpp v31, v31, v31 row_ror:1 row_mask:0xf bank_mask:0xf
    v_max3_f32 v38, v36, v28, v29
    v_max3_f32 v38, v38, v30, v31
    v_sub_f32 v39, v36, v38
    v_mul_f32 v39, s70, v39
    v_exp_f32 v39, v39
    v_mul_f32 v56, s70, v38
    v_mov_b32 v36, v38
    v_fma_f32 v48, v28, s70, -v56
    v_fma_f32 v49, v29, s70, -v56
    v_fma_f32 v50, v30, s70, -v56
    v_fma_f32 v51, v31, s70, -v56
    v_exp_f32 v48, v48
    v_exp_f32 v49, v49
    v_exp_f32 v50, v50
    v_exp_f32 v51, v51
    v_mul_f32 v37, v37, v39
    v_mul_f32 v16, v16, v39
    v_mul_f32 v17, v17, v39
    v_mul_f32 v18, v18, v39
    v_mul_f32 v19, v19, v39
    v_mul_f32 v20, v20, v39
    v_mul_f32 v21, v21, v39
    v_mul_f32 v22, v22, v39
    v_mul_f32 v23, v23, v39
    v_add_f32 v37, v37, v48
    v_add_f32 v37, v37, v49
    v_add_f32 v37, v37, v50
    v_add_f32 v37, v37, v51
    s_waitcnt vmcnt(7)
    v_lshlrev_b32 v40, 16, v80
    v_and_b32 v41, 0xffff0000, v80
    v_lshlrev_b32 v42, 16, v81
    v_and_b32 v43, 0xffff0000, v81
    v_lshlrev_b32 v44, 16, v82
    v_and_b32 v45, 0xffff0000, v82
    v_lshlrev_b32 v46, 16, v83
    v_and_b32 v47, 0xffff0000, v83
    buffer_load_dwordx4 v[80:83], v4, s[48:51], s100 offen offset:0 nt
    v_fmac_f32 v16, v40, v48
    v_fmac_f32 v17, v41, v48
    v_fmac_f32 v18, v42, v48
    v_fmac_f32 v19, v43, v48
    v_fmac_f32 v20, v44, v48
    v_fmac_f32 v21, v45, v48
    v_fmac_f32 v22, v46, v48
    v_fmac_f32 v23, v47, v48
    s_waitcnt vmcnt(7)
    v_lshlrev_b32 v40, 16, v84
    v_and_b32 v41, 0xffff0000, v84
    v_lshlrev_b32 v42, 16, v85
    v_and_b32 v43, 0xffff0000, v85
    v_lshlrev_b32 v44, 16, v86
    v_and_b32 v45, 0xffff0000, v86
    v_lshlrev_b32 v46, 16, v87
    v_and_b32 v47, 0xffff0000, v87
    buffer_load_dwordx4 v[84:87], v4, s[48:51], s100 offen offset:1024 nt
    s_mov_b64 exec, 1
    v_mov_b32 v8, 1
    ds_add_rtn_u32 v8, v10, v8
    s_mov_b64 exec, -1
    v_fmac_f32 v16, v40, v49
    v_fmac_f32 v17, v41, v49
    v_fmac_f32 v18, v42, v49
    v_fmac_f32 v19, v43, v49
    v_fmac_f32 v20, v44, v49
    v_fmac_f32 v21, v45, v49
    v_fmac_f32 v22, v46, v49
    v_fmac_f32 v23, v47, v49
    s_waitcnt vmcnt(7)
    v_lshlrev_b32 v40, 16, v88
    v_and_b32 v41, 0xffff0000, v88
    v_lshlrev_b32 v42, 16, v89
    v_and_b32 v43, 0xffff0000, v89
    v_lshlrev_b32 v44, 16, v90
    v_and_b32 v45, 0xffff0000, v90
    v_lshlrev_b32 v46, 16, v91
    v_and_b32 v47, 0xffff0000, v91
    buffer_load_dwordx4 v[88:91], v4, s[48:51], s100 offen offset:2048 nt
    s_waitcnt lgkmcnt(0)
    v_readfirstlane_b32 s84, v8
    s_mov_b64 exec, 1
    v_lshlrev_b32 v8, 2, v8
    ds_read_b32 v9, v8 offset:1024
    s_mov_b64 exec, -1
    v_fmac_f32 v16, v40, v50
    v_fmac_f32 v17, v41, v50
    v_fmac_f32 v18, v42, v50
    v_fmac_f32 v19, v43, v50
    v_fmac_f32 v20, v44, v50
    v_fmac_f32 v21, v45, v50
    v_fmac_f32 v22, v46, v50
    v_fmac_f32 v23, v47, v50
    s_waitcnt vmcnt(7)
    v_lshlrev_b32 v40, 16, v92
    v_and_b32 v41, 0xffff0000, v92
    v_lshlrev_b32 v42, 16, v93
    v_and_b32 v43, 0xffff0000, v93
    v_lshlrev_b32 v44, 16, v94
    v_and_b32 v45, 0xffff0000, v94
    v_lshlrev_b32 v46, 16, v95
    v_and_b32 v47, 0xffff0000, v95
    buffer_load_dwordx4 v[92:95], v4, s[48:51], s100 offen offset:3072 nt
    v_fmac_f32 v16, v40, v51
    v_fmac_f32 v17, v41, v51
    v_fmac_f32 v18, v42, v51
    v_fmac_f32 v19, v43, v51
    v_fmac_f32 v20, v44, v51
    v_fmac_f32 v21, v45, v51
    v_fmac_f32 v22, v46, v51
    v_fmac_f32 v23, v47, v51
    s_waitcnt lgkmcnt(0)
    v_readfirstlane_b32 s73, v9
    s_nop 0
    s_cmp_lg_u32 s73, -1
    s_cbranch_scc1 Lg_38
    s_mov_b32 s92, 0
Lgs_39:
    s_sleep 1
    s_mov_b64 exec, 1
    ds_read_b32 v9, v8 offset:1024
    s_mov_b64 exec, -1
    s_waitcnt lgkmcnt(0)
    v_readfirstlane_b32 s73, v9
    s_add_u32 s92, s92, 1
    s_cmp_lg_u32 s73, -1
    s_cbranch_scc1 Lg_38
    s_cmp_lt_u32 s92, 400000
    s_cbranch_scc1 Lgs_39
Lg_38:
    s_branch LBloop2_23
LBtail0_25:
    s_cmp_ge_u32 s71, s76
    s_cbranch_scc1 Lsw_40
Lswb_41:
    s_waitcnt vmcnt(7)
    v_dot2_f32_bf16 v28, v64, v24, 0
    v_dot2_f32_bf16 v28, v65, v25, v28
    v_dot2_f32_bf16 v28, v66, v26, v28
    v_dot2_f32_bf16 v28, v67, v27, v28
    s_waitcnt vmcnt(6)
    v_dot2_f32_bf16 v29, v68, v24, 0
    v_dot2_f32_bf16 v29, v69, v25, v29
    v_dot2_f32_bf16 v29, v70, v26, v29
    v_dot2_f32_bf16 v29, v71, v27, v29
    s_waitcnt vmcnt(5)
    v_dot2_f32_bf16 v30, v72, v24, 0
    v_dot2_f32_bf16 v30, v73, v25, v30
    v_dot2_f32_bf16 v30, v74, v26, v30
    v_dot2_f32_bf16 v30, v75, v27, v30
    s_waitcnt vmcnt(4)
    v_dot2_f32_bf16 v31, v76, v24, 0
    v_dot2_f32_bf16 v31, v77, v25, v31
    v_dot2_f32_bf16 v31, v78, v26, v31
    v_dot2_f32_bf16 v31, v79, v27, v31
    s_nop 2
    v_add_f32_dpp v28, v28, v28 row_ror:8 row_mask:0xf bank_mask:0xf
    v_add_f32_dpp v29, v29, v29 row_ror:8 row_mask:0xf bank_mask:0xf
    v_add_f32_dpp v30, v30, v30 row_ror:8 row_mask:0xf bank_mask:0xf
    v_add_f32_dpp v31, v31, v31 row_ror:8 row_mask:0xf bank_mask:0xf
    v_add_f32_dpp v28, v28, v28 row_ror:4 row_mask:0xf bank_mask:0xf
    v_add_f32_dpp v29, v29, v29 row_ror:4 row_mask:0xf bank_mask:0xf
    v_add_f32_dpp v30, v30, v30 row_ror:4 row_mask:0xf bank_mask:0xf
    v_add_f32_dpp v31, v31, v31 row_ror:4 row_mask:0xf bank_mask:0xf
    v_add_f32_dpp v28, v28, v28 row_ror:2 row_mask:0xf bank_mask:0xf
    v_add_f32_dpp v29, v29, v29 row_ror:2 row_mask:0xf bank_mask:0xf
    v_add_f32_dpp v30, v30, v30 row_ror:2 row_mask:0xf bank_mask:0xf
    v_add_f32_dpp v31, v31, v31 row_ror:2 row_mask:0xf bank_mask:0xf
    v_add_f32_dpp v28, v28, v28 row_ror:1 row_mask:0xf bank_mask:0xf
    v_add_f32_dpp v29, v29, v29 row_ror:1 row_mask:0xf bank_mask:0xf
    v_add_f32_dpp v30, v30, v30 row_ror:1 row_mask:0xf bank_mask:0xf
    v_add_f32_dpp v31, v31, v31 row_ror:1 row_mask:0xf bank_mask:0xf
    v_max3_f32 v38, v36, v28, v29
    v_max3_f32 v38, v38, v30, v31
    v_sub_f32 v39, v36, v38
    v_mul_f32 v39, s70, v39
    v_exp_f32 v39, v39
    v_mul_f32 v56, s70, v38
    v_mov_b32 v36, v38
    v_fma_f32 v48, v28, s70, -v56
    v_fma_f32 v49, v29, s70, -v56
    v_fma_f32 v50, v30, s70, -v56
    v_fma_f32 v51, v31, s70, -v56
    v_exp_f32 v48, v48
    v_exp_f32 v49, v49
    v_exp_f32 v50, v50
    v_exp_f32 v51, v51
    v_mul_f32 v37, v37, v39
    v_mul_f32 v16, v16, v39
    v_mul_f32 v17, v17, v39
    v_mul_f32 v18, v18, v39
    v_mul_f32 v19, v19, v39
    v_mul_f32 v20, v20, v39
    v_mul_f32 v21, v21, v39
    v_mul_f32 v22, v22, v39
    v_mul_f32 v23, v23, v39
    v_add_f32 v37, v37, v48
    v_add_f32 v37, v37, v49
    v_add_f32 v37, v37, v50
    v_add_f32 v37, v37, v51
    s_waitcnt vmcnt(3)
    v_lshlrev_b32 v40, 16, v80
    v_and_b32 v41, 0xffff0000, v80
    v_lshlrev_b32 v42, 16, v81
    v_and_b32 v43, 0xffff0000, v81
    v_lshlrev_b32 v44, 16, v82
    v_and_b32 v45, 0xffff0000, v82
    v_lshlrev_b32 v46, 16, v83
    v_and_b32 v47, 0xffff0000, v83
    v_fmac_f32 v16, v40, v48
    v_fmac_f32 v17, v41, v48
    v_fmac_f32 v18, v42, v48
    v_fmac_f32 v19, v43, v48
    v_fmac_f32 v20, v44, v48
    v_fmac_f32 v21, v45, v48
    v_fmac_f32 v22, v46, v48
    v_fmac_f32 v23, v47, v48
    s_waitcnt vmcnt(2)
    v_lshlrev_b32 v40, 16, v84
    v_and_b32 v41, 0xffff0000, v84
    v_lshlrev_b32 v42, 16, v85
    v_and_b32 v43, 0xffff0000, v85
    v_lshlrev_b32 v44, 16, v86
    v_and_b32 v45, 0xffff0000, v86
    v_lshlrev_b32 v46, 16, v87
    v_and_b32 v47, 0xffff0000, v87
    v_fmac_f32 v16, v40, v49
    v_fmac_f32 v17, v41, v49
    v_fmac_f32 v18, v42, v49
    v_fmac_f32 v19, v43, v49
    v_fmac_f32 v20, v44, v49
    v_fmac_f32 v21, v45, v49
    v_fmac_f32 v22, v46, v49
    v_fmac_f32 v23, v47, v49
    s_waitcnt vmcnt(1)
    v_lshlrev_b32 v40, 16, v88
    v_and_b32 v41, 0xffff0000, v88
    v_lshlrev_b32 v42, 16, v89
    v_and_b32 v43, 0xffff0000, v89
    v_lshlrev_b32 v44, 16, v90
    v_and_b32 v45, 0xffff0000, v90
    v_lshlrev_b32 v46, 16, v91
    v_and_b32 v47, 0xffff0000, v91
    v_fmac_f32 v16, v40, v50
    v_fmac_f32 v17, v41, v50
    v_fmac_f32 v18, v42, v50
    v_fmac_f32 v19, v43, v50
    v_fmac_f32 v20, v44, v50
    v_fmac_f32 v21, v45, v50
    v_fmac_f32 v22, v46, v50
    v_fmac_f32 v23, v47, v50
    s_waitcnt vmcnt(0)
    v_lshlrev_b32 v40, 16, v92
    v_and_b32 v41, 0xffff0000, v92
    v_lshlrev_b32 v42, 16, v93
    v_and_b32 v43, 0xffff0000, v93
    v_lshlrev_b32 v44, 16, v94
    v_and_b32 v45, 0xffff0000, v94
    v_lshlrev_b32 v46, 16, v95
    v_and_b32 v47, 0xffff0000, v95
    v_fmac_f32 v16, v40, v51
    v_fmac_f32 v17, v41, v51
    v_fmac_f32 v18, v42, v51
    v_fmac_f32 v19, v43, v51
    v_fmac_f32 v20, v44, v51
    v_fmac_f32 v21, v45, v51
    v_fmac_f32 v22, v46, v51
    v_fmac_f32 v23, v47, v51
    s_branch LBfin_27
LBf0_28:
    s_waitcnt vmcnt(0)
    v_dot2_f32_bf16 v28, v64, v24, 0
    v_dot2_f32_bf16 v28, v65, v25, v28
    v_dot2_f32_bf16 v28, v66, v26, v28
    v_dot2_f32_bf16 v28, v67, v27, v28
    v_dot2_f32_bf16 v29, v68, v24, 0
    v_dot2_f32_bf16 v29, v69, v25, v29
    v_dot2_f32_bf16 v29, v70, v26, v29
    v_dot2_f32_bf16 v29, v71, v27, v29
    v_dot2_f32_bf16 v30, v72, v24, 0
    v_dot2_f32_bf16 v30, v73, v25, v30
    v_dot2_f32_bf16 v30, v74, v26, v30
    v_dot2_f32_bf16 v30, v75, v27, v30
    v_dot2_f32_bf16 v31, v76, v24, 0
    v_dot2_f32_bf16 v31, v77, v25, v31
    v_dot2_f32_bf16 v31, v78, v26, v31
    v_dot2_f32_bf16 v31, v79, v27, v31
    s_nop 2
    v_add_f32_dpp v28, v28, v28 row_ror:8 row_mask:0xf bank_mask:0xf
    v_add_f32_dpp v29, v29, v29 row_ror:8 row_mask:0xf bank_mask:0xf
    v_add_f32_dpp v30, v30, v30 row_ror:8 row_mask:0xf bank_mask:0xf
    v_add_f32_dpp v31, v31, v31 row_ror:8 row_mask:0xf bank_mask:0xf
    v_add_f32_dpp v28, v28, v28 row_ror:4 row_mask:0xf bank_mask:0xf
    v_add_f32_dpp v29, v29, v29 row_ror:4 row_mask:0xf bank_mask:0xf
    v_add_f32_dpp v30, v30, v30 row_ror:4 row_mask:0xf bank_mask:0xf
    v_add_f32_dpp v31, v31, v31 row_ror:4 row_mask:0xf bank_mask:0xf
    v_add_f32_dpp v28, v28, v28 row_ror:2 row_mask:0xf bank_mask:0xf
    v_add_f32_dpp v29, v29, v29 row_ror:2 row_mask:0xf bank_mask:0xf
    v_add_f32_dpp v30, v30, v30 row_ror:2 row_mask:0xf bank_mask:0xf
    v_add_f32_dpp v31, v31, v31 row_ror:2 row_mask:0xf bank_mask:0xf
    v_add_f32_dpp v28, v28, v28 row_ror:1 row_mask:0xf bank_mask:0xf
    v_add_f32_dpp v29, v29, v29 row_ror:1 row_mask:0xf bank_mask:0xf
    v_add_f32_dpp v30, v30, v30 row_ror:1 row_mask:0xf bank_mask:0xf
    v_add_f32_dpp v31, v31, v31 row_ror:1 row_mask:0xf bank_mask:0xf
    v_max3_f32 v38, v36, v28, v29
    v_max3_f32 v38, v38, v30, v31
    v_sub_f32 v39, v36, v38
    v_mul_f32 v39, s70, v39
    v_exp_f32 v39, v39
    v_mul_f32 v56, s70, v38
    v_mov_b32 v36, v38
    v_fma_f32 v48, v28, s70, -v56
    v_fma_f32 v49, v29, s70, -v56
    v_fma_f32 v50, v30, s70, -v56
    v_fma_f32 v51, v31, s70, -v56
    v_exp_f32 v48, v48
    v_exp_f32 v49, v49
    v_exp_f32 v50, v50
    v_exp_f32 v51, v51
    v_mul_f32 v37, v37, v39
    v_mul_f32 v16, v16, v39
    v_mul_f32 v17, v17, v39
    v_mul_f32 v18, v18, v39
    v_mul_f32 v19, v19, v39
    v_mul_f32 v20, v20, v39
    v_mul_f32 v21, v21, v39
    v_mul_f32 v22, v22, v39
    v_mul_f32 v23, v23, v39
    v_add_f32 v37, v37, v48
    v_add_f32 v37, v37, v49
    v_add_f32 v37, v37, v50
    v_add_f32 v37, v37, v51
    v_lshlrev_b32 v40, 16, v80
    v_and_b32 v41, 0xffff0000, v80
    v_lshlrev_b32 v42, 16, v81
    v_and_b32 v43, 0xffff0000, v81
    v_lshlrev_b32 v44, 16, v82
    v_and_b32 v45, 0xffff0000, v82
    v_lshlrev_b32 v46, 16, v83
    v_and_b32 v47, 0xffff0000, v83
    v_fmac_f32 v16, v40, v48
    v_fmac_f32 v17, v41, v48
    v_fmac_f32 v18, v42, v48
    v_fmac_f32 v19, v43, v48
    v_fmac_f32 v20, v44, v48
    v_fmac_f32 v21, v45, v48
    v_fmac_f32 v22, v46, v48
    v_fmac_f32 v23, v47, v48
    v_lshlrev_b32 v40, 16, v84
    v_and_b32 v41, 0xffff0000, v84
    v_lshlrev_b32 v42, 16, v85
    v_and_b32 v43, 0xffff0000, v85
    v_lshlrev_b32 v44, 16, v86
    v_and_b32 v45, 0xffff0000, v86
    v_lshlrev_b32 v46, 16, v87
    v_and_b32 v47, 0xffff0000, v87
    v_fmac_f32 v16, v40, v49
    v_fmac_f32 v17, v41, v49
    v_fmac_f32 v18, v42, v49
    v_fmac_f32 v19, v43, v49
    v_fmac_f32 v20, v44, v49
    v_fmac_f32 v21, v45, v49
    v_fmac_f32 v22, v46, v49
    v_fmac_f32 v23, v47, v49
    v_lshlrev_b32 v40, 16, v88
    v_and_b32 v41, 0xffff0000, v88
    v_lshlrev_b32 v42, 16, v89
    v_and_b32 v43, 0xffff0000, v89
    v_lshlrev_b32 v44, 16, v90
    v_and_b32 v45, 0xffff0000, v90
    v_lshlrev_b32 v46, 16, v91
    v_and_b32 v47, 0xffff0000, v91
    v_fmac_f32 v16, v40, v50
    v_fmac_f32 v17, v41, v50
    v_fmac_f32 v18, v42, v50
    v_fmac_f32 v19, v43, v50
    v_fmac_f32 v20, v44, v50
    v_fmac_f32 v21, v45, v50
    v_fmac_f32 v22, v46, v50
    v_fmac_f32 v23, v47, v50
    v_lshlrev_b32 v40, 16, v92
    v_and_b32 v41, 0xffff0000, v92
    v_lshlrev_b32 v42, 16, v93
    v_and_b32 v43, 0xffff0000, v93
    v_lshlrev_b32 v44, 16, v94
    v_and_b32 v45, 0xffff0000, v94
    v_lshlrev_b32 v46, 16, v95
    v_and_b32 v47, 0xffff0000, v95
    v_fmac_f32 v16, v40, v51
    v_fmac_f32 v17, v41, v51
    v_fmac_f32 v18, v42, v51
    v_fmac_f32 v19, v43, v51
    v_fmac_f32 v20, v44, v51
    v_fmac_f32 v21, v45, v51
    v_fmac_f32 v22, v46, v51
    v_fmac_f32 v23, v47, v51
    v_dot2_f32_bf16 v28, v96, v24, 0
    v_dot2_f32_bf16 v28, v97, v25, v28
    v_dot2_f32_bf16 v28, v98, v26, v28
    v_dot2_f32_bf16 v28, v99, v27, v28
    v_dot2_f32_bf16 v29, v100, v24, 0
    v_dot2_f32_bf16 v29, v101, v25, v29
    v_dot2_f32_bf16 v29, v102, v26, v29
    v_dot2_f32_bf16 v29, v103, v27, v29
    v_dot2_f32_bf16 v30, v104, v24, 0
    v_dot2_f32_bf16 v30, v105, v25, v30
    v_dot2_f32_bf16 v30, v106, v26, v30
    v_dot2_f32_bf16 v30, v107, v27, v30
    v_dot2_f32_bf16 v31, v108, v24, 0
    v_dot2_f32_bf16 v31, v109, v25, v31
    v_dot2_f32_bf16 v31, v110, v26, v31
    v_dot2_f32_bf16 v31, v111, v27, v31
    s_nop 2
    v_add_f32_dpp v28, v28, v28 row_ror:8 row_mask:0xf bank_mask:0xf
    v_add_f32_dpp v29, v29, v29 row_ror:8 row_mask:0xf bank_mask:0xf
    v_add_f32_dpp v30, v30, v30 row_ror:8 row_mask:0xf bank_mask:0xf
    v_add_f32_dpp v31, v31, v31 row_ror:8 row_mask:0xf bank_mask:0xf
    v_add_f32_dpp v28, v28, v28 row_ror:4 row_mask:0xf bank_mask:0xf
    v_add_f32_dpp v29, v29, v29 row_ror:4 row_mask:0xf bank_mask:0xf
    v_add_f32_dpp v30, v30, v30 row_ror:4 row_mask:0xf bank_mask:0xf
    v_add_f32_dpp v31, v31, v31 row_ror:4 row_mask:0xf bank_mask:0xf
    v_add_f32_dpp v28, v28, v28 row_ror:2 row_mask:0xf bank_mask:0xf
    v_add_f32_dpp v29, v29, v29 row_ror:2 row_mask:0xf bank_mask:0xf
    v_add_f32_dpp v30, v30, v30 row_ror:2 row_mask:0xf bank_mask:0xf
    v_add_f32_dpp v31, v31, v31 row_ror:2 row_mask:0xf bank_mask:0xf
    v_add_f32_dpp v28, v28, v28 row_ror:1 row_mask:0xf bank_mask:0xf
    v_add_f32_dpp v29, v29, v29 row_ror:1 row_mask:0xf bank_mask:0xf
    v_add_f32_dpp v30, v30, v30 row_ror:1 row_mask:0xf bank_mask:0xf
    v_add_f32_dpp v31, v31, v31 row_ror:1 row_mask:0xf bank_mask:0xf
    v_max3_f32 v38, v36, v28, v29
    v_max3_f32 v38, v38, v30, v31
    v_sub_f32 v39, v36, v38
    v_mul_f32 v39, s70, v39
    v_exp_f32 v39, v39
    v_mul_f32 v56, s70, v38
    v_mov_b32 v36, v38
    v_fma_f32 v48, v28, s70, -v56
    v_fma_f32 v49, v29, s70, -v56
    v_fma_f32 v50, v30, s70, -v56
    v_fma_f32 v51, v31, s70, -v56
    v_exp_f32 v48, v48
    v_exp_f32 v49, v49
    v_exp_f32 v50, v50
    v_exp_f32 v51, v51
    v_mul_f32 v37, v37, v39
    v_mul_f32 v16, v16, v39
    v_mul_f32 v17, v17, v39
    v_mul_f32 v18, v18, v39
    v_mul_f32 v19, v19, v39
    v_mul_f32 v20, v20, v39
    v_mul_f32 v21, v21, v39
    v_mul_f32 v22, v22, v39
    v_mul_f32 v23, v23, v39
    v_add_f32 v37, v37, v48
    v_add_f32 v37, v37, v49
    v_add_f32 v37, v37, v50
    v_add_f32 v37, v37, v51
    v_lshlrev_b32 v40, 16, v112
    v_and_b32 v41, 0xffff0000, v112
    v_lshlrev_b32 v42, 16, v113
    v_and_b32 v43, 0xffff0000, v113
    v_lshlrev_b32 v44, 16, v114
    v_and_b32 v45, 0xffff0000, v114
    v_lshlrev_b32 v46, 16, v115
    v_and_b32 v47, 0xffff0000, v115
    v_fmac_f32 v16, v40, v48
    v_fmac_f32 v17, v41, v48
    v_fmac_f32 v18, v42, v48
    v_fmac_f32 v19, v43, v48
    v_fmac_f32 v20, v44, v48
    v_fmac_f32 v21, v45, v48
    v_fmac_f32 v22, v46, v48
    v_fmac_f32 v23, v47, v48
    v_lshlrev_b32 v40, 16, v116
    v_and_b32 v41, 0xffff0000, v116
    v_lshlrev_b32 v42, 16, v117
    v_and_b32 v43, 0xffff0000, v117
    v_lshlrev_b32 v44, 16, v118
    v_and_b32 v45, 0xffff0000, v118
    v_lshlrev_b32 v46, 16, v119
    v_and_b32 v47, 0xffff0000, v119
    v_fmac_f32 v16, v40, v49
    v_fmac_f32 v17, v41, v49
    v_fmac_f32 v18, v42, v49
    v_fmac_f32 v19, v43, v49
    v_fmac_f32 v20, v44, v49
    v_fmac_f32 v21, v45, v49
    v_fmac_f32 v22, v46, v49
    v_fmac_f32 v23, v47, v49
    v_lshlrev_b32 v40, 16, v120
    v_and_b32 v41, 0xffff0000, v120
    v_lshlrev_b32 v42, 16, v121
    v_and_b32 v43, 0xffff0000, v121
    v_lshlrev_b32 v44, 16, v122
    v_and_b32 v45, 0xffff0000, v122
    v_lshlrev_b32 v46, 16, v123
    v_and_b32 v47, 0xffff0000, v123
    v_fmac_f32 v16, v40, v50
    v_fmac_f32 v17, v41, v50
    v_fmac_f32 v18, v42, v50
    v_fmac_f32 v19, v43, v50
    v_fmac_f32 v20, v44, v50
    v_fmac_f32 v21, v45, v50
    v_fmac_f32 v22, v46, v50
    v_fmac_f32 v23, v47, v50
    v_lshlrev_b32 v40, 16, v124
    v_and_b32 v41, 0xffff0000, v124
    v_lshlrev_b32 v42, 16, v125
    v_and_b32 v43, 0xffff0000, v125
    v_lshlrev_b32 v44, 16, v126
    v_and_b32 v45, 0xffff0000, v126
    v_lshlrev_b32 v46, 16, v127
    v_and_b32 v47, 0xffff0000, v127
    v_fmac_f32 v16, v40, v51
    v_fmac_f32 v17, v41, v51
    v_fmac_f32 v18, v42, v51
    v_fmac_f32 v19, v43, v51
    v_fmac_f32 v20, v44, v51
    v_fmac_f32 v21, v45, v51
    v_fmac_f32 v22, v46, v51
    v_fmac_f32 v23, v47, v51
    v_dot2_f32_bf16 v28, v128, v24, 0
    v_dot2_f32_bf16 v28, v129, v25, v28
    v_dot2_f32_bf16 v28, v130, v26, v28
    v_dot2_f32_bf16 v28, v131, v27, v28
    v_dot2_f32_bf16 v29, v132, v24, 0
    v_dot2_f32_bf16 v29, v133, v25, v29
    v_dot2_f32_bf16 v29, v134, v26, v29
    v_dot2_f32_bf16 v29, v135, v27, v29
    v_dot2_f32_bf16 v30, v136, v24, 0
    v_dot2_f32_bf16 v30, v137, v25, v30
    v_dot2_f32_bf16 v30, v138, v26, v30
    v_dot2_f32_bf16 v30, v139, v27, v30
    v_dot2_f32_bf16 v31, v140, v24, 0
    v_dot2_f32_bf16 v31, v141, v25, v31
    v_dot2_f32_bf16 v31, v142, v26, v31
    v_dot2_f32_bf16 v31, v143, v27, v31
    s_nop 2
    v_add_f32_dpp v28, v28, v28 row_ror:8 row_mask:0xf bank_mask:0xf
    v_add_f32_dpp v29, v29, v29 row_ror:8 row_mask:0xf bank_mask:0xf
    v_add_f32_dpp v30, v30, v30 row_ror:8 row_mask:0xf bank_mask:0xf
    v_add_f32_dpp v31, v31, v31 row_ror:8 row_mask:0xf bank_mask:0xf
    v_add_f32_dpp v28, v28, v28 row_ror:4 row_mask:0xf bank_mask:0xf
    v_add_f32_dpp v29, v29, v29 row_ror:4 row_mask:0xf bank_mask:0xf
    v_add_f32_dpp v30, v30, v30 row_ror:4 row_mask:0xf bank_mask:0xf
    v_add_f32_dpp v31, v31, v31 row_ror:4 row_mask:0xf bank_mask:0xf
    v_add_f32_dpp v28, v28, v28 row_ror:2 row_mask:0xf bank_mask:0xf
    v_add_f32_dpp v29, v29, v29 row_ror:2 row_mask:0xf bank_mask:0xf
    v_add_f32_dpp v30, v30, v30 row_ror:2 row_mask:0xf bank_mask:0xf
    v_add_f32_dpp v31, v31, v31 row_ror:2 row_mask:0xf bank_mask:0xf
    v_add_f32_dpp v28, v28, v28 row_ror:1 row_mask:0xf bank_mask:0xf
    v_add_f32_dpp v29, v29, v29 row_ror:1 row_mask:0xf bank_mask:0xf
    v_add_f32_dpp v30, v30, v30 row_ror:1 row_mask:0xf bank_mask:0xf
    v_add_f32_dpp v31, v31, v31 row_ror:1 row_mask:0xf bank_mask:0xf
    v_max3_f32 v38, v36, v28, v29
    v_max3_f32 v38, v38, v30, v31
    v_sub_f32 v39, v36, v38
    v_mul_f32 v39, s70, v39
    v_exp_f32 v39, v39
    v_mul_f32 v56, s70, v38
    v_mov_b32 v36, v38
    v_fma_f32 v48, v28, s70, -v56
    v_fma_f32 v49, v29, s70, -v56
    v_fma_f32 v50, v30, s70, -v56
    v_fma_f32 v51, v31, s70, -v56
    v_exp_f32 v48, v48
    v_exp_f32 v49, v49
    v_exp_f32 v50, v50
    v_exp_f32 v51, v51
    v_mul_f32 v37, v37, v39
    v_mul_f32 v16, v16, v39
    v_mul_f32 v17, v17, v39
    v_mul_f32 v18, v18, v39
    v_mul_f32 v19, v19, v39
    v_mul_f32 v20, v20, v39
    v_mul_f32 v21, v21, v39
    v_mul_f32 v22, v22, v39
    v_mul_f32 v23, v23, v39
    v_add_f32 v37, v37, v48
    v_add_f32 v37, v37, v49
    v_add_f32 v37, v37, v50
    v_add_f32 v37, v37, v51
    v_lshlrev_b32 v40, 16, v144
    v_and_b32 v41, 0xffff0000, v144
    v_lshlrev_b32 v42, 16, v145
    v_and_b32 v43, 0xffff0000, v145
    v_lshlrev_b32 v44, 16, v146
    v_and_b32 v45, 0xffff0000, v146
    v_lshlrev_b32 v46, 16, v147
    v_and_b32 v47, 0xffff0000, v147
    v_fmac_f32 v16, v40, v48
    v_fmac_f32 v17, v41, v48
    v_fmac_f32 v18, v42, v48
    v_fmac_f32 v19, v43, v48
    v_fmac_f32 v20, v44, v48
    v_fmac_f32 v21, v45, v48
    v_fmac_f32 v22, v46, v48
    v_fmac_f32 v23, v47, v48
    v_lshlrev_b32 v40, 16, v148
    v_and_b32 v41, 0xffff0000, v148
    v_lshlrev_b32 v42, 16, v149
    v_and_b32 v43, 0xffff0000, v149
    v_lshlrev_b32 v44, 16, v150
    v_and_b32 v45, 0xffff0000, v150
    v_lshlrev_b32 v46, 16, v151
    v_and_b32 v47, 0xffff0000, v151
    v_fmac_f32 v16, v40, v49
    v_fmac_f32 v17, v41, v49
    v_fmac_f32 v18, v42, v49
    v_fmac_f32 v19, v43, v49
    v_fmac_f32 v20, v44, v49
    v_fmac_f32 v21, v45, v49
    v_fmac_f32 v22, v46, v49
    v_fmac_f32 v23, v47, v49
    v_lshlrev_b32 v40, 16, v152
    v_and_b32 v41, 0xffff0000, v152
    v_lshlrev_b32 v42, 16, v153
    v_and_b32 v43, 0xffff0000, v153
    v_lshlrev_b32 v44, 16, v154
    v_and_b32 v45, 0xffff0000, v154
    v_lshlrev_b32 v46, 16, v155
    v_and_b32 v47, 0xffff0000, v155
    v_fmac_f32 v16, v40, v50
    v_fmac_f32 v17, v41, v50
    v_fmac_f32 v18, v42, v50
    v_fmac_f32 v19, v43, v50
    v_fmac_f32 v20, v44, v50
    v_fmac_f32 v21, v45, v50
    v_fmac_f32 v22, v46, v50
    v_fmac_f32 v23, v47, v50
    v_lshlrev_b32 v40, 16, v156
    v_and_b32 v41, 0xffff0000, v156
    v_lshlrev_b32 v42, 16, v157
    v_and_b32 v43, 0xffff0000, v157
    v_lshlrev_b32 v44, 16, v158
    v_and_b32 v45, 0xffff0000, v158
    v_lshlrev_b32 v46, 16, v159
    v_and_b32 v47, 0xffff0000, v159
    v_fmac_f32 v16, v40, v51
    v_fmac_f32 v17, v41, v51
    v_fmac_f32 v18, v42, v51
    v_fmac_f32 v19, v43, v51
    v_fmac_f32 v20, v44, v51
    v_fmac_f32 v21, v45, v51
    v_fmac_f32 v22, v46, v51
    v_fmac_f32 v23, v47, v51
    v_dot2_f32_bf16 v28, v160, v24, 0
    v_dot2_f32_bf16 v28, v161, v25, v28
    v_dot2_f32_bf16 v28, v162, v26, v28
    v_dot2_f32_bf16 v28, v163, v27, v28
    v_dot2_f32_bf16 v29, v164, v24, 0
    v_dot2_f32_bf16 v29, v165, v25, v29
    v_dot2_f32_bf16 v29, v166, v26, v29
    v_dot2_f32_bf16 v29, v167, v27, v29
    v_dot2_f32_bf16 v30, v168, v24, 0
    v_dot2_f32_bf16 v30, v169, v25, v30
    v_dot2_f32_bf16 v30, v170, v26, v30
    v_dot2_f32_bf16 v30, v171, v27, v30
    v_dot2_f32_bf16 v31, v172, v24, 0
    v_dot2_f32_bf16 v31, v173, v25, v31
    v_dot2_f32_bf16 v31, v174, v26, v31
    v_dot2_f32_bf16 v31, v175, v27, v31
    s_nop 2
    v_add_f32_dpp v28, v28, v28 row_ror:8 row_mask:0xf bank_mask:0xf
    v_add_f32_dpp v29, v29, v29 row_ror:8 row_mask:0xf bank_mask:0xf
    v_add_f32_dpp v30, v30, v30 row_ror:8 row_mask:0xf bank_mask:0xf
    v_add_f32_dpp v31, v31, v31 row_ror:8 row_mask:0xf bank_mask:0xf
    v_add_f32_dpp v28, v28, v28 row_ror:4 row_mask:0xf bank_mask:0xf
    v_add_f32_dpp v29, v29, v29 row_ror:4 row_mask:0xf bank_mask:0xf
    v_add_f32_dpp v30, v30, v30 row_ror:4 row_mask:0xf bank_mask:0xf
    v_add_f32_dpp v31, v31, v31 row_ror:4 row_mask:0xf bank_mask:0xf
    v_add_f32_dpp v28, v28, v28 row_ror:2 row_mask:0xf bank_mask:0xf
    v_add_f32_dpp v29, v29, v29 row_ror:2 row_mask:0xf bank_mask:0xf
    v_add_f32_dpp v30, v30, v30 row_ror:2 row_mask:0xf bank_mask:0xf
    v_add_f32_dpp v31, v31, v31 row_ror:2 row_mask:0xf bank_mask:0xf
    v_add_f32_dpp v28, v28, v28 row_ror:1 row_mask:0xf bank_mask:0xf
    v_add_f32_dpp v29, v29, v29 row_ror:1 row_mask:0xf bank_mask:0xf
    v_add_f32_dpp v30, v30, v30 row_ror:1 row_mask:0xf bank_mask:0xf
    v_add_f32_dpp v31, v31, v31 row_ror:1 row_mask:0xf bank_mask:0xf
    v_max3_f32 v38, v36, v28, v29
    v_max3_f32 v38, v38, v30, v31
    v_sub_f32 v39, v36, v38
    v_mul_f32 v39, s70, v39
    v_exp_f32 v39, v39
    v_mul_f32 v56, s70, v38
    v_mov_b32 v36, v38
    v_fma_f32 v48, v28, s70, -v56
    v_fma_f32 v49, v29, s70, -v56
    v_fma_f32 v50, v30, s70, -v56
    v_fma_f32 v51, v31, s70, -v56
    v_exp_f32 v48, v48
    v_exp_f32 v49, v49
    v_exp_f32 v50, v50
    v_exp_f32 v51, v51
    v_mul_f32 v37, v37, v39
    v_mul_f32 v16, v16, v39
    v_mul_f32 v17, v17, v39
    v_mul_f32 v18, v18, v39
    v_mul_f32 v19, v19, v39
    v_mul_f32 v20, v20, v39
    v_mul_f32 v21, v21, v39
    v_mul_f32 v22, v22, v39
    v_mul_f32 v23, v23, v39
    v_add_f32 v37, v37, v48
    v_add_f32 v37, v37, v49
    v_add_f32 v37, v37, v50
    v_add_f32 v37, v37, v51
    v_lshlrev_b32 v40, 16, v176
    v_and_b32 v41, 0xffff0000, v176
    v_lshlrev_b32 v42, 16, v177
    v_and_b32 v43, 0xffff0000, v177
    v_lshlrev_b32 v44, 16, v178
    v_and_b32 v45, 0xffff0000, v178
    v_lshlrev_b32 v46, 16, v179
    v_and_b32 v47, 0xffff0000, v179
    v_fmac_f32 v16, v40, v48
    v_fmac_f32 v17, v41, v48
    v_fmac_f32 v18, v42, v48
    v_fmac_f32 v19, v43, v48
    v_fmac_f32 v20, v44, v48
    v_fmac_f32 v21, v45, v48
    v_fmac_f32 v22, v46, v48
    v_fmac_f32 v23, v47, v48
    v_lshlrev_b32 v40, 16, v180
    v_and_b32 v41, 0xffff0000, v180
    v_lshlrev_b32 v42, 16, v181
    v_and_b32 v43, 0xffff0000, v181
    v_lshlrev_b32 v44, 16, v182
    v_and_b32 v45, 0xffff0000, v182
    v_lshlrev_b32 v46, 16, v183
    v_and_b32 v47, 0xffff0000, v183
    v_fmac_f32 v16, v40, v49
    v_fmac_f32 v17, v41, v49
    v_fmac_f32 v18, v42, v49
    v_fmac_f32 v19, v43, v49
    v_fmac_f32 v20, v44, v49
    v_fmac_f32 v21, v45, v49
    v_fmac_f32 v22, v46, v49
    v_fmac_f32 v23, v47, v49
    v_lshlrev_b32 v40, 16, v184
    v_and_b32 v41, 0xffff0000, v184
    v_lshlrev_b32 v42, 16, v185
    v_and_b32 v43, 0xffff0000, v185
    v_lshlrev_b32 v44, 16, v186
    v_and_b32 v45, 0xffff0000, v186
    v_lshlrev_b32 v46, 16, v187
    v_and_b32 v47, 0xffff0000, v187
    v_fmac_f32 v16, v40, v50
    v_fmac_f32 v17, v41, v50
    v_fmac_f32 v18, v42, v50
    v_fmac_f32 v19, v43, v50
    v_fmac_f32 v20, v44, v50
    v_fmac_f32 v21, v45, v50
    v_fmac_f32 v22, v46, v50
    v_fmac_f32 v23, v47, v50
    v_lshlrev_b32 v40, 16, v188
    v_and_b32 v41, 0xffff0000, v188
    v_lshlrev_b32 v42, 16, v189
    v_and_b32 v43, 0xffff0000, v189
    v_lshlrev_b32 v44, 16, v190
    v_and_b32 v45, 0xffff0000, v190
    v_lshlrev_b32 v46, 16, v191
    v_and_b32 v47, 0xffff0000, v191
    v_fmac_f32 v16, v40, v51
    v_fmac_f32 v17, v41, v51
    v_fmac_f32 v18, v42, v51
    v_fmac_f32 v19, v43, v51
    v_fmac_f32 v20, v44, v51
    v_fmac_f32 v21, v45, v51
    v_fmac_f32 v22, v46, v51
    v_fmac_f32 v23, v47, v51
    s_branch LBfin_27
L_join_go:
    s_mov_b64 exec, 1
    v_mov_b32 v8, 1
    ds_add_rtn_u32 v8, v10, v8
    s_mov_b64 exec, -1
    v_lshlrev_b32 v40, 4, v3
    ds_read_b128 v[24:27], v40 offset:0
    v_mov_b32 v36, 0xff7fffff
    v_mov_b32 v37, 0
    v_mov_b32 v16, 0
    v_mov_b32 v17, 0
    v_mov_b32 v18, 0
    v_mov_b32 v19, 0
    v_mov_b32 v20, 0
    v_mov_b32 v21, 0
    v_mov_b32 v22, 0
    v_mov_b32 v23, 0
    v_lshlrev_b32 v6, 5, v3
    v_lshl_add_u32 v6, v2, 3, v6
    s_lshl_b32 s61, s56, 9
    v_add_u32 v7, s61, v6
    s_lshl_b32 s77, s56, 3
    s_mov_b32 s76, 33554432
    s_waitcnt lgkmcnt(0)
    v_readfirstlane_b32 s84, v8
    s_mov_b64 exec, 1
    v_lshlrev_b32 v8, 2, v8
    ds_read_b32 v9, v8 offset:1024
    s_mov_b64 exec, -1
    s_waitcnt lgkmcnt(0)
    v_readfirstlane_b32 s73, v9
    s_nop 0
    s_cmp_lg_u32 s73, -1
    s_cbranch_scc1 Lg_43
    s_mov_b32 s92, 0
Lgs_44:
    s_sleep 1
    s_mov_b64 exec, 1
    ds_read_b32 v9, v8 offset:1024
    s_mov_b64 exec, -1
    s_waitcnt lgkmcnt(0)
    v_readfirstlane_b32 s73, v9
    s_add_u32 s92, s92, 1
    s_cmp_lg_u32 s73, -1
    s_cbranch_scc1 Lg_43
    s_cmp_lt_u32 s92, 400000
    s_cbranch_scc1 Lgs_44
Lg_43:
    s_cmp_ge_u32 s73, 67108864
    s_cbranch_scc1 LBfin_27
    s_mov_b32 s71, s73
    s_mov_b64 exec, 1
    v_mov_b32 v8, 1
    ds_add_rtn_u32 v8, v10, v8
    s_mov_b64 exec, -1
    buffer_load_dwordx4 v[64:67], v4, s[44:47], s71 offen offset:0 nt
    buffer_load_dwordx4 v[68:71], v4, s[44:47], s71 offen offset:1024 nt
    buffer_load_dwordx4 v[72:75], v4, s[44:47], s71 offen offset:2048 nt
    buffer_load_dwordx4 v[76:79], v4, s[44:47], s71 offen offset:3072 nt
    buffer_load_dwordx4 v[80:83], v4, s[48:51], s71 offen offset:0 nt
    buffer_load_dwordx4 v[84:87], v4, s[48:51], s71 offen offset:1024 nt
    buffer_load_dwordx4 v[88:91], v4, s[48:51], s71 offen offset:2048 nt
    buffer_load_dwordx4 v[92:95], v4, s[48:51], s71 offen offset:3072 nt
    s_waitcnt lgkmcnt(0)
    v_readfirstlane_b32 s84, v8
    s_mov_b64 exec, 1
    v_lshlrev_b32 v8, 2, v8
    ds_read_b32 v9, v8 offset:1024
    s_mov_b64 exec, -1
    s_waitcnt lgkmcnt(0)
    v_readfirstlane_b32 s73, v9
    s_nop 0
    s_cmp_lg_u32 s73, -1
    s_cbranch_scc1 Lg_45
    s_mov_b32 s92, 0
Lgs_46:
    s_sleep 1
    s_mov_b64 exec, 1
    ds_read_b32 v9, v8 offset:1024
    s_mov_b64 exec, -1
    s_waitcnt lgkmcnt(0)
    v_readfirstlane_b32 s73, v9
    s_add_u32 s92, s92, 1
    s_cmp_lg_u32 s73, -1
    s_cbranch_scc1 Lg_45
    s_cmp_lt_u32 s92, 400000
    s_cbranch_scc1 Lgs_46
Lg_45:
    s_branch LBloop2_23
LBfin_27:
    v_mov_b32 v38, v36
    v_mov_b32 v40, v38
    s_nop 1
    v_permlane32_swap_b32 v38, v40
    s_nop 1
    v_max_f32 v38, v38, v40
    v_mov_b32 v40, v38
    s_nop 1
    v_permlane16_swap_b32 v38, v40
    s_nop 1
    v_max_f32 v38, v38, v40
    v_sub_f32 v39, v36, v38
    v_mul_f32 v39, s70, v39
    v_exp_f32 v39, v39
    s_nop 0
    v_mul_f32 v37, v37, v39
    v_mul_f32 v16, v16, v39
    v_mul_f32 v17, v17, v39
    v_mul_f32 v18, v18, v39
    v_mul_f32 v19, v19, v39
    v_mul_f32 v20, v20, v39
    v_mul_f32 v21, v21, v39
    v_mul_f32 v22, v22, v39
    v_mul_f32 v23, v23, v39
    v_mov_b32 v40, v37
    s_nop 1
    v_permlane32_swap_b32 v37, v40
    s_nop 1
    v_add_f32 v37, v37, v40
    v_mov_b32 v40, v37
    s_nop 1
    v_permlane16_swap_b32 v37, v40
    s_nop 1
    v_add_f32 v37, v37, v40
    s_nop 2
    v_permlane32_swap_b32 v16, v20
    v_permlane32_swap_b32 v17, v21
    v_permlane32_swap_b32 v18, v22
    v_permlane32_swap_b32 v19, v23
    s_nop 1
    v_add_f32 v16, v16, v20
    v_add_f32 v17, v17, v21
    v_add_f32 v18, v18, v22
    v_add_f32 v19, v19, v23
    s_nop 1
    v_permlane16_swap_b32 v16, v18
    v_permlane16_swap_b32 v17, v19
    s_nop 1
    v_add_f32 v16, v16, v18
    v_add_f32 v17, v17, v19
    ds_write_b64 v7, v[16:17] offset:4096
    v_mov_b32 v40, v38
    v_mov_b32 v41, v37
    v_mov_b32 v42, s77
    ds_write_b64 v42, v[40:41] offset:12288
    s_cmp_eq_u32 s76, -1
    s_cbranch_scc1 Lns_47
    v_mov_b32 v40, 0xff7fffff
    v_mov_b32 v41, 0
    v_mov_b32 v42, s77
    ds_write_b64 v42, v[40:41] offset:12352
    v_mov_b32 v40, 0
    ds_write_b64 v7, v[40:41] offset:8192
Lns_47:
    s_waitcnt lgkmcnt(0)
L_bend:
    s_barrier
    s_cmp_lt_u32 s56, 2
    s_cbranch_scc1 Lpub_48
    s_cmp_eq_u32 s74, 2
    s_cbranch_scc1 L_t2_head
    s_branch L_end
Lpub_48:
    s_lshl_b32 s62, s56, 6
    v_mov_b32 v42, s62
    ds_read_b128 v[28:31], v42 offset:12288
    ds_read_b128 v[32:35], v42 offset:12304
    ds_read_b128 v[48:51], v42 offset:12320
    ds_read_b128 v[52:55], v42 offset:12336
    v_and_b32 v43, 31, v1
    v_lshlrev_b32 v43, 4, v43
    s_lshl_b32 s62, s56, 12
    v_add_u32 v43, s62, v43
    ds_read_b128 v[64:67], v43 offset:4096
    ds_read_b128 v[68:71], v43 offset:4608
    ds_read_b128 v[72:75], v43 offset:5120
    ds_read_b128 v[76:79], v43 offset:5632
    ds_read_b128 v[80:83], v43 offset:6144
    ds_read_b128 v[84:87], v43 offset:6656
    ds_read_b128 v[88:91], v43 offset:7168
    ds_read_b128 v[92:95], v43 offset:7680
    s_waitcnt lgkmcnt(8)
    v_max3_f32 v38, v28, v30, v32
    v_max3_f32 v38, v38, v34, v48
    v_max3_f32 v38, v38, v50, v52
    v_max_f32 v38, v38, v54
    v_mul_f32 v56, s70, v38
    v_fma_f32 v28, v28, s70, -v56
    v_fma_f32 v30, v30, s70, -v56
    v_fma_f32 v32, v32, s70, -v56
    v_fma_f32 v34, v34, s70, -v56
    v_fma_f32 v48, v48, s70, -v56
    v_fma_f32 v50, v50, s70, -v56
    v_fma_f32 v52, v52, s70, -v56
    v_fma_f32 v54, v54, s70, -v56
    v_exp_f32 v28, v28
    v_exp_f32 v30, v30
    v_exp_f32 v32, v32
    v_exp_f32 v34, v34
    v_exp_f32 v48, v48
    v_exp_f32 v50, v50
    v_exp_f32 v52, v52
    v_exp_f32 v54, v54
    s_nop 0
    v_mul_f32 v37, v28, v29
    v_fmac_f32 v37, v30, v31
    v_fmac_f32 v37, v32, v33
    v_fmac_f32 v37, v34, v35
    v_fmac_f32 v37, v48, v49
    v_fmac_f32 v37, v50, v51
    v_fmac_f32 v37, v52, v53
    v_fmac_f32 v37, v54, v55
    s_waitcnt lgkmcnt(0)
    v_mul_f32 v40, v64, v28
    v_mul_f32 v41, v65, v28
    v_mul_f32 v42, v66, v28
    v_mul_f32 v43, v67, v28
    v_fmac_f32 v40, v68, v30
    v_fmac_f32 v41, v69, v30
    v_fmac_f32 v42, v70, v30
    v_fmac_f32 v43, v71, v30
    v_fmac_f32 v40, v72, v32
    v_fmac_f32 v41, v73, v32
    v_fmac_f32 v42, v74, v32
    v_fmac_f32 v43, v75, v32
    v_fmac_f32 v40, v76, v34
    v_fmac_f32 v41, v77, v34
    v_fmac_f32 v42, v78, v34
    v_fmac_f32 v43, v79, v34
    v_fmac_f32 v40, v80, v48
    v_fmac_f32 v41, v81, v48
    v_fmac_f32 v42, v82, v48
    v_fmac_f32 v43, v83, v48
    v_fmac_f32 v40, v84, v50
    v_fmac_f32 v41, v85, v50
    v_fmac_f32 v42, v86, v50
    v_fmac_f32 v43, v87, v50
    v_fmac_f32 v40, v88, v52
    v_fmac_f32 v41, v89, v52
    v_fmac_f32 v42, v90, v52
    v_fmac_f32 v43, v91, v52
    v_fmac_f32 v40, v92, v54
    v_fmac_f32 v41, v93, v54
    v_fmac_f32 v42, v94, v54
    v_fmac_f32 v43, v95, v54
    v_cmp_eq_u32 vcc, 32, v1
    v_mov_b32 v45, 0
    s_nop 0
    v_cndmask_b32 v40, v40, v38, vcc
    v_cndmask_b32 v41, v41, v37, vcc
    v_cndmask_b32 v42, v42, v45, vcc
    v_cndmask_b32 v43, v43, v45, vcc
    s_lshl_b32 s64, s56, 3
    s_add_u32 s64, s64, s67
    v_lshlrev_b32 v44, 4, v1
    s_lshl_b32 s61, s64, 9
    s_add_u32 s61, s61, 512
    v_add_u32 v44, s61, v44
    s_lshl_b32 s61, s64, 4
    s_add_u32 s61, s61, 128
    v_mov_b32 v46, s61
    v_cndmask_b32 v44, v44, v46, vcc
    s_add_u32 s61, s65, 32
    s_mul_i32 s61, s61, 16384
    s_mov_b32 exec_lo, -1
    s_mov_b32 exec_hi, 1
    buffer_store_dwordx4 v[40:43], v44, s[32:35], s61 offen sc0 sc1
    s_mov_b64 exec, -1
    s_cmp_eq_u32 s74, 0
    s_cbranch_scc1 L_end
    s_cmp_eq_u32 s74, 2
    s_cbranch_scc1 L_t2_head
    s_branch L_final
Lsw_32:
    v_mov_b32 v38, v36
    v_mov_b32 v40, v38
    s_nop 1
    v_permlane32_swap_b32 v38, v40
    s_nop 1
    v_max_f32 v38, v38, v40
    v_mov_b32 v40, v38
    s_nop 1
    v_permlane16_swap_b32 v38, v40
    s_nop 1
    v_max_f32 v38, v38, v40
    v_sub_f32 v39, v36, v38
    v_mul_f32 v39, s70, v39
    v_exp_f32 v39, v39
    s_nop 0
    v_mul_f32 v37, v37, v39
    v_mul_f32 v16, v16, v39
    v_mul_f32 v17, v17, v39
    v_mul_f32 v18, v18, v39
    v_mul_f32 v19, v19, v39
    v_mul_f32 v20, v20, v39
    v_mul_f32 v21, v21, v39
    v_mul_f32 v22, v22, v39
    v_mul_f32 v23, v23, v39
    v_mov_b32 v40, v37
    s_nop 1
    v_permlane32_swap_b32 v37, v40
    s_nop 1
    v_add_f32 v37, v37, v40
    v_mov_b32 v40, v37
    s_nop 1
    v_permlane16_swap_b32 v37, v40
    s_nop 1
    v_add_f32 v37, v37, v40
    s_nop 2
    v_permlane32_swap_b32 v16, v20
    v_permlane32_swap_b32 v17, v21
    v_permlane32_swap_b32 v18, v22
    v_permlane32_swap_b32 v19, v23
    s_nop 1
    v_add_f32 v16, v16, v20
    v_add_f32 v17, v17, v21
    v_add_f32 v18, v18, v22
    v_add_f32 v19, v19, v23
    s_nop 1
    v_permlane16_swap_b32 v16, v18
    v_permlane16_swap_b32 v17, v19
    s_nop 1
    v_add_f32 v16, v16, v18
    v_add_f32 v17, v17, v19
    ds_write_b64 v7, v[16:17] offset:4096
    v_mov_b32 v40, v38
    v_mov_b32 v41, v37
    v_mov_b32 v42, s77
    ds_write_b64 v42, v[40:41] offset:12288
    v_lshlrev_b32 v44, 4, v3
    ds_read_b128 v[24:27], v44 offset:256
    v_mov_b32 v36, 0xff7fffff
    v_mov_b32 v37, 0
    v_mov_b32 v16, 0
    v_mov_b32 v17, 0
    v_mov_b32 v18, 0
    v_mov_b32 v19, 0
    v_mov_b32 v20, 0
    v_mov_b32 v21, 0
    v_mov_b32 v22, 0
    v_mov_b32 v23, 0
    v_add_u32 v7, 4096, v7
    s_add_u32 s77, s77, 64
    s_mov_b32 s76, -1
    s_waitcnt lgkmcnt(0)
    s_branch Lswb_33
Lsw_36:
    v_mov_b32 v38, v36
    v_mov_b32 v40, v38
    s_nop 1
    v_permlane32_swap_b32 v38, v40
    s_nop 1
    v_max_f32 v38, v38, v40
    v_mov_b32 v40, v38
    s_nop 1
    v_permlane16_swap_b32 v38, v40
    s_nop 1
    v_max_f32 v38, v38, v40
    v_sub_f32 v39, v36, v38
    v_mul_f32 v39, s70, v39
    v_exp_f32 v39, v39
    s_nop 0
    v_mul_f32 v37, v37, v39
    v_mul_f32 v16, v16, v39
    v_mul_f32 v17, v17, v39
    v_mul_f32 v18, v18, v39
    v_mul_f32 v19, v19, v39
    v_mul_f32 v20, v20, v39
    v_mul_f32 v21, v21, v39
    v_mul_f32 v22, v22, v39
    v_mul_f32 v23, v23, v39
    v_mov_b32 v40, v37
    s_nop 1
    v_permlane32_swap_b32 v37, v40
    s_nop 1
    v_add_f32 v37, v37, v40
    v_mov_b32 v40, v37
    s_nop 1
    v_permlane16_swap_b32 v37, v40
    s_nop 1
    v_add_f32 v37, v37, v40
    s_nop 2
    v_permlane32_swap_b32 v16, v20
    v_permlane32_swap_b32 v17, v21
    v_permlane32_swap_b32 v18, v22
    v_permlane32_swap_b32 v19, v23
    s_nop 1
    v_add_f32 v16, v16, v20
    v_add_f32 v17, v17, v21
    v_add_f32 v18, v18, v22
    v_add_f32 v19, v19, v23
    s_nop 1
    v_permlane16_swap_b32 v16, v18
    v_permlane16_swap_b32 v17, v19
    s_nop 1
    v_add_f32 v16, v16, v18
    v_add_f32 v17, v17, v19
    ds_write_b64 v7, v[16:17] offset:4096
    v_mov_b32 v40, v38
    v_mov_b32 v41, v37
    v_mov_b32 v42, s77
    ds_write_b64 v42, v[40:41] offset:12288
    v_lshlrev_b32 v44, 4, v3
    ds_read_b128 v[24:27], v44 offset:256
    v_mov_b32 v36, 0xff7fffff
    v_mov_b32 v37, 0
    v_mov_b32 v16, 0
    v_mov_b32 v17, 0
    v_mov_b32 v18, 0
    v_mov_b32 v19, 0
    v_mov_b32 v20, 0
    v_mov_b32 v21, 0
    v_mov_b32 v22, 0
    v_mov_b32 v23, 0
    v_add_u32 v7, 4096, v7
    s_add_u32 s77, s77, 64
    s_mov_b32 s76, -1
    s_waitcnt lgkmcnt(0)
    s_branch Lswb_37
Lsw_40:
    v_mov_b32 v38, v36
    v_mov_b32 v40, v38
    s_nop 1
    v_permlane32_swap_b32 v38, v40
    s_nop 1
    v_max_f32 v38, v38, v40
    v_mov_b32 v40, v38
    s_nop 1
    v_permlane16_swap_b32 v38, v40
    s_nop 1
    v_max_f32 v38, v38, v40
    v_sub_f32 v39, v36, v38
    v_mul_f32 v39, s70, v39
    v_exp_f32 v39, v39
    s_nop 0
    v_mul_f32 v37, v37, v39
    v_mul_f32 v16, v16, v39
    v_mul_f32 v17, v17, v39
    v_mul_f32 v18, v18, v39
    v_mul_f32 v19, v19, v39
    v_mul_f32 v20, v20, v39
    v_mul_f32 v21, v21, v39
    v_mul_f32 v22, v22, v39
    v_mul_f32 v23, v23, v39
    v_mov_b32 v40, v37
    s_nop 1
    v_permlane32_swap_b32 v37, v40
    s_nop 1
    v_add_f32 v37, v37, v40
    v_mov_b32 v40, v37
    s_nop 1
    v_permlane16_swap_b32 v37, v40
    s_nop 1
    v_add_f32 v37, v37, v40
    s_nop 2
    v_permlane32_swap_b32 v16, v20
    v_permlane32_swap_b32 v17, v21
    v_permlane32_swap_b32 v18, v22
    v_permlane32_swap_b32 v19, v23
    s_nop 1
    v_add_f32 v16, v16, v20
    v_add_f32 v17, v17, v21
    v_add_f32 v18, v18, v22
    v_add_f32 v19, v19, v23
    s_nop 1
    v_permlane16_swap_b32 v16, v18
    v_permlane16_swap_b32 v17, v19
    s_nop 1
    v_add_f32 v16, v16, v18
    v_add_f32 v17, v17, v19
    ds_write_b64 v7, v[16:17] offset:4096
    v_mov_b32 v40, v38
    v_mov_b32 v41, v37
    v_mov_b32 v42, s77
    ds_write_b64 v42, v[40:41] offset:12288
    v_lshlrev_b32 v44, 4, v3
    ds_read_b128 v[24:27], v44 offset:256
    v_mov_b32 v36, 0xff7fffff
    v_mov_b32 v37, 0
    v_mov_b32 v16, 0
    v_mov_b32 v17, 0
    v_mov_b32 v18, 0
    v_mov_b32 v19, 0
    v_mov_b32 v20, 0
    v_mov_b32 v21, 0
    v_mov_b32 v22, 0
    v_mov_b32 v23, 0
    v_add_u32 v7, 4096, v7
    s_add_u32 s77, s77, 64
    s_mov_b32 s76, -1
    s_waitcnt lgkmcnt(0)
    s_branch Lswb_41
L_join:
    s_mov_b32 s78, 0
    s_mov_b32 s79, 0
    s_mov_b32 s80, 0
    s_mov_b32 s81, 0
    v_and_b32 v1, 63, v0
    v_lshrrev_b32 v2, 4, v1
    v_and_b32 v3, 15, v1
    s_lshl_b32 s61, s65, 20
    s_add_u32 s44, s18, s61
    s_addc_u32 s45, s19, 0
    s_and_b32 s45, s45, 0xffff
    s_mov_b32 s46, 34603008
    s_mov_b32 s47, 0x00020000
    s_add_u32 s48, s20, s61
    s_addc_u32 s49, s21, 0
    s_and_b32 s49, s49, 0xffff
    s_mov_b32 s50, 34603008
    s_mov_b32 s51, 0x00020000
    s_lshl_b32 s83, s65, 8
    s_add_u32 s83, s83, 1507328
    v_lshlrev_b32 v4, 4, v1
    s_mov_b32 s70, 1040356334
    v_mov_b32 v60, 0
    v_mov_b32 v10, 512
    s_mul_i32 s88, s65, 252
    s_and_b32 s88, s88, 255
    s_cmp_eq_u32 s56, 7
    s_cbranch_scc1 Lj7_49
    s_barrier
    s_branch L_join_go
Lj7_49:
    s_setprio 3
    s_branch L_svc_q
L_roleA2:
    s_add_u32 s75, s65, 32
    s_branch L_roleA
L_roleA1:
    s_mov_b32 s75, s65
L_roleA:
    v_and_b32 v1, 63, v0
    v_lshrrev_b32 v2, 4, v1
    v_and_b32 v3, 15, v1
    v_lshlrev_b32 v5, 4, v1
    v_lshlrev_b32 v4, 17, v2
    v_lshl_add_u32 v4, v3, 4, v4
    s_mov_b32 s68, 0x05040100
    s_mov_b32 s69, 0x07060302
    s_mul_i32 s93, s75, 16384
    v_mov_b32 v40, -1
    v_mov_b32 v41, -1
    v_mov_b32 v42, -1
    v_mov_b32 v43, -1
    v_lshlrev_b32 v44, 4, v0
    buffer_store_dwordx4 v[40:43], v44, s[32:35], s93 offen sc0 sc1
    v_cmp_gt_u32 vcc, 4608, v44
    s_and_saveexec_b64 s[94:95], vcc
    s_cbranch_execz Lci_50
    s_add_u32 s61, s93, 8192
    buffer_store_dwordx4 v[40:43], v44, s[32:35], s61 offen sc0 sc1
Lci_50:
    s_mov_b64 exec, s[94:95]
    s_cmp_lg_u32 s56, 5
    s_cbranch_scc1 Lcq_51
    v_mov_b32 v46, 0
    v_mov_b32 v47, 65536
    s_lshl_b32 s61, s75, 8
    s_add_u32 s61, s61, 1507328
    s_mov_b64 exec, 1
    buffer_store_dword v47, v46, s[32:35], s61 offen sc0 sc1
    s_mov_b64 exec, -1
Lcq_51:
    s_cmp_lg_u32 s56, 6
    s_cbranch_scc1 Lcq_52
    s_lshl_b32 s61, s75, 10
    s_add_u32 s61, s61, 1146880
    buffer_store_dwordx4 v[40:43], v5, s[32:35], s61 offen sc0 sc1
Lcq_52:
    s_mov_b32 s59, s65
    s_and_b32 s60, s58, 1
    s_bfe_u32 s62, s58, 0x10001
    s_lshr_b32 s61, s58, 2
    s_lshl_b32 s3, s61, 5
    s_add_u32 s3, s3, s59
    s_lshl_b32 s3, s3, 2
    s_add_u32 s3, s3, s62
    s_lshl_b32 s3, s3, 1
    s_add_u32 s3, s3, s60
    s_lshl_b32 s3, s3, 8
    s_add_u32 s3, s3, 1310720
    s_and_b32 s91, s59, 0xfc
    s_cmp_eq_u32 s61, 0
    s_cselect_b32 s36, s8, s22
    s_cselect_b32 s37, s9, s23
    s_cselect_b32 s40, s4, s16
    s_cselect_b32 s41, s5, s17
    s_and_b32 s37, s37, 0xffff
    s_and_b32 s41, s41, 0xffff
    s_mov_b32 s38, 4194304
    s_mov_b32 s39, 0x00020000
    s_mov_b32 s42, 2048
    s_mov_b32 s43, 0x00020000
    v_and_b32 v228, 63, v0
    v_lshrrev_b32 v229, 3, v228
    v_and_b32 v230, 7, v228
    v_lshlrev_b32 v231, 3, v229
    s_lshl_b32 s61, s56, 6
    s_lshl_b32 s62, s62, 9
    s_add_u32 s61, s61, s62
    buffer_load_dwordx2 v[208:209], v231, s[40:43], s61 offen offset:0
    buffer_load_dwordx2 v[210:211], v231, s[40:43], s61 offen offset:1024
    v_lshlrev_b32 v231, 15, v229
    v_lshl_add_u32 v231, v230, 4, v231
    s_lshl_b32 s61, s61, 12
    s_lshl_b32 s59, s59, 8
    s_lshl_b32 s60, s60, 7
    s_add_u32 s61, s61, s59
    s_add_u32 s61, s61, s60
    buffer_load_dwordx4 v[192:195], v231, s[36:39], s61 offen
    s_add_u32 s61, s61, 8192
    buffer_load_dwordx4 v[196:199], v231, s[36:39], s61 offen
    s_add_u32 s61, s61, 8192
    buffer_load_dwordx4 v[200:203], v231, s[36:39], s61 offen
    s_add_u32 s61, s61, 8192
    buffer_load_dwordx4 v[204:207], v231, s[36:39], s61 offen
    s_mov_b32 s68, 0x05040100
    s_mov_b32 s69, 0x07060302
    s_barrier
    s_cmp_lt_u32 s75, 32
    s_cbranch_scc1 L_roleT1
    s_sub_u32 s65, s75, 32
    s_lshl_b32 s61, s65, 18
    s_add_u32 s44, s6, s61
    s_addc_u32 s45, s7, 0
    s_and_b32 s45, s45, 0xffff
    s_mov_b32 s46, 262144
    s_mov_b32 s47, 0x00020000
    s_cmp_eq_u32 s56, 7
    s_cbranch_scc1 Lt2s_53
    s_lshl_b32 s85, s56, 14
    s_add_u32 m0, s85, 0
    v_xor_b32 v52, 0, v5
    s_add_u32 s86, s85, 0
    buffer_load_dwordx4 v52, s[44:47], s86 offen nt lds
    s_add_u32 m0, s85, 1024
    v_xor_b32 v53, 64, v5
    s_add_u32 s86, s85, 1024
    buffer_load_dwordx4 v53, s[44:47], s86 offen nt lds
    s_add_u32 m0, s85, 2048
    v_xor_b32 v52, 128, v5
    s_add_u32 s86, s85, 2048
    buffer_load_dwordx4 v52, s[44:47], s86 offen nt lds
    s_add_u32 m0, s85, 3072
    v_xor_b32 v53, 192, v5
    s_add_u32 s86, s85, 3072
    buffer_load_dwordx4 v53, s[44:47], s86 offen nt lds
    s_waitcnt vmcnt(4)
    v_perm_b32 v232, v196, v192, s68
    v_perm_b32 v233, v196, v192, s69
    v_perm_b32 v234, v197, v193, s68
    v_perm_b32 v235, v197, v193, s69
    v_perm_b32 v236, v198, v194, s68
    v_perm_b32 v237, v198, v194, s69
    v_perm_b32 v238, v199, v195, s68
    v_perm_b32 v239, v199, v195, s69
    v_dot2_f32_bf16 v212, v232, v208, 0
    v_dot2_f32_bf16 v213, v233, v208, 0
    v_dot2_f32_bf16 v214, v234, v208, 0
    v_dot2_f32_bf16 v215, v235, v208, 0
    v_dot2_f32_bf16 v216, v236, v208, 0
    v_dot2_f32_bf16 v217, v237, v208, 0
    v_dot2_f32_bf16 v218, v238, v208, 0
    v_dot2_f32_bf16 v219, v239, v208, 0
    v_dot2_f32_bf16 v220, v232, v210, 0
    v_dot2_f32_bf16 v221, v233, v210, 0
    v_dot2_f32_bf16 v222, v234, v210, 0
    v_dot2_f32_bf16 v223, v235, v210, 0
    v_dot2_f32_bf16 v224, v236, v210, 0
    v_dot2_f32_bf16 v225, v237, v210, 0
    v_dot2_f32_bf16 v226, v238, v210, 0
    v_dot2_f32_bf16 v227, v239, v210, 0
    v_perm_b32 v232, v204, v200, s68
    v_perm_b32 v233, v204, v200, s69
    v_perm_b32 v234, v205, v201, s68
    v_perm_b32 v235, v205, v201, s69
    v_perm_b32 v236, v206, v202, s68
    v_perm_b32 v237, v206, v202, s69
    v_perm_b32 v238, v207, v203, s68
    v_perm_b32 v239, v207, v203, s69
    v_dot2_f32_bf16 v212, v232, v209, v212
    v_dot2_f32_bf16 v213, v233, v209, v213
    v_dot2_f32_bf16 v214, v234, v209, v214
    v_dot2_f32_bf16 v215, v235, v209, v215
    v_dot2_f32_bf16 v216, v236, v209, v216
    v_dot2_f32_bf16 v217, v237, v209, v217
    v_dot2_f32_bf16 v218, v238, v209, v218
    v_dot2_f32_bf16 v219, v239, v209, v219
    v_dot2_f32_bf16 v220, v232, v211, v220
    v_dot2_f32_bf16 v221, v233, v211, v221
    v_dot2_f32_bf16 v222, v234, v211, v222
    v_dot2_f32_bf16 v223, v235, v211, v223
    v_dot2_f32_bf16 v224, v236, v211, v224
    v_dot2_f32_bf16 v225, v237, v211, v225
    v_dot2_f32_bf16 v226, v238, v211, v226
    v_dot2_f32_bf16 v227, v239, v211, v227
    s_nop 2
    v_permlane32_swap_b32 v212, v220
    v_permlane32_swap_b32 v213, v221
    v_permlane32_swap_b32 v214, v222
    v_permlane32_swap_b32 v215, v223
    v_permlane32_swap_b32 v216, v224
    v_permlane32_swap_b32 v217, v225
    v_permlane32_swap_b32 v218, v226
    v_permlane32_swap_b32 v219, v227
    s_nop 1
    v_add_f32 v212, v212, v220
    v_add_f32 v213, v213, v221
    v_add_f32 v214, v214, v222
    v_add_f32 v215, v215, v223
    v_add_f32 v216, v216, v224
    v_add_f32 v217, v217, v225
    v_add_f32 v218, v218, v226
    v_add_f32 v219, v219, v227
    s_nop 1
    v_permlane16_swap_b32 v212, v216
    v_permlane16_swap_b32 v213, v217
    v_permlane16_swap_b32 v214, v218
    v_permlane16_swap_b32 v215, v219
    s_nop 1
    v_add_f32 v212, v212, v216
    v_add_f32 v213, v213, v217
    v_add_f32 v214, v214, v218
    v_add_f32 v215, v215, v219
    s_nop 1
    v_add_f32_dpp v212, v212, v212 row_ror:8 row_mask:0xf bank_mask:0xf
    v_add_f32_dpp v213, v213, v213 row_ror:8 row_mask:0xf bank_mask:0xf
    v_add_f32_dpp v214, v214, v214 row_ror:8 row_mask:0xf bank_mask:0xf
    v_add_f32_dpp v215, v215, v215 row_ror:8 row_mask:0xf bank_mask:0xf
    v_lshrrev_b32 v232, 5, v228
    v_lshlrev_b32 v232, 8, v232
    v_bfe_u32 v233, v228, 4, 1
    v_lshl_add_u32 v232, v233, 4, v232
    v_lshl_add_u32 v232, v230, 5, v232
    s_lshl_b32 s61, s56, 9
    s_add_u32 s61, s61, 147456
    v_add_u32 v232, s61, v232
    ds_write_b128 v232, v[212:215]
    s_waitcnt lgkmcnt(0)
    s_barrier
    s_waitcnt vmcnt(4)
    s_add_u32 m0, s85, 4096
    v_xor_b32 v52, 0, v5
    s_add_u32 s86, s85, 4096
    buffer_load_dwordx4 v52, s[44:47], s86 offen nt lds
    s_waitcnt vmcnt(4)
    s_add_u32 m0, s85, 5120
    v_xor_b32 v53, 64, v5
    s_add_u32 s86, s85, 5120
    buffer_load_dwordx4 v53, s[44:47], s86 offen nt lds
    s_waitcnt vmcnt(4)
    s_add_u32 m0, s85, 6144
    v_xor_b32 v52, 128, v5
    s_add_u32 s86, s85, 6144
    buffer_load_dwordx4 v52, s[44:47], s86 offen nt lds
    s_waitcnt vmcnt(4)
    s_add_u32 m0, s85, 7168
    v_xor_b32 v53, 192, v5
    s_add_u32 s86, s85, 7168
    buffer_load_dwordx4 v53, s[44:47], s86 offen nt lds
    s_waitcnt vmcnt(4)
    s_add_u32 m0, s85, 8192
    v_xor_b32 v52, 32, v5
    s_add_u32 s86, s85, 8192
    buffer_load_dwordx4 v52, s[44:47], s86 offen nt lds
    s_waitcnt vmcnt(4)
    s_add_u32 m0, s85, 9216
    v_xor_b32 v53, 96, v5
    s_add_u32 s86, s85, 9216
    buffer_load_dwordx4 v53, s[44:47], s86 offen nt lds
    s_waitcnt vmcnt(4)
    s_add_u32 m0, s85, 10240
    v_xor_b32 v52, 160, v5
    s_add_u32 s86, s85, 10240
    buffer_load_dwordx4 v52, s[44:47], s86 offen nt lds
    s_waitcnt vmcnt(4)
    s_add_u32 m0, s85, 11264
    v_xor_b32 v53, 224, v5
    s_add_u32 s86, s85, 11264
    buffer_load_dwordx4 v53, s[44:47], s86 offen nt lds
    s_waitcnt vmcnt(4)
    s_add_u32 m0, s85, 12288
    v_xor_b32 v52, 32, v5
    s_add_u32 s86, s85, 12288
    buffer_load_dwordx4 v52, s[44:47], s86 offen nt lds
    s_waitcnt vmcnt(4)
    s_add_u32 m0, s85, 13312
    v_xor_b32 v53, 96, v5
    s_add_u32 s86, s85, 13312
    buffer_load_dwordx4 v53, s[44:47], s86 offen nt lds
    s_waitcnt vmcnt(4)
    s_add_u32 m0, s85, 14336
    v_xor_b32 v52, 160, v5
    s_add_u32 s86, s85, 14336
    buffer_load_dwordx4 v52, s[44:47], s86 offen nt lds
    s_waitcnt vmcnt(4)
    s_add_u32 m0, s85, 15360
    v_xor_b32 v53, 224, v5
    s_add_u32 s86, s85, 15360
    buffer_load_dwordx4 v53, s[44:47], s86 offen nt lds
    s_branch Lt2j_54
Lt2s_53:
    s_setprio 3
    s_waitcnt vmcnt(0)
    v_perm_b32 v232, v196, v192, s68
    v_perm_b32 v233, v196, v192, s69
    v_perm_b32 v234, v197, v193, s68
    v_perm_b32 v235, v197, v193, s69
    v_perm_b32 v236, v198, v194, s68
    v_perm_b32 v237, v198, v194, s69
    v_perm_b32 v238, v199, v195, s68
    v_perm_b32 v239, v199, v195, s69
    v_dot2_f32_bf16 v212, v232, v208, 0
    v_dot2_f32_bf16 v213, v233, v208, 0
    v_dot2_f32_bf16 v214, v234, v208, 0
    v_dot2_f32_bf16 v215, v235, v208, 0
    v_dot2_f32_bf16 v216, v236, v208, 0
    v_dot2_f32_bf16 v217, v237, v208, 0
    v_dot2_f32_bf16 v218, v238, v208, 0
    v_dot2_f32_bf16 v219, v239, v208, 0
    v_dot2_f32_bf16 v220, v232, v210, 0
    v_dot2_f32_bf16 v221, v233, v210, 0
    v_dot2_f32_bf16 v222, v234, v210, 0
    v_dot2_f32_bf16 v223, v235, v210, 0
    v_dot2_f32_bf16 v224, v236, v210, 0
    v_dot2_f32_bf16 v225, v237, v210, 0
    v_dot2_f32_bf16 v226, v238, v210, 0
    v_dot2_f32_bf16 v227, v239, v210, 0
    v_perm_b32 v232, v204, v200, s68
    v_perm_b32 v233, v204, v200, s69
    v_perm_b32 v234, v205, v201, s68
    v_perm_b32 v235, v205, v201, s69
    v_perm_b32 v236, v206, v202, s68
    v_perm_b32 v237, v206, v202, s69
    v_perm_b32 v238, v207, v203, s68
    v_perm_b32 v239, v207, v203, s69
    v_dot2_f32_bf16 v212, v232, v209, v212
    v_dot2_f32_bf16 v213, v233, v209, v213
    v_dot2_f32_bf16 v214, v234, v209, v214
    v_dot2_f32_bf16 v215, v235, v209, v215
    v_dot2_f32_bf16 v216, v236, v209, v216
    v_dot2_f32_bf16 v217, v237, v209, v217
    v_dot2_f32_bf16 v218, v238, v209, v218
    v_dot2_f32_bf16 v219, v239, v209, v219
    v_dot2_f32_bf16 v220, v232, v211, v220
    v_dot2_f32_bf16 v221, v233, v211, v221
    v_dot2_f32_bf16 v222, v234, v211, v222
    v_dot2_f32_bf16 v223, v235, v211, v223
    v_dot2_f32_bf16 v224, v236, v211, v224
    v_dot2_f32_bf16 v225, v237, v211, v225
    v_dot2_f32_bf16 v226, v238, v211, v226
    v_dot2_f32_bf16 v227, v239, v211, v227
    s_nop 2
    v_permlane32_swap_b32 v212, v220
    v_permlane32_swap_b32 v213, v221
    v_permlane32_swap_b32 v214, v222
    v_permlane32_swap_b32 v215, v223
    v_permlane32_swap_b32 v216, v224
    v_permlane32_swap_b32 v217, v225
    v_permlane32_swap_b32 v218, v226
    v_permlane32_swap_b32 v219, v227
    s_nop 1
    v_add_f32 v212, v212, v220
    v_add_f32 v213, v213, v221
    v_add_f32 v214, v214, v222
    v_add_f32 v215, v215, v223
    v_add_f32 v216, v216, v224
    v_add_f32 v217, v217, v225
    v_add_f32 v218, v218, v226
    v_add_f32 v219, v219, v227
    s_nop 1
    v_permlane16_swap_b32 v212, v216
    v_permlane16_swap_b32 v213, v217
    v_permlane16_swap_b32 v214, v218
    v_permlane16_swap_b32 v215, v219
    s_nop 1
    v_add_f32 v212, v212, v216
    v_add_f32 v213, v213, v217
    v_add_f32 v214, v214, v218
    v_add_f32 v215, v215, v219
    s_nop 1
    v_add_f32_dpp v212, v212, v212 row_ror:8 row_mask:0xf bank_mask:0xf
    v_add_f32_dpp v213, v213, v213 row_ror:8 row_mask:0xf bank_mask:0xf
    v_add_f32_dpp v214, v214, v214 row_ror:8 row_mask:0xf bank_mask:0xf
    v_add_f32_dpp v215, v215, v215 row_ror:8 row_mask:0xf bank_mask:0xf
    v_lshrrev_b32 v232, 5, v228
    v_lshlrev_b32 v232, 8, v232
    v_bfe_u32 v233, v228, 4, 1
    v_lshl_add_u32 v232, v233, 4, v232
    v_lshl_add_u32 v232, v230, 5, v232
    s_lshl_b32 s61, s56, 9
    s_add_u32 s61, s61, 147456
    v_add_u32 v232, s61, v232
    ds_write_b128 v232, v[212:215]
    s_waitcnt lgkmcnt(0)
    s_barrier
    v_mov_b32 v48, 1
    v_mov_b32 v49, 0
    s_mov_b64 exec, 1
    buffer_atomic_add v48, v49, s[52:55], 0 offen offset:128 sc1
    s_mov_b64 exec, -1
    v_mov_b32 v234, 0
    buffer_load_dword v235, v234, s[52:55], s91 offen offset:0 sc0 sc1
    v_and_b32 v232, 31, v228
    v_lshlrev_b32 v233, 4, v232
    v_add_u32 v233, 147456, v233
    ds_read_b128 v[192:195], v233 offset:0
    ds_read_b128 v[196:199], v233 offset:512
    ds_read_b128 v[200:203], v233 offset:1024
    ds_read_b128 v[204:207], v233 offset:1536
    ds_read_b128 v[208:211], v233 offset:2048
    ds_read_b128 v[212:215], v233 offset:2560
    ds_read_b128 v[216:219], v233 offset:3072
    ds_read_b128 v[220:223], v233 offset:3584
    s_waitcnt lgkmcnt(6)
    v_add_f32 v192, v192, v196
    v_add_f32 v193, v193, v197
    v_add_f32 v194, v194, v198
    v_add_f32 v195, v195, v199
    s_waitcnt lgkmcnt(5)
    v_add_f32 v192, v192, v200
    v_add_f32 v193, v193, v201
    v_add_f32 v194, v194, v202
    v_add_f32 v195, v195, v203
    s_waitcnt lgkmcnt(4)
    v_add_f32 v192, v192, v204
    v_add_f32 v193, v193, v205
    v_add_f32 v194, v194, v206
    v_add_f32 v195, v195, v207
    s_waitcnt lgkmcnt(3)
    v_add_f32 v192, v192, v208
    v_add_f32 v193, v193, v209
    v_add_f32 v194, v194, v210
    v_add_f32 v195, v195, v211
    s_waitcnt lgkmcnt(2)
    v_add_f32 v192, v192, v212
    v_add_f32 v193, v193, v213
    v_add_f32 v194, v194, v214
    v_add_f32 v195, v195, v215
    s_waitcnt lgkmcnt(1)
    v_add_f32 v192, v192, v216
    v_add_f32 v193, v193, v217
    v_add_f32 v194, v194, v218
    v_add_f32 v195, v195, v219
    s_waitcnt lgkmcnt(0)
    v_add_f32 v192, v192, v220
    v_add_f32 v193, v193, v221
    v_add_f32 v194, v194, v222
    v_add_f32 v195, v195, v223
    v_lshrrev_b32 v233, 4, v232
    v_lshlrev_b32 v233, 10, v233
    v_and_b32 v232, 15, v232
    v_lshl_add_u32 v233, v232, 4, v233
    s_waitcnt vmcnt(0)
    s_mov_b32 s92, 0
Lcf_55:
    v_readfirstlane_b32 s57, v235
    s_nop 3
    s_cmp_lg_u32 s57, 0
    s_cbranch_scc1 Lcfd_56
    s_sleep 2
    buffer_load_dword v235, v234, s[52:55], s91 offen offset:0 sc0 sc1
    s_waitcnt vmcnt(0)
    s_add_u32 s92, s92, 1
    s_cmp_lt_u32 s92, 400000
    s_cbranch_scc1 Lcf_55
Lcfd_56:
    s_mov_b64 exec, 0xffffffff
    buffer_store_dwordx4 v[192:195], v233, s[32:35], s3 offen sc0 sc1
    s_mov_b64 exec, -1
    s_setprio 0
    s_lshl_b32 s85, s56, 14
    s_add_u32 m0, s85, 0
    v_xor_b32 v52, 0, v5
    s_add_u32 s86, s85, 0
    buffer_load_dwordx4 v52, s[44:47], s86 offen nt lds
    s_add_u32 m0, s85, 1024
    v_xor_b32 v53, 64, v5
    s_add_u32 s86, s85, 1024
    buffer_load_dwordx4 v53, s[44:47], s86 offen nt lds
    s_add_u32 m0, s85, 2048
    v_xor_b32 v52, 128, v5
    s_add_u32 s86, s85, 2048
    buffer_load_dwordx4 v52, s[44:47], s86 offen nt lds
    s_add_u32 m0, s85, 3072
    v_xor_b32 v53, 192, v5
    s_add_u32 s86, s85, 3072
    buffer_load_dwordx4 v53, s[44:47], s86 offen nt lds
    s_add_u32 m0, s85, 4096
    v_xor_b32 v52, 0, v5
    s_add_u32 s86, s85, 4096
    buffer_load_dwordx4 v52, s[44:47], s86 offen nt lds
    s_add_u32 m0, s85, 5120
    v_xor_b32 v53, 64, v5
    s_add_u32 s86, s85, 5120
    buffer_load_dwordx4 v53, s[44:47], s86 offen nt lds
    s_add_u32 m0, s85, 6144
    v_xor_b32 v52, 128, v5
    s_add_u32 s86, s85, 6144
    buffer_load_dwordx4 v52, s[44:47], s86 offen nt lds
    s_add_u32 m0, s85, 7168
    v_xor_b32 v53, 192, v5
    s_add_u32 s86, s85, 7168
    buffer_load_dwordx4 v53, s[44:47], s86 offen nt lds
    s_add_u32 m0, s85, 8192
    v_xor_b32 v52, 32, v5
    s_add_u32 s86, s85, 8192
    buffer_load_dwordx4 v52, s[44:47], s86 offen nt lds
    s_add_u32 m0, s85, 9216
    v_xor_b32 v53, 96, v5
    s_add_u32 s86, s85, 9216
    buffer_load_dwordx4 v53, s[44:47], s86 offen nt lds
    s_add_u32 m0, s85, 10240
    v_xor_b32 v52, 160, v5
    s_add_u32 s86, s85, 10240
    buffer_load_dwordx4 v52, s[44:47], s86 offen nt lds
    s_add_u32 m0, s85, 11264
    v_xor_b32 v53, 224, v5
    s_add_u32 s86, s85, 11264
    buffer_load_dwordx4 v53, s[44:47], s86 offen nt lds
    s_add_u32 m0, s85, 12288
    v_xor_b32 v52, 32, v5
    s_add_u32 s86, s85, 12288
    buffer_load_dwordx4 v52, s[44:47], s86 offen nt lds
    s_add_u32 m0, s85, 13312
    v_xor_b32 v53, 96, v5
    s_add_u32 s86, s85, 13312
    buffer_load_dwordx4 v53, s[44:47], s86 offen nt lds
    s_add_u32 m0, s85, 14336
    v_xor_b32 v52, 160, v5
    s_add_u32 s86, s85, 14336
    buffer_load_dwordx4 v52, s[44:47], s86 offen nt lds
    s_add_u32 m0, s85, 15360
    v_xor_b32 v53, 224, v5
    s_add_u32 s86, s85, 15360
    buffer_load_dwordx4 v53, s[44:47], s86 offen nt lds
Lt2j_54:
    s_barrier
    s_lshl_b32 s85, s56, 14
    s_add_u32 s85, s85, 131072
    buffer_load_dwordx4 v[128:131], v5, s[44:47], s85 offen offset:0 nt
    buffer_load_dwordx4 v[132:135], v5, s[44:47], s85 offen offset:1024 nt
    buffer_load_dwordx4 v[136:139], v5, s[44:47], s85 offen offset:2048 nt
    buffer_load_dwordx4 v[140:143], v5, s[44:47], s85 offen offset:3072 nt
    s_add_u32 s85, s85, 4096
    buffer_load_dwordx4 v[144:147], v5, s[44:47], s85 offen offset:0 nt
    buffer_load_dwordx4 v[148:151], v5, s[44:47], s85 offen offset:1024 nt
    buffer_load_dwordx4 v[152:155], v5, s[44:47], s85 offen offset:2048 nt
    buffer_load_dwordx4 v[156:159], v5, s[44:47], s85 offen offset:3072 nt
    s_add_u32 s85, s85, 4096
    buffer_load_dwordx4 v[160:163], v5, s[44:47], s85 offen offset:0 nt
    buffer_load_dwordx4 v[164:167], v5, s[44:47], s85 offen offset:1024 nt
    buffer_load_dwordx4 v[168:171], v5, s[44:47], s85 offen offset:2048 nt
    buffer_load_dwordx4 v[172:175], v5, s[44:47], s85 offen offset:3072 nt
    s_add_u32 s85, s85, 4096
    buffer_load_dwordx4 v[176:179], v5, s[44:47], s85 offen offset:0 nt
    buffer_load_dwordx4 v[180:183], v5, s[44:47], s85 offen offset:1024 nt
    buffer_load_dwordx4 v[184:187], v5, s[44:47], s85 offen offset:2048 nt
    buffer_load_dwordx4 v[188:191], v5, s[44:47], s85 offen offset:3072 nt
    v_mov_b32 v55, 0
    buffer_load_dword v54, v55, s[52:55], 0 offen offset:128 sc0 sc1
    s_lshr_b32 s66, s65, 4
    s_and_b32 s67, s65, 15
    s_and_b32 s63, s56, 3
    s_lshr_b32 s64, s56, 2
    v_and_b32 v40, 3, v3
    v_lshlrev_b32 v40, 2, v40
    v_lshrrev_b32 v41, 3, v3
    v_lshl_or_b32 v40, v41, 1, v40
    s_lshl_b32 s61, s63, 15
    v_lshlrev_b32 v41, 10, v3
    v_add_u32 v41, s61, v41
    v_add_u32 v42, 0, v2
    v_xor_b32 v42, v42, v40
    v_lshl_add_u32 v8, v42, 4, v41
    v_add_u32 v42, 4, v2
    v_xor_b32 v42, v42, v40
    v_lshl_add_u32 v9, v42, 4, v41
    v_add_u32 v42, 8, v2
    v_xor_b32 v42, v42, v40
    v_lshl_add_u32 v10, v42, 4, v41
    v_add_u32 v42, 12, v2
    v_xor_b32 v42, v42, v40
    v_lshl_add_u32 v11, v42, 4, v41
    s_lshl_b32 s61, s64, 14
    s_add_u32 s61, s61, 131072
    s_lshl_b32 s62, s63, 15
    s_sub_u32 s61, s61, s62
    v_lshrrev_b32 v43, 1, v2
    v_and_b32 v44, 1, v2
    v_lshrrev_b32 v45, 2, v3
    v_lshl_add_u32 v46, v43, 3, v45
    v_lshlrev_b32 v47, 2, v45
    v_lshl_or_b32 v47, v43, 1, v47
    v_bfe_u32 v48, v3, 1, 1
    v_lshl_add_u32 v48, v44, 1, v48
    s_lshl_b32 s62, s56, 3
    s_add_u32 s62, s62, 0
    v_add_u32 v48, s62, v48
    v_xor_b32 v48, v48, v47
    v_lshlrev_b32 v48, 4, v48
    v_lshl_add_u32 v48, v46, 10, v48
    v_and_b32 v49, 1, v3
    v_lshl_add_u32 v12, v49, 3, v48
    v_bfe_u32 v48, v3, 1, 1
    v_lshl_add_u32 v48, v44, 1, v48
    s_lshl_b32 s62, s56, 3
    s_add_u32 s62, s62, 4
    v_add_u32 v48, s62, v48
    v_xor_b32 v48, v48, v47
    v_lshlrev_b32 v48, 4, v48
    v_lshl_add_u32 v48, v46, 10, v48
    v_and_b32 v49, 1, v3
    v_lshl_add_u32 v13, v49, 3, v48
    v_lshl_add_u32 v46, v43, 3, v45
    v_add_u32 v46, 4, v46
    v_lshlrev_b32 v47, 2, v45
    v_lshl_or_b32 v47, v43, 1, v47
    v_bfe_u32 v48, v3, 1, 1
    v_lshl_add_u32 v48, v44, 1, v48
    s_lshl_b32 s62, s56, 3
    s_add_u32 s62, s62, 0
    v_add_u32 v48, s62, v48
    v_xor_b32 v48, v48, v47
    v_lshlrev_b32 v48, 4, v48
    v_lshl_add_u32 v48, v46, 10, v48
    v_and_b32 v49, 1, v3
    v_lshl_add_u32 v14, v49, 3, v48
    v_bfe_u32 v48, v3, 1, 1
    v_lshl_add_u32 v48, v44, 1, v48
    s_lshl_b32 s62, s56, 3
    s_add_u32 s62, s62, 4
    v_add_u32 v48, s62, v48
    v_xor_b32 v48, v48, v47
    v_lshlrev_b32 v48, 4, v48
    v_lshl_add_u32 v48, v46, 10, v48
    v_and_b32 v49, 1, v3
    v_lshl_add_u32 v15, v49, 3, v48
    v_and_b32 v43, 31, v1
    v_lshrrev_b32 v44, 5, v1
    v_mul_u32_u24 v16, 272, v43
    v_lshl_add_u32 v16, v44, 4, v16
    v_add_u32 v16, 131072, v16
    v_lshlrev_b32 v23, 4, v43
    v_add_u32 v23, 139776, v23
    s_lshl_b32 s62, s64, 4
    v_add_u32 v43, s62, v3
    v_mul_u32_u24 v17, 272, v43
    v_lshl_add_u32 v17, v2, 3, v17
    s_lshl_b32 s62, s63, 6
    s_add_u32 s62, s62, 131072
    v_add_u32 v17, s62, v17
    v_lshlrev_b32 v22, 4, v43
    v_add_u32 v22, 139776, v22
    s_lshl_b32 s62, s63, 2
    v_add_u32 v21, s62, v22
    v_add_u32 v33, s61, v8
    v_mov_b32 v18, 0xff7fffff
    v_mov_b32 v20, 0xff7fffff
    v_mov_b32 v19, 0
    s_mov_b32 s100, s61
    s_cmp_lt_u32 s56, 4
    s_cbranch_scc1 Lqa0_57
    s_waitcnt vmcnt(17)
    s_branch Lqaj_58
Lqa0_57:
    s_waitcnt vmcnt(0)
    s_mov_b32 s92, 0
Lcf_59:
    v_readfirstlane_b32 s57, v54
    s_nop 3
    s_cmp_ge_u32 s57, 64
    s_cbranch_scc1 Lcfd_60
    s_sleep 8
    v_mov_b32 v55, 0
    buffer_load_dword v54, v55, s[52:55], 0 offen offset:128 sc0 sc1
    s_waitcnt vmcnt(0)
    s_add_u32 s92, s92, 1
    s_cmp_lt_u32 s92, 400000
    s_cbranch_scc1 Lcf_59
Lcfd_60:
    s_lshl_b32 s61, s66, 15
    s_lshl_b32 s62, s56, 13
    s_add_u32 s61, s61, s62
    s_add_u32 s61, s61, 1147900
    v_lshlrev_b32 v41, 10, v1
    s_mov_b64 exec, 0xff
    s_mov_b32 s92, 0
Lpoll_61:
    buffer_load_dword v42, v41, s[32:35], s61 offen sc0 sc1
    s_waitcnt vmcnt(0)
    v_mov_b32 v43, v42
    v_cmpx_eq_u32 vcc, -1, v43
    s_cbranch_execz Lpolld_62
    s_sleep 4
    s_add_u32 s92, s92, 1
    s_cmp_lt_u32 s92, 400000
    s_cbranch_scc1 Lpoll_61
Lpolld_62:
    s_mov_b64 exec, -1
    s_lshl_b32 s61, s66, 15
    s_lshl_b32 s62, s56, 13
    s_add_u32 s61, s61, s62
    s_add_u32 s61, s61, 1146880
    s_add_u32 s62, s61, 4096
    s_mov_b32 s92, 0
Lpoll_63:
    buffer_load_dwordx4 v[64:67], v5, s[32:35], s61 offen offset:0 sc0 sc1
    buffer_load_dwordx4 v[68:71], v5, s[32:35], s61 offen offset:1024 sc0 sc1
    buffer_load_dwordx4 v[72:75], v5, s[32:35], s61 offen offset:2048 sc0 sc1
    buffer_load_dwordx4 v[76:79], v5, s[32:35], s61 offen offset:3072 sc0 sc1
    buffer_load_dwordx4 v[80:83], v5, s[32:35], s62 offen offset:0 sc0 sc1
    buffer_load_dwordx4 v[84:87], v5, s[32:35], s62 offen offset:1024 sc0 sc1
    buffer_load_dwordx4 v[88:91], v5, s[32:35], s62 offen offset:2048 sc0 sc1
    buffer_load_dwordx4 v[92:95], v5, s[32:35], s62 offen offset:3072 sc0 sc1
    s_waitcnt vmcnt(0)
    v_mov_b32 v40, v64
    v_max3_u32 v40, v40, v65, v66
    v_max3_u32 v40, v40, v67, v68
    v_max3_u32 v40, v40, v69, v70
    v_max3_u32 v40, v40, v71, v72
    v_max3_u32 v40, v40, v73, v74
    v_max3_u32 v40, v40, v75, v76
    v_max3_u32 v40, v40, v77, v78
    v_max3_u32 v40, v40, v79, v80
    v_max3_u32 v40, v40, v81, v82
    v_max3_u32 v40, v40, v83, v84
    v_max3_u32 v40, v40, v85, v86
    v_max3_u32 v40, v40, v87, v88
    v_max3_u32 v40, v40, v89, v90
    v_max3_u32 v40, v40, v91, v92
    v_max3_u32 v40, v40, v93, v94
    v_max_u32 v40, v40, v95
    v_cmpx_eq_u32 vcc, -1, v40
    s_cbranch_execz Lpolld_64
    s_sleep 4
    s_add_u32 s92, s92, 1
    s_cmp_lt_u32 s92, 400000
    s_cbranch_scc1 Lpoll_63
Lpolld_64:
    s_mov_b64 exec, -1
    s_and_b32 s62, s56, 1
    s_lshl_b32 s62, s62, 5
    s_lshl_b32 s61, s56, 13
    s_add_u32 s61, s61, 131072
    s_add_u32 s57, s62, 0
    v_xor_b32 v40, s57, v5
    v_add_u32 v40, s61, v40
    ds_write_b128 v40, v[64:67] offset:0
    s_add_u32 s57, s62, 64
    v_xor_b32 v41, s57, v5
    v_add_u32 v41, s61, v41
    ds_write_b128 v41, v[68:71] offset:1024
    s_add_u32 s57, s62, 128
    v_xor_b32 v42, s57, v5
    v_add_u32 v42, s61, v42
    ds_write_b128 v42, v[72:75] offset:2048
    s_add_u32 s57, s62, 192
    v_xor_b32 v43, s57, v5
    v_add_u32 v43, s61, v43
    ds_write_b128 v43, v[76:79] offset:3072
    s_add_u32 s57, s62, 0
    v_xor_b32 v40, s57, v5
    v_add_u32 v40, s61, v40
    ds_write_b128 v40, v[80:83] offset:4096
    s_add_u32 s57, s62, 64
    v_xor_b32 v41, s57, v5
    v_add_u32 v41, s61, v41
    ds_write_b128 v41, v[84:87] offset:5120
    s_add_u32 s57, s62, 128
    v_xor_b32 v42, s57, v5
    v_add_u32 v42, s61, v42
    ds_write_b128 v42, v[88:91] offset:6144
    s_add_u32 s57, s62, 192
    v_xor_b32 v43, s57, v5
    v_add_u32 v43, s61, v43
    ds_write_b128 v43, v[92:95] offset:7168
    s_waitcnt lgkmcnt(0)
Lqaj_58:
    s_barrier
    v_add_u32 v40, s100, v8
    v_add_u32 v41, s100, v9
    v_add_u32 v42, s100, v10
    v_add_u32 v43, s100, v11
    ds_read_b128 v[192:195], v40 offset:0
    ds_read_b128 v[196:199], v41 offset:0
    ds_read_b128 v[200:203], v42 offset:0
    ds_read_b128 v[204:207], v43 offset:0
    ds_read_b128 v[208:211], v40 offset:256
    ds_read_b128 v[212:215], v41 offset:256
    ds_read_b128 v[216:219], v42 offset:256
    ds_read_b128 v[220:223], v43 offset:256
    ds_read_b128 v[224:227], v40 offset:512
    ds_read_b128 v[228:231], v41 offset:512
    ds_read_b128 v[232:235], v42 offset:512
    ds_read_b128 v[236:239], v43 offset:512
    ds_read_b128 v[240:243], v40 offset:768
    ds_read_b128 v[244:247], v41 offset:768
    ds_read_b128 v[248:251], v42 offset:768
    ds_read_b128 v[252:255], v43 offset:768
    s_waitcnt lgkmcnt(0)
    s_barrier
    ds_read_b128 v[96:99], v8 offset:0
    ds_read_b128 v[100:103], v8 offset:16384
    ds_read_b128 v[104:107], v9 offset:0
    ds_read_b128 v[108:111], v9 offset:16384
    ds_read_b128 v[112:115], v10 offset:0
    ds_read_b128 v[116:119], v10 offset:16384
    ds_read_b128 v[120:123], v11 offset:0
    ds_read_b128 v[124:127], v11 offset:16384
    s_waitcnt lgkmcnt(7)
    v_mfma_f32_16x16x32_bf16 v[24:27], v[96:99], v[192:195], 0
    ds_read_b128 v[96:99], v8 offset:256
    s_waitcnt lgkmcnt(7)
    v_mfma_f32_16x16x32_bf16 v[28:31], v[100:103], v[192:195], 0
    ds_read_b128 v[100:103], v8 offset:16640
    s_waitcnt lgkmcnt(7)
    v_mfma_f32_16x16x32_bf16 v[24:27], v[104:107], v[196:199], v[24:27]
    ds_read_b128 v[104:107], v9 offset:256
    s_waitcnt lgkmcnt(7)
    v_mfma_f32_16x16x32_bf16 v[28:31], v[108:111], v[196:199], v[28:31]
    ds_read_b128 v[108:111], v9 offset:16640
    s_waitcnt lgkmcnt(7)
    v_mfma_f32_16x16x32_bf16 v[24:27], v[112:115], v[200:203], v[24:27]
    ds_read_b128 v[112:115], v10 offset:256
    s_waitcnt lgkmcnt(7)
    v_mfma_f32_16x16x32_bf16 v[28:31], v[116:119], v[200:203], v[28:31]
    ds_read_b128 v[116:119], v10 offset:16640
    s_waitcnt lgkmcnt(7)
    v_mfma_f32_16x16x32_bf16 v[24:27], v[120:123], v[204:207], v[24:27]
    ds_read_b128 v[120:123], v11 offset:256
    s_waitcnt lgkmcnt(7)
    v_mfma_f32_16x16x32_bf16 v[28:31], v[124:127], v[204:207], v[28:31]
    ds_read_b128 v[124:127], v11 offset:16640
    s_waitcnt lgkmcnt(7)
    v_mfma_f32_16x16x32_bf16 v[24:27], v[96:99], v[208:211], v[24:27]
    ds_read_b128 v[96:99], v8 offset:512
    s_waitcnt lgkmcnt(7)
    v_mfma_f32_16x16x32_bf16 v[28:31], v[100:103], v[208:211], v[28:31]
    ds_read_b128 v[100:103], v8 offset:16896
    s_waitcnt lgkmcnt(7)
    v_mfma_f32_16x16x32_bf16 v[24:27], v[104:107], v[212:215], v[24:27]
    ds_read_b128 v[104:107], v9 offset:512
    s_waitcnt lgkmcnt(7)
    v_mfma_f32_16x16x32_bf16 v[28:31], v[108:111], v[212:215], v[28:31]
    ds_read_b128 v[108:111], v9 offset:16896
    s_waitcnt lgkmcnt(7)
    v_mfma_f32_16x16x32_bf16 v[24:27], v[112:115], v[216:219], v[24:27]
    ds_read_b128 v[112:115], v10 offset:512
    s_waitcnt lgkmcnt(7)
    v_mfma_f32_16x16x32_bf16 v[28:31], v[116:119], v[216:219], v[28:31]
    ds_read_b128 v[116:119], v10 offset:16896
    s_waitcnt lgkmcnt(7)
    v_mfma_f32_16x16x32_bf16 v[24:27], v[120:123], v[220:223], v[24:27]
    ds_read_b128 v[120:123], v11 offset:512
    s_waitcnt lgkmcnt(7)
    v_mfma_f32_16x16x32_bf16 v[28:31], v[124:127], v[220:223], v[28:31]
    ds_read_b128 v[124:127], v11 offset:16896
    s_waitcnt lgkmcnt(7)
    v_mfma_f32_16x16x32_bf16 v[24:27], v[96:99], v[224:227], v[24:27]
    ds_read_b128 v[96:99], v8 offset:768
    s_waitcnt lgkmcnt(7)
    v_mfma_f32_16x16x32_bf16 v[28:31], v[100:103], v[224:227], v[28:31]
    ds_read_b128 v[100:103], v8 offset:17152
    s_waitcnt lgkmcnt(7)
    v_mfma_f32_16x16x32_bf16 v[24:27], v[104:107], v[228:231], v[24:27]
    ds_read_b128 v[104:107], v9 offset:768
    s_waitcnt lgkmcnt(7)
    v_mfma_f32_16x16x32_bf16 v[28:31], v[108:111], v[228:231], v[28:31]
    ds_read_b128 v[108:111], v9 offset:17152
    s_waitcnt lgkmcnt(7)
    v_mfma_f32_16x16x32_bf16 v[24:27], v[112:115], v[232:235], v[24:27]
    ds_read_b128 v[112:115], v10 offset:768
    s_waitcnt lgkmcnt(7)
    v_mfma_f32_16x16x32_bf16 v[28:31], v[116:119], v[232:235], v[28:31]
    ds_read_b128 v[116:119], v10 offset:17152
    s_waitcnt lgkmcnt(7)
    v_mfma_f32_16x16x32_bf16 v[24:27], v[120:123], v[236:239], v[24:27]
    ds_read_b128 v[120:123], v11 offset:768
    s_waitcnt lgkmcnt(7)
    v_mfma_f32_16x16x32_bf16 v[28:31], v[124:127], v[236:239], v[28:31]
    ds_read_b128 v[124:127], v11 offset:17152
    s_waitcnt lgkmcnt(7)
    v_mfma_f32_16x16x32_bf16 v[24:27], v[96:99], v[240:243], v[24:27]
    s_waitcnt lgkmcnt(6)
    v_mfma_f32_16x16x32_bf16 v[28:31], v[100:103], v[240:243], v[28:31]
    s_waitcnt lgkmcnt(5)
    v_mfma_f32_16x16x32_bf16 v[24:27], v[104:107], v[244:247], v[24:27]
    s_waitcnt lgkmcnt(4)
    v_mfma_f32_16x16x32_bf16 v[28:31], v[108:111], v[244:247], v[28:31]
    s_waitcnt lgkmcnt(3)
    v_mfma_f32_16x16x32_bf16 v[24:27], v[112:115], v[248:251], v[24:27]
    s_waitcnt lgkmcnt(2)
    v_mfma_f32_16x16x32_bf16 v[28:31], v[116:119], v[248:251], v[28:31]
    s_waitcnt lgkmcnt(1)
    v_mfma_f32_16x16x32_bf16 v[24:27], v[120:123], v[252:255], v[24:27]
    s_waitcnt lgkmcnt(0)
    v_mfma_f32_16x16x32_bf16 v[28:31], v[124:127], v[252:255], v[28:31]
    s_nop 7
    s_nop 1
    v_max3_f32 v40, v24, v25, v26
    v_max3_f32 v40, v40, v27, v28
    v_max3_f32 v40, v40, v29, v30
    v_max_f32 v40, v40, v31
    v_mov_b32 v41, v40
    s_nop 1
    v_permlane32_swap_b32 v40, v41
    s_nop 1
    v_max_f32 v40, v40, v41
    v_mov_b32 v41, v40
    s_nop 1
    v_permlane16_swap_b32 v40, v41
    s_nop 1
    v_max_f32 v40, v40, v41
    ds_write_b32 v21, v40
    s_waitcnt lgkmcnt(0)
    s_barrier
    ds_read_b128 v[40:43], v22
    ds_read_b128 v[44:47], v23
    s_waitcnt lgkmcnt(1)
    v_max3_f32 v40, v40, v41, v42
    v_max3_f32 v20, v40, v43, v20
    v_sub_f32 v24, v24, v20
    v_sub_f32 v25, v25, v20
    v_sub_f32 v26, v26, v20
    v_sub_f32 v27, v27, v20
    v_sub_f32 v28, v28, v20
    v_sub_f32 v29, v29, v20
    v_sub_f32 v30, v30, v20
    v_sub_f32 v31, v31, v20
    v_exp_f32 v24, v24
    v_exp_f32 v25, v25
    v_exp_f32 v26, v26
    v_exp_f32 v27, v27
    v_exp_f32 v28, v28
    v_exp_f32 v29, v29
    v_exp_f32 v30, v30
    v_exp_f32 v31, v31
    s_waitcnt lgkmcnt(0)
    v_max3_f32 v44, v44, v45, v46
    v_max3_f32 v44, v44, v47, v18
    v_sub_f32 v32, v18, v44
    v_exp_f32 v32, v32
    v_mov_b32 v18, v44
    v_add_f32 v40, v24, v25
    v_add_f32 v40, v40, v26
    v_add_f32 v40, v40, v27
    v_add_f32 v40, v40, v28
    v_add_f32 v40, v40, v29
    v_add_f32 v40, v40, v30
    v_add_f32 v40, v40, v31
    v_cvt_pk_bf16_f32 v48, v24, v25
    v_cvt_pk_bf16_f32 v49, v26, v27
    v_cvt_pk_bf16_f32 v50, v28, v29
    v_cvt_pk_bf16_f32 v51, v30, v31
    ds_write_b64 v17, v[48:49] offset:0
    ds_write_b64 v17, v[50:51] offset:32
    v_mov_b32 v41, v40
    s_nop 1
    v_permlane32_swap_b32 v40, v41
    s_nop 1
    v_add_f32 v40, v40, v41
    v_mov_b32 v41, v40
    s_nop 1
    v_permlane16_swap_b32 v40, v41
    s_nop 1
    v_add_f32 v40, v40, v41
    ds_write_b32 v21, v40 offset:512
    s_waitcnt lgkmcnt(0)
    s_barrier
    ds_read_b128 v[40:43], v23 offset:512
    ds_read_b128 v[96:99], v16 offset:0
    ds_read_b64_tr_b16 v[100:101], v12 offset:0
    ds_read_b64_tr_b16 v[102:103], v14 offset:0
    ds_read_b64_tr_b16 v[104:105], v13 offset:0
    ds_read_b64_tr_b16 v[106:107], v15 offset:0
    ds_read_b128 v[108:111], v16 offset:32
    ds_read_b64_tr_b16 v[112:113], v12 offset:16384
    ds_read_b64_tr_b16 v[114:115], v14 offset:16384
    ds_read_b64_tr_b16 v[116:117], v13 offset:16384
    ds_read_b64_tr_b16 v[118:119], v15 offset:16384
    s_waitcnt lgkmcnt(5)
    v_mfma_f32_32x32x16_bf16 v[64:79], v[100:103], v[96:99], 0
    v_mfma_f32_32x32x16_bf16 v[80:95], v[104:107], v[96:99], 0
    ds_read_b128 v[96:99], v16 offset:64
    ds_read_b64_tr_b16 v[100:101], v12 offset:32768
    ds_read_b64_tr_b16 v[102:103], v14 offset:32768
    ds_read_b64_tr_b16 v[104:105], v13 offset:32768
    ds_read_b64_tr_b16 v[106:107], v15 offset:32768
    s_waitcnt lgkmcnt(5)
    v_mfma_f32_32x32x16_bf16 v[64:79], v[112:115], v[108:111], v[64:79]
    v_mfma_f32_32x32x16_bf16 v[80:95], v[116:119], v[108:111], v[80:95]
    ds_read_b128 v[108:111], v16 offset:96
    ds_read_b64_tr_b16 v[112:113], v12 offset:49152
    ds_read_b64_tr_b16 v[114:115], v14 offset:49152
    ds_read_b64_tr_b16 v[116:117], v13 offset:49152
    ds_read_b64_tr_b16 v[118:119], v15 offset:49152
    s_waitcnt lgkmcnt(5)
    v_mfma_f32_32x32x16_bf16 v[64:79], v[100:103], v[96:99], v[64:79]
    v_mfma_f32_32x32x16_bf16 v[80:95], v[104:107], v[96:99], v[80:95]
    v_add_u32 v12, 0x10000, v12
    v_add_u32 v13, 0x10000, v13
    v_add_u32 v14, 0x10000, v14
    v_add_u32 v15, 0x10000, v15
    ds_read_b128 v[96:99], v16 offset:128
    ds_read_b64_tr_b16 v[100:101], v12 offset:0
    ds_read_b64_tr_b16 v[102:103], v14 offset:0
    ds_read_b64_tr_b16 v[104:105], v13 offset:0
    ds_read_b64_tr_b16 v[106:107], v15 offset:0
    s_waitcnt lgkmcnt(5)
    v_mfma_f32_32x32x16_bf16 v[64:79], v[112:115], v[108:111], v[64:79]
    v_mfma_f32_32x32x16_bf16 v[80:95], v[116:119], v[108:111], v[80:95]
    ds_read_b128 v[108:111], v16 offset:160
    ds_read_b64_tr_b16 v[112:113], v12 offset:16384
    ds_read_b64_tr_b16 v[114:115], v14 offset:16384
    ds_read_b64_tr_b16 v[116:117], v13 offset:16384
    ds_read_b64_tr_b16 v[118:119], v15 offset:16384
    s_waitcnt lgkmcnt(5)
    v_mfma_f32_32x32x16_bf16 v[64:79], v[100:103], v[96:99], v[64:79]
    v_mfma_f32_32x32x16_bf16 v[80:95], v[104:107], v[96:99], v[80:95]
    ds_read_b128 v[96:99], v16 offset:192
    ds_read_b64_tr_b16 v[100:101], v12 offset:32768
    ds_read_b64_tr_b16 v[102:103], v14 offset:32768
    ds_read_b64_tr_b16 v[104:105], v13 offset:32768
    ds_read_b64_tr_b16 v[106:107], v15 offset:32768
    s_waitcnt lgkmcnt(5)
    v_mfma_f32_32x32x16_bf16 v[64:79], v[112:115], v[108:111], v[64:79]
    v_mfma_f32_32x32x16_bf16 v[80:95], v[116:119], v[108:111], v[80:95]
    ds_read_b128 v[108:111], v16 offset:224
    ds_read_b64_tr_b16 v[112:113], v12 offset:49152
    ds_read_b64_tr_b16 v[114:115], v14 offset:49152
    ds_read_b64_tr_b16 v[116:117], v13 offset:49152
    ds_read_b64_tr_b16 v[118:119], v15 offset:49152
    s_waitcnt lgkmcnt(5)
    v_mfma_f32_32x32x16_bf16 v[64:79], v[100:103], v[96:99], v[64:79]
    v_mfma_f32_32x32x16_bf16 v[80:95], v[104:107], v[96:99], v[80:95]
    s_waitcnt lgkmcnt(0)
    v_mfma_f32_32x32x16_bf16 v[64:79], v[112:115], v[108:111], v[64:79]
    v_mfma_f32_32x32x16_bf16 v[80:95], v[116:119], v[108:111], v[80:95]
    v_subrev_u32 v12, 0x10000, v12
    v_subrev_u32 v13, 0x10000, v13
    v_subrev_u32 v14, 0x10000, v14
    v_subrev_u32 v15, 0x10000, v15
    v_add_f32 v40, v40, v41
    v_add_f32 v42, v42, v43
    v_add_f32 v40, v40, v42
    v_fma_f32 v19, v19, v32, v40
    s_barrier
    s_waitcnt vmcnt(0)
    s_lshl_b32 s61, s56, 14
    v_xor_b32 v40, 0, v5
    v_add_u32 v40, s61, v40
    ds_write_b128 v40, v[128:131] offset:0
    v_xor_b32 v41, 64, v5
    v_add_u32 v41, s61, v41
    ds_write_b128 v41, v[132:135] offset:1024
    v_xor_b32 v42, 128, v5
    v_add_u32 v42, s61, v42
    ds_write_b128 v42, v[136:139] offset:2048
    v_xor_b32 v43, 192, v5
    v_add_u32 v43, s61, v43
    ds_write_b128 v43, v[140:143] offset:3072
    v_xor_b32 v40, 0, v5
    v_add_u32 v40, s61, v40
    ds_write_b128 v40, v[144:147] offset:4096
    v_xor_b32 v41, 64, v5
    v_add_u32 v41, s61, v41
    ds_write_b128 v41, v[148:151] offset:5120
    v_xor_b32 v42, 128, v5
    v_add_u32 v42, s61, v42
    ds_write_b128 v42, v[152:155] offset:6144
    v_xor_b32 v43, 192, v5
    v_add_u32 v43, s61, v43
    ds_write_b128 v43, v[156:159] offset:7168
    v_xor_b32 v40, 32, v5
    v_add_u32 v40, s61, v40
    ds_write_b128 v40, v[160:163] offset:8192
    v_xor_b32 v41, 96, v5
    v_add_u32 v41, s61, v41
    ds_write_b128 v41, v[164:167] offset:9216
    v_xor_b32 v42, 160, v5
    v_add_u32 v42, s61, v42
    ds_write_b128 v42, v[168:171] offset:10240
    v_xor_b32 v43, 224, v5
    v_add_u32 v43, s61, v43
    ds_write_b128 v43, v[172:175] offset:11264
    v_xor_b32 v40, 32, v5
    v_add_u32 v40, s61, v40
    ds_write_b128 v40, v[176:179] offset:12288
    v_xor_b32 v41, 96, v5
    v_add_u32 v41, s61, v41
    ds_write_b128 v41, v[180:183] offset:13312
    v_xor_b32 v42, 160, v5
    v_add_u32 v42, s61, v42
    ds_write_b128 v42, v[184:187] offset:14336
    v_xor_b32 v43, 224, v5
    v_add_u32 v43, s61, v43
    ds_write_b128 v43, v[188:191] offset:15360
    s_waitcnt lgkmcnt(0)
    s_barrier
    ds_read_b128 v[96:99], v8 offset:0
    ds_read_b128 v[100:103], v8 offset:16384
    ds_read_b128 v[104:107], v9 offset:0
    ds_read_b128 v[108:111], v9 offset:16384
    ds_read_b128 v[112:115], v10 offset:0
    ds_read_b128 v[116:119], v10 offset:16384
    ds_read_b128 v[120:123], v11 offset:0
    ds_read_b128 v[124:127], v11 offset:16384
    s_waitcnt lgkmcnt(7)
    v_mfma_f32_16x16x32_bf16 v[24:27], v[96:99], v[192:195], 0
    ds_read_b128 v[96:99], v8 offset:256
    s_waitcnt lgkmcnt(7)
    v_mfma_f32_16x16x32_bf16 v[28:31], v[100:103], v[192:195], 0
    ds_read_b128 v[100:103], v8 offset:16640
    s_waitcnt lgkmcnt(7)
    v_mfma_f32_16x16x32_bf16 v[24:27], v[104:107], v[196:199], v[24:27]
    ds_read_b128 v[104:107], v9 offset:256
    s_waitcnt lgkmcnt(7)
    v_mfma_f32_16x16x32_bf16 v[28:31], v[108:111], v[196:199], v[28:31]
    ds_read_b128 v[108:111], v9 offset:16640
    s_waitcnt lgkmcnt(7)
    v_mfma_f32_16x16x32_bf16 v[24:27], v[112:115], v[200:203], v[24:27]
    ds_read_b128 v[112:115], v10 offset:256
    s_waitcnt lgkmcnt(7)
    v_mfma_f32_16x16x32_bf16 v[28:31], v[116:119], v[200:203], v[28:31]
    ds_read_b128 v[116:119], v10 offset:16640
    s_waitcnt lgkmcnt(7)
    v_mfma_f32_16x16x32_bf16 v[24:27], v[120:123], v[204:207], v[24:27]
    ds_read_b128 v[120:123], v11 offset:256
    s_waitcnt lgkmcnt(7)
    v_mfma_f32_16x16x32_bf16 v[28:31], v[124:127], v[204:207], v[28:31]
    ds_read_b128 v[124:127], v11 offset:16640
    s_waitcnt lgkmcnt(7)
    v_mfma_f32_16x16x32_bf16 v[24:27], v[96:99], v[208:211], v[24:27]
    ds_read_b128 v[96:99], v8 offset:512
    s_waitcnt lgkmcnt(7)
    v_mfma_f32_16x16x32_bf16 v[28:31], v[100:103], v[208:211], v[28:31]
    ds_read_b128 v[100:103], v8 offset:16896
    s_waitcnt lgkmcnt(7)
    v_mfma_f32_16x16x32_bf16 v[24:27], v[104:107], v[212:215], v[24:27]
    ds_read_b128 v[104:107], v9 offset:512
    s_waitcnt lgkmcnt(7)
    v_mfma_f32_16x16x32_bf16 v[28:31], v[108:111], v[212:215], v[28:31]
    ds_read_b128 v[108:111], v9 offset:16896
    s_waitcnt lgkmcnt(7)
    v_mfma_f32_16x16x32_bf16 v[24:27], v[112:115], v[216:219], v[24:27]
    ds_read_b128 v[112:115], v10 offset:512
    s_waitcnt lgkmcnt(7)
    v_mfma_f32_16x16x32_bf16 v[28:31], v[116:119], v[216:219], v[28:31]
    ds_read_b128 v[116:119], v10 offset:16896
    s_waitcnt lgkmcnt(7)
    v_mfma_f32_16x16x32_bf16 v[24:27], v[120:123], v[220:223], v[24:27]
    ds_read_b128 v[120:123], v11 offset:512
    s_waitcnt lgkmcnt(7)
    v_mfma_f32_16x16x32_bf16 v[28:31], v[124:127], v[220:223], v[28:31]
    ds_read_b128 v[124:127], v11 offset:16896
    s_waitcnt lgkmcnt(7)
    v_mfma_f32_16x16x32_bf16 v[24:27], v[96:99], v[224:227], v[24:27]
    ds_read_b128 v[96:99], v8 offset:768
    s_waitcnt lgkmcnt(7)
    v_mfma_f32_16x16x32_bf16 v[28:31], v[100:103], v[224:227], v[28:31]
    ds_read_b128 v[100:103], v8 offset:17152
    s_waitcnt lgkmcnt(7)
    v_mfma_f32_16x16x32_bf16 v[24:27], v[104:107], v[228:231], v[24:27]
    ds_read_b128 v[104:107], v9 offset:768
    s_waitcnt lgkmcnt(7)
    v_mfma_f32_16x16x32_bf16 v[28:31], v[108:111], v[228:231], v[28:31]
    ds_read_b128 v[108:111], v9 offset:17152
    s_waitcnt lgkmcnt(7)
    v_mfma_f32_16x16x32_bf16 v[24:27], v[112:115], v[232:235], v[24:27]
    ds_read_b128 v[112:115], v10 offset:768
    s_waitcnt lgkmcnt(7)
    v_mfma_f32_16x16x32_bf16 v[28:31], v[116:119], v[232:235], v[28:31]
    ds_read_b128 v[116:119], v10 offset:17152
    s_waitcnt lgkmcnt(7)
    v_mfma_f32_16x16x32_bf16 v[24:27], v[120:123], v[236:239], v[24:27]
    ds_read_b128 v[120:123], v11 offset:768
    s_waitcnt lgkmcnt(7)
    v_mfma_f32_16x16x32_bf16 v[28:31], v[124:127], v[236:239], v[28:31]
    ds_read_b128 v[124:127], v11 offset:17152
    s_waitcnt lgkmcnt(7)
    v_mfma_f32_16x16x32_bf16 v[24:27], v[96:99], v[240:243], v[24:27]
    s_waitcnt lgkmcnt(6)
    v_mfma_f32_16x16x32_bf16 v[28:31], v[100:103], v[240:243], v[28:31]
    s_waitcnt lgkmcnt(5)
    v_mfma_f32_16x16x32_bf16 v[24:27], v[104:107], v[244:247], v[24:27]
    s_waitcnt lgkmcnt(4)
    v_mfma_f32_16x16x32_bf16 v[28:31], v[108:111], v[244:247], v[28:31]
    s_waitcnt lgkmcnt(3)
    v_mfma_f32_16x16x32_bf16 v[24:27], v[112:115], v[248:251], v[24:27]
    s_waitcnt lgkmcnt(2)
    v_mfma_f32_16x16x32_bf16 v[28:31], v[116:119], v[248:251], v[28:31]
    s_waitcnt lgkmcnt(1)
    v_mfma_f32_16x16x32_bf16 v[24:27], v[120:123], v[252:255], v[24:27]
    s_waitcnt lgkmcnt(0)
    v_mfma_f32_16x16x32_bf16 v[28:31], v[124:127], v[252:255], v[28:31]
    s_nop 7
    s_nop 1
    v_max3_f32 v40, v24, v25, v26
    v_max3_f32 v40, v40, v27, v28
    v_max3_f32 v40, v40, v29, v30
    v_max_f32 v40, v40, v31
    v_mov_b32 v41, v40
    s_nop 1
    v_permlane32_swap_b32 v40, v41
    s_nop 1
    v_max_f32 v40, v40, v41
    v_mov_b32 v41, v40
    s_nop 1
    v_permlane16_swap_b32 v40, v41
    s_nop 1
    v_max_f32 v40, v40, v41
    ds_write_b32 v21, v40
    s_waitcnt lgkmcnt(0)
    s_barrier
    ds_read_b128 v[40:43], v22
    ds_read_b128 v[44:47], v23
    s_waitcnt lgkmcnt(1)
    v_max3_f32 v40, v40, v41, v42
    v_max3_f32 v20, v40, v43, v20
    v_sub_f32 v24, v24, v20
    v_sub_f32 v25, v25, v20
    v_sub_f32 v26, v26, v20
    v_sub_f32 v27, v27, v20
    v_sub_f32 v28, v28, v20
    v_sub_f32 v29, v29, v20
    v_sub_f32 v30, v30, v20
    v_sub_f32 v31, v31, v20
    v_exp_f32 v24, v24
    v_exp_f32 v25, v25
    v_exp_f32 v26, v26
    v_exp_f32 v27, v27
    v_exp_f32 v28, v28
    v_exp_f32 v29, v29
    v_exp_f32 v30, v30
    v_exp_f32 v31, v31
    s_waitcnt lgkmcnt(0)
    v_max3_f32 v44, v44, v45, v46
    v_max3_f32 v44, v44, v47, v18
    v_sub_f32 v32, v18, v44
    v_exp_f32 v32, v32
    v_mov_b32 v18, v44
    v_add_f32 v40, v24, v25
    v_add_f32 v40, v40, v26
    v_add_f32 v40, v40, v27
    v_add_f32 v40, v40, v28
    v_add_f32 v40, v40, v29
    v_add_f32 v40, v40, v30
    v_add_f32 v40, v40, v31
    v_cvt_pk_bf16_f32 v48, v24, v25
    v_cvt_pk_bf16_f32 v49, v26, v27
    v_cvt_pk_bf16_f32 v50, v28, v29
    v_cvt_pk_bf16_f32 v51, v30, v31
    ds_write_b64 v17, v[48:49] offset:0
    ds_write_b64 v17, v[50:51] offset:32
    v_mov_b32 v41, v40
    s_nop 1
    v_permlane32_swap_b32 v40, v41
    s_nop 1
    v_add_f32 v40, v40, v41
    v_mov_b32 v41, v40
    s_nop 1
    v_permlane16_swap_b32 v40, v41
    s_nop 1
    v_add_f32 v40, v40, v41
    ds_write_b32 v21, v40 offset:512
    s_waitcnt lgkmcnt(0)
    s_barrier
    ds_read_b128 v[40:43], v23 offset:512
    v_mul_f32 v64, v64, v32
    v_mul_f32 v65, v65, v32
    v_mul_f32 v66, v66, v32
    v_mul_f32 v67, v67, v32
    v_mul_f32 v68, v68, v32
    v_mul_f32 v69, v69, v32
    v_mul_f32 v70, v70, v32
    v_mul_f32 v71, v71, v32
    v_mul_f32 v72, v72, v32
    v_mul_f32 v73, v73, v32
    v_mul_f32 v74, v74, v32
    v_mul_f32 v75, v75, v32
    v_mul_f32 v76, v76, v32
    v_mul_f32 v77, v77, v32
    v_mul_f32 v78, v78, v32
    v_mul_f32 v79, v79, v32
    v_mul_f32 v80, v80, v32
    v_mul_f32 v81, v81, v32
    v_mul_f32 v82, v82, v32
    v_mul_f32 v83, v83, v32
    v_mul_f32 v84, v84, v32
    v_mul_f32 v85, v85, v32
    v_mul_f32 v86, v86, v32
    v_mul_f32 v87, v87, v32
    v_mul_f32 v88, v88, v32
    v_mul_f32 v89, v89, v32
    v_mul_f32 v90, v90, v32
    v_mul_f32 v91, v91, v32
    v_mul_f32 v92, v92, v32
    v_mul_f32 v93, v93, v32
    v_mul_f32 v94, v94, v32
    v_mul_f32 v95, v95, v32
    ds_read_b128 v[96:99], v16 offset:0
    ds_read_b64_tr_b16 v[100:101], v12 offset:0
    ds_read_b64_tr_b16 v[102:103], v14 offset:0
    ds_read_b64_tr_b16 v[104:105], v13 offset:0
    ds_read_b64_tr_b16 v[106:107], v15 offset:0
    ds_read_b128 v[108:111], v16 offset:32
    ds_read_b64_tr_b16 v[112:113], v12 offset:16384
    ds_read_b64_tr_b16 v[114:115], v14 offset:16384
    ds_read_b64_tr_b16 v[116:117], v13 offset:16384
    ds_read_b64_tr_b16 v[118:119], v15 offset:16384
    s_waitcnt lgkmcnt(5)
    v_mfma_f32_32x32x16_bf16 v[64:79], v[100:103], v[96:99], v[64:79]
    v_mfma_f32_32x32x16_bf16 v[80:95], v[104:107], v[96:99], v[80:95]
    ds_read_b128 v[96:99], v16 offset:64
    ds_read_b64_tr_b16 v[100:101], v12 offset:32768
    ds_read_b64_tr_b16 v[102:103], v14 offset:32768
    ds_read_b64_tr_b16 v[104:105], v13 offset:32768
    ds_read_b64_tr_b16 v[106:107], v15 offset:32768
    s_waitcnt lgkmcnt(5)
    v_mfma_f32_32x32x16_bf16 v[64:79], v[112:115], v[108:111], v[64:79]
    v_mfma_f32_32x32x16_bf16 v[80:95], v[116:119], v[108:111], v[80:95]
    ds_read_b128 v[108:111], v16 offset:96
    ds_read_b64_tr_b16 v[112:113], v12 offset:49152
    ds_read_b64_tr_b16 v[114:115], v14 offset:49152
    ds_read_b64_tr_b16 v[116:117], v13 offset:49152
    ds_read_b64_tr_b16 v[118:119], v15 offset:49152
    s_waitcnt lgkmcnt(5)
    v_mfma_f32_32x32x16_bf16 v[64:79], v[100:103], v[96:99], v[64:79]
    v_mfma_f32_32x32x16_bf16 v[80:95], v[104:107], v[96:99], v[80:95]
    v_add_u32 v12, 0x10000, v12
    v_add_u32 v13, 0x10000, v13
    v_add_u32 v14, 0x10000, v14
    v_add_u32 v15, 0x10000, v15
    ds_read_b128 v[96:99], v16 offset:128
    ds_read_b64_tr_b16 v[100:101], v12 offset:0
    ds_read_b64_tr_b16 v[102:103], v14 offset:0
    ds_read_b64_tr_b16 v[104:105], v13 offset:0
    ds_read_b64_tr_b16 v[106:107], v15 offset:0
    s_waitcnt lgkmcnt(5)
    v_mfma_f32_32x32x16_bf16 v[64:79], v[112:115], v[108:111], v[64:79]
    v_mfma_f32_32x32x16_bf16 v[80:95], v[116:119], v[108:111], v[80:95]
    ds_read_b128 v[108:111], v16 offset:160
    ds_read_b64_tr_b16 v[112:113], v12 offset:16384
    ds_read_b64_tr_b16 v[114:115], v14 offset:16384
    ds_read_b64_tr_b16 v[116:117], v13 offset:16384
    ds_read_b64_tr_b16 v[118:119], v15 offset:16384
    s_waitcnt lgkmcnt(5)
    v_mfma_f32_32x32x16_bf16 v[64:79], v[100:103], v[96:99], v[64:79]
    v_mfma_f32_32x32x16_bf16 v[80:95], v[104:107], v[96:99], v[80:95]
    ds_read_b128 v[96:99], v16 offset:192
    ds_read_b64_tr_b16 v[100:101], v12 offset:32768
    ds_read_b64_tr_b16 v[102:103], v14 offset:32768
    ds_read_b64_tr_b16 v[104:105], v13 offset:32768
    ds_read_b64_tr_b16 v[106:107], v15 offset:32768
    s_waitcnt lgkmcnt(5)
    v_mfma_f32_32x32x16_bf16 v[64:79], v[112:115], v[108:111], v[64:79]
    v_mfma_f32_32x32x16_bf16 v[80:95], v[116:119], v[108:111], v[80:95]
    ds_read_b128 v[108:111], v16 offset:224
    ds_read_b64_tr_b16 v[112:113], v12 offset:49152
    ds_read_b64_tr_b16 v[114:115], v14 offset:49152
    ds_read_b64_tr_b16 v[116:117], v13 offset:49152
    ds_read_b64_tr_b16 v[118:119], v15 offset:49152
    s_waitcnt lgkmcnt(5)
    v_mfma_f32_32x32x16_bf16 v[64:79], v[100:103], v[96:99], v[64:79]
    v_mfma_f32_32x32x16_bf16 v[80:95], v[104:107], v[96:99], v[80:95]
    s_waitcnt lgkmcnt(0)
    v_mfma_f32_32x32x16_bf16 v[64:79], v[112:115], v[108:111], v[64:79]
    v_mfma_f32_32x32x16_bf16 v[80:95], v[116:119], v[108:111], v[80:95]
    v_subrev_u32 v12, 0x10000, v12
    v_subrev_u32 v13, 0x10000, v13
    v_subrev_u32 v14, 0x10000, v14
    v_subrev_u32 v15, 0x10000, v15
    v_add_f32 v40, v40, v41
    v_add_f32 v42, v42, v43
    v_add_f32 v40, v40, v42
    v_fma_f32 v19, v19, v32, v40
    s_barrier
    s_nop 7
    s_nop 3
    v_and_b32 v43, 31, v1
    v_lshrrev_b32 v44, 5, v1
    v_mul_u32_u24 v40, 1040, v43
    v_lshl_add_u32 v40, v44, 3, v40
    s_lshl_b32 s61, s56, 7
    v_add_u32 v40, s61, v40
    v_cvt_pk_bf16_f32 v64, v64, v65
    v_cvt_pk_bf16_f32 v65, v66, v67
    ds_write_b64 v40, v[64:65] offset:0
    v_cvt_pk_bf16_f32 v68, v68, v69
    v_cvt_pk_bf16_f32 v69, v70, v71
    ds_write_b64 v40, v[68:69] offset:16
    v_cvt_pk_bf16_f32 v72, v72, v73
    v_cvt_pk_bf16_f32 v73, v74, v75
    ds_write_b64 v40, v[72:73] offset:32
    v_cvt_pk_bf16_f32 v76, v76, v77
    v_cvt_pk_bf16_f32 v77, v78, v79
    ds_write_b64 v40, v[76:77] offset:48
    v_cvt_pk_bf16_f32 v80, v80, v81
    v_cvt_pk_bf16_f32 v81, v82, v83
    ds_write_b64 v40, v[80:81] offset:64
    v_cvt_pk_bf16_f32 v84, v84, v85
    v_cvt_pk_bf16_f32 v85, v86, v87
    ds_write_b64 v40, v[84:85] offset:80
    v_cvt_pk_bf16_f32 v88, v88, v89
    v_cvt_pk_bf16_f32 v89, v90, v91
    ds_write_b64 v40, v[88:89] offset:96
    v_cvt_pk_bf16_f32 v92, v92, v93
    v_cvt_pk_bf16_f32 v93, v94, v95
    ds_write_b64 v40, v[92:93] offset:112
    v_mov_b32 v46, v18
    v_mov_b32 v47, v19
    v_lshlrev_b32 v45, 8, v43
    s_lshl_b32 s62, s65, 3
    s_add_u32 s62, s62, 1245184
    s_cmp_lg_u32 s56, 0
    s_cbranch_scc1 Lml_65
    s_mov_b64 exec, 0xffffffff
    buffer_store_dwordx2 v[46:47], v45, s[32:35], s62 offen sc0 sc1
    s_mov_b64 exec, -1
Lml_65:
    s_waitcnt lgkmcnt(0)
    s_barrier
    s_mul_i32 s61, s56, 4160
    v_add_u32 v40, s61, v5
    ds_read_b128 v[96:99], v40 offset:0
    ds_read_b128 v[100:103], v40 offset:1040
    ds_read_b128 v[104:107], v40 offset:2080
    ds_read_b128 v[108:111], v40 offset:3120
    s_lshl_b32 s61, s65, 15
    s_lshl_b32 s62, s56, 12
    s_add_u32 s61, s61, s62
    s_add_u32 s61, s61, 2097152
    s_waitcnt lgkmcnt(3)
    buffer_store_dwordx4 v[96:99], v5, s[32:35], s61 offen offset:0 sc0 sc1
    s_waitcnt lgkmcnt(2)
    buffer_store_dwordx4 v[100:103], v5, s[32:35], s61 offen offset:1024 sc0 sc1
    s_waitcnt lgkmcnt(1)
    buffer_store_dwordx4 v[104:107], v5, s[32:35], s61 offen offset:2048 sc0 sc1
    s_waitcnt lgkmcnt(0)
    buffer_store_dwordx4 v[108:111], v5, s[32:35], s61 offen offset:3072 sc0 sc1
    s_waitcnt vmcnt(0)
    s_barrier
    s_cmp_lg_u32 s56, 0
    s_cbranch_scc1 Lpf_66
    v_lshlrev_b32 v40, 14, v1
    v_mov_b32 v41, 0
    s_lshl_b32 s61, s65, 2
    s_add_u32 s61, s61, 0
    s_mov_b64 exec, 0xffffffff
    buffer_store_dword v41, v40, s[32:35], s61 offen sc0 sc1
    s_mov_b64 exec, -1
Lpf_66:
    s_mov_b32 s36, s24
    s_mov_b32 s37, s25
    s_and_b32 s37, s37, 0xffff
    s_mov_b32 s38, 4194304
    s_mov_b32 s39, 0x00020000
    s_lshl_b32 s61, s56, 14
    s_lshl_b32 s62, s65, 17
    s_add_u32 s62, s62, s61
    s_add_u32 m0, s61, 0
    v_xor_b32 v52, 0, v5
    buffer_load_dwordx4 v52, s[36:39], s62 offen nt lds
    s_add_u32 s62, s62, 1024
    s_add_u32 m0, s61, 1024
    v_xor_b32 v53, 64, v5
    buffer_load_dwordx4 v53, s[36:39], s62 offen nt lds
    s_add_u32 s62, s62, 1024
    s_add_u32 m0, s61, 2048
    v_xor_b32 v52, 128, v5
    buffer_load_dwordx4 v52, s[36:39], s62 offen nt lds
    s_add_u32 s62, s62, 1024
    s_add_u32 m0, s61, 3072
    v_xor_b32 v53, 192, v5
    buffer_load_dwordx4 v53, s[36:39], s62 offen nt lds
    s_add_u32 s62, s62, 1024
    s_add_u32 m0, s61, 4096
    v_xor_b32 v52, 0, v5
    buffer_load_dwordx4 v52, s[36:39], s62 offen nt lds
    s_add_u32 s62, s62, 1024
    s_add_u32 m0, s61, 5120
    v_xor_b32 v53, 64, v5
    buffer_load_dwordx4 v53, s[36:39], s62 offen nt lds
    s_add_u32 s62, s62, 1024
    s_add_u32 m0, s61, 6144
    v_xor_b32 v52, 128, v5
    buffer_load_dwordx4 v52, s[36:39], s62 offen nt lds
    s_add_u32 s62, s62, 1024
    s_add_u32 m0, s61, 7168
    v_xor_b32 v53, 192, v5
    buffer_load_dwordx4 v53, s[36:39], s62 offen nt lds
    s_add_u32 s62, s62, 1024
    s_add_u32 m0, s61, 8192
    v_xor_b32 v52, 32, v5
    buffer_load_dwordx4 v52, s[36:39], s62 offen nt lds
    s_add_u32 s62, s62, 1024
    s_add_u32 m0, s61, 9216
    v_xor_b32 v53, 96, v5
    buffer_load_dwordx4 v53, s[36:39], s62 offen nt lds
    s_add_u32 s62, s62, 1024
    s_add_u32 m0, s61, 10240
    v_xor_b32 v52, 160, v5
    buffer_load_dwordx4 v52, s[36:39], s62 offen nt lds
    s_add_u32 s62, s62, 1024
    s_add_u32 m0, s61, 11264
    v_xor_b32 v53, 224, v5
    buffer_load_dwordx4 v53, s[36:39], s62 offen nt lds
    s_add_u32 s62, s62, 1024
    s_add_u32 m0, s61, 12288
    v_xor_b32 v52, 32, v5
    buffer_load_dwordx4 v52, s[36:39], s62 offen nt lds
    s_add_u32 s62, s62, 1024
    s_add_u32 m0, s61, 13312
    v_xor_b32 v53, 96, v5
    buffer_load_dwordx4 v53, s[36:39], s62 offen nt lds
    s_add_u32 s62, s62, 1024
    s_add_u32 m0, s61, 14336
    v_xor_b32 v52, 160, v5
    buffer_load_dwordx4 v52, s[36:39], s62 offen nt lds
    s_add_u32 s62, s62, 1024
    s_add_u32 m0, s61, 15360
    v_xor_b32 v53, 224, v5
    buffer_load_dwordx4 v53, s[36:39], s62 offen nt lds
    s_waitcnt vmcnt(0)
    s_barrier
    v_lshrrev_b32 v40, 2, v3
    v_and_b32 v41, 1, v2
    v_lshlrev_b32 v42, 2, v40
    v_lshl_or_b32 v42, v41, 1, v42
    v_lshl_add_u32 v43, v2, 3, v40
    v_lshlrev_b32 v43, 10, v43
    v_and_b32 v44, 1, v3
    v_lshl_add_u32 v43, v44, 3, v43
    v_bfe_u32 v44, v3, 1, 1
    s_lshl_b32 s61, s56, 3
    s_add_u32 s62, s61, 0
    v_add_u32 v45, s62, v44
    v_xor_b32 v45, v45, v42
    v_lshl_add_u32 v48, v45, 4, v43
    s_add_u32 s62, s61, 2
    v_add_u32 v45, s62, v44
    v_xor_b32 v45, v45, v42
    v_lshl_add_u32 v49, v45, 4, v43
    s_add_u32 s62, s61, 4
    v_add_u32 v45, s62, v44
    v_xor_b32 v45, v45, v42
    v_lshl_add_u32 v50, v45, 4, v43
    s_add_u32 s62, s61, 6
    v_add_u32 v45, s62, v44
    v_xor_b32 v45, v45, v42
    v_lshl_add_u32 v51, v45, 4, v43
    ds_read_b64_tr_b16 v[128:129], v48 offset:0
    ds_read_b64_tr_b16 v[130:131], v48 offset:4096
    ds_read_b64_tr_b16 v[144:145], v49 offset:0
    ds_read_b64_tr_b16 v[146:147], v49 offset:4096
    ds_read_b64_tr_b16 v[160:161], v50 offset:0
    ds_read_b64_tr_b16 v[162:163], v50 offset:4096
    ds_read_b64_tr_b16 v[176:177], v51 offset:0
    ds_read_b64_tr_b16 v[178:179], v51 offset:4096
    s_waitcnt lgkmcnt(0)
    ds_read_b64_tr_b16 v[132:133], v48 offset:32768
    ds_read_b64_tr_b16 v[134:135], v48 offset:36864
    ds_read_b64_tr_b16 v[148:149], v49 offset:32768
    ds_read_b64_tr_b16 v[150:151], v49 offset:36864
    ds_read_b64_tr_b16 v[164:165], v50 offset:32768
    ds_read_b64_tr_b16 v[166:167], v50 offset:36864
    ds_read_b64_tr_b16 v[180:181], v51 offset:32768
    ds_read_b64_tr_b16 v[182:183], v51 offset:36864
    s_waitcnt lgkmcnt(0)
    v_add_u32 v48, 0x10000, v48
    v_add_u32 v49, 0x10000, v49
    v_add_u32 v50, 0x10000, v50
    v_add_u32 v51, 0x10000, v51
    ds_read_b64_tr_b16 v[136:137], v48 offset:0
    ds_read_b64_tr_b16 v[138:139], v48 offset:4096
    ds_read_b64_tr_b16 v[152:153], v49 offset:0
    ds_read_b64_tr_b16 v[154:155], v49 offset:4096
    ds_read_b64_tr_b16 v[168:169], v50 offset:0
    ds_read_b64_tr_b16 v[170:171], v50 offset:4096
    ds_read_b64_tr_b16 v[184:185], v51 offset:0
    ds_read_b64_tr_b16 v[186:187], v51 offset:4096
    s_waitcnt lgkmcnt(0)
    ds_read_b64_tr_b16 v[140:141], v48 offset:32768
    ds_read_b64_tr_b16 v[142:143], v48 offset:36864
    ds_read_b64_tr_b16 v[156:157], v49 offset:32768
    ds_read_b64_tr_b16 v[158:159], v49 offset:36864
    ds_read_b64_tr_b16 v[172:173], v50 offset:32768
    ds_read_b64_tr_b16 v[174:175], v50 offset:36864
    ds_read_b64_tr_b16 v[188:189], v51 offset:32768
    ds_read_b64_tr_b16 v[190:191], v51 offset:36864
    s_waitcnt lgkmcnt(0)
L_t2_head:
    v_lshrrev_b32 v40, 5, v1
    v_lshlrev_b32 v41, 12, v40
    v_and_b32 v42, 31, v1
    v_lshl_add_u32 v41, v42, 4, v41
    v_add_u32 v41, 512, v41
    v_lshlrev_b32 v43, 7, v40
    s_lshl_b32 s61, s56, 9
    s_add_u32 s61, s61, 131072
    v_lshlrev_b32 v46, 3, v1
    v_add_u32 v46, s61, v46
    v_and_b32 v47, 1, v3
    v_lshlrev_b32 v47, 8, v47
    v_lshl_add_u32 v47, v2, 4, v47
    v_add_u32 v47, s61, v47
    s_mov_b32 s70, 1040356334
    v_lshlrev_b32 v48, 4, v1
    v_add_u32 v48, 135168, v48
    v_lshlrev_b32 v49, 3, v40
    v_add_u32 v49, 143360, v49
    s_cmp_ge_u32 s56, 6
    s_cbranch_scc1 Lhnp_67
    s_mov_b32 s62, s56
    s_lshl_b32 s63, s62, 9
    s_add_u32 s63, s63, s93
    s_lshl_b32 s64, s62, 4
    s_add_u32 s64, s64, s93
    s_mov_b32 s92, 0
Lpoll_68:
    buffer_load_dwordx4 v[64:67], v41, s[32:35], s63 offen sc0 sc1
    buffer_load_dwordx2 v[68:69], v43, s[32:35], s64 offen offset:128 sc0 sc1
    s_waitcnt vmcnt(0)
    v_mov_b32 v45, v64
    v_max3_u32 v45, v45, v65, v66
    v_max3_u32 v45, v45, v67, v68
    v_max_u32 v45, v45, v69
    v_cmpx_eq_u32 vcc, -1, v45
    s_cbranch_execz Lpolld_69
    s_sleep 1
    s_add_u32 s92, s92, 1
    s_cmp_lt_u32 s92, 400000
    s_cbranch_scc1 Lpoll_68
Lpolld_69:
    s_mov_b64 exec, -1
    s_lshl_b32 s62, s56, 10
    v_add_u32 v44, s62, v48
    ds_write_b128 v44, v[64:67]
    s_lshl_b32 s62, s56, 4
    v_add_u32 v44, s62, v49
    ds_write_b64 v44, v[68:69]
    s_waitcnt lgkmcnt(0)
Lhnp_67:
    s_barrier
    ds_read_b64 v[88:89], v49 offset:0
    ds_read_b64 v[90:91], v49 offset:16
    ds_read_b64 v[92:93], v49 offset:32
    ds_read_b64 v[94:95], v49 offset:48
    ds_read_b64 v[96:97], v49 offset:64
    ds_read_b64 v[98:99], v49 offset:80
    ds_read_b128 v[64:67], v48 offset:0
    ds_read_b128 v[68:71], v48 offset:1024
    ds_read_b128 v[72:75], v48 offset:2048
    ds_read_b128 v[76:79], v48 offset:3072
    ds_read_b128 v[80:83], v48 offset:4096
    ds_read_b128 v[84:87], v48 offset:5120
    s_waitcnt lgkmcnt(6)
    v_max3_f32 v45, v88, v90, v92
    v_max3_f32 v45, v45, v94, v96
    v_max_f32 v45, v45, v98
    v_mul_f32 v44, s70, v45
    v_fma_f32 v88, v88, s70, -v44
    v_fma_f32 v90, v90, s70, -v44
    v_fma_f32 v92, v92, s70, -v44
    v_fma_f32 v94, v94, s70, -v44
    v_fma_f32 v96, v96, s70, -v44
    v_fma_f32 v98, v98, s70, -v44
    v_exp_f32 v88, v88
    v_exp_f32 v90, v90
    v_exp_f32 v92, v92
    v_exp_f32 v94, v94
    v_exp_f32 v96, v96
    v_exp_f32 v98, v98
    s_nop 0
    v_mul_f32 v45, v88, v89
    v_fmac_f32 v45, v90, v91
    v_fmac_f32 v45, v92, v93
    v_fmac_f32 v45, v94, v95
    v_fmac_f32 v45, v96, v97
    v_fmac_f32 v45, v98, v99
    v_rcp_f32 v45, v45
    s_waitcnt lgkmcnt(0)
    v_mul_f32 v64, v64, v88
    v_mul_f32 v65, v65, v88
    v_mul_f32 v66, v66, v88
    v_mul_f32 v67, v67, v88
    v_fmac_f32 v64, v68, v90
    v_fmac_f32 v65, v69, v90
    v_fmac_f32 v66, v70, v90
    v_fmac_f32 v67, v71, v90
    v_fmac_f32 v64, v72, v92
    v_fmac_f32 v65, v73, v92
    v_fmac_f32 v66, v74, v92
    v_fmac_f32 v67, v75, v92
    v_fmac_f32 v64, v76, v94
    v_fmac_f32 v65, v77, v94
    v_fmac_f32 v66, v78, v94
    v_fmac_f32 v67, v79, v94
    v_fmac_f32 v64, v80, v96
    v_fmac_f32 v65, v81, v96
    v_fmac_f32 v66, v82, v96
    v_fmac_f32 v67, v83, v96
    v_fmac_f32 v64, v84, v98
    v_fmac_f32 v65, v85, v98
    v_fmac_f32 v66, v86, v98
    v_fmac_f32 v67, v87, v98
    v_mul_f32 v64, v64, v45
    v_mul_f32 v65, v65, v45
    v_mul_f32 v66, v66, v45
    v_mul_f32 v67, v67, v45
    v_cvt_pk_bf16_f32 v64, v64, v65
    v_cvt_pk_bf16_f32 v65, v66, v67
    ds_write_b64 v46, v[64:65]
    s_waitcnt lgkmcnt(0)
    ds_read_b128 v[24:27], v47 offset:0
    ds_read_b128 v[28:31], v47 offset:64
    ds_read_b128 v[32:35], v47 offset:128
    ds_read_b128 v[36:39], v47 offset:192
    v_and_b32 v40, 1, v1
    v_lshlrev_b32 v40, 19, v40
    v_lshl_add_u32 v40, v2, 4, v40
    s_lshl_b32 s61, s56, 16
    s_lshl_b32 s62, s65, 6
    s_add_u32 s61, s61, s62
    s_add_u32 s61, s61, 8704
    s_waitcnt lgkmcnt(3)
    v_mfma_f32_16x16x32_bf16 v[8:11], v[128:131], v[24:27], 0
    v_mfma_f32_16x16x32_bf16 v[12:15], v[144:147], v[24:27], 0
    v_mfma_f32_16x16x32_bf16 v[16:19], v[160:163], v[24:27], 0
    v_mfma_f32_16x16x32_bf16 v[20:23], v[176:179], v[24:27], 0
    s_waitcnt lgkmcnt(2)
    v_mfma_f32_16x16x32_bf16 v[8:11], v[132:135], v[28:31], v[8:11]
    v_mfma_f32_16x16x32_bf16 v[12:15], v[148:151], v[28:31], v[12:15]
    v_mfma_f32_16x16x32_bf16 v[16:19], v[164:167], v[28:31], v[16:19]
    v_mfma_f32_16x16x32_bf16 v[20:23], v[180:183], v[28:31], v[20:23]
    s_waitcnt lgkmcnt(1)
    v_mfma_f32_16x16x32_bf16 v[8:11], v[136:139], v[32:35], v[8:11]
    v_mfma_f32_16x16x32_bf16 v[12:15], v[152:155], v[32:35], v[12:15]
    v_mfma_f32_16x16x32_bf16 v[16:19], v[168:171], v[32:35], v[16:19]
    v_mfma_f32_16x16x32_bf16 v[20:23], v[184:187], v[32:35], v[20:23]
    s_waitcnt lgkmcnt(0)
    v_mfma_f32_16x16x32_bf16 v[8:11], v[140:143], v[36:39], v[8:11]
    v_mfma_f32_16x16x32_bf16 v[12:15], v[156:159], v[36:39], v[12:15]
    v_mfma_f32_16x16x32_bf16 v[16:19], v[172:175], v[36:39], v[16:19]
    v_mfma_f32_16x16x32_bf16 v[20:23], v[188:191], v[36:39], v[20:23]
    s_mov_b32 exec_lo, 0x00030003
    s_mov_b32 exec_hi, 0x00030003
    s_nop 2
    s_nop 1
    buffer_store_dwordx4 v[8:11], v40, s[32:35], s61 offen sc0 sc1
    s_add_u32 s61, s61, 16384
    buffer_store_dwordx4 v[12:15], v40, s[32:35], s61 offen sc0 sc1
    s_add_u32 s61, s61, 16384
    buffer_store_dwordx4 v[16:19], v40, s[32:35], s61 offen sc0 sc1
    s_add_u32 s61, s61, 16384
    s_nop 3
    buffer_store_dwordx4 v[20:23], v40, s[32:35], s61 offen sc0 sc1
    s_mov_b64 exec, -1
    s_branch L_final
L_roleT1:
    s_mov_b32 s65, s75
    s_mov_b32 s44, s10
    s_mov_b32 s45, s11
    s_and_b32 s45, s45, 0xffff
    s_mov_b32 s46, 4194304
    s_mov_b32 s47, 0x00020000
    s_cmp_eq_u32 s56, 7
    s_cbranch_scc1 Lt1s_70
    s_lshl_b32 s85, s56, 19
    s_lshl_b32 s86, s65, 8
    s_add_u32 s85, s85, s86
    buffer_load_dwordx4 v[128:131], v4, s[44:47], s85 offen nt
    s_add_u32 s85, s85, 8192
    buffer_load_dwordx4 v[132:135], v4, s[44:47], s85 offen nt
    s_add_u32 s85, s85, 8192
    buffer_load_dwordx4 v[136:139], v4, s[44:47], s85 offen nt
    s_add_u32 s85, s85, 8192
    buffer_load_dwordx4 v[140:143], v4, s[44:47], s85 offen nt
    s_add_u32 s85, s85, 8192
    s_waitcnt vmcnt(4)
    v_perm_b32 v232, v196, v192, s68
    v_perm_b32 v233, v196, v192, s69
    v_perm_b32 v234, v197, v193, s68
    v_perm_b32 v235, v197, v193, s69
    v_perm_b32 v236, v198, v194, s68
    v_perm_b32 v237, v198, v194, s69
    v_perm_b32 v238, v199, v195, s68
    v_perm_b32 v239, v199, v195, s69
    v_dot2_f32_bf16 v212, v232, v208, 0
    v_dot2_f32_bf16 v213, v233, v208, 0
    v_dot2_f32_bf16 v214, v234, v208, 0
    v_dot2_f32_bf16 v215, v235, v208, 0
    v_dot2_f32_bf16 v216, v236, v208, 0
    v_dot2_f32_bf16 v217, v237, v208, 0
    v_dot2_f32_bf16 v218, v238, v208, 0
    v_dot2_f32_bf16 v219, v239, v208, 0
    v_dot2_f32_bf16 v220, v232, v210, 0
    v_dot2_f32_bf16 v221, v233, v210, 0
    v_dot2_f32_bf16 v222, v234, v210, 0
    v_dot2_f32_bf16 v223, v235, v210, 0
    v_dot2_f32_bf16 v224, v236, v210, 0
    v_dot2_f32_bf16 v225, v237, v210, 0
    v_dot2_f32_bf16 v226, v238, v210, 0
    v_dot2_f32_bf16 v227, v239, v210, 0
    v_perm_b32 v232, v204, v200, s68
    v_perm_b32 v233, v204, v200, s69
    v_perm_b32 v234, v205, v201, s68
    v_perm_b32 v235, v205, v201, s69
    v_perm_b32 v236, v206, v202, s68
    v_perm_b32 v237, v206, v202, s69
    v_perm_b32 v238, v207, v203, s68
    v_perm_b32 v239, v207, v203, s69
    v_dot2_f32_bf16 v212, v232, v209, v212
    v_dot2_f32_bf16 v213, v233, v209, v213
    v_dot2_f32_bf16 v214, v234, v209, v214
    v_dot2_f32_bf16 v215, v235, v209, v215
    v_dot2_f32_bf16 v216, v236, v209, v216
    v_dot2_f32_bf16 v217, v237, v209, v217
    v_dot2_f32_bf16 v218, v238, v209, v218
    v_dot2_f32_bf16 v219, v239, v209, v219
    v_dot2_f32_bf16 v220, v232, v211, v220
    v_dot2_f32_bf16 v221, v233, v211, v221
    v_dot2_f32_bf16 v222, v234, v211, v222
    v_dot2_f32_bf16 v223, v235, v211, v223
    v_dot2_f32_bf16 v224, v236, v211, v224
    v_dot2_f32_bf16 v225, v237, v211, v225
    v_dot2_f32_bf16 v226, v238, v211, v226
    v_dot2_f32_bf16 v227, v239, v211, v227
    s_nop 2
    v_permlane32_swap_b32 v212, v220
    v_permlane32_swap_b32 v213, v221
    v_permlane32_swap_b32 v214, v222
    v_permlane32_swap_b32 v215, v223
    v_permlane32_swap_b32 v216, v224
    v_permlane32_swap_b32 v217, v225
    v_permlane32_swap_b32 v218, v226
    v_permlane32_swap_b32 v219, v227
    s_nop 1
    v_add_f32 v212, v212, v220
    v_add_f32 v213, v213, v221
    v_add_f32 v214, v214, v222
    v_add_f32 v215, v215, v223
    v_add_f32 v216, v216, v224
    v_add_f32 v217, v217, v225
    v_add_f32 v218, v218, v226
    v_add_f32 v219, v219, v227
    s_nop 1
    v_permlane16_swap_b32 v212, v216
    v_permlane16_swap_b32 v213, v217
    v_permlane16_swap_b32 v214, v218
    v_permlane16_swap_b32 v215, v219
    s_nop 1
    v_add_f32 v212, v212, v216
    v_add_f32 v213, v213, v217
    v_add_f32 v214, v214, v218
    v_add_f32 v215, v215, v219
    s_nop 1
    v_add_f32_dpp v212, v212, v212 row_ror:8 row_mask:0xf bank_mask:0xf
    v_add_f32_dpp v213, v213, v213 row_ror:8 row_mask:0xf bank_mask:0xf
    v_add_f32_dpp v214, v214, v214 row_ror:8 row_mask:0xf bank_mask:0xf
    v_add_f32_dpp v215, v215, v215 row_ror:8 row_mask:0xf bank_mask:0xf
    v_lshrrev_b32 v232, 5, v228
    v_lshlrev_b32 v232, 8, v232
    v_bfe_u32 v233, v228, 4, 1
    v_lshl_add_u32 v232, v233, 4, v232
    v_lshl_add_u32 v232, v230, 5, v232
    s_lshl_b32 s61, s56, 9
    s_add_u32 s61, s61, 131072
    v_add_u32 v232, s61, v232
    ds_write_b128 v232, v[212:215]
    s_waitcnt lgkmcnt(0)
    s_barrier
    s_waitcnt vmcnt(4)
    buffer_load_dwordx4 v[144:147], v4, s[44:47], s85 offen nt
    s_add_u32 s85, s85, 8192
    s_waitcnt vmcnt(4)
    buffer_load_dwordx4 v[148:151], v4, s[44:47], s85 offen nt
    s_add_u32 s85, s85, 8192
    s_waitcnt vmcnt(4)
    buffer_load_dwordx4 v[152:155], v4, s[44:47], s85 offen nt
    s_add_u32 s85, s85, 8192
    s_waitcnt vmcnt(4)
    buffer_load_dwordx4 v[156:159], v4, s[44:47], s85 offen nt
    s_add_u32 s85, s85, 8192
    s_waitcnt vmcnt(4)
    buffer_load_dwordx4 v[160:163], v4, s[44:47], s85 offen nt
    s_add_u32 s85, s85, 8192
    s_waitcnt vmcnt(4)
    buffer_load_dwordx4 v[164:167], v4, s[44:47], s85 offen nt
    s_add_u32 s85, s85, 8192
    s_waitcnt vmcnt(4)
    buffer_load_dwordx4 v[168:171], v4, s[44:47], s85 offen nt
    s_add_u32 s85, s85, 8192
    s_waitcnt vmcnt(4)
    buffer_load_dwordx4 v[172:175], v4, s[44:47], s85 offen nt
    s_add_u32 s85, s85, 8192
    s_waitcnt vmcnt(4)
    buffer_load_dwordx4 v[176:179], v4, s[44:47], s85 offen nt
    s_add_u32 s85, s85, 8192
    s_waitcnt vmcnt(4)
    buffer_load_dwordx4 v[180:183], v4, s[44:47], s85 offen nt
    s_add_u32 s85, s85, 8192
    s_waitcnt vmcnt(4)
    buffer_load_dwordx4 v[184:187], v4, s[44:47], s85 offen nt
    s_add_u32 s85, s85, 8192
    s_waitcnt vmcnt(4)
    buffer_load_dwordx4 v[188:191], v4, s[44:47], s85 offen nt
    s_branch Lt1j_71
Lt1s_70:
    s_setprio 3
    s_waitcnt vmcnt(0)
    v_perm_b32 v232, v196, v192, s68
    v_perm_b32 v233, v196, v192, s69
    v_perm_b32 v234, v197, v193, s68
    v_perm_b32 v235, v197, v193, s69
    v_perm_b32 v236, v198, v194, s68
    v_perm_b32 v237, v198, v194, s69
    v_perm_b32 v238, v199, v195, s68
    v_perm_b32 v239, v199, v195, s69
    v_dot2_f32_bf16 v212, v232, v208, 0
    v_dot2_f32_bf16 v213, v233, v208, 0
    v_dot2_f32_bf16 v214, v234, v208, 0
    v_dot2_f32_bf16 v215, v235, v208, 0
    v_dot2_f32_bf16 v216, v236, v208, 0
    v_dot2_f32_bf16 v217, v237, v208, 0
    v_dot2_f32_bf16 v218, v238, v208, 0
    v_dot2_f32_bf16 v219, v239, v208, 0
    v_dot2_f32_bf16 v220, v232, v210, 0
    v_dot2_f32_bf16 v221, v233, v210, 0
    v_dot2_f32_bf16 v222, v234, v210, 0
    v_dot2_f32_bf16 v223, v235, v210, 0
    v_dot2_f32_bf16 v224, v236, v210, 0
    v_dot2_f32_bf16 v225, v237, v210, 0
    v_dot2_f32_bf16 v226, v238, v210, 0
    v_dot2_f32_bf16 v227, v239, v210, 0
    v_perm_b32 v232, v204, v200, s68
    v_perm_b32 v233, v204, v200, s69
    v_perm_b32 v234, v205, v201, s68
    v_perm_b32 v235, v205, v201, s69
    v_perm_b32 v236, v206, v202, s68
    v_perm_b32 v237, v206, v202, s69
    v_perm_b32 v238, v207, v203, s68
    v_perm_b32 v239, v207, v203, s69
    v_dot2_f32_bf16 v212, v232, v209, v212
    v_dot2_f32_bf16 v213, v233, v209, v213
    v_dot2_f32_bf16 v214, v234, v209, v214
    v_dot2_f32_bf16 v215, v235, v209, v215
    v_dot2_f32_bf16 v216, v236, v209, v216
    v_dot2_f32_bf16 v217, v237, v209, v217
    v_dot2_f32_bf16 v218, v238, v209, v218
    v_dot2_f32_bf16 v219, v239, v209, v219
    v_dot2_f32_bf16 v220, v232, v211, v220
    v_dot2_f32_bf16 v221, v233, v211, v221
    v_dot2_f32_bf16 v222, v234, v211, v222
    v_dot2_f32_bf16 v223, v235, v211, v223
    v_dot2_f32_bf16 v224, v236, v211, v224
    v_dot2_f32_bf16 v225, v237, v211, v225
    v_dot2_f32_bf16 v226, v238, v211, v226
    v_dot2_f32_bf16 v227, v239, v211, v227
    s_nop 2
    v_permlane32_swap_b32 v212, v220
    v_permlane32_swap_b32 v213, v221
    v_permlane32_swap_b32 v214, v222
    v_permlane32_swap_b32 v215, v223
    v_permlane32_swap_b32 v216, v224
    v_permlane32_swap_b32 v217, v225
    v_permlane32_swap_b32 v218, v226
    v_permlane32_swap_b32 v219, v227
    s_nop 1
    v_add_f32 v212, v212, v220
    v_add_f32 v213, v213, v221
    v_add_f32 v214, v214, v222
    v_add_f32 v215, v215, v223
    v_add_f32 v216, v216, v224
    v_add_f32 v217, v217, v225
    v_add_f32 v218, v218, v226
    v_add_f32 v219, v219, v227
    s_nop 1
    v_permlane16_swap_b32 v212, v216
    v_permlane16_swap_b32 v213, v217
    v_permlane16_swap_b32 v214, v218
    v_permlane16_swap_b32 v215, v219
    s_nop 1
    v_add_f32 v212, v212, v216
    v_add_f32 v213, v213, v217
    v_add_f32 v214, v214, v218
    v_add_f32 v215, v215, v219
    s_nop 1
    v_add_f32_dpp v212, v212, v212 row_ror:8 row_mask:0xf bank_mask:0xf
    v_add_f32_dpp v213, v213, v213 row_ror:8 row_mask:0xf bank_mask:0xf
    v_add_f32_dpp v214, v214, v214 row_ror:8 row_mask:0xf bank_mask:0xf
    v_add_f32_dpp v215, v215, v215 row_ror:8 row_mask:0xf bank_mask:0xf
    v_lshrrev_b32 v232, 5, v228
    v_lshlrev_b32 v232, 8, v232
    v_bfe_u32 v233, v228, 4, 1
    v_lshl_add_u32 v232, v233, 4, v232
    v_lshl_add_u32 v232, v230, 5, v232
    s_lshl_b32 s61, s56, 9
    s_add_u32 s61, s61, 131072
    v_add_u32 v232, s61, v232
    ds_write_b128 v232, v[212:215]
    s_waitcnt lgkmcnt(0)
    s_barrier
    v_mov_b32 v48, 1
    v_mov_b32 v49, 0
    s_mov_b64 exec, 1
    buffer_atomic_add v48, v49, s[52:55], 0 offen offset:128 sc1
    s_mov_b64 exec, -1
    v_mov_b32 v234, 0
    buffer_load_dword v235, v234, s[52:55], s91 offen offset:0 sc0 sc1
    v_and_b32 v232, 31, v228
    v_lshlrev_b32 v233, 4, v232
    v_add_u32 v233, 131072, v233
    ds_read_b128 v[192:195], v233 offset:0
    ds_read_b128 v[196:199], v233 offset:512
    ds_read_b128 v[200:203], v233 offset:1024
    ds_read_b128 v[204:207], v233 offset:1536
    ds_read_b128 v[208:211], v233 offset:2048
    ds_read_b128 v[212:215], v233 offset:2560
    ds_read_b128 v[216:219], v233 offset:3072
    ds_read_b128 v[220:223], v233 offset:3584
    s_waitcnt lgkmcnt(6)
    v_add_f32 v192, v192, v196
    v_add_f32 v193, v193, v197
    v_add_f32 v194, v194, v198
    v_add_f32 v195, v195, v199
    s_waitcnt lgkmcnt(5)
    v_add_f32 v192, v192, v200
    v_add_f32 v193, v193, v201
    v_add_f32 v194, v194, v202
    v_add_f32 v195, v195, v203
    s_waitcnt lgkmcnt(4)
    v_add_f32 v192, v192, v204
    v_add_f32 v193, v193, v205
    v_add_f32 v194, v194, v206
    v_add_f32 v195, v195, v207
    s_waitcnt lgkmcnt(3)
    v_add_f32 v192, v192, v208
    v_add_f32 v193, v193, v209
    v_add_f32 v194, v194, v210
    v_add_f32 v195, v195, v211
    s_waitcnt lgkmcnt(2)
    v_add_f32 v192, v192, v212
    v_add_f32 v193, v193, v213
    v_add_f32 v194, v194, v214
    v_add_f32 v195, v195, v215
    s_waitcnt lgkmcnt(1)
    v_add_f32 v192, v192, v216
    v_add_f32 v193, v193, v217
    v_add_f32 v194, v194, v218
    v_add_f32 v195, v195, v219
    s_waitcnt lgkmcnt(0)
    v_add_f32 v192, v192, v220
    v_add_f32 v193, v193, v221
    v_add_f32 v194, v194, v222
    v_add_f32 v195, v195, v223
    v_lshrrev_b32 v233, 4, v232
    v_lshlrev_b32 v233, 10, v233
    v_and_b32 v232, 15, v232
    v_lshl_add_u32 v233, v232, 4, v233
    s_waitcnt vmcnt(0)
    s_mov_b32 s92, 0
Lcf_72:
    v_readfirstlane_b32 s57, v235
    s_nop 3
    s_cmp_lg_u32 s57, 0
    s_cbranch_scc1 Lcfd_73
    s_sleep 2
    buffer_load_dword v235, v234, s[52:55], s91 offen offset:0 sc0 sc1
    s_waitcnt vmcnt(0)
    s_add_u32 s92, s92, 1
    s_cmp_lt_u32 s92, 400000
    s_cbranch_scc1 Lcf_72
Lcfd_73:
    s_mov_b64 exec, 0xffffffff
    buffer_store_dwordx4 v[192:195], v233, s[32:35], s3 offen sc0 sc1
    s_mov_b64 exec, -1
    s_lshl_b32 s85, s56, 19
    s_lshl_b32 s86, s65, 8
    s_add_u32 s85, s85, s86
    buffer_load_dwordx4 v[128:131], v4, s[44:47], s85 offen nt
    s_add_u32 s85, s85, 8192
    buffer_load_dwordx4 v[132:135], v4, s[44:47], s85 offen nt
    s_add_u32 s85, s85, 8192
    buffer_load_dwordx4 v[136:139], v4, s[44:47], s85 offen nt
    s_add_u32 s85, s85, 8192
    buffer_load_dwordx4 v[140:143], v4, s[44:47], s85 offen nt
    s_add_u32 s85, s85, 8192
    buffer_load_dwordx4 v[144:147], v4, s[44:47], s85 offen nt
    s_add_u32 s85, s85, 8192
    buffer_load_dwordx4 v[148:151], v4, s[44:47], s85 offen nt
    s_add_u32 s85, s85, 8192
    buffer_load_dwordx4 v[152:155], v4, s[44:47], s85 offen nt
    s_add_u32 s85, s85, 8192
    buffer_load_dwordx4 v[156:159], v4, s[44:47], s85 offen nt
    s_add_u32 s85, s85, 8192
    buffer_load_dwordx4 v[160:163], v4, s[44:47], s85 offen nt
    s_add_u32 s85, s85, 8192
    buffer_load_dwordx4 v[164:167], v4, s[44:47], s85 offen nt
    s_add_u32 s85, s85, 8192
    buffer_load_dwordx4 v[168:171], v4, s[44:47], s85 offen nt
    s_add_u32 s85, s85, 8192
    buffer_load_dwordx4 v[172:175], v4, s[44:47], s85 offen nt
    s_add_u32 s85, s85, 8192
    buffer_load_dwordx4 v[176:179], v4, s[44:47], s85 offen nt
    s_add_u32 s85, s85, 8192
    buffer_load_dwordx4 v[180:183], v4, s[44:47], s85 offen nt
    s_add_u32 s85, s85, 8192
    buffer_load_dwordx4 v[184:187], v4, s[44:47], s85 offen nt
    s_add_u32 s85, s85, 8192
    buffer_load_dwordx4 v[188:191], v4, s[44:47], s85 offen nt
    v_mov_b32 v7, 0
    buffer_load_dword v6, v7, s[52:55], 0 offen offset:128 sc0 sc1
    v_lshlrev_b32 v40, 4, v1
    s_lshl_b32 s61, s65, 11
    s_add_u32 s61, s61, 1310720
    s_mov_b32 s92, 0
Lpoll_74:
    buffer_load_dwordx4 v[24:27], v40, s[32:35], s61 offen offset:0 sc0 sc1
    buffer_load_dwordx4 v[32:35], v40, s[32:35], s61 offen offset:1024 sc0 sc1
    s_waitcnt vmcnt(0)
    v_mov_b32 v41, v24
    v_max3_u32 v41, v41, v25, v26
    v_max3_u32 v41, v41, v27, v32
    v_max3_u32 v41, v41, v33, v34
    v_max_u32 v41, v41, v35
    v_cmpx_eq_u32 vcc, -1, v41
    s_cbranch_execz Lpolld_75
    s_sleep 4
    s_add_u32 s92, s92, 1
    s_cmp_lt_u32 s92, 400000
    s_cbranch_scc1 Lpoll_74
Lpolld_75:
    s_mov_b64 exec, -1
    v_mov_b32 v28, v24
    v_mov_b32 v29, v25
    v_mov_b32 v30, v26
    v_mov_b32 v31, v27
    v_mov_b32 v36, v32
    v_mov_b32 v37, v33
    v_mov_b32 v38, v34
    v_mov_b32 v39, v35
    s_nop 1
    v_permlane32_swap_b32 v24, v28
    v_permlane32_swap_b32 v25, v29
    v_permlane32_swap_b32 v26, v30
    v_permlane32_swap_b32 v27, v31
    v_permlane32_swap_b32 v32, v36
    v_permlane32_swap_b32 v33, v37
    v_permlane32_swap_b32 v34, v38
    v_permlane32_swap_b32 v35, v39
    s_nop 1
    v_add_f32 v24, v24, v28
    v_add_f32 v25, v25, v29
    v_add_f32 v26, v26, v30
    v_add_f32 v27, v27, v31
    v_cvt_pk_bf16_f32 v24, v24, v25
    v_cvt_pk_bf16_f32 v25, v26, v27
    v_add_f32 v32, v32, v36
    v_add_f32 v33, v33, v37
    v_add_f32 v34, v34, v38
    v_add_f32 v35, v35, v39
    v_cvt_pk_bf16_f32 v32, v32, v33
    v_cvt_pk_bf16_f32 v33, v34, v35
    s_mov_b32 s92, 0
Lcf_76:
    v_readfirstlane_b32 s57, v6
    s_nop 3
    s_cmp_ge_u32 s57, 64
    s_cbranch_scc1 Lcfd_77
    s_sleep 8
    v_mov_b32 v7, 0
    buffer_load_dword v6, v7, s[52:55], 0 offen offset:128 sc0 sc1
    s_waitcnt vmcnt(0)
    s_add_u32 s92, s92, 1
    s_cmp_lt_u32 s92, 400000
    s_cbranch_scc1 Lcf_76
Lcfd_77:
    v_and_b32 v42, 31, v1
    v_lshlrev_b32 v42, 3, v42
    v_add_u32 v42, 135168, v42
    ds_write_b64 v42, v[24:25] offset:0
    ds_write_b64 v42, v[32:33] offset:256
    s_waitcnt lgkmcnt(0)
    s_setprio 0
Lt1j_71:
    s_barrier
    v_lshlrev_b32 v40, 4, v3
    v_add_u32 v40, 135168, v40
    ds_read_b128 v[56:59], v40
    ds_read_b128 v[60:63], v40 offset:256
    s_waitcnt lgkmcnt(0)
    s_waitcnt vmcnt(15)
    v_dot2_f32_bf16 v192, v128, v56, 0
    v_dot2_f32_bf16 v192, v129, v57, v192
    v_dot2_f32_bf16 v192, v130, v58, v192
    v_dot2_f32_bf16 v192, v131, v59, v192
    v_dot2_f32_bf16 v208, v128, v60, 0
    v_dot2_f32_bf16 v208, v129, v61, v208
    v_dot2_f32_bf16 v208, v130, v62, v208
    v_dot2_f32_bf16 v208, v131, v63, v208
    s_waitcnt vmcnt(14)
    v_dot2_f32_bf16 v193, v132, v56, 0
    v_dot2_f32_bf16 v193, v133, v57, v193
    v_dot2_f32_bf16 v193, v134, v58, v193
    v_dot2_f32_bf16 v193, v135, v59, v193
    v_dot2_f32_bf16 v209, v132, v60, 0
    v_dot2_f32_bf16 v209, v133, v61, v209
    v_dot2_f32_bf16 v209, v134, v62, v209
    v_dot2_f32_bf16 v209, v135, v63, v209
    s_waitcnt vmcnt(13)
    v_dot2_f32_bf16 v194, v136, v56, 0
    v_dot2_f32_bf16 v194, v137, v57, v194
    v_dot2_f32_bf16 v194, v138, v58, v194
    v_dot2_f32_bf16 v194, v139, v59, v194
    v_dot2_f32_bf16 v210, v136, v60, 0
    v_dot2_f32_bf16 v210, v137, v61, v210
    v_dot2_f32_bf16 v210, v138, v62, v210
    v_dot2_f32_bf16 v210, v139, v63, v210
    s_waitcnt vmcnt(12)
    v_dot2_f32_bf16 v195, v140, v56, 0
    v_dot2_f32_bf16 v195, v141, v57, v195
    v_dot2_f32_bf16 v195, v142, v58, v195
    v_dot2_f32_bf16 v195, v143, v59, v195
    v_dot2_f32_bf16 v211, v140, v60, 0
    v_dot2_f32_bf16 v211, v141, v61, v211
    v_dot2_f32_bf16 v211, v142, v62, v211
    v_dot2_f32_bf16 v211, v143, v63, v211
    s_waitcnt vmcnt(11)
    v_dot2_f32_bf16 v196, v144, v56, 0
    v_dot2_f32_bf16 v196, v145, v57, v196
    v_dot2_f32_bf16 v196, v146, v58, v196
    v_dot2_f32_bf16 v196, v147, v59, v196
    v_dot2_f32_bf16 v212, v144, v60, 0
    v_dot2_f32_bf16 v212, v145, v61, v212
    v_dot2_f32_bf16 v212, v146, v62, v212
    v_dot2_f32_bf16 v212, v147, v63, v212
    s_waitcnt vmcnt(10)
    v_dot2_f32_bf16 v197, v148, v56, 0
    v_dot2_f32_bf16 v197, v149, v57, v197
    v_dot2_f32_bf16 v197, v150, v58, v197
    v_dot2_f32_bf16 v197, v151, v59, v197
    v_dot2_f32_bf16 v213, v148, v60, 0
    v_dot2_f32_bf16 v213, v149, v61, v213
    v_dot2_f32_bf16 v213, v150, v62, v213
    v_dot2_f32_bf16 v213, v151, v63, v213
    s_waitcnt vmcnt(9)
    v_dot2_f32_bf16 v198, v152, v56, 0
    v_dot2_f32_bf16 v198, v153, v57, v198
    v_dot2_f32_bf16 v198, v154, v58, v198
    v_dot2_f32_bf16 v198, v155, v59, v198
    v_dot2_f32_bf16 v214, v152, v60, 0
    v_dot2_f32_bf16 v214, v153, v61, v214
    v_dot2_f32_bf16 v214, v154, v62, v214
    v_dot2_f32_bf16 v214, v155, v63, v214
    s_waitcnt vmcnt(8)
    v_dot2_f32_bf16 v199, v156, v56, 0
    v_dot2_f32_bf16 v199, v157, v57, v199
    v_dot2_f32_bf16 v199, v158, v58, v199
    v_dot2_f32_bf16 v199, v159, v59, v199
    v_dot2_f32_bf16 v215, v156, v60, 0
    v_dot2_f32_bf16 v215, v157, v61, v215
    v_dot2_f32_bf16 v215, v158, v62, v215
    v_dot2_f32_bf16 v215, v159, v63, v215
    s_waitcnt vmcnt(7)
    v_dot2_f32_bf16 v200, v160, v56, 0
    v_dot2_f32_bf16 v200, v161, v57, v200
    v_dot2_f32_bf16 v200, v162, v58, v200
    v_dot2_f32_bf16 v200, v163, v59, v200
    v_dot2_f32_bf16 v216, v160, v60, 0
    v_dot2_f32_bf16 v216, v161, v61, v216
    v_dot2_f32_bf16 v216, v162, v62, v216
    v_dot2_f32_bf16 v216, v163, v63, v216
    s_waitcnt vmcnt(6)
    v_dot2_f32_bf16 v201, v164, v56, 0
    v_dot2_f32_bf16 v201, v165, v57, v201
    v_dot2_f32_bf16 v201, v166, v58, v201
    v_dot2_f32_bf16 v201, v167, v59, v201
    v_dot2_f32_bf16 v217, v164, v60, 0
    v_dot2_f32_bf16 v217, v165, v61, v217
    v_dot2_f32_bf16 v217, v166, v62, v217
    v_dot2_f32_bf16 v217, v167, v63, v217
    s_waitcnt vmcnt(5)
    v_dot2_f32_bf16 v202, v168, v56, 0
    v_dot2_f32_bf16 v202, v169, v57, v202
    v_dot2_f32_bf16 v202, v170, v58, v202
    v_dot2_f32_bf16 v202, v171, v59, v202
    v_dot2_f32_bf16 v218, v168, v60, 0
    v_dot2_f32_bf16 v218, v169, v61, v218
    v_dot2_f32_bf16 v218, v170, v62, v218
    v_dot2_f32_bf16 v218, v171, v63, v218
    s_waitcnt vmcnt(4)
    v_dot2_f32_bf16 v203, v172, v56, 0
    v_dot2_f32_bf16 v203, v173, v57, v203
    v_dot2_f32_bf16 v203, v174, v58, v203
    v_dot2_f32_bf16 v203, v175, v59, v203
    v_dot2_f32_bf16 v219, v172, v60, 0
    v_dot2_f32_bf16 v219, v173, v61, v219
    v_dot2_f32_bf16 v219, v174, v62, v219
    v_dot2_f32_bf16 v219, v175, v63, v219
    s_waitcnt vmcnt(3)
    v_dot2_f32_bf16 v204, v176, v56, 0
    v_dot2_f32_bf16 v204, v177, v57, v204
    v_dot2_f32_bf16 v204, v178, v58, v204
    v_dot2_f32_bf16 v204, v179, v59, v204
    v_dot2_f32_bf16 v220, v176, v60, 0
    v_dot2_f32_bf16 v220, v177, v61, v220
    v_dot2_f32_bf16 v220, v178, v62, v220
    v_dot2_f32_bf16 v220, v179, v63, v220
    s_waitcnt vmcnt(2)
    v_dot2_f32_bf16 v205, v180, v56, 0
    v_dot2_f32_bf16 v205, v181, v57, v205
    v_dot2_f32_bf16 v205, v182, v58, v205
    v_dot2_f32_bf16 v205, v183, v59, v205
    v_dot2_f32_bf16 v221, v180, v60, 0
    v_dot2_f32_bf16 v221, v181, v61, v221
    v_dot2_f32_bf16 v221, v182, v62, v221
    v_dot2_f32_bf16 v221, v183, v63, v221
    s_waitcnt vmcnt(1)
    v_dot2_f32_bf16 v206, v184, v56, 0
    v_dot2_f32_bf16 v206, v185, v57, v206
    v_dot2_f32_bf16 v206, v186, v58, v206
    v_dot2_f32_bf16 v206, v187, v59, v206
    v_dot2_f32_bf16 v222, v184, v60, 0
    v_dot2_f32_bf16 v222, v185, v61, v222
    v_dot2_f32_bf16 v222, v186, v62, v222
    v_dot2_f32_bf16 v222, v187, v63, v222
    s_waitcnt vmcnt(0)
    v_dot2_f32_bf16 v207, v188, v56, 0
    v_dot2_f32_bf16 v207, v189, v57, v207
    v_dot2_f32_bf16 v207, v190, v58, v207
    v_dot2_f32_bf16 v207, v191, v59, v207
    v_dot2_f32_bf16 v223, v188, v60, 0
    v_dot2_f32_bf16 v223, v189, v61, v223
    v_dot2_f32_bf16 v223, v190, v62, v223
    v_dot2_f32_bf16 v223, v191, v63, v223
    s_nop 2
    v_add_f32_dpp v192, v192, v192 row_ror:8 row_mask:0xf bank_mask:0xf
    v_add_f32_dpp v193, v193, v193 row_ror:8 row_mask:0xf bank_mask:0xf
    v_add_f32_dpp v194, v194, v194 row_ror:8 row_mask:0xf bank_mask:0xf
    v_add_f32_dpp v195, v195, v195 row_ror:8 row_mask:0xf bank_mask:0xf
    v_add_f32_dpp v196, v196, v196 row_ror:8 row_mask:0xf bank_mask:0xf
    v_add_f32_dpp v197, v197, v197 row_ror:8 row_mask:0xf bank_mask:0xf
    v_add_f32_dpp v198, v198, v198 row_ror:8 row_mask:0xf bank_mask:0xf
    v_add_f32_dpp v199, v199, v199 row_ror:8 row_mask:0xf bank_mask:0xf
    v_add_f32_dpp v200, v200, v200 row_ror:8 row_mask:0xf bank_mask:0xf
    v_add_f32_dpp v201, v201, v201 row_ror:8 row_mask:0xf bank_mask:0xf
    v_add_f32_dpp v202, v202, v202 row_ror:8 row_mask:0xf bank_mask:0xf
    v_add_f32_dpp v203, v203, v203 row_ror:8 row_mask:0xf bank_mask:0xf
    v_add_f32_dpp v204, v204, v204 row_ror:8 row_mask:0xf bank_mask:0xf
    v_add_f32_dpp v205, v205, v205 row_ror:8 row_mask:0xf bank_mask:0xf
    v_add_f32_dpp v206, v206, v206 row_ror:8 row_mask:0xf bank_mask:0xf
    v_add_f32_dpp v207, v207, v207 row_ror:8 row_mask:0xf bank_mask:0xf
    v_add_f32_dpp v208, v208, v208 row_ror:8 row_mask:0xf bank_mask:0xf
    v_add_f32_dpp v209, v209, v209 row_ror:8 row_mask:0xf bank_mask:0xf
    v_add_f32_dpp v210, v210, v210 row_ror:8 row_mask:0xf bank_mask:0xf
    v_add_f32_dpp v211, v211, v211 row_ror:8 row_mask:0xf bank_mask:0xf
    v_add_f32_dpp v212, v212, v212 row_ror:8 row_mask:0xf bank_mask:0xf
    v_add_f32_dpp v213, v213, v213 row_ror:8 row_mask:0xf bank_mask:0xf
    v_add_f32_dpp v214, v214, v214 row_ror:8 row_mask:0xf bank_mask:0xf
    v_add_f32_dpp v215, v215, v215 row_ror:8 row_mask:0xf bank_mask:0xf
    v_add_f32_dpp v216, v216, v216 row_ror:8 row_mask:0xf bank_mask:0xf
    v_add_f32_dpp v217, v217, v217 row_ror:8 row_mask:0xf bank_mask:0xf
    v_add_f32_dpp v218, v218, v218 row_ror:8 row_mask:0xf bank_mask:0xf
    v_add_f32_dpp v219, v219, v219 row_ror:8 row_mask:0xf bank_mask:0xf
    v_add_f32_dpp v220, v220, v220 row_ror:8 row_mask:0xf bank_mask:0xf
    v_add_f32_dpp v221, v221, v221 row_ror:8 row_mask:0xf bank_mask:0xf
    v_add_f32_dpp v222, v222, v222 row_ror:8 row_mask:0xf bank_mask:0xf
    v_add_f32_dpp v223, v223, v223 row_ror:8 row_mask:0xf bank_mask:0xf
    v_add_f32_dpp v192, v192, v192 row_ror:4 row_mask:0xf bank_mask:0xf
    v_add_f32_dpp v193, v193, v193 row_ror:4 row_mask:0xf bank_mask:0xf
    v_add_f32_dpp v194, v194, v194 row_ror:4 row_mask:0xf bank_mask:0xf
    v_add_f32_dpp v195, v195, v195 row_ror:4 row_mask:0xf bank_mask:0xf
    v_add_f32_dpp v196, v196, v196 row_ror:4 row_mask:0xf bank_mask:0xf
    v_add_f32_dpp v197, v197, v197 row_ror:4 row_mask:0xf bank_mask:0xf
    v_add_f32_dpp v198, v198, v198 row_ror:4 row_mask:0xf bank_mask:0xf
    v_add_f32_dpp v199, v199, v199 row_ror:4 row_mask:0xf bank_mask:0xf
    v_add_f32_dpp v200, v200, v200 row_ror:4 row_mask:0xf bank_mask:0xf
    v_add_f32_dpp v201, v201, v201 row_ror:4 row_mask:0xf bank_mask:0xf
    v_add_f32_dpp v202, v202, v202 row_ror:4 row_mask:0xf bank_mask:0xf
    v_add_f32_dpp v203, v203, v203 row_ror:4 row_mask:0xf bank_mask:0xf
    v_add_f32_dpp v204, v204, v204 row_ror:4 row_mask:0xf bank_mask:0xf
    v_add_f32_dpp v205, v205, v205 row_ror:4 row_mask:0xf bank_mask:0xf
    v_add_f32_dpp v206, v206, v206 row_ror:4 row_mask:0xf bank_mask:0xf
    v_add_f32_dpp v207, v207, v207 row_ror:4 row_mask:0xf bank_mask:0xf
    v_add_f32_dpp v208, v208, v208 row_ror:4 row_mask:0xf bank_mask:0xf
    v_add_f32_dpp v209, v209, v209 row_ror:4 row_mask:0xf bank_mask:0xf
    v_add_f32_dpp v210, v210, v210 row_ror:4 row_mask:0xf bank_mask:0xf
    v_add_f32_dpp v211, v211, v211 row_ror:4 row_mask:0xf bank_mask:0xf
    v_add_f32_dpp v212, v212, v212 row_ror:4 row_mask:0xf bank_mask:0xf
    v_add_f32_dpp v213, v213, v213 row_ror:4 row_mask:0xf bank_mask:0xf
    v_add_f32_dpp v214, v214, v214 row_ror:4 row_mask:0xf bank_mask:0xf
    v_add_f32_dpp v215, v215, v215 row_ror:4 row_mask:0xf bank_mask:0xf
    v_add_f32_dpp v216, v216, v216 row_ror:4 row_mask:0xf bank_mask:0xf
    v_add_f32_dpp v217, v217, v217 row_ror:4 row_mask:0xf bank_mask:0xf
    v_add_f32_dpp v218, v218, v218 row_ror:4 row_mask:0xf bank_mask:0xf
    v_add_f32_dpp v219, v219, v219 row_ror:4 row_mask:0xf bank_mask:0xf
    v_add_f32_dpp v220, v220, v220 row_ror:4 row_mask:0xf bank_mask:0xf
    v_add_f32_dpp v221, v221, v221 row_ror:4 row_mask:0xf bank_mask:0xf
    v_add_f32_dpp v222, v222, v222 row_ror:4 row_mask:0xf bank_mask:0xf
    v_add_f32_dpp v223, v223, v223 row_ror:4 row_mask:0xf bank_mask:0xf
    v_add_f32_dpp v192, v192, v192 row_ror:2 row_mask:0xf bank_mask:0xf
    v_add_f32_dpp v193, v193, v193 row_ror:2 row_mask:0xf bank_mask:0xf
    v_add_f32_dpp v194, v194, v194 row_ror:2 row_mask:0xf bank_mask:0xf
    v_add_f32_dpp v195, v195, v195 row_ror:2 row_mask:0xf bank_mask:0xf
    v_add_f32_dpp v196, v196, v196 row_ror:2 row_mask:0xf bank_mask:0xf
    v_add_f32_dpp v197, v197, v197 row_ror:2 row_mask:0xf bank_mask:0xf
    v_add_f32_dpp v198, v198, v198 row_ror:2 row_mask:0xf bank_mask:0xf
    v_add_f32_dpp v199, v199, v199 row_ror:2 row_mask:0xf bank_mask:0xf
    v_add_f32_dpp v200, v200, v200 row_ror:2 row_mask:0xf bank_mask:0xf
    v_add_f32_dpp v201, v201, v201 row_ror:2 row_mask:0xf bank_mask:0xf
    v_add_f32_dpp v202, v202, v202 row_ror:2 row_mask:0xf bank_mask:0xf
    v_add_f32_dpp v203, v203, v203 row_ror:2 row_mask:0xf bank_mask:0xf
    v_add_f32_dpp v204, v204, v204 row_ror:2 row_mask:0xf bank_mask:0xf
    v_add_f32_dpp v205, v205, v205 row_ror:2 row_mask:0xf bank_mask:0xf
    v_add_f32_dpp v206, v206, v206 row_ror:2 row_mask:0xf bank_mask:0xf
    v_add_f32_dpp v207, v207, v207 row_ror:2 row_mask:0xf bank_mask:0xf
    v_add_f32_dpp v208, v208, v208 row_ror:2 row_mask:0xf bank_mask:0xf
    v_add_f32_dpp v209, v209, v209 row_ror:2 row_mask:0xf bank_mask:0xf
    v_add_f32_dpp v210, v210, v210 row_ror:2 row_mask:0xf bank_mask:0xf
    v_add_f32_dpp v211, v211, v211 row_ror:2 row_mask:0xf bank_mask:0xf
    v_add_f32_dpp v212, v212, v212 row_ror:2 row_mask:0xf bank_mask:0xf
    v_add_f32_dpp v213, v213, v213 row_ror:2 row_mask:0xf bank_mask:0xf
    v_add_f32_dpp v214, v214, v214 row_ror:2 row_mask:0xf bank_mask:0xf
    v_add_f32_dpp v215, v215, v215 row_ror:2 row_mask:0xf bank_mask:0xf
    v_add_f32_dpp v216, v216, v216 row_ror:2 row_mask:0xf bank_mask:0xf
    v_add_f32_dpp v217, v217, v217 row_ror:2 row_mask:0xf bank_mask:0xf
    v_add_f32_dpp v218, v218, v218 row_ror:2 row_mask:0xf bank_mask:0xf
    v_add_f32_dpp v219, v219, v219 row_ror:2 row_mask:0xf bank_mask:0xf
    v_add_f32_dpp v220, v220, v220 row_ror:2 row_mask:0xf bank_mask:0xf
    v_add_f32_dpp v221, v221, v221 row_ror:2 row_mask:0xf bank_mask:0xf
    v_add_f32_dpp v222, v222, v222 row_ror:2 row_mask:0xf bank_mask:0xf
    v_add_f32_dpp v223, v223, v223 row_ror:2 row_mask:0xf bank_mask:0xf
    v_add_f32_dpp v192, v192, v192 row_ror:1 row_mask:0xf bank_mask:0xf
    v_add_f32_dpp v193, v193, v193 row_ror:1 row_mask:0xf bank_mask:0xf
    v_add_f32_dpp v194, v194, v194 row_ror:1 row_mask:0xf bank_mask:0xf
    v_add_f32_dpp v195, v195, v195 row_ror:1 row_mask:0xf bank_mask:0xf
    v_add_f32_dpp v196, v196, v196 row_ror:1 row_mask:0xf bank_mask:0xf
    v_add_f32_dpp v197, v197, v197 row_ror:1 row_mask:0xf bank_mask:0xf
    v_add_f32_dpp v198, v198, v198 row_ror:1 row_mask:0xf bank_mask:0xf
    v_add_f32_dpp v199, v199, v199 row_ror:1 row_mask:0xf bank_mask:0xf
    v_add_f32_dpp v200, v200, v200 row_ror:1 row_mask:0xf bank_mask:0xf
    v_add_f32_dpp v201, v201, v201 row_ror:1 row_mask:0xf bank_mask:0xf
    v_add_f32_dpp v202, v202, v202 row_ror:1 row_mask:0xf bank_mask:0xf
    v_add_f32_dpp v203, v203, v203 row_ror:1 row_mask:0xf bank_mask:0xf
    v_add_f32_dpp v204, v204, v204 row_ror:1 row_mask:0xf bank_mask:0xf
    v_add_f32_dpp v205, v205, v205 row_ror:1 row_mask:0xf bank_mask:0xf
    v_add_f32_dpp v206, v206, v206 row_ror:1 row_mask:0xf bank_mask:0xf
    v_add_f32_dpp v207, v207, v207 row_ror:1 row_mask:0xf bank_mask:0xf
    v_add_f32_dpp v208, v208, v208 row_ror:1 row_mask:0xf bank_mask:0xf
    v_add_f32_dpp v209, v209, v209 row_ror:1 row_mask:0xf bank_mask:0xf
    v_add_f32_dpp v210, v210, v210 row_ror:1 row_mask:0xf bank_mask:0xf
    v_add_f32_dpp v211, v211, v211 row_ror:1 row_mask:0xf bank_mask:0xf
    v_add_f32_dpp v212, v212, v212 row_ror:1 row_mask:0xf bank_mask:0xf
    v_add_f32_dpp v213, v213, v213 row_ror:1 row_mask:0xf bank_mask:0xf
    v_add_f32_dpp v214, v214, v214 row_ror:1 row_mask:0xf bank_mask:0xf
    v_add_f32_dpp v215, v215, v215 row_ror:1 row_mask:0xf bank_mask:0xf
    v_add_f32_dpp v216, v216, v216 row_ror:1 row_mask:0xf bank_mask:0xf
    v_add_f32_dpp v217, v217, v217 row_ror:1 row_mask:0xf bank_mask:0xf
    v_add_f32_dpp v218, v218, v218 row_ror:1 row_mask:0xf bank_mask:0xf
    v_add_f32_dpp v219, v219, v219 row_ror:1 row_mask:0xf bank_mask:0xf
    v_add_f32_dpp v220, v220, v220 row_ror:1 row_mask:0xf bank_mask:0xf
    v_add_f32_dpp v221, v221, v221 row_ror:1 row_mask:0xf bank_mask:0xf
    v_add_f32_dpp v222, v222, v222 row_ror:1 row_mask:0xf bank_mask:0xf
    v_add_f32_dpp v223, v223, v223 row_ror:1 row_mask:0xf bank_mask:0xf
    s_mov_b32 s70, 1040356334
    v_mul_f32 v192, s70, v192
    v_mul_f32 v193, s70, v193
    v_mul_f32 v194, s70, v194
    v_mul_f32 v195, s70, v195
    v_mul_f32 v196, s70, v196
    v_mul_f32 v197, s70, v197
    v_mul_f32 v198, s70, v198
    v_mul_f32 v199, s70, v199
    v_mul_f32 v200, s70, v200
    v_mul_f32 v201, s70, v201
    v_mul_f32 v202, s70, v202
    v_mul_f32 v203, s70, v203
    v_mul_f32 v204, s70, v204
    v_mul_f32 v205, s70, v205
    v_mul_f32 v206, s70, v206
    v_mul_f32 v207, s70, v207
    v_mul_f32 v208, s70, v208
    v_mul_f32 v209, s70, v209
    v_mul_f32 v210, s70, v210
    v_mul_f32 v211, s70, v211
    v_mul_f32 v212, s70, v212
    v_mul_f32 v213, s70, v213
    v_mul_f32 v214, s70, v214
    v_mul_f32 v215, s70, v215
    v_mul_f32 v216, s70, v216
    v_mul_f32 v217, s70, v217
    v_mul_f32 v218, s70, v218
    v_mul_f32 v219, s70, v219
    v_mul_f32 v220, s70, v220
    v_mul_f32 v221, s70, v221
    v_mul_f32 v222, s70, v222
    v_mul_f32 v223, s70, v223
    s_lshl_b32 s61, s56, 8
    s_add_u32 s61, s61, 139264
    v_lshlrev_b32 v40, 6, v2
    v_add_u32 v40, s61, v40
    s_mov_b64 s[94:95], exec
    s_mov_b32 exec_lo, 0x00010001
    s_mov_b32 exec_hi, 0x00010001
    ds_write_b128 v40, v[192:195] offset:0
    ds_write_b128 v40, v[196:199] offset:16
    ds_write_b128 v40, v[200:203] offset:32
    ds_write_b128 v40, v[204:207] offset:48
    ds_write_b128 v40, v[208:211] offset:2048
    ds_write_b128 v40, v[212:215] offset:2064
    ds_write_b128 v40, v[216:219] offset:2080
    ds_write_b128 v40, v[220:223] offset:2096
    s_mov_b64 exec, s[94:95]
    s_waitcnt lgkmcnt(0)
    s_barrier
    s_cmp_eq_u32 s56, 0
    s_cbranch_scc1 Lqa0_78
    s_barrier
    s_mov_b32 s44, s12
    s_mov_b32 s45, s13
    s_and_b32 s45, s45, 0xffff
    s_mov_b32 s46, 4194304
    s_mov_b32 s47, 0x00020000
    s_lshl_b32 s61, s56, 19
    s_lshl_b32 s62, s65, 8
    s_add_u32 s61, s61, s62
    buffer_load_dwordx4 v[64:67], v4, s[44:47], s61 offen nt
    s_add_u32 s61, s61, 8192
    buffer_load_dwordx4 v[68:71], v4, s[44:47], s61 offen nt
    s_add_u32 s61, s61, 8192
    buffer_load_dwordx4 v[72:75], v4, s[44:47], s61 offen nt
    s_add_u32 s61, s61, 8192
    buffer_load_dwordx4 v[76:79], v4, s[44:47], s61 offen nt
    s_add_u32 s61, s61, 8192
    buffer_load_dwordx4 v[80:83], v4, s[44:47], s61 offen nt
    s_add_u32 s61, s61, 8192
    buffer_load_dwordx4 v[84:87], v4, s[44:47], s61 offen nt
    s_add_u32 s61, s61, 8192
    buffer_load_dwordx4 v[88:91], v4, s[44:47], s61 offen nt
    s_add_u32 s61, s61, 8192
    buffer_load_dwordx4 v[92:95], v4, s[44:47], s61 offen nt
    s_add_u32 s61, s61, 8192
    buffer_load_dwordx4 v[96:99], v4, s[44:47], s61 offen nt
    s_add_u32 s61, s61, 8192
    buffer_load_dwordx4 v[100:103], v4, s[44:47], s61 offen nt
    s_add_u32 s61, s61, 8192
    buffer_load_dwordx4 v[104:107], v4, s[44:47], s61 offen nt
    s_add_u32 s61, s61, 8192
    buffer_load_dwordx4 v[108:111], v4, s[44:47], s61 offen nt
    s_add_u32 s61, s61, 8192
    buffer_load_dwordx4 v[112:115], v4, s[44:47], s61 offen nt
    s_add_u32 s61, s61, 8192
    buffer_load_dwordx4 v[116:119], v4, s[44:47], s61 offen nt
    s_add_u32 s61, s61, 8192
    buffer_load_dwordx4 v[120:123], v4, s[44:47], s61 offen nt
    s_add_u32 s61, s61, 8192
    buffer_load_dwordx4 v[124:127], v4, s[44:47], s61 offen nt
    s_mov_b32 s36, s14
    s_mov_b32 s37, s15
    s_and_b32 s37, s37, 0xffff
    s_mov_b32 s38, 4194304
    s_mov_b32 s39, 0x00020000
    s_lshl_b32 s61, s56, 14
    s_lshl_b32 s62, s65, 17
    s_add_u32 s62, s62, s61
    s_add_u32 m0, s61, 0
    v_xor_b32 v52, 0, v5
    buffer_load_dwordx4 v52, s[36:39], s62 offen nt lds
    s_add_u32 s62, s62, 1024
    s_add_u32 m0, s61, 1024
    v_xor_b32 v53, 64, v5
    buffer_load_dwordx4 v53, s[36:39], s62 offen nt lds
    s_add_u32 s62, s62, 1024
    s_add_u32 m0, s61, 2048
    v_xor_b32 v52, 128, v5
    buffer_load_dwordx4 v52, s[36:39], s62 offen nt lds
    s_add_u32 s62, s62, 1024
    s_add_u32 m0, s61, 3072
    v_xor_b32 v53, 192, v5
    buffer_load_dwordx4 v53, s[36:39], s62 offen nt lds
    s_add_u32 s62, s62, 1024
    s_add_u32 m0, s61, 4096
    v_xor_b32 v52, 0, v5
    buffer_load_dwordx4 v52, s[36:39], s62 offen nt lds
    s_add_u32 s62, s62, 1024
    s_add_u32 m0, s61, 5120
    v_xor_b32 v53, 64, v5
    buffer_load_dwordx4 v53, s[36:39], s62 offen nt lds
    s_add_u32 s62, s62, 1024
    s_add_u32 m0, s61, 6144
    v_xor_b32 v52, 128, v5
    buffer_load_dwordx4 v52, s[36:39], s62 offen nt lds
    s_add_u32 s62, s62, 1024
    s_add_u32 m0, s61, 7168
    v_xor_b32 v53, 192, v5
    buffer_load_dwordx4 v53, s[36:39], s62 offen nt lds
    s_add_u32 s62, s62, 1024
    s_add_u32 m0, s61, 8192
    v_xor_b32 v52, 32, v5
    buffer_load_dwordx4 v52, s[36:39], s62 offen nt lds
    s_add_u32 s62, s62, 1024
    s_add_u32 m0, s61, 9216
    v_xor_b32 v53, 96, v5
    buffer_load_dwordx4 v53, s[36:39], s62 offen nt lds
    s_add_u32 s62, s62, 1024
    s_add_u32 m0, s61, 10240
    v_xor_b32 v52, 160, v5
    buffer_load_dwordx4 v52, s[36:39], s62 offen nt lds
    s_add_u32 s62, s62, 1024
    s_add_u32 m0, s61, 11264
    v_xor_b32 v53, 224, v5
    buffer_load_dwordx4 v53, s[36:39], s62 offen nt lds
    s_add_u32 s62, s62, 1024
    s_add_u32 m0, s61, 12288
    v_xor_b32 v52, 32, v5
    buffer_load_dwordx4 v52, s[36:39], s62 offen nt lds
    s_add_u32 s62, s62, 1024
    s_add_u32 m0, s61, 13312
    v_xor_b32 v53, 96, v5
    buffer_load_dwordx4 v53, s[36:39], s62 offen nt lds
    s_add_u32 s62, s62, 1024
    s_add_u32 m0, s61, 14336
    v_xor_b32 v52, 160, v5
    buffer_load_dwordx4 v52, s[36:39], s62 offen nt lds
    s_add_u32 s62, s62, 1024
    s_add_u32 m0, s61, 15360
    v_xor_b32 v53, 224, v5
    buffer_load_dwordx4 v53, s[36:39], s62 offen nt lds
    s_branch Lqaj_79
Lqa0_78:
    v_lshlrev_b32 v40, 5, v1
    v_add_u32 v40, 139264, v40
    ds_read_b128 v[192:195], v40 offset:0
    ds_read_b128 v[196:199], v40 offset:16
    ds_read_b128 v[200:203], v40 offset:2048
    ds_read_b128 v[204:207], v40 offset:2064
    s_waitcnt lgkmcnt(0)
    s_lshl_b32 s61, s65, 10
    s_add_u32 s61, s61, 1146880
    v_cvt_pk_bf16_f32 v208, v192, v193
    v_cvt_pk_bf16_f32 v209, v194, v195
    v_cvt_pk_bf16_f32 v210, v196, v197
    v_cvt_pk_bf16_f32 v211, v198, v199
    buffer_store_dwordx4 v[208:211], v5, s[32:35], s61 offen sc0 sc1
    s_add_u32 s61, s61, 32768
    v_cvt_pk_bf16_f32 v212, v200, v201
    v_cvt_pk_bf16_f32 v213, v202, v203
    v_cvt_pk_bf16_f32 v214, v204, v205
    v_cvt_pk_bf16_f32 v215, v206, v207
    buffer_store_dwordx4 v[212:215], v5, s[32:35], s61 offen sc0 sc1
    s_barrier
    s_mov_b32 s44, s12
    s_mov_b32 s45, s13
    s_and_b32 s45, s45, 0xffff
    s_mov_b32 s46, 4194304
    s_mov_b32 s47, 0x00020000
    s_lshl_b32 s61, s56, 19
    s_lshl_b32 s62, s65, 8
    s_add_u32 s61, s61, s62
    buffer_load_dwordx4 v[64:67], v4, s[44:47], s61 offen nt
    s_add_u32 s61, s61, 8192
    buffer_load_dwordx4 v[68:71], v4, s[44:47], s61 offen nt
    s_add_u32 s61, s61, 8192
    buffer_load_dwordx4 v[72:75], v4, s[44:47], s61 offen nt
    s_add_u32 s61, s61, 8192
    buffer_load_dwordx4 v[76:79], v4, s[44:47], s61 offen nt
    s_add_u32 s61, s61, 8192
    buffer_load_dwordx4 v[80:83], v4, s[44:47], s61 offen nt
    s_add_u32 s61, s61, 8192
    buffer_load_dwordx4 v[84:87], v4, s[44:47], s61 offen nt
    s_add_u32 s61, s61, 8192
    buffer_load_dwordx4 v[88:91], v4, s[44:47], s61 offen nt
    s_add_u32 s61, s61, 8192
    buffer_load_dwordx4 v[92:95], v4, s[44:47], s61 offen nt
    s_add_u32 s61, s61, 8192
    buffer_load_dwordx4 v[96:99], v4, s[44:47], s61 offen nt
    s_add_u32 s61, s61, 8192
    buffer_load_dwordx4 v[100:103], v4, s[44:47], s61 offen nt
    s_add_u32 s61, s61, 8192
    buffer_load_dwordx4 v[104:107], v4, s[44:47], s61 offen nt
    s_add_u32 s61, s61, 8192
    buffer_load_dwordx4 v[108:111], v4, s[44:47], s61 offen nt
    s_add_u32 s61, s61, 8192
    buffer_load_dwordx4 v[112:115], v4, s[44:47], s61 offen nt
    s_add_u32 s61, s61, 8192
    buffer_load_dwordx4 v[116:119], v4, s[44:47], s61 offen nt
    s_add_u32 s61, s61, 8192
    buffer_load_dwordx4 v[120:123], v4, s[44:47], s61 offen nt
    s_add_u32 s61, s61, 8192
    buffer_load_dwordx4 v[124:127], v4, s[44:47], s61 offen nt
    s_mov_b32 s36, s14
    s_mov_b32 s37, s15
    s_and_b32 s37, s37, 0xffff
    s_mov_b32 s38, 4194304
    s_mov_b32 s39, 0x00020000
    s_lshl_b32 s61, s56, 14
    s_lshl_b32 s62, s65, 17
    s_add_u32 s62, s62, s61
    s_add_u32 m0, s61, 0
    v_xor_b32 v52, 0, v5
    buffer_load_dwordx4 v52, s[36:39], s62 offen nt lds
    s_add_u32 s62, s62, 1024
    s_add_u32 m0, s61, 1024
    v_xor_b32 v53, 64, v5
    buffer_load_dwordx4 v53, s[36:39], s62 offen nt lds
    s_add_u32 s62, s62, 1024
    s_add_u32 m0, s61, 2048
    v_xor_b32 v52, 128, v5
    buffer_load_dwordx4 v52, s[36:39], s62 offen nt lds
    s_add_u32 s62, s62, 1024
    s_add_u32 m0, s61, 3072
    v_xor_b32 v53, 192, v5
    buffer_load_dwordx4 v53, s[36:39], s62 offen nt lds
    s_add_u32 s62, s62, 1024
    s_add_u32 m0, s61, 4096
    v_xor_b32 v52, 0, v5
    buffer_load_dwordx4 v52, s[36:39], s62 offen nt lds
    s_add_u32 s62, s62, 1024
    s_add_u32 m0, s61, 5120
    v_xor_b32 v53, 64, v5
    buffer_load_dwordx4 v53, s[36:39], s62 offen nt lds
    s_add_u32 s62, s62, 1024
    s_add_u32 m0, s61, 6144
    v_xor_b32 v52, 128, v5
    buffer_load_dwordx4 v52, s[36:39], s62 offen nt lds
    s_add_u32 s62, s62, 1024
    s_add_u32 m0, s61, 7168
    v_xor_b32 v53, 192, v5
    buffer_load_dwordx4 v53, s[36:39], s62 offen nt lds
    s_add_u32 s62, s62, 1024
    s_add_u32 m0, s61, 8192
    v_xor_b32 v52, 32, v5
    buffer_load_dwordx4 v52, s[36:39], s62 offen nt lds
    s_add_u32 s62, s62, 1024
    s_add_u32 m0, s61, 9216
    v_xor_b32 v53, 96, v5
    buffer_load_dwordx4 v53, s[36:39], s62 offen nt lds
    s_add_u32 s62, s62, 1024
    s_add_u32 m0, s61, 10240
    v_xor_b32 v52, 160, v5
    buffer_load_dwordx4 v52, s[36:39], s62 offen nt lds
    s_add_u32 s62, s62, 1024
    s_add_u32 m0, s61, 11264
    v_xor_b32 v53, 224, v5
    buffer_load_dwordx4 v53, s[36:39], s62 offen nt lds
    s_add_u32 s62, s62, 1024
    s_add_u32 m0, s61, 12288
    v_xor_b32 v52, 32, v5
    buffer_load_dwordx4 v52, s[36:39], s62 offen nt lds
    s_add_u32 s62, s62, 1024
    s_add_u32 m0, s61, 13312
    v_xor_b32 v53, 96, v5
    buffer_load_dwordx4 v53, s[36:39], s62 offen nt lds
    s_add_u32 s62, s62, 1024
    s_add_u32 m0, s61, 14336
    v_xor_b32 v52, 160, v5
    buffer_load_dwordx4 v52, s[36:39], s62 offen nt lds
    s_add_u32 s62, s62, 1024
    s_add_u32 m0, s61, 15360
    v_xor_b32 v53, 224, v5
    buffer_load_dwordx4 v53, s[36:39], s62 offen nt lds
Lqaj_79:
    s_waitcnt vmcnt(0)
    s_barrier
    v_lshrrev_b32 v40, 2, v3
    v_and_b32 v41, 1, v2
    v_lshlrev_b32 v42, 2, v40
    v_lshl_or_b32 v42, v41, 1, v42
    v_lshl_add_u32 v43, v2, 3, v40
    v_lshlrev_b32 v43, 10, v43
    v_and_b32 v44, 1, v3
    v_lshl_add_u32 v43, v44, 3, v43
    v_bfe_u32 v44, v3, 1, 1
    s_lshl_b32 s61, s56, 3
    s_add_u32 s62, s61, 0
    v_add_u32 v45, s62, v44
    v_xor_b32 v45, v45, v42
    v_lshl_add_u32 v48, v45, 4, v43
    s_add_u32 s62, s61, 2
    v_add_u32 v45, s62, v44
    v_xor_b32 v45, v45, v42
    v_lshl_add_u32 v49, v45, 4, v43
    s_add_u32 s62, s61, 4
    v_add_u32 v45, s62, v44
    v_xor_b32 v45, v45, v42
    v_lshl_add_u32 v50, v45, 4, v43
    s_add_u32 s62, s61, 6
    v_add_u32 v45, s62, v44
    v_xor_b32 v45, v45, v42
    v_lshl_add_u32 v51, v45, 4, v43
    ds_read_b64_tr_b16 v[128:129], v48 offset:0
    ds_read_b64_tr_b16 v[130:131], v48 offset:4096
    ds_read_b64_tr_b16 v[144:145], v49 offset:0
    ds_read_b64_tr_b16 v[146:147], v49 offset:4096
    ds_read_b64_tr_b16 v[160:161], v50 offset:0
    ds_read_b64_tr_b16 v[162:163], v50 offset:4096
    ds_read_b64_tr_b16 v[176:177], v51 offset:0
    ds_read_b64_tr_b16 v[178:179], v51 offset:4096
    s_waitcnt lgkmcnt(0)
    ds_read_b64_tr_b16 v[132:133], v48 offset:32768
    ds_read_b64_tr_b16 v[134:135], v48 offset:36864
    ds_read_b64_tr_b16 v[148:149], v49 offset:32768
    ds_read_b64_tr_b16 v[150:151], v49 offset:36864
    ds_read_b64_tr_b16 v[164:165], v50 offset:32768
    ds_read_b64_tr_b16 v[166:167], v50 offset:36864
    ds_read_b64_tr_b16 v[180:181], v51 offset:32768
    ds_read_b64_tr_b16 v[182:183], v51 offset:36864
    s_waitcnt lgkmcnt(0)
    v_add_u32 v48, 0x10000, v48
    v_add_u32 v49, 0x10000, v49
    v_add_u32 v50, 0x10000, v50
    v_add_u32 v51, 0x10000, v51
    ds_read_b64_tr_b16 v[136:137], v48 offset:0
    ds_read_b64_tr_b16 v[138:139], v48 offset:4096
    ds_read_b64_tr_b16 v[152:153], v49 offset:0
    ds_read_b64_tr_b16 v[154:155], v49 offset:4096
    ds_read_b64_tr_b16 v[168:169], v50 offset:0
    ds_read_b64_tr_b16 v[170:171], v50 offset:4096
    ds_read_b64_tr_b16 v[184:185], v51 offset:0
    ds_read_b64_tr_b16 v[186:187], v51 offset:4096
    s_waitcnt lgkmcnt(0)
    ds_read_b64_tr_b16 v[140:141], v48 offset:32768
    ds_read_b64_tr_b16 v[142:143], v48 offset:36864
    ds_read_b64_tr_b16 v[156:157], v49 offset:32768
    ds_read_b64_tr_b16 v[158:159], v49 offset:36864
    ds_read_b64_tr_b16 v[172:173], v50 offset:32768
    ds_read_b64_tr_b16 v[174:175], v50 offset:36864
    ds_read_b64_tr_b16 v[188:189], v51 offset:32768
    ds_read_b64_tr_b16 v[190:191], v51 offset:36864
    s_waitcnt lgkmcnt(0)
    s_barrier
    s_cmp_lg_u32 s56, 0
    s_cbranch_scc1 Lwf_80
    v_lshlrev_b32 v40, 2, v1
    s_mov_b64 exec, 0xffffffff
    s_mov_b32 s92, 0
Lpoll_81:
    buffer_load_dword v41, v40, s[32:35], s93 offen offset:0 sc0 sc1
    s_waitcnt vmcnt(0)
    v_mov_b32 v42, v41
    v_cmpx_eq_u32 vcc, -1, v42
    s_cbranch_execz Lpolld_82
    s_sleep 8
    s_add_u32 s92, s92, 1
    s_cmp_lt_u32 s92, 400000
    s_cbranch_scc1 Lpoll_81
Lpolld_82:
    s_mov_b64 exec, -1
Lwf_80:
    s_barrier
    s_lshr_b32 s66, s56, 2
    s_and_b32 s63, s56, 3
    s_lshl_b32 s61, s56, 17
    s_lshl_b32 s62, s65, 10
    s_add_u32 s61, s61, s62
    s_add_u32 s61, s61, 2097152
    v_lshlrev_b32 v40, 3, v3
    s_lshl_b32 s62, s65, 8
    s_lshl_b32 s64, s66, 7
    s_add_u32 s62, s62, s64
    s_add_u32 s62, s62, 1245184
    buffer_load_dwordx2 v[42:43], v40, s[32:35], s62 offen sc0 sc1
    buffer_load_dwordx4 v[192:195], v5, s[32:35], s61 offen sc0 sc1
    s_add_u32 s61, s61, 32768
    buffer_load_dwordx4 v[196:199], v5, s[32:35], s61 offen sc0 sc1
    s_add_u32 s61, s61, 32768
    buffer_load_dwordx4 v[200:203], v5, s[32:35], s61 offen sc0 sc1
    s_add_u32 s61, s61, 32768
    buffer_load_dwordx4 v[204:207], v5, s[32:35], s61 offen sc0 sc1
    s_waitcnt vmcnt(4)
    v_mov_b32 v44, v42
    s_nop 1
    v_max_f32_dpp v44, v44, v44 row_ror:8 row_mask:0xf bank_mask:0xf
    s_nop 1
    v_max_f32_dpp v44, v44, v44 row_ror:4 row_mask:0xf bank_mask:0xf
    s_nop 1
    v_max_f32_dpp v44, v44, v44 row_ror:2 row_mask:0xf bank_mask:0xf
    s_nop 1
    v_max_f32_dpp v44, v44, v44 row_ror:1 row_mask:0xf bank_mask:0xf
    v_sub_f32 v42, v42, v44
    v_exp_f32 v42, v42
    s_nop 0
    v_mul_f32 v43, v43, v42
    s_nop 1
    v_add_f32_dpp v43, v43, v43 row_ror:8 row_mask:0xf bank_mask:0xf
    s_nop 1
    v_add_f32_dpp v43, v43, v43 row_ror:4 row_mask:0xf bank_mask:0xf
    s_nop 1
    v_add_f32_dpp v43, v43, v43 row_ror:2 row_mask:0xf bank_mask:0xf
    s_nop 1
    v_add_f32_dpp v43, v43, v43 row_ror:1 row_mask:0xf bank_mask:0xf
    v_rcp_f32 v43, v43
    s_nop 0
    v_mul_f32 v42, v42, v43
    s_lshl_b32 s63, s63, 2
    s_nop 1
    s_add_u32 s64, s63, 0
    v_readlane_b32 s76, v42, s64
    s_add_u32 s64, s63, 1
    v_readlane_b32 s77, v42, s64
    s_add_u32 s64, s63, 2
    v_readlane_b32 s78, v42, s64
    s_add_u32 s64, s63, 3
    v_readlane_b32 s79, v42, s64
    s_nop 1
    s_waitcnt vmcnt(3)
    v_lshlrev_b32 v48, 16, v192
    v_and_b32 v49, 0xffff0000, v192
    v_lshlrev_b32 v50, 16, v193
    v_and_b32 v51, 0xffff0000, v193
    v_lshlrev_b32 v52, 16, v194
    v_and_b32 v53, 0xffff0000, v194
    v_lshlrev_b32 v54, 16, v195
    v_and_b32 v55, 0xffff0000, v195
    v_mul_f32 v24, s76, v48
    v_mul_f32 v25, s76, v49
    v_mul_f32 v26, s76, v50
    v_mul_f32 v27, s76, v51
    v_mul_f32 v28, s76, v52
    v_mul_f32 v29, s76, v53
    v_mul_f32 v30, s76, v54
    v_mul_f32 v31, s76, v55
    s_waitcnt vmcnt(2)
    v_lshlrev_b32 v48, 16, v196
    v_and_b32 v49, 0xffff0000, v196
    v_lshlrev_b32 v50, 16, v197
    v_and_b32 v51, 0xffff0000, v197
    v_lshlrev_b32 v52, 16, v198
    v_and_b32 v53, 0xffff0000, v198
    v_lshlrev_b32 v54, 16, v199
    v_and_b32 v55, 0xffff0000, v199
    v_fmac_f32 v24, s77, v48
    v_fmac_f32 v25, s77, v49
    v_fmac_f32 v26, s77, v50
    v_fmac_f32 v27, s77, v51
    v_fmac_f32 v28, s77, v52
    v_fmac_f32 v29, s77, v53
    v_fmac_f32 v30, s77, v54
    v_fmac_f32 v31, s77, v55
    s_waitcnt vmcnt(1)
    v_lshlrev_b32 v48, 16, v200
    v_and_b32 v49, 0xffff0000, v200
    v_lshlrev_b32 v50, 16, v201
    v_and_b32 v51, 0xffff0000, v201
    v_lshlrev_b32 v52, 16, v202
    v_and_b32 v53, 0xffff0000, v202
    v_lshlrev_b32 v54, 16, v203
    v_and_b32 v55, 0xffff0000, v203
    v_fmac_f32 v24, s78, v48
    v_fmac_f32 v25, s78, v49
    v_fmac_f32 v26, s78, v50
    v_fmac_f32 v27, s78, v51
    v_fmac_f32 v28, s78, v52
    v_fmac_f32 v29, s78, v53
    v_fmac_f32 v30, s78, v54
    v_fmac_f32 v31, s78, v55
    s_waitcnt vmcnt(0)
    v_lshlrev_b32 v48, 16, v204
    v_and_b32 v49, 0xffff0000, v204
    v_lshlrev_b32 v50, 16, v205
    v_and_b32 v51, 0xffff0000, v205
    v_lshlrev_b32 v52, 16, v206
    v_and_b32 v53, 0xffff0000, v206
    v_lshlrev_b32 v54, 16, v207
    v_and_b32 v55, 0xffff0000, v207
    v_fmac_f32 v24, s79, v48
    v_fmac_f32 v25, s79, v49
    v_fmac_f32 v26, s79, v50
    v_fmac_f32 v27, s79, v51
    v_fmac_f32 v28, s79, v52
    v_fmac_f32 v29, s79, v53
    v_fmac_f32 v30, s79, v54
    v_fmac_f32 v31, s79, v55
    s_lshl_b32 s61, s56, 11
    v_lshlrev_b32 v40, 5, v1
    v_add_u32 v40, s61, v40
    ds_write_b128 v40, v[24:27] offset:16384
    ds_write_b128 v40, v[28:31] offset:16400
    s_waitcnt lgkmcnt(0)
    s_barrier
    v_and_b32 v40, 255, v0
    v_lshlrev_b32 v40, 3, v40
    s_lshl_b32 s61, s66, 13
    v_add_u32 v40, s61, v40
    ds_read_b64 v[24:25], v40 offset:16384
    ds_read_b64 v[26:27], v40 offset:18432
    ds_read_b64 v[28:29], v40 offset:20480
    ds_read_b64 v[30:31], v40 offset:22528
    s_waitcnt lgkmcnt(0)
    v_add_f32 v24, v24, v26
    v_add_f32 v25, v25, v27
    v_add_f32 v24, v24, v28
    v_add_f32 v25, v25, v29
    v_add_f32 v24, v24, v30
    v_add_f32 v25, v25, v31
    v_cvt_pk_bf16_f32 v24, v24, v25
    v_lshlrev_b32 v40, 2, v0
    ds_write_b32 v40, v24 offset:32768
    s_waitcnt lgkmcnt(0)
    s_barrier
    s_lshl_b32 s61, s56, 7
    v_lshlrev_b32 v40, 5, v2
    v_add_u32 v40, s61, v40
    ds_read_b128 v[8:11], v40 offset:32768
    ds_read_b128 v[12:15], v40 offset:32784
    ds_read_b128 v[16:19], v40 offset:33792
    ds_read_b128 v[20:23], v40 offset:33808
    s_waitcnt lgkmcnt(0)
    v_mov_b32 v24, 0
    v_mov_b32 v25, 0
    v_mov_b32 v26, 0
    v_mov_b32 v27, 0
    v_mov_b32 v28, 0
    v_mov_b32 v29, 0
    v_mov_b32 v30, 0
    v_mov_b32 v31, 0
    v_mov_b32 v32, 0
    v_mov_b32 v33, 0
    v_mov_b32 v34, 0
    v_mov_b32 v35, 0
    v_mov_b32 v36, 0
    v_mov_b32 v37, 0
    v_mov_b32 v38, 0
    v_mov_b32 v39, 0
    v_perm_b32 v40, v68, v64, s68
    v_perm_b32 v41, v68, v64, s69
    v_perm_b32 v42, v69, v65, s68
    v_perm_b32 v43, v69, v65, s69
    v_perm_b32 v44, v70, v66, s68
    v_perm_b32 v45, v70, v66, s69
    v_perm_b32 v46, v71, v67, s68
    v_perm_b32 v47, v71, v67, s69
    v_dot2_f32_bf16 v24, v40, v8, v24
    v_dot2_f32_bf16 v25, v41, v8, v25
    v_dot2_f32_bf16 v26, v42, v8, v26
    v_dot2_f32_bf16 v27, v43, v8, v27
    v_dot2_f32_bf16 v28, v44, v8, v28
    v_dot2_f32_bf16 v29, v45, v8, v29
    v_dot2_f32_bf16 v30, v46, v8, v30
    v_dot2_f32_bf16 v31, v47, v8, v31
    v_dot2_f32_bf16 v32, v40, v16, v32
    v_dot2_f32_bf16 v33, v41, v16, v33
    v_dot2_f32_bf16 v34, v42, v16, v34
    v_dot2_f32_bf16 v35, v43, v16, v35
    v_dot2_f32_bf16 v36, v44, v16, v36
    v_dot2_f32_bf16 v37, v45, v16, v37
    v_dot2_f32_bf16 v38, v46, v16, v38
    v_dot2_f32_bf16 v39, v47, v16, v39
    v_perm_b32 v40, v76, v72, s68
    v_perm_b32 v41, v76, v72, s69
    v_perm_b32 v42, v77, v73, s68
    v_perm_b32 v43, v77, v73, s69
    v_perm_b32 v44, v78, v74, s68
    v_perm_b32 v45, v78, v74, s69
    v_perm_b32 v46, v79, v75, s68
    v_perm_b32 v47, v79, v75, s69
    v_dot2_f32_bf16 v24, v40, v9, v24
    v_dot2_f32_bf16 v25, v41, v9, v25
    v_dot2_f32_bf16 v26, v42, v9, v26
    v_dot2_f32_bf16 v27, v43, v9, v27
    v_dot2_f32_bf16 v28, v44, v9, v28
    v_dot2_f32_bf16 v29, v45, v9, v29
    v_dot2_f32_bf16 v30, v46, v9, v30
    v_dot2_f32_bf16 v31, v47, v9, v31
    v_dot2_f32_bf16 v32, v40, v17, v32
    v_dot2_f32_bf16 v33, v41, v17, v33
    v_dot2_f32_bf16 v34, v42, v17, v34
    v_dot2_f32_bf16 v35, v43, v17, v35
    v_dot2_f32_bf16 v36, v44, v17, v36
    v_dot2_f32_bf16 v37, v45, v17, v37
    v_dot2_f32_bf16 v38, v46, v17, v38
    v_dot2_f32_bf16 v39, v47, v17, v39
    v_perm_b32 v40, v84, v80, s68
    v_perm_b32 v41, v84, v80, s69
    v_perm_b32 v42, v85, v81, s68
    v_perm_b32 v43, v85, v81, s69
    v_perm_b32 v44, v86, v82, s68
    v_perm_b32 v45, v86, v82, s69
    v_perm_b32 v46, v87, v83, s68
    v_perm_b32 v47, v87, v83, s69
    v_dot2_f32_bf16 v24, v40, v10, v24
    v_dot2_f32_bf16 v25, v41, v10, v25
    v_dot2_f32_bf16 v26, v42, v10, v26
    v_dot2_f32_bf16 v27, v43, v10, v27
    v_dot2_f32_bf16 v28, v44, v10, v28
    v_dot2_f32_bf16 v29, v45, v10, v29
    v_dot2_f32_bf16 v30, v46, v10, v30
    v_dot2_f32_bf16 v31, v47, v10, v31
    v_dot2_f32_bf16 v32, v40, v18, v32
    v_dot2_f32_bf16 v33, v41, v18, v33
    v_dot2_f32_bf16 v34, v42, v18, v34
    v_dot2_f32_bf16 v35, v43, v18, v35
    v_dot2_f32_bf16 v36, v44, v18, v36
    v_dot2_f32_bf16 v37, v45, v18, v37
    v_dot2_f32_bf16 v38, v46, v18, v38
    v_dot2_f32_bf16 v39, v47, v18, v39
    v_perm_b32 v40, v92, v88, s68
    v_perm_b32 v41, v92, v88, s69
    v_perm_b32 v42, v93, v89, s68
    v_perm_b32 v43, v93, v89, s69
    v_perm_b32 v44, v94, v90, s68
    v_perm_b32 v45, v94, v90, s69
    v_perm_b32 v46, v95, v91, s68
    v_perm_b32 v47, v95, v91, s69
    v_dot2_f32_bf16 v24, v40, v11, v24
    v_dot2_f32_bf16 v25, v41, v11, v25
    v_dot2_f32_bf16 v26, v42, v11, v26
    v_dot2_f32_bf16 v27, v43, v11, v27
    v_dot2_f32_bf16 v28, v44, v11, v28
    v_dot2_f32_bf16 v29, v45, v11, v29
    v_dot2_f32_bf16 v30, v46, v11, v30
    v_dot2_f32_bf16 v31, v47, v11, v31
    v_dot2_f32_bf16 v32, v40, v19, v32
    v_dot2_f32_bf16 v33, v41, v19, v33
    v_dot2_f32_bf16 v34, v42, v19, v34
    v_dot2_f32_bf16 v35, v43, v19, v35
    v_dot2_f32_bf16 v36, v44, v19, v36
    v_dot2_f32_bf16 v37, v45, v19, v37
    v_dot2_f32_bf16 v38, v46, v19, v38
    v_dot2_f32_bf16 v39, v47, v19, v39
    v_perm_b32 v40, v100, v96, s68
    v_perm_b32 v41, v100, v96, s69
    v_perm_b32 v42, v101, v97, s68
    v_perm_b32 v43, v101, v97, s69
    v_perm_b32 v44, v102, v98, s68
    v_perm_b32 v45, v102, v98, s69
    v_perm_b32 v46, v103, v99, s68
    v_perm_b32 v47, v103, v99, s69
    v_dot2_f32_bf16 v24, v40, v12, v24
    v_dot2_f32_bf16 v25, v41, v12, v25
    v_dot2_f32_bf16 v26, v42, v12, v26
    v_dot2_f32_bf16 v27, v43, v12, v27
    v_dot2_f32_bf16 v28, v44, v12, v28
    v_dot2_f32_bf16 v29, v45, v12, v29
    v_dot2_f32_bf16 v30, v46, v12, v30
    v_dot2_f32_bf16 v31, v47, v12, v31
    v_dot2_f32_bf16 v32, v40, v20, v32
    v_dot2_f32_bf16 v33, v41, v20, v33
    v_dot2_f32_bf16 v34, v42, v20, v34
    v_dot2_f32_bf16 v35, v43, v20, v35
    v_dot2_f32_bf16 v36, v44, v20, v36
    v_dot2_f32_bf16 v37, v45, v20, v37
    v_dot2_f32_bf16 v38, v46, v20, v38
    v_dot2_f32_bf16 v39, v47, v20, v39
    v_perm_b32 v40, v108, v104, s68
    v_perm_b32 v41, v108, v104, s69
    v_perm_b32 v42, v109, v105, s68
    v_perm_b32 v43, v109, v105, s69
    v_perm_b32 v44, v110, v106, s68
    v_perm_b32 v45, v110, v106, s69
    v_perm_b32 v46, v111, v107, s68
    v_perm_b32 v47, v111, v107, s69
    v_dot2_f32_bf16 v24, v40, v13, v24
    v_dot2_f32_bf16 v25, v41, v13, v25
    v_dot2_f32_bf16 v26, v42, v13, v26
    v_dot2_f32_bf16 v27, v43, v13, v27
    v_dot2_f32_bf16 v28, v44, v13, v28
    v_dot2_f32_bf16 v29, v45, v13, v29
    v_dot2_f32_bf16 v30, v46, v13, v30
    v_dot2_f32_bf16 v31, v47, v13, v31
    v_dot2_f32_bf16 v32, v40, v21, v32
    v_dot2_f32_bf16 v33, v41, v21, v33
    v_dot2_f32_bf16 v34, v42, v21, v34
    v_dot2_f32_bf16 v35, v43, v21, v35
    v_dot2_f32_bf16 v36, v44, v21, v36
    v_dot2_f32_bf16 v37, v45, v21, v37
    v_dot2_f32_bf16 v38, v46, v21, v38
    v_dot2_f32_bf16 v39, v47, v21, v39
    v_perm_b32 v40, v116, v112, s68
    v_perm_b32 v41, v116, v112, s69
    v_perm_b32 v42, v117, v113, s68
    v_perm_b32 v43, v117, v113, s69
    v_perm_b32 v44, v118, v114, s68
    v_perm_b32 v45, v118, v114, s69
    v_perm_b32 v46, v119, v115, s68
    v_perm_b32 v47, v119, v115, s69
    v_dot2_f32_bf16 v24, v40, v14, v24
    v_dot2_f32_bf16 v25, v41, v14, v25
    v_dot2_f32_bf16 v26, v42, v14, v26
    v_dot2_f32_bf16 v27, v43, v14, v27
    v_dot2_f32_bf16 v28, v44, v14, v28
    v_dot2_f32_bf16 v29, v45, v14, v29
    v_dot2_f32_bf16 v30, v46, v14, v30
    v_dot2_f32_bf16 v31, v47, v14, v31
    v_dot2_f32_bf16 v32, v40, v22, v32
    v_dot2_f32_bf16 v33, v41, v22, v33
    v_dot2_f32_bf16 v34, v42, v22, v34
    v_dot2_f32_bf16 v35, v43, v22, v35
    v_dot2_f32_bf16 v36, v44, v22, v36
    v_dot2_f32_bf16 v37, v45, v22, v37
    v_dot2_f32_bf16 v38, v46, v22, v38
    v_dot2_f32_bf16 v39, v47, v22, v39
    v_perm_b32 v40, v124, v120, s68
    v_perm_b32 v41, v124, v120, s69
    v_perm_b32 v42, v125, v121, s68
    v_perm_b32 v43, v125, v121, s69
    v_perm_b32 v44, v126, v122, s68
    v_perm_b32 v45, v126, v122, s69
    v_perm_b32 v46, v127, v123, s68
    v_perm_b32 v47, v127, v123, s69
    v_dot2_f32_bf16 v24, v40, v15, v24
    v_dot2_f32_bf16 v25, v41, v15, v25
    v_dot2_f32_bf16 v26, v42, v15, v26
    v_dot2_f32_bf16 v27, v43, v15, v27
    v_dot2_f32_bf16 v28, v44, v15, v28
    v_dot2_f32_bf16 v29, v45, v15, v29
    v_dot2_f32_bf16 v30, v46, v15, v30
    v_dot2_f32_bf16 v31, v47, v15, v31
    v_dot2_f32_bf16 v32, v40, v23, v32
    v_dot2_f32_bf16 v33, v41, v23, v33
    v_dot2_f32_bf16 v34, v42, v23, v34
    v_dot2_f32_bf16 v35, v43, v23, v35
    v_dot2_f32_bf16 v36, v44, v23, v36
    v_dot2_f32_bf16 v37, v45, v23, v37
    v_dot2_f32_bf16 v38, v46, v23, v38
    v_dot2_f32_bf16 v39, v47, v23, v39
    s_nop 2
    v_permlane32_swap_b32 v24, v28
    v_permlane32_swap_b32 v25, v29
    v_permlane32_swap_b32 v26, v30
    v_permlane32_swap_b32 v27, v31
    v_permlane32_swap_b32 v32, v36
    v_permlane32_swap_b32 v33, v37
    v_permlane32_swap_b32 v34, v38
    v_permlane32_swap_b32 v35, v39
    s_nop 1
    v_add_f32 v24, v24, v28
    v_add_f32 v25, v25, v29
    v_add_f32 v26, v26, v30
    v_add_f32 v27, v27, v31
    v_add_f32 v32, v32, v36
    v_add_f32 v33, v33, v37
    v_add_f32 v34, v34, v38
    v_add_f32 v35, v35, v39
    s_nop 1
    v_permlane16_swap_b32 v24, v26
    v_permlane16_swap_b32 v25, v27
    v_permlane16_swap_b32 v32, v34
    v_permlane16_swap_b32 v33, v35
    s_nop 1
    v_add_f32 v24, v24, v26
    v_add_f32 v25, v25, v27
    v_add_f32 v32, v32, v34
    v_add_f32 v33, v33, v35
    v_lshlrev_b32 v48, 5, v3
    v_lshl_add_u32 v48, v2, 3, v48
    s_lshl_b32 s61, s56, 9
    v_add_u32 v49, s61, v48
    ds_write_b64 v49, v[24:25] offset:0
    ds_write_b64 v49, v[32:33] offset:4096
    s_waitcnt lgkmcnt(0)
    s_barrier
    v_lshrrev_b32 v40, 5, v1
    v_lshlrev_b32 v40, 12, v40
    v_and_b32 v41, 31, v1
    v_lshl_add_u32 v40, v41, 4, v40
    ds_read_b128 v[192:195], v40 offset:0
    ds_read_b128 v[196:199], v40 offset:512
    ds_read_b128 v[200:203], v40 offset:1024
    ds_read_b128 v[204:207], v40 offset:1536
    ds_read_b128 v[208:211], v40 offset:2048
    ds_read_b128 v[212:215], v40 offset:2560
    ds_read_b128 v[216:219], v40 offset:3072
    ds_read_b128 v[220:223], v40 offset:3584
    s_lshl_b32 s61, s56, 9
    s_add_u32 s61, s61, 131072
    v_lshlrev_b32 v46, 3, v1
    v_add_u32 v46, s61, v46
    v_and_b32 v47, 1, v3
    v_lshlrev_b32 v47, 8, v47
    v_lshl_add_u32 v47, v2, 4, v47
    v_add_u32 v47, s61, v47
    s_waitcnt lgkmcnt(6)
    v_add_f32 v192, v192, v196
    v_add_f32 v193, v193, v197
    v_add_f32 v194, v194, v198
    v_add_f32 v195, v195, v199
    s_waitcnt lgkmcnt(5)
    v_add_f32 v192, v192, v200
    v_add_f32 v193, v193, v201
    v_add_f32 v194, v194, v202
    v_add_f32 v195, v195, v203
    s_waitcnt lgkmcnt(4)
    v_add_f32 v192, v192, v204
    v_add_f32 v193, v193, v205
    v_add_f32 v194, v194, v206
    v_add_f32 v195, v195, v207
    s_waitcnt lgkmcnt(3)
    v_add_f32 v192, v192, v208
    v_add_f32 v193, v193, v209
    v_add_f32 v194, v194, v210
    v_add_f32 v195, v195, v211
    s_waitcnt lgkmcnt(2)
    v_add_f32 v192, v192, v212
    v_add_f32 v193, v193, v213
    v_add_f32 v194, v194, v214
    v_add_f32 v195, v195, v215
    s_waitcnt lgkmcnt(1)
    v_add_f32 v192, v192, v216
    v_add_f32 v193, v193, v217
    v_add_f32 v194, v194, v218
    v_add_f32 v195, v195, v219
    s_waitcnt lgkmcnt(0)
    v_add_f32 v192, v192, v220
    v_add_f32 v193, v193, v221
    v_add_f32 v194, v194, v222
    v_add_f32 v195, v195, v223
    v_cvt_pk_bf16_f32 v192, v192, v193
    v_cvt_pk_bf16_f32 v193, v194, v195
    ds_write_b64 v46, v[192:193]
    s_waitcnt lgkmcnt(0)
    ds_read_b128 v[24:27], v47 offset:0
    ds_read_b128 v[28:31], v47 offset:64
    ds_read_b128 v[32:35], v47 offset:128
    ds_read_b128 v[36:39], v47 offset:192
    v_and_b32 v40, 1, v1
    v_lshlrev_b32 v40, 19, v40
    v_lshl_add_u32 v40, v2, 4, v40
    s_lshl_b32 s61, s56, 16
    s_lshl_b32 s62, s65, 6
    s_add_u32 s61, s61, s62
    s_add_u32 s61, s61, 10752
    s_waitcnt lgkmcnt(3)
    v_mfma_f32_16x16x32_bf16 v[8:11], v[128:131], v[24:27], 0
    v_mfma_f32_16x16x32_bf16 v[12:15], v[144:147], v[24:27], 0
    v_mfma_f32_16x16x32_bf16 v[16:19], v[160:163], v[24:27], 0
    v_mfma_f32_16x16x32_bf16 v[20:23], v[176:179], v[24:27], 0
    s_waitcnt lgkmcnt(2)
    v_mfma_f32_16x16x32_bf16 v[8:11], v[132:135], v[28:31], v[8:11]
    v_mfma_f32_16x16x32_bf16 v[12:15], v[148:151], v[28:31], v[12:15]
    v_mfma_f32_16x16x32_bf16 v[16:19], v[164:167], v[28:31], v[16:19]
    v_mfma_f32_16x16x32_bf16 v[20:23], v[180:183], v[28:31], v[20:23]
    s_waitcnt lgkmcnt(1)
    v_mfma_f32_16x16x32_bf16 v[8:11], v[136:139], v[32:35], v[8:11]
    v_mfma_f32_16x16x32_bf16 v[12:15], v[152:155], v[32:35], v[12:15]
    v_mfma_f32_16x16x32_bf16 v[16:19], v[168:171], v[32:35], v[16:19]
    v_mfma_f32_16x16x32_bf16 v[20:23], v[184:187], v[32:35], v[20:23]
    s_waitcnt lgkmcnt(0)
    v_mfma_f32_16x16x32_bf16 v[8:11], v[140:143], v[36:39], v[8:11]
    v_mfma_f32_16x16x32_bf16 v[12:15], v[156:159], v[36:39], v[12:15]
    v_mfma_f32_16x16x32_bf16 v[16:19], v[172:175], v[36:39], v[16:19]
    v_mfma_f32_16x16x32_bf16 v[20:23], v[188:191], v[36:39], v[20:23]
    s_mov_b32 exec_lo, 0x00030003
    s_mov_b32 exec_hi, 0x00030003
    s_nop 2
    s_nop 1
    buffer_store_dwordx4 v[8:11], v40, s[32:35], s61 offen sc0 sc1
    s_add_u32 s61, s61, 16384
    buffer_store_dwordx4 v[12:15], v40, s[32:35], s61 offen sc0 sc1
    s_add_u32 s61, s61, 16384
    buffer_store_dwordx4 v[16:19], v40, s[32:35], s61 offen sc0 sc1
    s_add_u32 s61, s61, 16384
    s_nop 3
    buffer_store_dwordx4 v[20:23], v40, s[32:35], s61 offen sc0 sc1
    s_mov_b64 exec, -1
    s_branch L_final
L_final:
    s_cmp_ge_u32 s56, 2
    s_cbranch_scc1 L_end
    s_lshr_b32 s66, s75, 5
    s_and_b32 s64, s75, 31
    v_lshlrev_b32 v8, 5, v1
    s_lshl_b32 s61, s56, 11
    s_add_u32 s61, s61, 8704
    s_add_u32 s61, s61, s93
    s_mov_b32 s92, 0
Lpoll_85:
    buffer_load_dwordx4 v[12:15], v8, s[32:35], s61 offen sc0 sc1
    buffer_load_dwordx4 v[16:19], v8, s[32:35], s61 offen offset:16 sc0 sc1
    s_waitcnt vmcnt(0)
    v_mov_b32 v22, v12
    v_max3_u32 v22, v22, v13, v14
    v_max3_u32 v22, v22, v15, v16
    v_max3_u32 v22, v22, v17, v18
    v_max_u32 v22, v22, v19
    v_cmpx_eq_u32 vcc, -1, v22
    s_cbranch_execz Lpolld_86
    s_sleep 2
    s_add_u32 s92, s92, 1
    s_cmp_lt_u32 s92, 400000
    s_cbranch_scc1 Lpoll_85
Lpolld_86:
    s_mov_b64 exec, -1
Lfsk_83:
    s_nop 1
    v_permlane32_swap_b32 v12, v16
    v_permlane32_swap_b32 v13, v17
    v_permlane32_swap_b32 v14, v18
    v_permlane32_swap_b32 v15, v19
    s_nop 1
    v_add_f32 v12, v12, v16
    v_add_f32 v13, v13, v17
    v_add_f32 v14, v14, v18
    v_add_f32 v15, v15, v19
    s_nop 1
    v_permlane16_swap_b32 v12, v14
    v_permlane16_swap_b32 v13, v15
    s_nop 1
    v_add_f32 v12, v12, v14
    v_add_f32 v13, v13, v15
    s_nop 0
    v_add_f32_dpp v12, v12, v12 row_ror:8 row_mask:0xf bank_mask:0xf
    v_add_f32_dpp v13, v13, v13 row_ror:8 row_mask:0xf bank_mask:0xf
    s_nop 0
    v_add_f32_dpp v12, v12, v12 row_ror:4 row_mask:0xf bank_mask:0xf
    v_add_f32_dpp v13, v13, v13 row_ror:4 row_mask:0xf bank_mask:0xf
    s_nop 0
    v_add_f32_dpp v12, v12, v12 quad_perm:[2,3,0,1] row_mask:0xf bank_mask:0xf
    v_add_f32_dpp v13, v13, v13 quad_perm:[2,3,0,1] row_mask:0xf bank_mask:0xf
    v_cvt_pk_bf16_f32 v12, v12, v13
    v_and_b32 v6, 1, v1
    v_lshlrev_b32 v6, 4, v6
    v_lshl_add_u32 v6, v2, 2, v6
    s_lshl_b32 s57, s66, 11
    s_lshl_b32 s58, s64, 5
    s_add_u32 s57, s57, s58
    s_xor_b32 s58, s56, 1
    s_lshl_b32 s58, s58, 10
    s_add_u32 s57, s57, s58
    s_mov_b32 s36, s26
    s_mov_b32 s37, s27
    s_and_b32 s37, s37, 0xffff
    s_mov_b32 s38, 4096
    s_mov_b32 s39, 0x00020000
    s_mov_b32 exec_lo, 0x00030003
    s_mov_b32 exec_hi, 0x00030003
    buffer_store_dword v12, v6, s[36:39], s57 offen
    s_mov_b64 exec, -1
    s_branch L_end
L_end:
    s_endpgm
.section .rodata,"a"
.p2align 6
.amdhsa_kernel concat_heads__compressed_kv_cla__gqa_block_cached__decode_kernel
  .amdhsa_next_free_vgpr 256
  .amdhsa_next_free_sgpr 102
  .amdhsa_accum_offset 256
  .amdhsa_group_segment_fixed_size 0
  .amdhsa_kernarg_size 112
  .amdhsa_user_sgpr_count 2
  .amdhsa_user_sgpr_kernarg_segment_ptr 1
  .amdhsa_system_sgpr_workgroup_id_x 1
.end_amdhsa_kernel
```

```asm
; @launch grid=(256,1,1) block=(512,1,1) lds=163840
.amdgcn_target "amdgcn-amd-amdhsa--gfx950"
.text
.globl concat_heads__compressed_kv_cla__gqa_block_cached__decode_kernel
.p2align 8
.type concat_heads__compressed_kv_cla__gqa_block_cached__decode_kernel,@function
concat_heads__compressed_kv_cla__gqa_block_cached__decode_kernel:
    s_cmp_ge_u32 s2, 256
    s_cbranch_scc1 L_end
    s_load_dwordx16 s[4:19], s[0:1], 0
    s_load_dwordx8 s[20:27], s[0:1], 64
    s_load_dwordx4 s[28:31], s[0:1], 96
    v_lshrrev_b32 v1, 6, v0
    s_lshr_b32 s57, s2, 3
    v_readfirstlane_b32 s56, v1
    s_and_b32 s58, s2, 7
    s_waitcnt lgkmcnt(0)
    s_mov_b32 s32, s30
    s_mov_b32 s33, s31
    s_and_b32 s33, s33, 0xffff
    s_mov_b32 s34, 268435456
    s_mov_b32 s35, 0x00020000
    s_mov_b32 s52, s28
    s_mov_b32 s53, s29
    s_and_b32 s53, s53, 0xffff
    s_mov_b32 s54, 256
    s_mov_b32 s55, 0x00020000
    s_cmp_ge_u32 s2, 8
    s_cbranch_scc1 Lcq_1
    v_mov_b32 v40, -1
    v_mov_b32 v41, -1
    v_mov_b32 v42, -1
    v_mov_b32 v43, -1
    v_lshlrev_b32 v45, 4, v0
    s_lshl_b32 s61, s2, 13
    s_add_u32 s61, s61, 1310720
    buffer_store_dwordx4 v[40:43], v45, s[32:35], s61 offen sc0 sc1
    s_add_u32 s61, s61, 65536
    buffer_store_dwordx4 v[40:43], v45, s[32:35], s61 offen sc0 sc1
    s_waitcnt vmcnt(0)
    s_barrier
    s_cmp_lg_u32 s56, 7
    s_cbranch_scc1 Lcq_1
    v_mov_b32 v45, 1
    v_mov_b32 v46, 0
    s_lshl_b32 s61, s2, 2
    s_mov_b64 exec, 1
    buffer_atomic_add v45, v46, s[52:55], s61 offen offset:0 sc1
    s_mov_b64 exec, -1
Lcq_1:
    s_mul_i32 s59, s58, 8
    s_add_u32 s57, s57, s59
    s_and_b32 s57, s57, 31
    s_mov_b32 s65, s57
    s_and_b32 s59, s57, 7
    s_cmp_eq_u32 s58, s59
    s_cbranch_scc1 L_roleA1
    s_xor_b32 s60, s59, 5
    s_cmp_eq_u32 s58, s60
    s_cbranch_scc1 L_roleA2
    s_mov_b32 s67, s58
    s_cmp_gt_u32 s58, s59
    s_subb_u32 s67, s67, 0
    s_cmp_gt_u32 s58, s60
    s_subb_u32 s67, s67, 0
    s_mov_b32 s74, 0
    s_mov_b32 s59, s65
    s_and_b32 s60, s58, 1
    s_bfe_u32 s62, s58, 0x10001
    s_lshr_b32 s61, s58, 2
    s_lshl_b32 s3, s61, 5
    s_add_u32 s3, s3, s59
    s_lshl_b32 s3, s3, 2
    s_add_u32 s3, s3, s62
    s_lshl_b32 s3, s3, 1
    s_add_u32 s3, s3, s60
    s_lshl_b32 s3, s3, 8
    s_add_u32 s3, s3, 1310720
    s_and_b32 s91, s59, 0xfc
    s_cmp_eq_u32 s61, 0
    s_cselect_b32 s36, s8, s22
    s_cselect_b32 s37, s9, s23
    s_cselect_b32 s40, s4, s16
    s_cselect_b32 s41, s5, s17
    s_and_b32 s37, s37, 0xffff
    s_and_b32 s41, s41, 0xffff
    s_mov_b32 s38, 4194304
    s_mov_b32 s39, 0x00020000
    s_mov_b32 s42, 2048
    s_mov_b32 s43, 0x00020000
    v_and_b32 v228, 63, v0
    v_lshrrev_b32 v229, 3, v228
    v_and_b32 v230, 7, v228
    v_lshlrev_b32 v231, 3, v229
    s_lshl_b32 s61, s56, 6
    s_lshl_b32 s62, s62, 9
    s_add_u32 s61, s61, s62
    buffer_load_dwordx2 v[208:209], v231, s[40:43], s61 offen offset:0
    buffer_load_dwordx2 v[210:211], v231, s[40:43], s61 offen offset:1024
    v_lshlrev_b32 v231, 15, v229
    v_lshl_add_u32 v231, v230, 4, v231
    s_lshl_b32 s61, s61, 12
    s_lshl_b32 s59, s59, 8
    s_lshl_b32 s60, s60, 7
    s_add_u32 s61, s61, s59
    s_add_u32 s61, s61, s60
    buffer_load_dwordx4 v[192:195], v231, s[36:39], s61 offen
    s_add_u32 s61, s61, 8192
    buffer_load_dwordx4 v[196:199], v231, s[36:39], s61 offen
    s_add_u32 s61, s61, 8192
    buffer_load_dwordx4 v[200:203], v231, s[36:39], s61 offen
    s_add_u32 s61, s61, 8192
    buffer_load_dwordx4 v[204:207], v231, s[36:39], s61 offen
    s_mov_b32 s68, 0x05040100
    s_mov_b32 s69, 0x07060302
    s_barrier
    s_mul_i32 s80, s67, 43691
    s_add_u32 s78, s80, 43691
    s_lshr_b32 s80, s80, 10
    s_lshr_b32 s78, s78, 10
    s_sub_u32 s78, s78, s80
    s_add_u32 s79, s78, 26
    s_mul_i32 s81, s67, 26
    s_sub_u32 s81, s81, s78
    v_and_b32 v1, 63, v0
    v_lshrrev_b32 v2, 4, v1
    v_and_b32 v3, 15, v1
    s_lshl_b32 s61, s65, 20
    s_add_u32 s44, s18, s61
    s_addc_u32 s45, s19, 0
    s_and_b32 s45, s45, 0xffff
    s_mov_b32 s46, 34603008
    s_mov_b32 s47, 0x00020000
    s_add_u32 s48, s20, s61
    s_addc_u32 s49, s21, 0
    s_and_b32 s49, s49, 0xffff
    s_mov_b32 s50, 34603008
    s_mov_b32 s51, 0x00020000
    s_lshl_b32 s83, s65, 8
    s_add_u32 s83, s83, 1507328
    v_lshlrev_b32 v4, 4, v1
    s_mov_b32 s70, 1040356334
    v_mov_b32 v60, 0
    v_mov_b32 v10, 512
    s_mul_i32 s88, s65, 252
    s_and_b32 s88, s88, 255
    s_cmp_eq_u32 s56, 7
    s_cbranch_scc1 Lsvc_2
    s_add_u32 s62, s80, s56
    s_add_u32 s62, s62, s88
    s_mov_b32 s71, 0
    s_mov_b32 s72, 0
    s_mov_b32 s84, s62
    s_add_u32 s100, s84, 0
    s_and_b32 s100, s100, 255
    s_lshl_b32 s100, s100, 12
    buffer_load_dwordx4 v[64:67], v4, s[44:47], s100 offen offset:0 nt
    buffer_load_dwordx4 v[68:71], v4, s[44:47], s100 offen offset:1024 nt
    buffer_load_dwordx4 v[72:75], v4, s[44:47], s100 offen offset:2048 nt
    buffer_load_dwordx4 v[76:79], v4, s[44:47], s100 offen offset:3072 nt
    buffer_load_dwordx4 v[80:83], v4, s[48:51], s100 offen offset:0 nt
    buffer_load_dwordx4 v[84:87], v4, s[48:51], s100 offen offset:1024 nt
    buffer_load_dwordx4 v[88:91], v4, s[48:51], s100 offen offset:2048 nt
    buffer_load_dwordx4 v[92:95], v4, s[48:51], s100 offen offset:3072 nt
    s_add_u32 s100, s84, 7
    s_and_b32 s100, s100, 255
    s_lshl_b32 s100, s100, 12
    s_waitcnt vmcnt(8)
    v_perm_b32 v232, v196, v192, s68
    v_perm_b32 v233, v196, v192, s69
    v_perm_b32 v234, v197, v193, s68
    v_perm_b32 v235, v197, v193, s69
    v_perm_b32 v236, v198, v194, s68
    v_perm_b32 v237, v198, v194, s69
    v_perm_b32 v238, v199, v195, s68
    v_perm_b32 v239, v199, v195, s69
    v_dot2_f32_bf16 v212, v232, v208, 0
    v_dot2_f32_bf16 v213, v233, v208, 0
    v_dot2_f32_bf16 v214, v234, v208, 0
    v_dot2_f32_bf16 v215, v235, v208, 0
    v_dot2_f32_bf16 v216, v236, v208, 0
    v_dot2_f32_bf16 v217, v237, v208, 0
    v_dot2_f32_bf16 v218, v238, v208, 0
    v_dot2_f32_bf16 v219, v239, v208, 0
    v_dot2_f32_bf16 v220, v232, v210, 0
    v_dot2_f32_bf16 v221, v233, v210, 0
    v_dot2_f32_bf16 v222, v234, v210, 0
    v_dot2_f32_bf16 v223, v235, v210, 0
    v_dot2_f32_bf16 v224, v236, v210, 0
    v_dot2_f32_bf16 v225, v237, v210, 0
    v_dot2_f32_bf16 v226, v238, v210, 0
    v_dot2_f32_bf16 v227, v239, v210, 0
    v_perm_b32 v232, v204, v200, s68
    v_perm_b32 v233, v204, v200, s69
    v_perm_b32 v234, v205, v201, s68
    v_perm_b32 v235, v205, v201, s69
    v_perm_b32 v236, v206, v202, s68
    v_perm_b32 v237, v206, v202, s69
    v_perm_b32 v238, v207, v203, s68
    v_perm_b32 v239, v207, v203, s69
    v_dot2_f32_bf16 v212, v232, v209, v212
    v_dot2_f32_bf16 v213, v233, v209, v213
    v_dot2_f32_bf16 v214, v234, v209, v214
    v_dot2_f32_bf16 v215, v235, v209, v215
    v_dot2_f32_bf16 v216, v236, v209, v216
    v_dot2_f32_bf16 v217, v237, v209, v217
    v_dot2_f32_bf16 v218, v238, v209, v218
    v_dot2_f32_bf16 v219, v239, v209, v219
    v_dot2_f32_bf16 v220, v232, v211, v220
    v_dot2_f32_bf16 v221, v233, v211, v221
    v_dot2_f32_bf16 v222, v234, v211, v222
    v_dot2_f32_bf16 v223, v235, v211, v223
    v_dot2_f32_bf16 v224, v236, v211, v224
    v_dot2_f32_bf16 v225, v237, v211, v225
    v_dot2_f32_bf16 v226, v238, v211, v226
    v_dot2_f32_bf16 v227, v239, v211, v227
    s_nop 2
    v_permlane32_swap_b32 v212, v220
    v_permlane32_swap_b32 v213, v221
    v_permlane32_swap_b32 v214, v222
    v_permlane32_swap_b32 v215, v223
    v_permlane32_swap_b32 v216, v224
    v_permlane32_swap_b32 v217, v225
    v_permlane32_swap_b32 v218, v226
    v_permlane32_swap_b32 v219, v227
    s_nop 1
    v_add_f32 v212, v212, v220
    v_add_f32 v213, v213, v221
    v_add_f32 v214, v214, v222
    v_add_f32 v215, v215, v223
    v_add_f32 v216, v216, v224
    v_add_f32 v217, v217, v225
    v_add_f32 v218, v218, v226
    v_add_f32 v219, v219, v227
    s_nop 1
    v_permlane16_swap_b32 v212, v216
    v_permlane16_swap_b32 v213, v217
    v_permlane16_swap_b32 v214, v218
    v_permlane16_swap_b32 v215, v219
    s_nop 1
    v_add_f32 v212, v212, v216
    v_add_f32 v213, v213, v217
    v_add_f32 v214, v214, v218
    v_add_f32 v215, v215, v219
    s_nop 1
    v_add_f32_dpp v212, v212, v212 row_ror:8 row_mask:0xf bank_mask:0xf
    v_add_f32_dpp v213, v213, v213 row_ror:8 row_mask:0xf bank_mask:0xf
    v_add_f32_dpp v214, v214, v214 row_ror:8 row_mask:0xf bank_mask:0xf
    v_add_f32_dpp v215, v215, v215 row_ror:8 row_mask:0xf bank_mask:0xf
    v_lshrrev_b32 v232, 5, v228
    v_lshlrev_b32 v232, 8, v232
    v_bfe_u32 v233, v228, 4, 1
    v_lshl_add_u32 v232, v233, 4, v232
    v_lshl_add_u32 v232, v230, 5, v232
    s_lshl_b32 s61, s56, 9
    s_add_u32 s61, s61, 16384
    v_add_u32 v232, s61, v232
    ds_write_b128 v232, v[212:215]
    s_waitcnt lgkmcnt(0)
    s_barrier
    s_waitcnt vmcnt(3)
    buffer_load_dwordx4 v[96:99], v4, s[44:47], s100 offen offset:0 nt
    s_waitcnt vmcnt(3)
    buffer_load_dwordx4 v[100:103], v4, s[44:47], s100 offen offset:1024 nt
    s_waitcnt vmcnt(3)
    buffer_load_dwordx4 v[104:107], v4, s[44:47], s100 offen offset:2048 nt
    s_waitcnt vmcnt(3)
    buffer_load_dwordx4 v[108:111], v4, s[44:47], s100 offen offset:3072 nt
    s_waitcnt vmcnt(3)
    buffer_load_dwordx4 v[112:115], v4, s[48:51], s100 offen offset:0 nt
    s_waitcnt vmcnt(3)
    buffer_load_dwordx4 v[116:119], v4, s[48:51], s100 offen offset:1024 nt
    s_waitcnt vmcnt(3)
    buffer_load_dwordx4 v[120:123], v4, s[48:51], s100 offen offset:2048 nt
    s_waitcnt vmcnt(3)
    buffer_load_dwordx4 v[124:127], v4, s[48:51], s100 offen offset:3072 nt
    s_add_u32 s100, s84, 14
    s_and_b32 s100, s100, 255
    s_lshl_b32 s100, s100, 12
    s_waitcnt vmcnt(3)
    buffer_load_dwordx4 v[128:131], v4, s[44:47], s100 offen offset:0 nt
    s_waitcnt vmcnt(3)
    buffer_load_dwordx4 v[132:135], v4, s[44:47], s100 offen offset:1024 nt
    s_waitcnt vmcnt(3)
    buffer_load_dwordx4 v[136:139], v4, s[44:47], s100 offen offset:2048 nt
    s_waitcnt vmcnt(3)
    buffer_load_dwordx4 v[140:143], v4, s[44:47], s100 offen offset:3072 nt
    s_waitcnt vmcnt(3)
    buffer_load_dwordx4 v[144:147], v4, s[48:51], s100 offen offset:0 nt
    s_waitcnt vmcnt(3)
    buffer_load_dwordx4 v[148:151], v4, s[48:51], s100 offen offset:1024 nt
    s_waitcnt vmcnt(3)
    buffer_load_dwordx4 v[152:155], v4, s[48:51], s100 offen offset:2048 nt
    s_waitcnt vmcnt(3)
    buffer_load_dwordx4 v[156:159], v4, s[48:51], s100 offen offset:3072 nt
    s_add_u32 s100, s84, 21
    s_and_b32 s100, s100, 255
    s_lshl_b32 s100, s100, 12
    s_waitcnt vmcnt(3)
    buffer_load_dwordx4 v[160:163], v4, s[44:47], s100 offen offset:0 nt
    s_waitcnt vmcnt(3)
    buffer_load_dwordx4 v[164:167], v4, s[44:47], s100 offen offset:1024 nt
    s_waitcnt vmcnt(3)
    buffer_load_dwordx4 v[168:171], v4, s[44:47], s100 offen offset:2048 nt
    s_waitcnt vmcnt(3)
    buffer_load_dwordx4 v[172:175], v4, s[44:47], s100 offen offset:3072 nt
    s_waitcnt vmcnt(3)
    buffer_load_dwordx4 v[176:179], v4, s[48:51], s100 offen offset:0 nt
    s_waitcnt vmcnt(3)
    buffer_load_dwordx4 v[180:183], v4, s[48:51], s100 offen offset:1024 nt
    s_waitcnt vmcnt(3)
    buffer_load_dwordx4 v[184:187], v4, s[48:51], s100 offen offset:2048 nt
    s_waitcnt vmcnt(3)
    buffer_load_dwordx4 v[188:191], v4, s[48:51], s100 offen offset:3072 nt
    s_branch Lgo_3
Lsvc_2:
    s_setprio 3
    s_waitcnt vmcnt(0)
    v_perm_b32 v232, v196, v192, s68
    v_perm_b32 v233, v196, v192, s69
    v_perm_b32 v234, v197, v193, s68
    v_perm_b32 v235, v197, v193, s69
    v_perm_b32 v236, v198, v194, s68
    v_perm_b32 v237, v198, v194, s69
    v_perm_b32 v238, v199, v195, s68
    v_perm_b32 v239, v199, v195, s69
    v_dot2_f32_bf16 v212, v232, v208, 0
    v_dot2_f32_bf16 v213, v233, v208, 0
    v_dot2_f32_bf16 v214, v234, v208, 0
    v_dot2_f32_bf16 v215, v235, v208, 0
    v_dot2_f32_bf16 v216, v236, v208, 0
    v_dot2_f32_bf16 v217, v237, v208, 0
    v_dot2_f32_bf16 v218, v238, v208, 0
    v_dot2_f32_bf16 v219, v239, v208, 0
    v_dot2_f32_bf16 v220, v232, v210, 0
    v_dot2_f32_bf16 v221, v233, v210, 0
    v_dot2_f32_bf16 v222, v234, v210, 0
    v_dot2_f32_bf16 v223, v235, v210, 0
    v_dot2_f32_bf16 v224, v236, v210, 0
    v_dot2_f32_bf16 v225, v237, v210, 0
    v_dot2_f32_bf16 v226, v238, v210, 0
    v_dot2_f32_bf16 v227, v239, v210, 0
    v_perm_b32 v232, v204, v200, s68
    v_perm_b32 v233, v204, v200, s69
    v_perm_b32 v234, v205, v201, s68
    v_perm_b32 v235, v205, v201, s69
    v_perm_b32 v236, v206, v202, s68
    v_perm_b32 v237, v206, v202, s69
    v_perm_b32 v238, v207, v203, s68
    v_perm_b32 v239, v207, v203, s69
    v_dot2_f32_bf16 v212, v232, v209, v212
    v_dot2_f32_bf16 v213, v233, v209, v213
    v_dot2_f32_bf16 v214, v234, v209, v214
    v_dot2_f32_bf16 v215, v235, v209, v215
    v_dot2_f32_bf16 v216, v236, v209, v216
    v_dot2_f32_bf16 v217, v237, v209, v217
    v_dot2_f32_bf16 v218, v238, v209, v218
    v_dot2_f32_bf16 v219, v239, v209, v219
    v_dot2_f32_bf16 v220, v232, v211, v220
    v_dot2_f32_bf16 v221, v233, v211, v221
    v_dot2_f32_bf16 v222, v234, v211, v222
    v_dot2_f32_bf16 v223, v235, v211, v223
    v_dot2_f32_bf16 v224, v236, v211, v224
    v_dot2_f32_bf16 v225, v237, v211, v225
    v_dot2_f32_bf16 v226, v238, v211, v226
    v_dot2_f32_bf16 v227, v239, v211, v227
    s_nop 2
    v_permlane32_swap_b32 v212, v220
    v_permlane32_swap_b32 v213, v221
    v_permlane32_swap_b32 v214, v222
    v_permlane32_swap_b32 v215, v223
    v_permlane32_swap_b32 v216, v224
    v_permlane32_swap_b32 v217, v225
    v_permlane32_swap_b32 v218, v226
    v_permlane32_swap_b32 v219, v227
    s_nop 1
    v_add_f32 v212, v212, v220
    v_add_f32 v213, v213, v221
    v_add_f32 v214, v214, v222
    v_add_f32 v215, v215, v223
    v_add_f32 v216, v216, v224
    v_add_f32 v217, v217, v225
    v_add_f32 v218, v218, v226
    v_add_f32 v219, v219, v227
    s_nop 1
    v_permlane16_swap_b32 v212, v216
    v_permlane16_swap_b32 v213, v217
    v_permlane16_swap_b32 v214, v218
    v_permlane16_swap_b32 v215, v219
    s_nop 1
    v_add_f32 v212, v212, v216
    v_add_f32 v213, v213, v217
    v_add_f32 v214, v214, v218
    v_add_f32 v215, v215, v219
    s_nop 1
    v_add_f32_dpp v212, v212, v212 row_ror:8 row_mask:0xf bank_mask:0xf
    v_add_f32_dpp v213, v213, v213 row_ror:8 row_mask:0xf bank_mask:0xf
    v_add_f32_dpp v214, v214, v214 row_ror:8 row_mask:0xf bank_mask:0xf
    v_add_f32_dpp v215, v215, v215 row_ror:8 row_mask:0xf bank_mask:0xf
    v_lshrrev_b32 v232, 5, v228
    v_lshlrev_b32 v232, 8, v232
    v_bfe_u32 v233, v228, 4, 1
    v_lshl_add_u32 v232, v233, 4, v232
    v_lshl_add_u32 v232, v230, 5, v232
    s_lshl_b32 s61, s56, 9
    s_add_u32 s61, s61, 16384
    v_add_u32 v232, s61, v232
    ds_write_b128 v232, v[212:215]
    s_waitcnt lgkmcnt(0)
    s_barrier
    v_mov_b32 v234, 0
    buffer_load_dword v235, v234, s[52:55], s91 offen offset:0 sc0 sc1
    v_and_b32 v232, 31, v228
    v_lshlrev_b32 v233, 4, v232
    v_add_u32 v233, 16384, v233
    ds_read_b128 v[192:195], v233 offset:0
    ds_read_b128 v[196:199], v233 offset:512
    ds_read_b128 v[200:203], v233 offset:1024
    ds_read_b128 v[204:207], v233 offset:1536
    ds_read_b128 v[208:211], v233 offset:2048
    ds_read_b128 v[212:215], v233 offset:2560
    ds_read_b128 v[216:219], v233 offset:3072
    ds_read_b128 v[220:223], v233 offset:3584
    s_waitcnt lgkmcnt(6)
    v_add_f32 v192, v192, v196
    v_add_f32 v193, v193, v197
    v_add_f32 v194, v194, v198
    v_add_f32 v195, v195, v199
    s_waitcnt lgkmcnt(5)
    v_add_f32 v192, v192, v200
    v_add_f32 v193, v193, v201
    v_add_f32 v194, v194, v202
    v_add_f32 v195, v195, v203
    s_waitcnt lgkmcnt(4)
    v_add_f32 v192, v192, v204
    v_add_f32 v193, v193, v205
    v_add_f32 v194, v194, v206
    v_add_f32 v195, v195, v207
    s_waitcnt lgkmcnt(3)
    v_add_f32 v192, v192, v208
    v_add_f32 v193, v193, v209
    v_add_f32 v194, v194, v210
    v_add_f32 v195, v195, v211
    s_waitcnt lgkmcnt(2)
    v_add_f32 v192, v192, v212
    v_add_f32 v193, v193, v213
    v_add_f32 v194, v194, v214
    v_add_f32 v195, v195, v215
    s_waitcnt lgkmcnt(1)
    v_add_f32 v192, v192, v216
    v_add_f32 v193, v193, v217
    v_add_f32 v194, v194, v218
    v_add_f32 v195, v195, v219
    s_waitcnt lgkmcnt(0)
    v_add_f32 v192, v192, v220
    v_add_f32 v193, v193, v221
    v_add_f32 v194, v194, v222
    v_add_f32 v195, v195, v223
    v_lshrrev_b32 v233, 4, v232
    v_lshlrev_b32 v233, 10, v233
    v_and_b32 v232, 15, v232
    v_lshl_add_u32 v233, v232, 4, v233
    s_waitcnt vmcnt(0)
    s_mov_b32 s92, 0
Lcf_5:
    v_readfirstlane_b32 s57, v235
    s_nop 3
    s_cmp_lg_u32 s57, 0
    s_cbranch_scc1 Lcfd_6
    s_sleep 2
    buffer_load_dword v235, v234, s[52:55], s91 offen offset:0 sc0 sc1
    s_waitcnt vmcnt(0)
    s_add_u32 s92, s92, 1
    s_cmp_lt_u32 s92, 400000
    s_cbranch_scc1 Lcf_5
Lcfd_6:
    s_mov_b64 exec, 0xffffffff
    buffer_store_dwordx4 v[192:195], v233, s[32:35], s3 offen sc0 sc1
    s_mov_b64 exec, -1
L_svc_q:
    v_lshlrev_b32 v40, 4, v1
    s_lshl_b32 s61, s65, 11
    s_add_u32 s61, s61, 1376256
    s_mov_b32 s92, 0
Lpoll_7:
    buffer_load_dwordx4 v[48:51], v40, s[32:35], s61 offen offset:0 sc0 sc1
    buffer_load_dwordx4 v[56:59], v40, s[32:35], s61 offen offset:1024 sc0 sc1
    s_waitcnt vmcnt(0)
    v_mov_b32 v41, v48
    v_max3_u32 v41, v41, v49, v50
    v_max3_u32 v41, v41, v51, v56
    v_max3_u32 v41, v41, v57, v58
    v_max_u32 v41, v41, v59
    v_cmpx_eq_u32 vcc, -1, v41
    s_cbranch_execz Lpolld_8
    s_sleep 4
    s_add_u32 s92, s92, 1
    s_cmp_lt_u32 s92, 400000
    s_cbranch_scc1 Lpoll_7
Lpolld_8:
    s_mov_b64 exec, -1
    v_mov_b32 v52, v48
    v_mov_b32 v53, v49
    v_mov_b32 v54, v50
    v_mov_b32 v55, v51
    v_mov_b32 v60, v56
    v_mov_b32 v61, v57
    v_mov_b32 v62, v58
    v_mov_b32 v63, v59
    s_nop 1
    v_permlane32_swap_b32 v48, v52
    v_permlane32_swap_b32 v49, v53
    v_permlane32_swap_b32 v50, v54
    v_permlane32_swap_b32 v51, v55
    v_permlane32_swap_b32 v56, v60
    v_permlane32_swap_b32 v57, v61
    v_permlane32_swap_b32 v58, v62
    v_permlane32_swap_b32 v59, v63
    s_nop 1
    v_add_f32 v48, v48, v52
    v_add_f32 v49, v49, v53
    v_add_f32 v50, v50, v54
    v_add_f32 v51, v51, v55
    v_cvt_pk_bf16_f32 v48, v48, v49
    v_cvt_pk_bf16_f32 v49, v50, v51
    v_add_f32 v56, v56, v60
    v_add_f32 v57, v57, v61
    v_add_f32 v58, v58, v62
    v_add_f32 v59, v59, v63
    v_cvt_pk_bf16_f32 v56, v56, v57
    v_cvt_pk_bf16_f32 v57, v58, v59
    v_mov_b32 v60, 0
    v_and_b32 v42, 31, v1
    v_lshlrev_b32 v42, 3, v42
    ds_write_b64 v42, v[48:49] offset:0
    ds_write_b64 v42, v[56:57] offset:256
    v_add_u32 v40, 0, v1
    v_add_u32 v41, s80, v40
    v_add_u32 v41, s88, v41
    v_and_b32 v41, 255, v41
    v_lshlrev_b32 v41, 12, v41
    v_add_u32 v42, s81, v40
    v_add_u32 v42, s88, v42
    v_and_b32 v42, 255, v42
    v_lshlrev_b32 v42, 12, v42
    v_add_u32 v42, 33554432, v42
    v_cmp_gt_u32 vcc, s78, v40
    s_nop 1
    v_cndmask_b32 v41, v42, v41, vcc
    v_cmp_gt_u32 vcc, s79, v40
    v_mov_b32 v42, -1
    v_lshlrev_b32 v43, 2, v40
    v_cndmask_b32 v41, v42, v41, vcc
    ds_write_b32 v43, v41 offset:1024
    v_add_u32 v40, 64, v1
    v_add_u32 v41, s80, v40
    v_add_u32 v41, s88, v41
    v_and_b32 v41, 255, v41
    v_lshlrev_b32 v41, 12, v41
    v_add_u32 v42, s81, v40
    v_add_u32 v42, s88, v42
    v_and_b32 v42, 255, v42
    v_lshlrev_b32 v42, 12, v42
    v_add_u32 v42, 33554432, v42
    v_cmp_gt_u32 vcc, s78, v40
    s_nop 1
    v_cndmask_b32 v41, v42, v41, vcc
    v_cmp_gt_u32 vcc, s79, v40
    v_mov_b32 v42, -1
    v_lshlrev_b32 v43, 2, v40
    v_cndmask_b32 v41, v42, v41, vcc
    ds_write_b32 v43, v41 offset:1024
    v_add_u32 v40, 128, v1
    v_add_u32 v41, s80, v40
    v_add_u32 v41, s88, v41
    v_and_b32 v41, 255, v41
    v_lshlrev_b32 v41, 12, v41
    v_add_u32 v42, s81, v40
    v_add_u32 v42, s88, v42
    v_and_b32 v42, 255, v42
    v_lshlrev_b32 v42, 12, v42
    v_add_u32 v42, 33554432, v42
    v_cmp_gt_u32 vcc, s78, v40
    s_nop 1
    v_cndmask_b32 v41, v42, v41, vcc
    v_cmp_gt_u32 vcc, s79, v40
    v_mov_b32 v42, -1
    v_lshlrev_b32 v43, 2, v40
    v_cndmask_b32 v41, v42, v41, vcc
    ds_write_b32 v43, v41 offset:1024
    v_add_u32 v40, 192, v1
    v_add_u32 v41, s80, v40
    v_add_u32 v41, s88, v41
    v_and_b32 v41, 255, v41
    v_lshlrev_b32 v41, 12, v41
    v_add_u32 v42, s81, v40
    v_add_u32 v42, s88, v42
    v_and_b32 v42, 255, v42
    v_lshlrev_b32 v42, 12, v42
    v_add_u32 v42, 33554432, v42
    v_cmp_gt_u32 vcc, s78, v40
    s_nop 1
    v_cndmask_b32 v41, v42, v41, vcc
    v_cmp_gt_u32 vcc, s79, v40
    v_mov_b32 v42, -1
    v_lshlrev_b32 v43, 2, v40
    v_cndmask_b32 v41, v42, v41, vcc
    ds_write_b32 v43, v41 offset:1024
    v_add_u32 v40, 256, v1
    v_add_u32 v41, s80, v40
    v_add_u32 v41, s88, v41
    v_and_b32 v41, 255, v41
    v_lshlrev_b32 v41, 12, v41
    v_add_u32 v42, s81, v40
    v_add_u32 v42, s88, v42
    v_and_b32 v42, 255, v42
    v_lshlrev_b32 v42, 12, v42
    v_add_u32 v42, 33554432, v42
    v_cmp_gt_u32 vcc, s78, v40
    s_nop 1
    v_cndmask_b32 v41, v42, v41, vcc
    v_cmp_gt_u32 vcc, s79, v40
    v_mov_b32 v42, -1
    v_lshlrev_b32 v43, 2, v40
    v_cndmask_b32 v41, v42, v41, vcc
    ds_write_b32 v43, v41 offset:1024
    v_add_u32 v40, 320, v1
    v_add_u32 v41, s80, v40
    v_add_u32 v41, s88, v41
    v_and_b32 v41, 255, v41
    v_lshlrev_b32 v41, 12, v41
    v_add_u32 v42, s81, v40
    v_add_u32 v42, s88, v42
    v_and_b32 v42, 255, v42
    v_lshlrev_b32 v42, 12, v42
    v_add_u32 v42, 33554432, v42
    v_cmp_gt_u32 vcc, s78, v40
    s_nop 1
    v_cndmask_b32 v41, v42, v41, vcc
    v_cmp_gt_u32 vcc, s79, v40
    v_mov_b32 v42, -1
    v_lshlrev_b32 v43, 2, v40
    v_cndmask_b32 v41, v42, v41, vcc
    ds_write_b32 v43, v41 offset:1024
    v_add_u32 v40, 384, v1
    v_add_u32 v41, s80, v40
    v_add_u32 v41, s88, v41
    v_and_b32 v41, 255, v41
    v_lshlrev_b32 v41, 12, v41
    v_add_u32 v42, s81, v40
    v_add_u32 v42, s88, v42
    v_and_b32 v42, 255, v42
    v_lshlrev_b32 v42, 12, v42
    v_add_u32 v42, 33554432, v42
    v_cmp_gt_u32 vcc, s78, v40
    s_nop 1
    v_cndmask_b32 v41, v42, v41, vcc
    v_cmp_gt_u32 vcc, s79, v40
    v_mov_b32 v42, -1
    v_lshlrev_b32 v43, 2, v40
    v_cndmask_b32 v41, v42, v41, vcc
    ds_write_b32 v43, v41 offset:1024
    v_add_u32 v40, 448, v1
    v_add_u32 v41, s80, v40
    v_add_u32 v41, s88, v41
    v_and_b32 v41, 255, v41
    v_lshlrev_b32 v41, 12, v41
    v_add_u32 v42, s81, v40
    v_add_u32 v42, s88, v42
    v_and_b32 v42, 255, v42
    v_lshlrev_b32 v42, 12, v42
    v_add_u32 v42, 33554432, v42
    v_cmp_gt_u32 vcc, s78, v40
    s_nop 1
    v_cndmask_b32 v41, v42, v41, vcc
    v_cmp_gt_u32 vcc, s79, v40
    v_mov_b32 v42, -1
    v_lshlrev_b32 v43, 2, v40
    v_cndmask_b32 v41, v42, v41, vcc
    ds_write_b32 v43, v41 offset:1024
    v_mov_b32 v40, 0xff7fffff
    v_mov_b32 v41, 0
    v_mov_b32 v42, 56
    ds_write_b64 v42, v[40:41] offset:12288
    ds_write_b64 v42, v[40:41] offset:12352
    v_mov_b32 v40, 0
    v_lshlrev_b32 v42, 3, v1
    ds_write_b64 v42, v[40:41] offset:7680
    ds_write_b64 v42, v[40:41] offset:11776
    s_mov_b32 s82, s79
    s_cmp_eq_u32 s74, 0
    s_cselect_b32 s61, 28, 0
    v_mov_b32 v40, s61
    ds_write_b32 v10, v40
    s_mov_b32 s62, 0
    s_cbranch_scc1 Lnopre_9
    s_mov_b32 s61, 14
    v_mov_b32 v40, s61
    s_mov_b64 exec, 1
    buffer_atomic_add v40, v60, s[32:35], s83 offen sc0 sc1
    s_mov_b64 exec, -1
    s_waitcnt vmcnt(0)
    v_readfirstlane_b32 s62, v40
    s_nop 0
    s_sub_u32 s62, s62, 65536
    v_add_u32 v40, s62, v1
    v_add_u32 v41, 412, v40
    v_add_u32 v41, s88, v41
    v_and_b32 v41, 255, v41
    v_lshlrev_b32 v41, 12, v41
    v_add_u32 v41, 33554432, v41
    v_mov_b32 v42, 67108864
    v_cmp_gt_u32 vcc, 100, v40
    v_add_u32 v43, s82, v1
    v_lshlrev_b32 v43, 2, v43
    v_cndmask_b32 v41, v42, v41, vcc
    s_bfm_b64 exec, s61, 0
    ds_write_b32 v43, v41 offset:1024
    s_mov_b64 exec, -1
    s_add_u32 s82, s82, s61
    s_add_u32 s62, s62, s61
Lnopre_9:
    s_waitcnt lgkmcnt(0)
    s_barrier
    s_cmp_ge_u32 s62, 100
    s_cbranch_scc1 Lpoolend_11
    s_mov_b32 s92, 0
    s_mov_b32 s84, 0
    s_mov_b32 s87, s74
Lpool_10:
    ds_read_b32 v40, v10
    s_waitcnt lgkmcnt(0)
    v_readfirstlane_b32 s61, v40
    s_nop 0
    s_cmp_lg_u32 s87, 0
    s_cbranch_scc1 Lcfe_13
    s_cmp_lt_u32 s61, 30
    s_cbranch_scc1 Lcfe_13
    s_mov_b32 s87, s61
    v_mov_b32 v44, 0
    s_mov_b32 s92, 0
Lcf_14:
    buffer_load_dword v45, v44, s[52:55], 0 offen offset:128 sc0 sc1
    s_waitcnt vmcnt(0)
    v_readfirstlane_b32 s57, v45
    s_nop 3
    s_cmp_ge_u32 s57, 64
    s_cbranch_scc1 Lcfd_15
    s_sleep 16
    s_add_u32 s92, s92, 1
    s_cmp_lt_u32 s92, 400000
    s_cbranch_scc1 Lcf_14
Lcfd_15:
    s_mov_b32 s61, s87
Lcfe_13:
    s_add_u32 s61, s61, 4
    s_sub_i32 s61, s61, s82
    s_cmp_gt_i32 s61, 0
    s_cbranch_scc0 Lpoolslp_12
    s_min_i32 s61, s61, 7
    s_cmp_lg_u32 s87, 0
    s_cbranch_scc1 Lcfk_16
    s_mov_b32 s87, s61
    v_mov_b32 v44, 0
    s_mov_b32 s92, 0
Lcf_17:
    buffer_load_dword v45, v44, s[52:55], 0 offen offset:128 sc0 sc1
    s_waitcnt vmcnt(0)
    v_readfirstlane_b32 s57, v45
    s_nop 3
    s_cmp_ge_u32 s57, 64
    s_cbranch_scc1 Lcfd_18
    s_sleep 16
    s_add_u32 s92, s92, 1
    s_cmp_lt_u32 s92, 400000
    s_cbranch_scc1 Lcf_17
Lcfd_18:
    s_mov_b32 s61, s87
Lcfk_16:
    v_mov_b32 v40, s61
    s_mov_b64 exec, 1
    buffer_atomic_add v40, v60, s[32:35], s83 offen sc0 sc1
    s_mov_b64 exec, -1
    s_waitcnt vmcnt(0)
    v_readfirstlane_b32 s62, v40
    s_nop 0
    s_sub_u32 s62, s62, 65536
    v_add_u32 v40, s62, v1
    v_add_u32 v41, 412, v40
    v_add_u32 v41, s88, v41
    v_and_b32 v41, 255, v41
    v_lshlrev_b32 v41, 12, v41
    v_add_u32 v41, 33554432, v41
    v_mov_b32 v42, 67108864
    v_cmp_gt_u32 vcc, 100, v40
    v_add_u32 v43, s82, v1
    v_lshlrev_b32 v43, 2, v43
    v_cndmask_b32 v41, v42, v41, vcc
    s_bfm_b64 exec, s61, 0
    ds_write_b32 v43, v41 offset:1024
    s_mov_b64 exec, -1
    s_add_u32 s82, s82, s61
    s_add_u32 s62, s62, s61
    s_cmp_ge_u32 s62, 100
    s_cbranch_scc1 Lpoolend_11
Lpoolslp_12:
    s_sleep 2
    s_add_u32 s92, s92, 1
    s_cmp_lt_u32 s92, 400000
    s_cbranch_scc1 Lpool_10
Lpoolend_11:
    v_add_u32 v43, s82, v1
    v_min_u32 v43, 511, v43
    v_lshlrev_b32 v43, 2, v43
    v_mov_b32 v42, 67108864
    ds_write_b32 v43, v42 offset:1024
    s_waitcnt lgkmcnt(0)
    s_setprio 0
    s_branch L_bend
Lgo_3:
    s_barrier
    s_mov_b64 exec, 1
    v_mov_b32 v8, 1
    ds_add_rtn_u32 v8, v10, v8
    s_mov_b64 exec, -1
    v_lshlrev_b32 v40, 4, v3
    ds_read_b128 v[24:27], v40 offset:0
    v_mov_b32 v36, 0xff7fffff
    v_mov_b32 v37, 0
    v_mov_b32 v16, 0
    v_mov_b32 v17, 0
    v_mov_b32 v18, 0
    v_mov_b32 v19, 0
    v_mov_b32 v20, 0
    v_mov_b32 v21, 0
    v_mov_b32 v22, 0
    v_mov_b32 v23, 0
    v_lshlrev_b32 v6, 5, v3
    v_lshl_add_u32 v6, v2, 3, v6
    s_lshl_b32 s61, s56, 9
    v_add_u32 v7, s61, v6
    s_lshl_b32 s77, s56, 3
    s_mov_b32 s76, 33554432
    s_waitcnt lgkmcnt(0)
    v_readfirstlane_b32 s84, v8
    s_mov_b64 exec, 1
    v_lshlrev_b32 v8, 2, v8
    ds_read_b32 v9, v8 offset:1024
    s_mov_b64 exec, -1
    s_waitcnt lgkmcnt(0)
    v_readfirstlane_b32 s73, v9
    s_nop 0
    s_cmp_lg_u32 s73, -1
    s_cbranch_scc1 Lg_19
    s_mov_b32 s92, 0
Lgs_20:
    s_sleep 1
    s_mov_b64 exec, 1
    ds_read_b32 v9, v8 offset:1024
    s_mov_b64 exec, -1
    s_waitcnt lgkmcnt(0)
    v_readfirstlane_b32 s73, v9
    s_add_u32 s92, s92, 1
    s_cmp_lg_u32 s73, -1
    s_cbranch_scc1 Lg_19
    s_cmp_lt_u32 s92, 400000
    s_cbranch_scc1 Lgs_20
Lg_19:
    s_cmp_ge_u32 s73, 67108864
    s_cbranch_scc1 LBf0_28
    s_mov_b32 s100, s73
    s_mov_b32 s71, s73
    v_dot2_f32_bf16 v28, v64, v24, 0
    v_dot2_f32_bf16 v28, v65, v25, v28
    v_dot2_f32_bf16 v28, v66, v26, v28
    v_dot2_f32_bf16 v28, v67, v27, v28
    s_waitcnt vmcnt(7)
    buffer_load_dwordx4 v[64:67], v4, s[44:47], s100 offen offset:0 nt
    v_dot2_f32_bf16 v29, v68, v24, 0
    v_dot2_f32_bf16 v29, v69, v25, v29
    v_dot2_f32_bf16 v29, v70, v26, v29
    v_dot2_f32_bf16 v29, v71, v27, v29
    s_waitcnt vmcnt(7)
    buffer_load_dwordx4 v[68:71], v4, s[44:47], s100 offen offset:1024 nt
    v_dot2_f32_bf16 v30, v72, v24, 0
    v_dot2_f32_bf16 v30, v73, v25, v30
    v_dot2_f32_bf16 v30, v74, v26, v30
    v_dot2_f32_bf16 v30, v75, v27, v30
    s_waitcnt vmcnt(7)
    buffer_load_dwordx4 v[72:75], v4, s[44:47], s100 offen offset:2048 nt
    v_dot2_f32_bf16 v31, v76, v24, 0
    v_dot2_f32_bf16 v31, v77, v25, v31
    v_dot2_f32_bf16 v31, v78, v26, v31
    v_dot2_f32_bf16 v31, v79, v27, v31
    s_waitcnt vmcnt(7)
    buffer_load_dwordx4 v[76:79], v4, s[44:47], s100 offen offset:3072 nt
    s_nop 2
    v_add_f32_dpp v28, v28, v28 row_ror:8 row_mask:0xf bank_mask:0xf
    v_add_f32_dpp v29, v29, v29 row_ror:8 row_mask:0xf bank_mask:0xf
    v_add_f32_dpp v30, v30, v30 row_ror:8 row_mask:0xf bank_mask:0xf
    v_add_f32_dpp v31, v31, v31 row_ror:8 row_mask:0xf bank_mask:0xf
    v_add_f32_dpp v28, v28, v28 row_ror:4 row_mask:0xf bank_mask:0xf
    v_add_f32_dpp v29, v29, v29 row_ror:4 row_mask:0xf bank_mask:0xf
    v_add_f32_dpp v30, v30, v30 row_ror:4 row_mask:0xf bank_mask:0xf
    v_add_f32_dpp v31, v31, v31 row_ror:4 row_mask:0xf bank_mask:0xf
    v_add_f32_dpp v28, v28, v28 row_ror:2 row_mask:0xf bank_mask:0xf
    v_add_f32_dpp v29, v29, v29 row_ror:2 row_mask:0xf bank_mask:0xf
    v_add_f32_dpp v30, v30, v30 row_ror:2 row_mask:0xf bank_mask:0xf
    v_add_f32_dpp v31, v31, v31 row_ror:2 row_mask:0xf bank_mask:0xf
    v_add_f32_dpp v28, v28, v28 row_ror:1 row_mask:0xf bank_mask:0xf
    v_add_f32_dpp v29, v29, v29 row_ror:1 row_mask:0xf bank_mask:0xf
    v_add_f32_dpp v30, v30, v30 row_ror:1 row_mask:0xf bank_mask:0xf
    v_add_f32_dpp v31, v31, v31 row_ror:1 row_mask:0xf bank_mask:0xf
    v_max3_f32 v38, v36, v28, v29
    v_max3_f32 v38, v38, v30, v31
    v_sub_f32 v39, v36, v38
    v_mul_f32 v39, s70, v39
    v_exp_f32 v39, v39
    v_mul_f32 v56, s70, v38
    v_mov_b32 v36, v38
    v_fma_f32 v48, v28, s70, -v56
    v_fma_f32 v49, v29, s70, -v56
    v_fma_f32 v50, v30, s70, -v56
    v_fma_f32 v51, v31, s70, -v56
    v_exp_f32 v48, v48
    v_exp_f32 v49, v49
    v_exp_f32 v50, v50
    v_exp_f32 v51, v51
    v_mul_f32 v37, v37, v39
    v_mul_f32 v16, v16, v39
    v_mul_f32 v17, v17, v39
    v_mul_f32 v18, v18, v39
    v_mul_f32 v19, v19, v39
    v_mul_f32 v20, v20, v39
    v_mul_f32 v21, v21, v39
    v_mul_f32 v22, v22, v39
    v_mul_f32 v23, v23, v39
    v_add_f32 v37, v37, v48
    v_add_f32 v37, v37, v49
    v_add_f32 v37, v37, v50
    v_add_f32 v37, v37, v51
    v_lshlrev_b32 v40, 16, v80
    v_and_b32 v41, 0xffff0000, v80
    v_lshlrev_b32 v42, 16, v81
    v_and_b32 v43, 0xffff0000, v81
    v_lshlrev_b32 v44, 16, v82
    v_and_b32 v45, 0xffff0000, v82
    v_lshlrev_b32 v46, 16, v83
    v_and_b32 v47, 0xffff0000, v83
    s_waitcnt vmcnt(7)
    buffer_load_dwordx4 v[80:83], v4, s[48:51], s100 offen offset:0 nt
    v_fmac_f32 v16, v40, v48
    v_fmac_f32 v17, v41, v48
    v_fmac_f32 v18, v42, v48
    v_fmac_f32 v19, v43, v48
    v_fmac_f32 v20, v44, v48
    v_fmac_f32 v21, v45, v48
    v_fmac_f32 v22, v46, v48
    v_fmac_f32 v23, v47, v48
    v_lshlrev_b32 v40, 16, v84
    v_and_b32 v41, 0xffff0000, v84
    v_lshlrev_b32 v42, 16, v85
    v_and_b32 v43, 0xffff0000, v85
    v_lshlrev_b32 v44, 16, v86
    v_and_b32 v45, 0xffff0000, v86
    v_lshlrev_b32 v46, 16, v87
    v_and_b32 v47, 0xffff0000, v87
    s_waitcnt vmcnt(7)
    buffer_load_dwordx4 v[84:87], v4, s[48:51], s100 offen offset:1024 nt
    s_mov_b64 exec, 1
    v_mov_b32 v8, 1
    ds_add_rtn_u32 v8, v10, v8
    s_mov_b64 exec, -1
    v_fmac_f32 v16, v40, v49
    v_fmac_f32 v17, v41, v49
    v_fmac_f32 v18, v42, v49
    v_fmac_f32 v19, v43, v49
    v_fmac_f32 v20, v44, v49
    v_fmac_f32 v21, v45, v49
    v_fmac_f32 v22, v46, v49
    v_fmac_f32 v23, v47, v49
    v_lshlrev_b32 v40, 16, v88
    v_and_b32 v41, 0xffff0000, v88
    v_lshlrev_b32 v42, 16, v89
    v_and_b32 v43, 0xffff0000, v89
    v_lshlrev_b32 v44, 16, v90
    v_and_b32 v45, 0xffff0000, v90
    v_lshlrev_b32 v46, 16, v91
    v_and_b32 v47, 0xffff0000, v91
    s_waitcnt vmcnt(7)
    buffer_load_dwordx4 v[88:91], v4, s[48:51], s100 offen offset:2048 nt
    s_waitcnt lgkmcnt(0)
    v_readfirstlane_b32 s84, v8
    s_mov_b64 exec, 1
    v_lshlrev_b32 v8, 2, v8
    ds_read_b32 v9, v8 offset:1024
    s_mov_b64 exec, -1
    v_fmac_f32 v16, v40, v50
    v_fmac_f32 v17, v41, v50
    v_fmac_f32 v18, v42, v50
    v_fmac_f32 v19, v43, v50
    v_fmac_f32 v20, v44, v50
    v_fmac_f32 v21, v45, v50
    v_fmac_f32 v22, v46, v50
    v_fmac_f32 v23, v47, v50
    v_lshlrev_b32 v40, 16, v92
    v_and_b32 v41, 0xffff0000, v92
    v_lshlrev_b32 v42, 16, v93
    v_and_b32 v43, 0xffff0000, v93
    v_lshlrev_b32 v44, 16, v94
    v_and_b32 v45, 0xffff0000, v94
    v_lshlrev_b32 v46, 16, v95
    v_and_b32 v47, 0xffff0000, v95
    s_waitcnt vmcnt(7)
    buffer_load_dwordx4 v[92:95], v4, s[48:51], s100 offen offset:3072 nt
    v_fmac_f32 v16, v40, v51
    v_fmac_f32 v17, v41, v51
    v_fmac_f32 v18, v42, v51
    v_fmac_f32 v19, v43, v51
    v_fmac_f32 v20, v44, v51
    v_fmac_f32 v21, v45, v51
    v_fmac_f32 v22, v46, v51
    v_fmac_f32 v23, v47, v51
    s_waitcnt lgkmcnt(0)
    v_readfirstlane_b32 s73, v9
    s_nop 0
    s_cmp_lg_u32 s73, -1
    s_cbranch_scc1 Lg_34
    s_mov_b32 s92, 0
Lgs_35:
    s_sleep 1
    s_mov_b64 exec, 1
    ds_read_b32 v9, v8 offset:1024
    s_mov_b64 exec, -1
    s_waitcnt lgkmcnt(0)
    v_readfirstlane_b32 s73, v9
    s_add_u32 s92, s92, 1
    s_cmp_lg_u32 s73, -1
    s_cbranch_scc1 Lg_34
    s_cmp_lt_u32 s92, 400000
    s_cbranch_scc1 Lgs_35
Lg_34:
    v_dot2_f32_bf16 v28, v96, v24, 0
    v_dot2_f32_bf16 v28, v97, v25, v28
    v_dot2_f32_bf16 v28, v98, v26, v28
    v_dot2_f32_bf16 v28, v99, v27, v28
    v_dot2_f32_bf16 v29, v100, v24, 0
    v_dot2_f32_bf16 v29, v101, v25, v29
    v_dot2_f32_bf16 v29, v102, v26, v29
    v_dot2_f32_bf16 v29, v103, v27, v29
    v_dot2_f32_bf16 v30, v104, v24, 0
    v_dot2_f32_bf16 v30, v105, v25, v30
    v_dot2_f32_bf16 v30, v106, v26, v30
    v_dot2_f32_bf16 v30, v107, v27, v30
    v_dot2_f32_bf16 v31, v108, v24, 0
    v_dot2_f32_bf16 v31, v109, v25, v31
    v_dot2_f32_bf16 v31, v110, v26, v31
    v_dot2_f32_bf16 v31, v111, v27, v31
    s_nop 2
    v_add_f32_dpp v28, v28, v28 row_ror:8 row_mask:0xf bank_mask:0xf
    v_add_f32_dpp v29, v29, v29 row_ror:8 row_mask:0xf bank_mask:0xf
    v_add_f32_dpp v30, v30, v30 row_ror:8 row_mask:0xf bank_mask:0xf
    v_add_f32_dpp v31, v31, v31 row_ror:8 row_mask:0xf bank_mask:0xf
    v_add_f32_dpp v28, v28, v28 row_ror:4 row_mask:0xf bank_mask:0xf
    v_add_f32_dpp v29, v29, v29 row_ror:4 row_mask:0xf bank_mask:0xf
    v_add_f32_dpp v30, v30, v30 row_ror:4 row_mask:0xf bank_mask:0xf
    v_add_f32_dpp v31, v31, v31 row_ror:4 row_mask:0xf bank_mask:0xf
    v_add_f32_dpp v28, v28, v28 row_ror:2 row_mask:0xf bank_mask:0xf
    v_add_f32_dpp v29, v29, v29 row_ror:2 row_mask:0xf bank_mask:0xf
    v_add_f32_dpp v30, v30, v30 row_ror:2 row_mask:0xf bank_mask:0xf
    v_add_f32_dpp v31, v31, v31 row_ror:2 row_mask:0xf bank_mask:0xf
    v_add_f32_dpp v28, v28, v28 row_ror:1 row_mask:0xf bank_mask:0xf
    v_add_f32_dpp v29, v29, v29 row_ror:1 row_mask:0xf bank_mask:0xf
    v_add_f32_dpp v30, v30, v30 row_ror:1 row_mask:0xf bank_mask:0xf
    v_add_f32_dpp v31, v31, v31 row_ror:1 row_mask:0xf bank_mask:0xf
    v_max3_f32 v38, v36, v28, v29
    v_max3_f32 v38, v38, v30, v31
    v_sub_f32 v39, v36, v38
    v_mul_f32 v39, s70, v39
    v_exp_f32 v39, v39
    v_mul_f32 v56, s70, v38
    v_mov_b32 v36, v38
    v_fma_f32 v48, v28, s70, -v56
    v_fma_f32 v49, v29, s70, -v56
    v_fma_f32 v50, v30, s70, -v56
    v_fma_f32 v51, v31, s70, -v56
    v_exp_f32 v48, v48
    v_exp_f32 v49, v49
    v_exp_f32 v50, v50
    v_exp_f32 v51, v51
    v_mul_f32 v37, v37, v39
    v_mul_f32 v16, v16, v39
    v_mul_f32 v17, v17, v39
    v_mul_f32 v18, v18, v39
    v_mul_f32 v19, v19, v39
    v_mul_f32 v20, v20, v39
    v_mul_f32 v21, v21, v39
    v_mul_f32 v22, v22, v39
    v_mul_f32 v23, v23, v39
    v_add_f32 v37, v37, v48
    v_add_f32 v37, v37, v49
    v_add_f32 v37, v37, v50
    v_add_f32 v37, v37, v51
    v_lshlrev_b32 v40, 16, v112
    v_and_b32 v41, 0xffff0000, v112
    v_lshlrev_b32 v42, 16, v113
    v_and_b32 v43, 0xffff0000, v113
    v_lshlrev_b32 v44, 16, v114
    v_and_b32 v45, 0xffff0000, v114
    v_lshlrev_b32 v46, 16, v115
    v_and_b32 v47, 0xffff0000, v115
    v_fmac_f32 v16, v40, v48
    v_fmac_f32 v17, v41, v48
    v_fmac_f32 v18, v42, v48
    v_fmac_f32 v19, v43, v48
    v_fmac_f32 v20, v44, v48
    v_fmac_f32 v21, v45, v48
    v_fmac_f32 v22, v46, v48
    v_fmac_f32 v23, v47, v48
    v_lshlrev_b32 v40, 16, v116
    v_and_b32 v41, 0xffff0000, v116
    v_lshlrev_b32 v42, 16, v117
    v_and_b32 v43, 0xffff0000, v117
    v_lshlrev_b32 v44, 16, v118
    v_and_b32 v45, 0xffff0000, v118
    v_lshlrev_b32 v46, 16, v119
    v_and_b32 v47, 0xffff0000, v119
    v_fmac_f32 v16, v40, v49
    v_fmac_f32 v17, v41, v49
    v_fmac_f32 v18, v42, v49
    v_fmac_f32 v19, v43, v49
    v_fmac_f32 v20, v44, v49
    v_fmac_f32 v21, v45, v49
    v_fmac_f32 v22, v46, v49
    v_fmac_f32 v23, v47, v49
    v_lshlrev_b32 v40, 16, v120
    v_and_b32 v41, 0xffff0000, v120
    v_lshlrev_b32 v42, 16, v121
    v_and_b32 v43, 0xffff0000, v121
    v_lshlrev_b32 v44, 16, v122
    v_and_b32 v45, 0xffff0000, v122
    v_lshlrev_b32 v46, 16, v123
    v_and_b32 v47, 0xffff0000, v123
    v_fmac_f32 v16, v40, v50
    v_fmac_f32 v17, v41, v50
    v_fmac_f32 v18, v42, v50
    v_fmac_f32 v19, v43, v50
    v_fmac_f32 v20, v44, v50
    v_fmac_f32 v21, v45, v50
    v_fmac_f32 v22, v46, v50
    v_fmac_f32 v23, v47, v50
    v_lshlrev_b32 v40, 16, v124
    v_and_b32 v41, 0xffff0000, v124
    v_lshlrev_b32 v42, 16, v125
    v_and_b32 v43, 0xffff0000, v125
    v_lshlrev_b32 v44, 16, v126
    v_and_b32 v45, 0xffff0000, v126
    v_lshlrev_b32 v46, 16, v127
    v_and_b32 v47, 0xffff0000, v127
    v_fmac_f32 v16, v40, v51
    v_fmac_f32 v17, v41, v51
    v_fmac_f32 v18, v42, v51
    v_fmac_f32 v19, v43, v51
    v_fmac_f32 v20, v44, v51
    v_fmac_f32 v21, v45, v51
    v_fmac_f32 v22, v46, v51
    v_fmac_f32 v23, v47, v51
    v_dot2_f32_bf16 v28, v128, v24, 0
    v_dot2_f32_bf16 v28, v129, v25, v28
    v_dot2_f32_bf16 v28, v130, v26, v28
    v_dot2_f32_bf16 v28, v131, v27, v28
    v_dot2_f32_bf16 v29, v132, v24, 0
    v_dot2_f32_bf16 v29, v133, v25, v29
    v_dot2_f32_bf16 v29, v134, v26, v29
    v_dot2_f32_bf16 v29, v135, v27, v29
    v_dot2_f32_bf16 v30, v136, v24, 0
    v_dot2_f32_bf16 v30, v137, v25, v30
    v_dot2_f32_bf16 v30, v138, v26, v30
    v_dot2_f32_bf16 v30, v139, v27, v30
    v_dot2_f32_bf16 v31, v140, v24, 0
    v_dot2_f32_bf16 v31, v141, v25, v31
    v_dot2_f32_bf16 v31, v142, v26, v31
    v_dot2_f32_bf16 v31, v143, v27, v31
    s_nop 2
    v_add_f32_dpp v28, v28, v28 row_ror:8 row_mask:0xf bank_mask:0xf
    v_add_f32_dpp v29, v29, v29 row_ror:8 row_mask:0xf bank_mask:0xf
    v_add_f32_dpp v30, v30, v30 row_ror:8 row_mask:0xf bank_mask:0xf
    v_add_f32_dpp v31, v31, v31 row_ror:8 row_mask:0xf bank_mask:0xf
    v_add_f32_dpp v28, v28, v28 row_ror:4 row_mask:0xf bank_mask:0xf
    v_add_f32_dpp v29, v29, v29 row_ror:4 row_mask:0xf bank_mask:0xf
    v_add_f32_dpp v30, v30, v30 row_ror:4 row_mask:0xf bank_mask:0xf
    v_add_f32_dpp v31, v31, v31 row_ror:4 row_mask:0xf bank_mask:0xf
    v_add_f32_dpp v28, v28, v28 row_ror:2 row_mask:0xf bank_mask:0xf
    v_add_f32_dpp v29, v29, v29 row_ror:2 row_mask:0xf bank_mask:0xf
    v_add_f32_dpp v30, v30, v30 row_ror:2 row_mask:0xf bank_mask:0xf
    v_add_f32_dpp v31, v31, v31 row_ror:2 row_mask:0xf bank_mask:0xf
    v_add_f32_dpp v28, v28, v28 row_ror:1 row_mask:0xf bank_mask:0xf
    v_add_f32_dpp v29, v29, v29 row_ror:1 row_mask:0xf bank_mask:0xf
    v_add_f32_dpp v30, v30, v30 row_ror:1 row_mask:0xf bank_mask:0xf
    v_add_f32_dpp v31, v31, v31 row_ror:1 row_mask:0xf bank_mask:0xf
    v_max3_f32 v38, v36, v28, v29
    v_max3_f32 v38, v38, v30, v31
    v_sub_f32 v39, v36, v38
    v_mul_f32 v39, s70, v39
    v_exp_f32 v39, v39
    v_mul_f32 v56, s70, v38
    v_mov_b32 v36, v38
    v_fma_f32 v48, v28, s70, -v56
    v_fma_f32 v49, v29, s70, -v56
    v_fma_f32 v50, v30, s70, -v56
    v_fma_f32 v51, v31, s70, -v56
    v_exp_f32 v48, v48
    v_exp_f32 v49, v49
    v_exp_f32 v50, v50
    v_exp_f32 v51, v51
    v_mul_f32 v37, v37, v39
    v_mul_f32 v16, v16, v39
    v_mul_f32 v17, v17, v39
    v_mul_f32 v18, v18, v39
    v_mul_f32 v19, v19, v39
    v_mul_f32 v20, v20, v39
    v_mul_f32 v21, v21, v39
    v_mul_f32 v22, v22, v39
    v_mul_f32 v23, v23, v39
    v_add_f32 v37, v37, v48
    v_add_f32 v37, v37, v49
    v_add_f32 v37, v37, v50
    v_add_f32 v37, v37, v51
    v_lshlrev_b32 v40, 16, v144
    v_and_b32 v41, 0xffff0000, v144
    v_lshlrev_b32 v42, 16, v145
    v_and_b32 v43, 0xffff0000, v145
    v_lshlrev_b32 v44, 16, v146
    v_and_b32 v45, 0xffff0000, v146
    v_lshlrev_b32 v46, 16, v147
    v_and_b32 v47, 0xffff0000, v147
    v_fmac_f32 v16, v40, v48
    v_fmac_f32 v17, v41, v48
    v_fmac_f32 v18, v42, v48
    v_fmac_f32 v19, v43, v48
    v_fmac_f32 v20, v44, v48
    v_fmac_f32 v21, v45, v48
    v_fmac_f32 v22, v46, v48
    v_fmac_f32 v23, v47, v48
    v_lshlrev_b32 v40, 16, v148
    v_and_b32 v41, 0xffff0000, v148
    v_lshlrev_b32 v42, 16, v149
    v_and_b32 v43, 0xffff0000, v149
    v_lshlrev_b32 v44, 16, v150
    v_and_b32 v45, 0xffff0000, v150
    v_lshlrev_b32 v46, 16, v151
    v_and_b32 v47, 0xffff0000, v151
    v_fmac_f32 v16, v40, v49
    v_fmac_f32 v17, v41, v49
    v_fmac_f32 v18, v42, v49
    v_fmac_f32 v19, v43, v49
    v_fmac_f32 v20, v44, v49
    v_fmac_f32 v21, v45, v49
    v_fmac_f32 v22, v46, v49
    v_fmac_f32 v23, v47, v49
    v_lshlrev_b32 v40, 16, v152
    v_and_b32 v41, 0xffff0000, v152
    v_lshlrev_b32 v42, 16, v153
    v_and_b32 v43, 0xffff0000, v153
    v_lshlrev_b32 v44, 16, v154
    v_and_b32 v45, 0xffff0000, v154
    v_lshlrev_b32 v46, 16, v155
    v_and_b32 v47, 0xffff0000, v155
    v_fmac_f32 v16, v40, v50
    v_fmac_f32 v17, v41, v50
    v_fmac_f32 v18, v42, v50
    v_fmac_f32 v19, v43, v50
    v_fmac_f32 v20, v44, v50
    v_fmac_f32 v21, v45, v50
    v_fmac_f32 v22, v46, v50
    v_fmac_f32 v23, v47, v50
    v_lshlrev_b32 v40, 16, v156
    v_and_b32 v41, 0xffff0000, v156
    v_lshlrev_b32 v42, 16, v157
    v_and_b32 v43, 0xffff0000, v157
    v_lshlrev_b32 v44, 16, v158
    v_and_b32 v45, 0xffff0000, v158
    v_lshlrev_b32 v46, 16, v159
    v_and_b32 v47, 0xffff0000, v159
    v_fmac_f32 v16, v40, v51
    v_fmac_f32 v17, v41, v51
    v_fmac_f32 v18, v42, v51
    v_fmac_f32 v19, v43, v51
    v_fmac_f32 v20, v44, v51
    v_fmac_f32 v21, v45, v51
    v_fmac_f32 v22, v46, v51
    v_fmac_f32 v23, v47, v51
    s_waitcnt vmcnt(8)
    v_dot2_f32_bf16 v28, v160, v24, 0
    v_dot2_f32_bf16 v28, v161, v25, v28
    v_dot2_f32_bf16 v28, v162, v26, v28
    v_dot2_f32_bf16 v28, v163, v27, v28
    v_dot2_f32_bf16 v29, v164, v24, 0
    v_dot2_f32_bf16 v29, v165, v25, v29
    v_dot2_f32_bf16 v29, v166, v26, v29
    v_dot2_f32_bf16 v29, v167, v27, v29
    v_dot2_f32_bf16 v30, v168, v24, 0
    v_dot2_f32_bf16 v30, v169, v25, v30
    v_dot2_f32_bf16 v30, v170, v26, v30
    v_dot2_f32_bf16 v30, v171, v27, v30
    v_dot2_f32_bf16 v31, v172, v24, 0
    v_dot2_f32_bf16 v31, v173, v25, v31
    v_dot2_f32_bf16 v31, v174, v26, v31
    v_dot2_f32_bf16 v31, v175, v27, v31
    s_nop 2
    v_add_f32_dpp v28, v28, v28 row_ror:8 row_mask:0xf bank_mask:0xf
    v_add_f32_dpp v29, v29, v29 row_ror:8 row_mask:0xf bank_mask:0xf
    v_add_f32_dpp v30, v30, v30 row_ror:8 row_mask:0xf bank_mask:0xf
    v_add_f32_dpp v31, v31, v31 row_ror:8 row_mask:0xf bank_mask:0xf
    v_add_f32_dpp v28, v28, v28 row_ror:4 row_mask:0xf bank_mask:0xf
    v_add_f32_dpp v29, v29, v29 row_ror:4 row_mask:0xf bank_mask:0xf
    v_add_f32_dpp v30, v30, v30 row_ror:4 row_mask:0xf bank_mask:0xf
    v_add_f32_dpp v31, v31, v31 row_ror:4 row_mask:0xf bank_mask:0xf
    v_add_f32_dpp v28, v28, v28 row_ror:2 row_mask:0xf bank_mask:0xf
    v_add_f32_dpp v29, v29, v29 row_ror:2 row_mask:0xf bank_mask:0xf
    v_add_f32_dpp v30, v30, v30 row_ror:2 row_mask:0xf bank_mask:0xf
    v_add_f32_dpp v31, v31, v31 row_ror:2 row_mask:0xf bank_mask:0xf
    v_add_f32_dpp v28, v28, v28 row_ror:1 row_mask:0xf bank_mask:0xf
    v_add_f32_dpp v29, v29, v29 row_ror:1 row_mask:0xf bank_mask:0xf
    v_add_f32_dpp v30, v30, v30 row_ror:1 row_mask:0xf bank_mask:0xf
    v_add_f32_dpp v31, v31, v31 row_ror:1 row_mask:0xf bank_mask:0xf
    v_max3_f32 v38, v36, v28, v29
    v_max3_f32 v38, v38, v30, v31
    v_sub_f32 v39, v36, v38
    v_mul_f32 v39, s70, v39
    v_exp_f32 v39, v39
    v_mul_f32 v56, s70, v38
    v_mov_b32 v36, v38
    v_fma_f32 v48, v28, s70, -v56
    v_fma_f32 v49, v29, s70, -v56
    v_fma_f32 v50, v30, s70, -v56
    v_fma_f32 v51, v31, s70, -v56
    v_exp_f32 v48, v48
    v_exp_f32 v49, v49
    v_exp_f32 v50, v50
    v_exp_f32 v51, v51
    v_mul_f32 v37, v37, v39
    v_mul_f32 v16, v16, v39
    v_mul_f32 v17, v17, v39
    v_mul_f32 v18, v18, v39
    v_mul_f32 v19, v19, v39
    v_mul_f32 v20, v20, v39
    v_mul_f32 v21, v21, v39
    v_mul_f32 v22, v22, v39
    v_mul_f32 v23, v23, v39
    v_add_f32 v37, v37, v48
    v_add_f32 v37, v37, v49
    v_add_f32 v37, v37, v50
    v_add_f32 v37, v37, v51
    v_lshlrev_b32 v40, 16, v176
    v_and_b32 v41, 0xffff0000, v176
    v_lshlrev_b32 v42, 16, v177
    v_and_b32 v43, 0xffff0000, v177
    v_lshlrev_b32 v44, 16, v178
    v_and_b32 v45, 0xffff0000, v178
    v_lshlrev_b32 v46, 16, v179
    v_and_b32 v47, 0xffff0000, v179
    v_fmac_f32 v16, v40, v48
    v_fmac_f32 v17, v41, v48
    v_fmac_f32 v18, v42, v48
    v_fmac_f32 v19, v43, v48
    v_fmac_f32 v20, v44, v48
    v_fmac_f32 v21, v45, v48
    v_fmac_f32 v22, v46, v48
    v_fmac_f32 v23, v47, v48
    v_lshlrev_b32 v40, 16, v180
    v_and_b32 v41, 0xffff0000, v180
    v_lshlrev_b32 v42, 16, v181
    v_and_b32 v43, 0xffff0000, v181
    v_lshlrev_b32 v44, 16, v182
    v_and_b32 v45, 0xffff0000, v182
    v_lshlrev_b32 v46, 16, v183
    v_and_b32 v47, 0xffff0000, v183
    v_fmac_f32 v16, v40, v49
    v_fmac_f32 v17, v41, v49
    v_fmac_f32 v18, v42, v49
    v_fmac_f32 v19, v43, v49
    v_fmac_f32 v20, v44, v49
    v_fmac_f32 v21, v45, v49
    v_fmac_f32 v22, v46, v49
    v_fmac_f32 v23, v47, v49
    v_lshlrev_b32 v40, 16, v184
    v_and_b32 v41, 0xffff0000, v184
    v_lshlrev_b32 v42, 16, v185
    v_and_b32 v43, 0xffff0000, v185
    v_lshlrev_b32 v44, 16, v186
    v_and_b32 v45, 0xffff0000, v186
    v_lshlrev_b32 v46, 16, v187
    v_and_b32 v47, 0xffff0000, v187
    v_fmac_f32 v16, v40, v50
    v_fmac_f32 v17, v41, v50
    v_fmac_f32 v18, v42, v50
    v_fmac_f32 v19, v43, v50
    v_fmac_f32 v20, v44, v50
    v_fmac_f32 v21, v45, v50
    v_fmac_f32 v22, v46, v50
    v_fmac_f32 v23, v47, v50
    v_lshlrev_b32 v40, 16, v188
    v_and_b32 v41, 0xffff0000, v188
    v_lshlrev_b32 v42, 16, v189
    v_and_b32 v43, 0xffff0000, v189
    v_lshlrev_b32 v44, 16, v190
    v_and_b32 v45, 0xffff0000, v190
    v_lshlrev_b32 v46, 16, v191
    v_and_b32 v47, 0xffff0000, v191
    v_fmac_f32 v16, v40, v51
    v_fmac_f32 v17, v41, v51
    v_fmac_f32 v18, v42, v51
    v_fmac_f32 v19, v43, v51
    v_fmac_f32 v20, v44, v51
    v_fmac_f32 v21, v45, v51
    v_fmac_f32 v22, v46, v51
    v_fmac_f32 v23, v47, v51
LBloop_21:
    s_cmp_ge_u32 s73, 67108864
    s_cbranch_scc1 LBtail0_25
    s_cmp_ge_u32 s84, 42
    s_cbranch_scc1 LBloop2_23
    s_cmp_ge_u32 s71, s76
    s_cbranch_scc1 Lsw_36
Lswb_37:
    s_mov_b32 s100, s73
    s_mov_b32 s71, s73
    s_waitcnt vmcnt(7)
    v_dot2_f32_bf16 v28, v64, v24, 0
    v_dot2_f32_bf16 v28, v65, v25, v28
    v_dot2_f32_bf16 v28, v66, v26, v28
    v_dot2_f32_bf16 v28, v67, v27, v28
    s_waitcnt vmcnt(3)
    buffer_load_dwordx4 v[64:67], v4, s[44:47], s100 offen offset:0 nt
    s_waitcnt vmcnt(7)
    v_dot2_f32_bf16 v29, v68, v24, 0
    v_dot2_f32_bf16 v29, v69, v25, v29
    v_dot2_f32_bf16 v29, v70, v26, v29
    v_dot2_f32_bf16 v29, v71, v27, v29
    s_waitcnt vmcnt(3)
    buffer_load_dwordx4 v[68:71], v4, s[44:47], s100 offen offset:1024 nt
    s_waitcnt vmcnt(7)
    v_dot2_f32_bf16 v30, v72, v24, 0
    v_dot2_f32_bf16 v30, v73, v25, v30
    v_dot2_f32_bf16 v30, v74, v26, v30
    v_dot2_f32_bf16 v30, v75, v27, v30
    s_waitcnt vmcnt(3)
    buffer_load_dwordx4 v[72:75], v4, s[44:47], s100 offen offset:2048 nt
    s_waitcnt vmcnt(7)
    v_dot2_f32_bf16 v31, v76, v24, 0
    v_dot2_f32_bf16 v31, v77, v25, v31
    v_dot2_f32_bf16 v31, v78, v26, v31
    v_dot2_f32_bf16 v31, v79, v27, v31
    s_waitcnt vmcnt(3)
    buffer_load_dwordx4 v[76:79], v4, s[44:47], s100 offen offset:3072 nt
    s_nop 2
    v_add_f32_dpp v28, v28, v28 row_ror:8 row_mask:0xf bank_mask:0xf
    v_add_f32_dpp v29, v29, v29 row_ror:8 row_mask:0xf bank_mask:0xf
    v_add_f32_dpp v30, v30, v30 row_ror:8 row_mask:0xf bank_mask:0xf
    v_add_f32_dpp v31, v31, v31 row_ror:8 row_mask:0xf bank_mask:0xf
    v_add_f32_dpp v28, v28, v28 row_ror:4 row_mask:0xf bank_mask:0xf
    v_add_f32_dpp v29, v29, v29 row_ror:4 row_mask:0xf bank_mask:0xf
    v_add_f32_dpp v30, v30, v30 row_ror:4 row_mask:0xf bank_mask:0xf
    v_add_f32_dpp v31, v31, v31 row_ror:4 row_mask:0xf bank_mask:0xf
    v_add_f32_dpp v28, v28, v28 row_ror:2 row_mask:0xf bank_mask:0xf
    v_add_f32_dpp v29, v29, v29 row_ror:2 row_mask:0xf bank_mask:0xf
    v_add_f32_dpp v30, v30, v30 row_ror:2 row_mask:0xf bank_mask:0xf
    v_add_f32_dpp v31, v31, v31 row_ror:2 row_mask:0xf bank_mask:0xf
    v_add_f32_dpp v28, v28, v28 row_ror:1 row_mask:0xf bank_mask:0xf
    v_add_f32_dpp v29, v29, v29 row_ror:1 row_mask:0xf bank_mask:0xf
    v_add_f32_dpp v30, v30, v30 row_ror:1 row_mask:0xf bank_mask:0xf
    v_add_f32_dpp v31, v31, v31 row_ror:1 row_mask:0xf bank_mask:0xf
    v_max3_f32 v38, v36, v28, v29
    v_max3_f32 v38, v38, v30, v31
    v_sub_f32 v39, v36, v38
    v_mul_f32 v39, s70, v39
    v_exp_f32 v39, v39
    v_mul_f32 v56, s70, v38
    v_mov_b32 v36, v38
    v_fma_f32 v48, v28, s70, -v56
    v_fma_f32 v49, v29, s70, -v56
    v_fma_f32 v50, v30, s70, -v56
    v_fma_f32 v51, v31, s70, -v56
    v_exp_f32 v48, v48
    v_exp_f32 v49, v49
    v_exp_f32 v50, v50
    v_exp_f32 v51, v51
    v_mul_f32 v37, v37, v39
    v_mul_f32 v16, v16, v39
    v_mul_f32 v17, v17, v39
    v_mul_f32 v18, v18, v39
    v_mul_f32 v19, v19, v39
    v_mul_f32 v20, v20, v39
    v_mul_f32 v21, v21, v39
    v_mul_f32 v22, v22, v39
    v_mul_f32 v23, v23, v39
    v_add_f32 v37, v37, v48
    v_add_f32 v37, v37, v49
    v_add_f32 v37, v37, v50
    v_add_f32 v37, v37, v51
    s_waitcnt vmcnt(7)
    v_lshlrev_b32 v40, 16, v80
    v_and_b32 v41, 0xffff0000, v80
    v_lshlrev_b32 v42, 16, v81
    v_and_b32 v43, 0xffff0000, v81
    v_lshlrev_b32 v44, 16, v82
    v_and_b32 v45, 0xffff0000, v82
    v_lshlrev_b32 v46, 16, v83
    v_and_b32 v47, 0xffff0000, v83
    s_waitcnt vmcnt(3)
    buffer_load_dwordx4 v[80:83], v4, s[48:51], s100 offen offset:0 nt
    v_fmac_f32 v16, v40, v48
    v_fmac_f32 v17, v41, v48
    v_fmac_f32 v18, v42, v48
    v_fmac_f32 v19, v43, v48
    v_fmac_f32 v20, v44, v48
    v_fmac_f32 v21, v45, v48
    v_fmac_f32 v22, v46, v48
    v_fmac_f32 v23, v47, v48
    s_waitcnt vmcnt(7)
    v_lshlrev_b32 v40, 16, v84
    v_and_b32 v41, 0xffff0000, v84
    v_lshlrev_b32 v42, 16, v85
    v_and_b32 v43, 0xffff0000, v85
    v_lshlrev_b32 v44, 16, v86
    v_and_b32 v45, 0xffff0000, v86
    v_lshlrev_b32 v46, 16, v87
    v_and_b32 v47, 0xffff0000, v87
    s_waitcnt vmcnt(3)
    buffer_load_dwordx4 v[84:87], v4, s[48:51], s100 offen offset:1024 nt
    s_mov_b64 exec, 1
    v_mov_b32 v8, 1
    ds_add_rtn_u32 v8, v10, v8
    s_mov_b64 exec, -1
    v_fmac_f32 v16, v40, v49
    v_fmac_f32 v17, v41, v49
    v_fmac_f32 v18, v42, v49
    v_fmac_f32 v19, v43, v49
    v_fmac_f32 v20, v44, v49
    v_fmac_f32 v21, v45, v49
    v_fmac_f32 v22, v46, v49
    v_fmac_f32 v23, v47, v49
    s_waitcnt vmcnt(7)
    v_lshlrev_b32 v40, 16, v88
    v_and_b32 v41, 0xffff0000, v88
    v_lshlrev_b32 v42, 16, v89
    v_and_b32 v43, 0xffff0000, v89
    v_lshlrev_b32 v44, 16, v90
    v_and_b32 v45, 0xffff0000, v90
    v_lshlrev_b32 v46, 16, v91
    v_and_b32 v47, 0xffff0000, v91
    s_waitcnt vmcnt(3)
    buffer_load_dwordx4 v[88:91], v4, s[48:51], s100 offen offset:2048 nt
    s_waitcnt lgkmcnt(0)
    v_readfirstlane_b32 s84, v8
    s_mov_b64 exec, 1
    v_lshlrev_b32 v8, 2, v8
    ds_read_b32 v9, v8 offset:1024
    s_mov_b64 exec, -1
    v_fmac_f32 v16, v40, v50
    v_fmac_f32 v17, v41, v50
    v_fmac_f32 v18, v42, v50
    v_fmac_f32 v19, v43, v50
    v_fmac_f32 v20, v44, v50
    v_fmac_f32 v21, v45, v50
    v_fmac_f32 v22, v46, v50
    v_fmac_f32 v23, v47, v50
    s_waitcnt vmcnt(7)
    v_lshlrev_b32 v40, 16, v92
    v_and_b32 v41, 0xffff0000, v92
    v_lshlrev_b32 v42, 16, v93
    v_and_b32 v43, 0xffff0000, v93
    v_lshlrev_b32 v44, 16, v94
    v_and_b32 v45, 0xffff0000, v94
    v_lshlrev_b32 v46, 16, v95
    v_and_b32 v47, 0xffff0000, v95
    s_waitcnt vmcnt(3)
    buffer_load_dwordx4 v[92:95], v4, s[48:51], s100 offen offset:3072 nt
    v_fmac_f32 v16, v40, v51
    v_fmac_f32 v17, v41, v51
    v_fmac_f32 v18, v42, v51
    v_fmac_f32 v19, v43, v51
    v_fmac_f32 v20, v44, v51
    v_fmac_f32 v21, v45, v51
    v_fmac_f32 v22, v46, v51
    v_fmac_f32 v23, v47, v51
    s_waitcnt lgkmcnt(0)
    v_readfirstlane_b32 s73, v9
    s_nop 0
    s_cmp_lg_u32 s73, -1
    s_cbranch_scc1 Lg_38
    s_mov_b32 s92, 0
Lgs_39:
    s_sleep 1
    s_mov_b64 exec, 1
    ds_read_b32 v9, v8 offset:1024
    s_mov_b64 exec, -1
    s_waitcnt lgkmcnt(0)
    v_readfirstlane_b32 s73, v9
    s_add_u32 s92, s92, 1
    s_cmp_lg_u32 s73, -1
    s_cbranch_scc1 Lg_38
    s_cmp_lt_u32 s92, 400000
    s_cbranch_scc1 Lgs_39
Lg_38:
    s_branch LBloop_21
LBloop2_23:
    s_cmp_ge_u32 s73, 67108864
    s_cbranch_scc1 LBtail0_25
    s_cmp_ge_u32 s71, s76
    s_cbranch_scc1 Lsw_40
Lswb_41:
    s_and_b32 s100, s73, 0xfffffffe
    s_mov_b32 s71, s73
    s_waitcnt vmcnt(7)
    v_dot2_f32_bf16 v28, v64, v24, 0
    v_dot2_f32_bf16 v28, v65, v25, v28
    v_dot2_f32_bf16 v28, v66, v26, v28
    v_dot2_f32_bf16 v28, v67, v27, v28
    buffer_load_dwordx4 v[64:67], v4, s[44:47], s100 offen offset:0 nt
    s_waitcnt vmcnt(7)
    v_dot2_f32_bf16 v29, v68, v24, 0
    v_dot2_f32_bf16 v29, v69, v25, v29
    v_dot2_f32_bf16 v29, v70, v26, v29
    v_dot2_f32_bf16 v29, v71, v27, v29
    buffer_load_dwordx4 v[68:71], v4, s[44:47], s100 offen offset:1024 nt
    s_waitcnt vmcnt(7)
    v_dot2_f32_bf16 v30, v72, v24, 0
    v_dot2_f32_bf16 v30, v73, v25, v30
    v_dot2_f32_bf16 v30, v74, v26, v30
    v_dot2_f32_bf16 v30, v75, v27, v30
    buffer_load_dwordx4 v[72:75], v4, s[44:47], s100 offen offset:2048 nt
    s_waitcnt vmcnt(7)
    v_dot2_f32_bf16 v31, v76, v24, 0
    v_dot2_f32_bf16 v31, v77, v25, v31
    v_dot2_f32_bf16 v31, v78, v26, v31
    v_dot2_f32_bf16 v31, v79, v27, v31
    buffer_load_dwordx4 v[76:79], v4, s[44:47], s100 offen offset:3072 nt
    s_nop 2
    v_add_f32_dpp v28, v28, v28 row_ror:8 row_mask:0xf bank_mask:0xf
    v_add_f32_dpp v29, v29, v29 row_ror:8 row_mask:0xf bank_mask:0xf
    v_add_f32_dpp v30, v30, v30 row_ror:8 row_mask:0xf bank_mask:0xf
    v_add_f32_dpp v31, v31, v31 row_ror:8 row_mask:0xf bank_mask:0xf
    v_add_f32_dpp v28, v28, v28 row_ror:4 row_mask:0xf bank_mask:0xf
    v_add_f32_dpp v29, v29, v29 row_ror:4 row_mask:0xf bank_mask:0xf
    v_add_f32_dpp v30, v30, v30 row_ror:4 row_mask:0xf bank_mask:0xf
    v_add_f32_dpp v31, v31, v31 row_ror:4 row_mask:0xf bank_mask:0xf
    v_add_f32_dpp v28, v28, v28 row_ror:2 row_mask:0xf bank_mask:0xf
    v_add_f32_dpp v29, v29, v29 row_ror:2 row_mask:0xf bank_mask:0xf
    v_add_f32_dpp v30, v30, v30 row_ror:2 row_mask:0xf bank_mask:0xf
    v_add_f32_dpp v31, v31, v31 row_ror:2 row_mask:0xf bank_mask:0xf
    v_add_f32_dpp v28, v28, v28 row_ror:1 row_mask:0xf bank_mask:0xf
    v_add_f32_dpp v29, v29, v29 row_ror:1 row_mask:0xf bank_mask:0xf
    v_add_f32_dpp v30, v30, v30 row_ror:1 row_mask:0xf bank_mask:0xf
    v_add_f32_dpp v31, v31, v31 row_ror:1 row_mask:0xf bank_mask:0xf
    v_max3_f32 v38, v36, v28, v29
    v_max3_f32 v38, v38, v30, v31
    v_sub_f32 v39, v36, v38
    v_mul_f32 v39, s70, v39
    v_exp_f32 v39, v39
    v_mul_f32 v56, s70, v38
    v_mov_b32 v36, v38
    v_fma_f32 v48, v28, s70, -v56
    v_fma_f32 v49, v29, s70, -v56
    v_fma_f32 v50, v30, s70, -v56
    v_fma_f32 v51, v31, s70, -v56
    v_exp_f32 v48, v48
    v_exp_f32 v49, v49
    v_exp_f32 v50, v50
    v_exp_f32 v51, v51
    v_mul_f32 v37, v37, v39
    v_mul_f32 v16, v16, v39
    v_mul_f32 v17, v17, v39
    v_mul_f32 v18, v18, v39
    v_mul_f32 v19, v19, v39
    v_mul_f32 v20, v20, v39
    v_mul_f32 v21, v21, v39
    v_mul_f32 v22, v22, v39
    v_mul_f32 v23, v23, v39
    v_add_f32 v37, v37, v48
    v_add_f32 v37, v37, v49
    v_add_f32 v37, v37, v50
    v_add_f32 v37, v37, v51
    s_waitcnt vmcnt(7)
    v_lshlrev_b32 v40, 16, v80
    v_and_b32 v41, 0xffff0000, v80
    v_lshlrev_b32 v42, 16, v81
    v_and_b32 v43, 0xffff0000, v81
    v_lshlrev_b32 v44, 16, v82
    v_and_b32 v45, 0xffff0000, v82
    v_lshlrev_b32 v46, 16, v83
    v_and_b32 v47, 0xffff0000, v83
    buffer_load_dwordx4 v[80:83], v4, s[48:51], s100 offen offset:0 nt
    v_fmac_f32 v16, v40, v48
    v_fmac_f32 v17, v41, v48
    v_fmac_f32 v18, v42, v48
    v_fmac_f32 v19, v43, v48
    v_fmac_f32 v20, v44, v48
    v_fmac_f32 v21, v45, v48
    v_fmac_f32 v22, v46, v48
    v_fmac_f32 v23, v47, v48
    s_waitcnt vmcnt(7)
    v_lshlrev_b32 v40, 16, v84
    v_and_b32 v41, 0xffff0000, v84
    v_lshlrev_b32 v42, 16, v85
    v_and_b32 v43, 0xffff0000, v85
    v_lshlrev_b32 v44, 16, v86
    v_and_b32 v45, 0xffff0000, v86
    v_lshlrev_b32 v46, 16, v87
    v_and_b32 v47, 0xffff0000, v87
    buffer_load_dwordx4 v[84:87], v4, s[48:51], s100 offen offset:1024 nt
    s_mov_b64 exec, 1
    v_mov_b32 v8, 1
    ds_add_rtn_u32 v8, v10, v8
    s_mov_b64 exec, -1
    v_fmac_f32 v16, v40, v49
    v_fmac_f32 v17, v41, v49
    v_fmac_f32 v18, v42, v49
    v_fmac_f32 v19, v43, v49
    v_fmac_f32 v20, v44, v49
    v_fmac_f32 v21, v45, v49
    v_fmac_f32 v22, v46, v49
    v_fmac_f32 v23, v47, v49
    s_waitcnt vmcnt(7)
    v_lshlrev_b32 v40, 16, v88
    v_and_b32 v41, 0xffff0000, v88
    v_lshlrev_b32 v42, 16, v89
    v_and_b32 v43, 0xffff0000, v89
    v_lshlrev_b32 v44, 16, v90
    v_and_b32 v45, 0xffff0000, v90
    v_lshlrev_b32 v46, 16, v91
    v_and_b32 v47, 0xffff0000, v91
    buffer_load_dwordx4 v[88:91], v4, s[48:51], s100 offen offset:2048 nt
    s_waitcnt lgkmcnt(0)
    v_readfirstlane_b32 s84, v8
    s_mov_b64 exec, 1
    v_lshlrev_b32 v8, 2, v8
    ds_read_b32 v9, v8 offset:1024
    s_mov_b64 exec, -1
    v_fmac_f32 v16, v40, v50
    v_fmac_f32 v17, v41, v50
    v_fmac_f32 v18, v42, v50
    v_fmac_f32 v19, v43, v50
    v_fmac_f32 v20, v44, v50
    v_fmac_f32 v21, v45, v50
    v_fmac_f32 v22, v46, v50
    v_fmac_f32 v23, v47, v50
    s_waitcnt vmcnt(7)
    v_lshlrev_b32 v40, 16, v92
    v_and_b32 v41, 0xffff0000, v92
    v_lshlrev_b32 v42, 16, v93
    v_and_b32 v43, 0xffff0000, v93
    v_lshlrev_b32 v44, 16, v94
    v_and_b32 v45, 0xffff0000, v94
    v_lshlrev_b32 v46, 16, v95
    v_and_b32 v47, 0xffff0000, v95
    buffer_load_dwordx4 v[92:95], v4, s[48:51], s100 offen offset:3072 nt
    v_fmac_f32 v16, v40, v51
    v_fmac_f32 v17, v41, v51
    v_fmac_f32 v18, v42, v51
    v_fmac_f32 v19, v43, v51
    v_fmac_f32 v20, v44, v51
    v_fmac_f32 v21, v45, v51
    v_fmac_f32 v22, v46, v51
    v_fmac_f32 v23, v47, v51
    s_waitcnt lgkmcnt(0)
    v_readfirstlane_b32 s73, v9
    s_nop 0
    s_cmp_lg_u32 s73, -1
    s_cbranch_scc1 Lg_42
    s_mov_b32 s92, 0
Lgs_43:
    s_sleep 1
    s_mov_b64 exec, 1
    ds_read_b32 v9, v8 offset:1024
    s_mov_b64 exec, -1
    s_waitcnt lgkmcnt(0)
    v_readfirstlane_b32 s73, v9
    s_add_u32 s92, s92, 1
    s_cmp_lg_u32 s73, -1
    s_cbranch_scc1 Lg_42
    s_cmp_lt_u32 s92, 400000
    s_cbranch_scc1 Lgs_43
Lg_42:
    s_branch LBloop2_23
LBtail0_25:
    s_cmp_ge_u32 s71, s76
    s_cbranch_scc1 Lsw_44
Lswb_45:
    s_waitcnt vmcnt(7)
    v_dot2_f32_bf16 v28, v64, v24, 0
    v_dot2_f32_bf16 v28, v65, v25, v28
    v_dot2_f32_bf16 v28, v66, v26, v28
    v_dot2_f32_bf16 v28, v67, v27, v28
    s_waitcnt vmcnt(6)
    v_dot2_f32_bf16 v29, v68, v24, 0
    v_dot2_f32_bf16 v29, v69, v25, v29
    v_dot2_f32_bf16 v29, v70, v26, v29
    v_dot2_f32_bf16 v29, v71, v27, v29
    s_waitcnt vmcnt(5)
    v_dot2_f32_bf16 v30, v72, v24, 0
    v_dot2_f32_bf16 v30, v73, v25, v30
    v_dot2_f32_bf16 v30, v74, v26, v30
    v_dot2_f32_bf16 v30, v75, v27, v30
    s_waitcnt vmcnt(4)
    v_dot2_f32_bf16 v31, v76, v24, 0
    v_dot2_f32_bf16 v31, v77, v25, v31
    v_dot2_f32_bf16 v31, v78, v26, v31
    v_dot2_f32_bf16 v31, v79, v27, v31
    s_nop 2
    v_add_f32_dpp v28, v28, v28 row_ror:8 row_mask:0xf bank_mask:0xf
    v_add_f32_dpp v29, v29, v29 row_ror:8 row_mask:0xf bank_mask:0xf
    v_add_f32_dpp v30, v30, v30 row_ror:8 row_mask:0xf bank_mask:0xf
    v_add_f32_dpp v31, v31, v31 row_ror:8 row_mask:0xf bank_mask:0xf
    v_add_f32_dpp v28, v28, v28 row_ror:4 row_mask:0xf bank_mask:0xf
    v_add_f32_dpp v29, v29, v29 row_ror:4 row_mask:0xf bank_mask:0xf
    v_add_f32_dpp v30, v30, v30 row_ror:4 row_mask:0xf bank_mask:0xf
    v_add_f32_dpp v31, v31, v31 row_ror:4 row_mask:0xf bank_mask:0xf
    v_add_f32_dpp v28, v28, v28 row_ror:2 row_mask:0xf bank_mask:0xf
    v_add_f32_dpp v29, v29, v29 row_ror:2 row_mask:0xf bank_mask:0xf
    v_add_f32_dpp v30, v30, v30 row_ror:2 row_mask:0xf bank_mask:0xf
    v_add_f32_dpp v31, v31, v31 row_ror:2 row_mask:0xf bank_mask:0xf
    v_add_f32_dpp v28, v28, v28 row_ror:1 row_mask:0xf bank_mask:0xf
    v_add_f32_dpp v29, v29, v29 row_ror:1 row_mask:0xf bank_mask:0xf
    v_add_f32_dpp v30, v30, v30 row_ror:1 row_mask:0xf bank_mask:0xf
    v_add_f32_dpp v31, v31, v31 row_ror:1 row_mask:0xf bank_mask:0xf
    v_max3_f32 v38, v36, v28, v29
    v_max3_f32 v38, v38, v30, v31
    v_sub_f32 v39, v36, v38
    v_mul_f32 v39, s70, v39
    v_exp_f32 v39, v39
    v_mul_f32 v56, s70, v38
    v_mov_b32 v36, v38
    v_fma_f32 v48, v28, s70, -v56
    v_fma_f32 v49, v29, s70, -v56
    v_fma_f32 v50, v30, s70, -v56
    v_fma_f32 v51, v31, s70, -v56
    v_exp_f32 v48, v48
    v_exp_f32 v49, v49
    v_exp_f32 v50, v50
    v_exp_f32 v51, v51
    v_mul_f32 v37, v37, v39
    v_mul_f32 v16, v16, v39
    v_mul_f32 v17, v17, v39
    v_mul_f32 v18, v18, v39
    v_mul_f32 v19, v19, v39
    v_mul_f32 v20, v20, v39
    v_mul_f32 v21, v21, v39
    v_mul_f32 v22, v22, v39
    v_mul_f32 v23, v23, v39
    v_add_f32 v37, v37, v48
    v_add_f32 v37, v37, v49
    v_add_f32 v37, v37, v50
    v_add_f32 v37, v37, v51
    s_waitcnt vmcnt(3)
    v_lshlrev_b32 v40, 16, v80
    v_and_b32 v41, 0xffff0000, v80
    v_lshlrev_b32 v42, 16, v81
    v_and_b32 v43, 0xffff0000, v81
    v_lshlrev_b32 v44, 16, v82
    v_and_b32 v45, 0xffff0000, v82
    v_lshlrev_b32 v46, 16, v83
    v_and_b32 v47, 0xffff0000, v83
    v_fmac_f32 v16, v40, v48
    v_fmac_f32 v17, v41, v48
    v_fmac_f32 v18, v42, v48
    v_fmac_f32 v19, v43, v48
    v_fmac_f32 v20, v44, v48
    v_fmac_f32 v21, v45, v48
    v_fmac_f32 v22, v46, v48
    v_fmac_f32 v23, v47, v48
    s_waitcnt vmcnt(2)
    v_lshlrev_b32 v40, 16, v84
    v_and_b32 v41, 0xffff0000, v84
    v_lshlrev_b32 v42, 16, v85
    v_and_b32 v43, 0xffff0000, v85
    v_lshlrev_b32 v44, 16, v86
    v_and_b32 v45, 0xffff0000, v86
    v_lshlrev_b32 v46, 16, v87
    v_and_b32 v47, 0xffff0000, v87
    v_fmac_f32 v16, v40, v49
    v_fmac_f32 v17, v41, v49
    v_fmac_f32 v18, v42, v49
    v_fmac_f32 v19, v43, v49
    v_fmac_f32 v20, v44, v49
    v_fmac_f32 v21, v45, v49
    v_fmac_f32 v22, v46, v49
    v_fmac_f32 v23, v47, v49
    s_waitcnt vmcnt(1)
    v_lshlrev_b32 v40, 16, v88
    v_and_b32 v41, 0xffff0000, v88
    v_lshlrev_b32 v42, 16, v89
    v_and_b32 v43, 0xffff0000, v89
    v_lshlrev_b32 v44, 16, v90
    v_and_b32 v45, 0xffff0000, v90
    v_lshlrev_b32 v46, 16, v91
    v_and_b32 v47, 0xffff0000, v91
    v_fmac_f32 v16, v40, v50
    v_fmac_f32 v17, v41, v50
    v_fmac_f32 v18, v42, v50
    v_fmac_f32 v19, v43, v50
    v_fmac_f32 v20, v44, v50
    v_fmac_f32 v21, v45, v50
    v_fmac_f32 v22, v46, v50
    v_fmac_f32 v23, v47, v50
    s_waitcnt vmcnt(0)
    v_lshlrev_b32 v40, 16, v92
    v_and_b32 v41, 0xffff0000, v92
    v_lshlrev_b32 v42, 16, v93
    v_and_b32 v43, 0xffff0000, v93
    v_lshlrev_b32 v44, 16, v94
    v_and_b32 v45, 0xffff0000, v94
    v_lshlrev_b32 v46, 16, v95
    v_and_b32 v47, 0xffff0000, v95
    v_fmac_f32 v16, v40, v51
    v_fmac_f32 v17, v41, v51
    v_fmac_f32 v18, v42, v51
    v_fmac_f32 v19, v43, v51
    v_fmac_f32 v20, v44, v51
    v_fmac_f32 v21, v45, v51
    v_fmac_f32 v22, v46, v51
    v_fmac_f32 v23, v47, v51
    s_branch LBfin_27
LBf0_28:
    s_waitcnt vmcnt(0)
    v_dot2_f32_bf16 v28, v64, v24, 0
    v_dot2_f32_bf16 v28, v65, v25, v28
    v_dot2_f32_bf16 v28, v66, v26, v28
    v_dot2_f32_bf16 v28, v67, v27, v28
    v_dot2_f32_bf16 v29, v68, v24, 0
    v_dot2_f32_bf16 v29, v69, v25, v29
    v_dot2_f32_bf16 v29, v70, v26, v29
    v_dot2_f32_bf16 v29, v71, v27, v29
    v_dot2_f32_bf16 v30, v72, v24, 0
    v_dot2_f32_bf16 v30, v73, v25, v30
    v_dot2_f32_bf16 v30, v74, v26, v30
    v_dot2_f32_bf16 v30, v75, v27, v30
    v_dot2_f32_bf16 v31, v76, v24, 0
    v_dot2_f32_bf16 v31, v77, v25, v31
    v_dot2_f32_bf16 v31, v78, v26, v31
    v_dot2_f32_bf16 v31, v79, v27, v31
    s_nop 2
    v_add_f32_dpp v28, v28, v28 row_ror:8 row_mask:0xf bank_mask:0xf
    v_add_f32_dpp v29, v29, v29 row_ror:8 row_mask:0xf bank_mask:0xf
    v_add_f32_dpp v30, v30, v30 row_ror:8 row_mask:0xf bank_mask:0xf
    v_add_f32_dpp v31, v31, v31 row_ror:8 row_mask:0xf bank_mask:0xf
    v_add_f32_dpp v28, v28, v28 row_ror:4 row_mask:0xf bank_mask:0xf
    v_add_f32_dpp v29, v29, v29 row_ror:4 row_mask:0xf bank_mask:0xf
    v_add_f32_dpp v30, v30, v30 row_ror:4 row_mask:0xf bank_mask:0xf
    v_add_f32_dpp v31, v31, v31 row_ror:4 row_mask:0xf bank_mask:0xf
    v_add_f32_dpp v28, v28, v28 row_ror:2 row_mask:0xf bank_mask:0xf
    v_add_f32_dpp v29, v29, v29 row_ror:2 row_mask:0xf bank_mask:0xf
    v_add_f32_dpp v30, v30, v30 row_ror:2 row_mask:0xf bank_mask:0xf
    v_add_f32_dpp v31, v31, v31 row_ror:2 row_mask:0xf bank_mask:0xf
    v_add_f32_dpp v28, v28, v28 row_ror:1 row_mask:0xf bank_mask:0xf
    v_add_f32_dpp v29, v29, v29 row_ror:1 row_mask:0xf bank_mask:0xf
    v_add_f32_dpp v30, v30, v30 row_ror:1 row_mask:0xf bank_mask:0xf
    v_add_f32_dpp v31, v31, v31 row_ror:1 row_mask:0xf bank_mask:0xf
    v_max3_f32 v38, v36, v28, v29
    v_max3_f32 v38, v38, v30, v31
    v_sub_f32 v39, v36, v38
    v_mul_f32 v39, s70, v39
    v_exp_f32 v39, v39
    v_mul_f32 v56, s70, v38
    v_mov_b32 v36, v38
    v_fma_f32 v48, v28, s70, -v56
    v_fma_f32 v49, v29, s70, -v56
    v_fma_f32 v50, v30, s70, -v56
    v_fma_f32 v51, v31, s70, -v56
    v_exp_f32 v48, v48
    v_exp_f32 v49, v49
    v_exp_f32 v50, v50
    v_exp_f32 v51, v51
    v_mul_f32 v37, v37, v39
    v_mul_f32 v16, v16, v39
    v_mul_f32 v17, v17, v39
    v_mul_f32 v18, v18, v39
    v_mul_f32 v19, v19, v39
    v_mul_f32 v20, v20, v39
    v_mul_f32 v21, v21, v39
    v_mul_f32 v22, v22, v39
    v_mul_f32 v23, v23, v39
    v_add_f32 v37, v37, v48
    v_add_f32 v37, v37, v49
    v_add_f32 v37, v37, v50
    v_add_f32 v37, v37, v51
    v_lshlrev_b32 v40, 16, v80
    v_and_b32 v41, 0xffff0000, v80
    v_lshlrev_b32 v42, 16, v81
    v_and_b32 v43, 0xffff0000, v81
    v_lshlrev_b32 v44, 16, v82
    v_and_b32 v45, 0xffff0000, v82
    v_lshlrev_b32 v46, 16, v83
    v_and_b32 v47, 0xffff0000, v83
    v_fmac_f32 v16, v40, v48
    v_fmac_f32 v17, v41, v48
    v_fmac_f32 v18, v42, v48
    v_fmac_f32 v19, v43, v48
    v_fmac_f32 v20, v44, v48
    v_fmac_f32 v21, v45, v48
    v_fmac_f32 v22, v46, v48
    v_fmac_f32 v23, v47, v48
    v_lshlrev_b32 v40, 16, v84
    v_and_b32 v41, 0xffff0000, v84
    v_lshlrev_b32 v42, 16, v85
    v_and_b32 v43, 0xffff0000, v85
    v_lshlrev_b32 v44, 16, v86
    v_and_b32 v45, 0xffff0000, v86
    v_lshlrev_b32 v46, 16, v87
    v_and_b32 v47, 0xffff0000, v87
    v_fmac_f32 v16, v40, v49
    v_fmac_f32 v17, v41, v49
    v_fmac_f32 v18, v42, v49
    v_fmac_f32 v19, v43, v49
    v_fmac_f32 v20, v44, v49
    v_fmac_f32 v21, v45, v49
    v_fmac_f32 v22, v46, v49
    v_fmac_f32 v23, v47, v49
    v_lshlrev_b32 v40, 16, v88
    v_and_b32 v41, 0xffff0000, v88
    v_lshlrev_b32 v42, 16, v89
    v_and_b32 v43, 0xffff0000, v89
    v_lshlrev_b32 v44, 16, v90
    v_and_b32 v45, 0xffff0000, v90
    v_lshlrev_b32 v46, 16, v91
    v_and_b32 v47, 0xffff0000, v91
    v_fmac_f32 v16, v40, v50
    v_fmac_f32 v17, v41, v50
    v_fmac_f32 v18, v42, v50
    v_fmac_f32 v19, v43, v50
    v_fmac_f32 v20, v44, v50
    v_fmac_f32 v21, v45, v50
    v_fmac_f32 v22, v46, v50
    v_fmac_f32 v23, v47, v50
    v_lshlrev_b32 v40, 16, v92
    v_and_b32 v41, 0xffff0000, v92
    v_lshlrev_b32 v42, 16, v93
    v_and_b32 v43, 0xffff0000, v93
    v_lshlrev_b32 v44, 16, v94
    v_and_b32 v45, 0xffff0000, v94
    v_lshlrev_b32 v46, 16, v95
    v_and_b32 v47, 0xffff0000, v95
    v_fmac_f32 v16, v40, v51
    v_fmac_f32 v17, v41, v51
    v_fmac_f32 v18, v42, v51
    v_fmac_f32 v19, v43, v51
    v_fmac_f32 v20, v44, v51
    v_fmac_f32 v21, v45, v51
    v_fmac_f32 v22, v46, v51
    v_fmac_f32 v23, v47, v51
    v_dot2_f32_bf16 v28, v96, v24, 0
    v_dot2_f32_bf16 v28, v97, v25, v28
    v_dot2_f32_bf16 v28, v98, v26, v28
    v_dot2_f32_bf16 v28, v99, v27, v28
    v_dot2_f32_bf16 v29, v100, v24, 0
    v_dot2_f32_bf16 v29, v101, v25, v29
    v_dot2_f32_bf16 v29, v102, v26, v29
    v_dot2_f32_bf16 v29, v103, v27, v29
    v_dot2_f32_bf16 v30, v104, v24, 0
    v_dot2_f32_bf16 v30, v105, v25, v30
    v_dot2_f32_bf16 v30, v106, v26, v30
    v_dot2_f32_bf16 v30, v107, v27, v30
    v_dot2_f32_bf16 v31, v108, v24, 0
    v_dot2_f32_bf16 v31, v109, v25, v31
    v_dot2_f32_bf16 v31, v110, v26, v31
    v_dot2_f32_bf16 v31, v111, v27, v31
    s_nop 2
    v_add_f32_dpp v28, v28, v28 row_ror:8 row_mask:0xf bank_mask:0xf
    v_add_f32_dpp v29, v29, v29 row_ror:8 row_mask:0xf bank_mask:0xf
    v_add_f32_dpp v30, v30, v30 row_ror:8 row_mask:0xf bank_mask:0xf
    v_add_f32_dpp v31, v31, v31 row_ror:8 row_mask:0xf bank_mask:0xf
    v_add_f32_dpp v28, v28, v28 row_ror:4 row_mask:0xf bank_mask:0xf
    v_add_f32_dpp v29, v29, v29 row_ror:4 row_mask:0xf bank_mask:0xf
    v_add_f32_dpp v30, v30, v30 row_ror:4 row_mask:0xf bank_mask:0xf
    v_add_f32_dpp v31, v31, v31 row_ror:4 row_mask:0xf bank_mask:0xf
    v_add_f32_dpp v28, v28, v28 row_ror:2 row_mask:0xf bank_mask:0xf
    v_add_f32_dpp v29, v29, v29 row_ror:2 row_mask:0xf bank_mask:0xf
    v_add_f32_dpp v30, v30, v30 row_ror:2 row_mask:0xf bank_mask:0xf
    v_add_f32_dpp v31, v31, v31 row_ror:2 row_mask:0xf bank_mask:0xf
    v_add_f32_dpp v28, v28, v28 row_ror:1 row_mask:0xf bank_mask:0xf
    v_add_f32_dpp v29, v29, v29 row_ror:1 row_mask:0xf bank_mask:0xf
    v_add_f32_dpp v30, v30, v30 row_ror:1 row_mask:0xf bank_mask:0xf
    v_add_f32_dpp v31, v31, v31 row_ror:1 row_mask:0xf bank_mask:0xf
    v_max3_f32 v38, v36, v28, v29
    v_max3_f32 v38, v38, v30, v31
    v_sub_f32 v39, v36, v38
    v_mul_f32 v39, s70, v39
    v_exp_f32 v39, v39
    v_mul_f32 v56, s70, v38
    v_mov_b32 v36, v38
    v_fma_f32 v48, v28, s70, -v56
    v_fma_f32 v49, v29, s70, -v56
    v_fma_f32 v50, v30, s70, -v56
    v_fma_f32 v51, v31, s70, -v56
    v_exp_f32 v48, v48
    v_exp_f32 v49, v49
    v_exp_f32 v50, v50
    v_exp_f32 v51, v51
    v_mul_f32 v37, v37, v39
    v_mul_f32 v16, v16, v39
    v_mul_f32 v17, v17, v39
    v_mul_f32 v18, v18, v39
    v_mul_f32 v19, v19, v39
    v_mul_f32 v20, v20, v39
    v_mul_f32 v21, v21, v39
    v_mul_f32 v22, v22, v39
    v_mul_f32 v23, v23, v39
    v_add_f32 v37, v37, v48
    v_add_f32 v37, v37, v49
    v_add_f32 v37, v37, v50
    v_add_f32 v37, v37, v51
    v_lshlrev_b32 v40, 16, v112
    v_and_b32 v41, 0xffff0000, v112
    v_lshlrev_b32 v42, 16, v113
    v_and_b32 v43, 0xffff0000, v113
    v_lshlrev_b32 v44, 16, v114
    v_and_b32 v45, 0xffff0000, v114
    v_lshlrev_b32 v46, 16, v115
    v_and_b32 v47, 0xffff0000, v115
    v_fmac_f32 v16, v40, v48
    v_fmac_f32 v17, v41, v48
    v_fmac_f32 v18, v42, v48
    v_fmac_f32 v19, v43, v48
    v_fmac_f32 v20, v44, v48
    v_fmac_f32 v21, v45, v48
    v_fmac_f32 v22, v46, v48
    v_fmac_f32 v23, v47, v48
    v_lshlrev_b32 v40, 16, v116
    v_and_b32 v41, 0xffff0000, v116
    v_lshlrev_b32 v42, 16, v117
    v_and_b32 v43, 0xffff0000, v117
    v_lshlrev_b32 v44, 16, v118
    v_and_b32 v45, 0xffff0000, v118
    v_lshlrev_b32 v46, 16, v119
    v_and_b32 v47, 0xffff0000, v119
    v_fmac_f32 v16, v40, v49
    v_fmac_f32 v17, v41, v49
    v_fmac_f32 v18, v42, v49
    v_fmac_f32 v19, v43, v49
    v_fmac_f32 v20, v44, v49
    v_fmac_f32 v21, v45, v49
    v_fmac_f32 v22, v46, v49
    v_fmac_f32 v23, v47, v49
    v_lshlrev_b32 v40, 16, v120
    v_and_b32 v41, 0xffff0000, v120
    v_lshlrev_b32 v42, 16, v121
    v_and_b32 v43, 0xffff0000, v121
    v_lshlrev_b32 v44, 16, v122
    v_and_b32 v45, 0xffff0000, v122
    v_lshlrev_b32 v46, 16, v123
    v_and_b32 v47, 0xffff0000, v123
    v_fmac_f32 v16, v40, v50
    v_fmac_f32 v17, v41, v50
    v_fmac_f32 v18, v42, v50
    v_fmac_f32 v19, v43, v50
    v_fmac_f32 v20, v44, v50
    v_fmac_f32 v21, v45, v50
    v_fmac_f32 v22, v46, v50
    v_fmac_f32 v23, v47, v50
    v_lshlrev_b32 v40, 16, v124
    v_and_b32 v41, 0xffff0000, v124
    v_lshlrev_b32 v42, 16, v125
    v_and_b32 v43, 0xffff0000, v125
    v_lshlrev_b32 v44, 16, v126
    v_and_b32 v45, 0xffff0000, v126
    v_lshlrev_b32 v46, 16, v127
    v_and_b32 v47, 0xffff0000, v127
    v_fmac_f32 v16, v40, v51
    v_fmac_f32 v17, v41, v51
    v_fmac_f32 v18, v42, v51
    v_fmac_f32 v19, v43, v51
    v_fmac_f32 v20, v44, v51
    v_fmac_f32 v21, v45, v51
    v_fmac_f32 v22, v46, v51
    v_fmac_f32 v23, v47, v51
    v_dot2_f32_bf16 v28, v128, v24, 0
    v_dot2_f32_bf16 v28, v129, v25, v28
    v_dot2_f32_bf16 v28, v130, v26, v28
    v_dot2_f32_bf16 v28, v131, v27, v28
    v_dot2_f32_bf16 v29, v132, v24, 0
    v_dot2_f32_bf16 v29, v133, v25, v29
    v_dot2_f32_bf16 v29, v134, v26, v29
    v_dot2_f32_bf16 v29, v135, v27, v29
    v_dot2_f32_bf16 v30, v136, v24, 0
    v_dot2_f32_bf16 v30, v137, v25, v30
    v_dot2_f32_bf16 v30, v138, v26, v30
    v_dot2_f32_bf16 v30, v139, v27, v30
    v_dot2_f32_bf16 v31, v140, v24, 0
    v_dot2_f32_bf16 v31, v141, v25, v31
    v_dot2_f32_bf16 v31, v142, v26, v31
    v_dot2_f32_bf16 v31, v143, v27, v31
    s_nop 2
    v_add_f32_dpp v28, v28, v28 row_ror:8 row_mask:0xf bank_mask:0xf
    v_add_f32_dpp v29, v29, v29 row_ror:8 row_mask:0xf bank_mask:0xf
    v_add_f32_dpp v30, v30, v30 row_ror:8 row_mask:0xf bank_mask:0xf
    v_add_f32_dpp v31, v31, v31 row_ror:8 row_mask:0xf bank_mask:0xf
    v_add_f32_dpp v28, v28, v28 row_ror:4 row_mask:0xf bank_mask:0xf
    v_add_f32_dpp v29, v29, v29 row_ror:4 row_mask:0xf bank_mask:0xf
    v_add_f32_dpp v30, v30, v30 row_ror:4 row_mask:0xf bank_mask:0xf
    v_add_f32_dpp v31, v31, v31 row_ror:4 row_mask:0xf bank_mask:0xf
    v_add_f32_dpp v28, v28, v28 row_ror:2 row_mask:0xf bank_mask:0xf
    v_add_f32_dpp v29, v29, v29 row_ror:2 row_mask:0xf bank_mask:0xf
    v_add_f32_dpp v30, v30, v30 row_ror:2 row_mask:0xf bank_mask:0xf
    v_add_f32_dpp v31, v31, v31 row_ror:2 row_mask:0xf bank_mask:0xf
    v_add_f32_dpp v28, v28, v28 row_ror:1 row_mask:0xf bank_mask:0xf
    v_add_f32_dpp v29, v29, v29 row_ror:1 row_mask:0xf bank_mask:0xf
    v_add_f32_dpp v30, v30, v30 row_ror:1 row_mask:0xf bank_mask:0xf
    v_add_f32_dpp v31, v31, v31 row_ror:1 row_mask:0xf bank_mask:0xf
    v_max3_f32 v38, v36, v28, v29
    v_max3_f32 v38, v38, v30, v31
    v_sub_f32 v39, v36, v38
    v_mul_f32 v39, s70, v39
    v_exp_f32 v39, v39
    v_mul_f32 v56, s70, v38
    v_mov_b32 v36, v38
    v_fma_f32 v48, v28, s70, -v56
    v_fma_f32 v49, v29, s70, -v56
    v_fma_f32 v50, v30, s70, -v56
    v_fma_f32 v51, v31, s70, -v56
    v_exp_f32 v48, v48
    v_exp_f32 v49, v49
    v_exp_f32 v50, v50
    v_exp_f32 v51, v51
    v_mul_f32 v37, v37, v39
    v_mul_f32 v16, v16, v39
    v_mul_f32 v17, v17, v39
    v_mul_f32 v18, v18, v39
    v_mul_f32 v19, v19, v39
    v_mul_f32 v20, v20, v39
    v_mul_f32 v21, v21, v39
    v_mul_f32 v22, v22, v39
    v_mul_f32 v23, v23, v39
    v_add_f32 v37, v37, v48
    v_add_f32 v37, v37, v49
    v_add_f32 v37, v37, v50
    v_add_f32 v37, v37, v51
    v_lshlrev_b32 v40, 16, v144
    v_and_b32 v41, 0xffff0000, v144
    v_lshlrev_b32 v42, 16, v145
    v_and_b32 v43, 0xffff0000, v145
    v_lshlrev_b32 v44, 16, v146
    v_and_b32 v45, 0xffff0000, v146
    v_lshlrev_b32 v46, 16, v147
    v_and_b32 v47, 0xffff0000, v147
    v_fmac_f32 v16, v40, v48
    v_fmac_f32 v17, v41, v48
    v_fmac_f32 v18, v42, v48
    v_fmac_f32 v19, v43, v48
    v_fmac_f32 v20, v44, v48
    v_fmac_f32 v21, v45, v48
    v_fmac_f32 v22, v46, v48
    v_fmac_f32 v23, v47, v48
    v_lshlrev_b32 v40, 16, v148
    v_and_b32 v41, 0xffff0000, v148
    v_lshlrev_b32 v42, 16, v149
    v_and_b32 v43, 0xffff0000, v149
    v_lshlrev_b32 v44, 16, v150
    v_and_b32 v45, 0xffff0000, v150
    v_lshlrev_b32 v46, 16, v151
    v_and_b32 v47, 0xffff0000, v151
    v_fmac_f32 v16, v40, v49
    v_fmac_f32 v17, v41, v49
    v_fmac_f32 v18, v42, v49
    v_fmac_f32 v19, v43, v49
    v_fmac_f32 v20, v44, v49
    v_fmac_f32 v21, v45, v49
    v_fmac_f32 v22, v46, v49
    v_fmac_f32 v23, v47, v49
    v_lshlrev_b32 v40, 16, v152
    v_and_b32 v41, 0xffff0000, v152
    v_lshlrev_b32 v42, 16, v153
    v_and_b32 v43, 0xffff0000, v153
    v_lshlrev_b32 v44, 16, v154
    v_and_b32 v45, 0xffff0000, v154
    v_lshlrev_b32 v46, 16, v155
    v_and_b32 v47, 0xffff0000, v155
    v_fmac_f32 v16, v40, v50
    v_fmac_f32 v17, v41, v50
    v_fmac_f32 v18, v42, v50
    v_fmac_f32 v19, v43, v50
    v_fmac_f32 v20, v44, v50
    v_fmac_f32 v21, v45, v50
    v_fmac_f32 v22, v46, v50
    v_fmac_f32 v23, v47, v50
    v_lshlrev_b32 v40, 16, v156
    v_and_b32 v41, 0xffff0000, v156
    v_lshlrev_b32 v42, 16, v157
    v_and_b32 v43, 0xffff0000, v157
    v_lshlrev_b32 v44, 16, v158
    v_and_b32 v45, 0xffff0000, v158
    v_lshlrev_b32 v46, 16, v159
    v_and_b32 v47, 0xffff0000, v159
    v_fmac_f32 v16, v40, v51
    v_fmac_f32 v17, v41, v51
    v_fmac_f32 v18, v42, v51
    v_fmac_f32 v19, v43, v51
    v_fmac_f32 v20, v44, v51
    v_fmac_f32 v21, v45, v51
    v_fmac_f32 v22, v46, v51
    v_fmac_f32 v23, v47, v51
    v_dot2_f32_bf16 v28, v160, v24, 0
    v_dot2_f32_bf16 v28, v161, v25, v28
    v_dot2_f32_bf16 v28, v162, v26, v28
    v_dot2_f32_bf16 v28, v163, v27, v28
    v_dot2_f32_bf16 v29, v164, v24, 0
    v_dot2_f32_bf16 v29, v165, v25, v29
    v_dot2_f32_bf16 v29, v166, v26, v29
    v_dot2_f32_bf16 v29, v167, v27, v29
    v_dot2_f32_bf16 v30, v168, v24, 0
    v_dot2_f32_bf16 v30, v169, v25, v30
    v_dot2_f32_bf16 v30, v170, v26, v30
    v_dot2_f32_bf16 v30, v171, v27, v30
    v_dot2_f32_bf16 v31, v172, v24, 0
    v_dot2_f32_bf16 v31, v173, v25, v31
    v_dot2_f32_bf16 v31, v174, v26, v31
    v_dot2_f32_bf16 v31, v175, v27, v31
    s_nop 2
    v_add_f32_dpp v28, v28, v28 row_ror:8 row_mask:0xf bank_mask:0xf
    v_add_f32_dpp v29, v29, v29 row_ror:8 row_mask:0xf bank_mask:0xf
    v_add_f32_dpp v30, v30, v30 row_ror:8 row_mask:0xf bank_mask:0xf
    v_add_f32_dpp v31, v31, v31 row_ror:8 row_mask:0xf bank_mask:0xf
    v_add_f32_dpp v28, v28, v28 row_ror:4 row_mask:0xf bank_mask:0xf
    v_add_f32_dpp v29, v29, v29 row_ror:4 row_mask:0xf bank_mask:0xf
    v_add_f32_dpp v30, v30, v30 row_ror:4 row_mask:0xf bank_mask:0xf
    v_add_f32_dpp v31, v31, v31 row_ror:4 row_mask:0xf bank_mask:0xf
    v_add_f32_dpp v28, v28, v28 row_ror:2 row_mask:0xf bank_mask:0xf
    v_add_f32_dpp v29, v29, v29 row_ror:2 row_mask:0xf bank_mask:0xf
    v_add_f32_dpp v30, v30, v30 row_ror:2 row_mask:0xf bank_mask:0xf
    v_add_f32_dpp v31, v31, v31 row_ror:2 row_mask:0xf bank_mask:0xf
    v_add_f32_dpp v28, v28, v28 row_ror:1 row_mask:0xf bank_mask:0xf
    v_add_f32_dpp v29, v29, v29 row_ror:1 row_mask:0xf bank_mask:0xf
    v_add_f32_dpp v30, v30, v30 row_ror:1 row_mask:0xf bank_mask:0xf
    v_add_f32_dpp v31, v31, v31 row_ror:1 row_mask:0xf bank_mask:0xf
    v_max3_f32 v38, v36, v28, v29
    v_max3_f32 v38, v38, v30, v31
    v_sub_f32 v39, v36, v38
    v_mul_f32 v39, s70, v39
    v_exp_f32 v39, v39
    v_mul_f32 v56, s70, v38
    v_mov_b32 v36, v38
    v_fma_f32 v48, v28, s70, -v56
    v_fma_f32 v49, v29, s70, -v56
    v_fma_f32 v50, v30, s70, -v56
    v_fma_f32 v51, v31, s70, -v56
    v_exp_f32 v48, v48
    v_exp_f32 v49, v49
    v_exp_f32 v50, v50
    v_exp_f32 v51, v51
    v_mul_f32 v37, v37, v39
    v_mul_f32 v16, v16, v39
    v_mul_f32 v17, v17, v39
    v_mul_f32 v18, v18, v39
    v_mul_f32 v19, v19, v39
    v_mul_f32 v20, v20, v39
    v_mul_f32 v21, v21, v39
    v_mul_f32 v22, v22, v39
    v_mul_f32 v23, v23, v39
    v_add_f32 v37, v37, v48
    v_add_f32 v37, v37, v49
    v_add_f32 v37, v37, v50
    v_add_f32 v37, v37, v51
    v_lshlrev_b32 v40, 16, v176
    v_and_b32 v41, 0xffff0000, v176
    v_lshlrev_b32 v42, 16, v177
    v_and_b32 v43, 0xffff0000, v177
    v_lshlrev_b32 v44, 16, v178
    v_and_b32 v45, 0xffff0000, v178
    v_lshlrev_b32 v46, 16, v179
    v_and_b32 v47, 0xffff0000, v179
    v_fmac_f32 v16, v40, v48
    v_fmac_f32 v17, v41, v48
    v_fmac_f32 v18, v42, v48
    v_fmac_f32 v19, v43, v48
    v_fmac_f32 v20, v44, v48
    v_fmac_f32 v21, v45, v48
    v_fmac_f32 v22, v46, v48
    v_fmac_f32 v23, v47, v48
    v_lshlrev_b32 v40, 16, v180
    v_and_b32 v41, 0xffff0000, v180
    v_lshlrev_b32 v42, 16, v181
    v_and_b32 v43, 0xffff0000, v181
    v_lshlrev_b32 v44, 16, v182
    v_and_b32 v45, 0xffff0000, v182
    v_lshlrev_b32 v46, 16, v183
    v_and_b32 v47, 0xffff0000, v183
    v_fmac_f32 v16, v40, v49
    v_fmac_f32 v17, v41, v49
    v_fmac_f32 v18, v42, v49
    v_fmac_f32 v19, v43, v49
    v_fmac_f32 v20, v44, v49
    v_fmac_f32 v21, v45, v49
    v_fmac_f32 v22, v46, v49
    v_fmac_f32 v23, v47, v49
    v_lshlrev_b32 v40, 16, v184
    v_and_b32 v41, 0xffff0000, v184
    v_lshlrev_b32 v42, 16, v185
    v_and_b32 v43, 0xffff0000, v185
    v_lshlrev_b32 v44, 16, v186
    v_and_b32 v45, 0xffff0000, v186
    v_lshlrev_b32 v46, 16, v187
    v_and_b32 v47, 0xffff0000, v187
    v_fmac_f32 v16, v40, v50
    v_fmac_f32 v17, v41, v50
    v_fmac_f32 v18, v42, v50
    v_fmac_f32 v19, v43, v50
    v_fmac_f32 v20, v44, v50
    v_fmac_f32 v21, v45, v50
    v_fmac_f32 v22, v46, v50
    v_fmac_f32 v23, v47, v50
    v_lshlrev_b32 v40, 16, v188
    v_and_b32 v41, 0xffff0000, v188
    v_lshlrev_b32 v42, 16, v189
    v_and_b32 v43, 0xffff0000, v189
    v_lshlrev_b32 v44, 16, v190
    v_and_b32 v45, 0xffff0000, v190
    v_lshlrev_b32 v46, 16, v191
    v_and_b32 v47, 0xffff0000, v191
    v_fmac_f32 v16, v40, v51
    v_fmac_f32 v17, v41, v51
    v_fmac_f32 v18, v42, v51
    v_fmac_f32 v19, v43, v51
    v_fmac_f32 v20, v44, v51
    v_fmac_f32 v21, v45, v51
    v_fmac_f32 v22, v46, v51
    v_fmac_f32 v23, v47, v51
    s_branch LBfin_27
L_join_go:
    s_mov_b64 exec, 1
    v_mov_b32 v8, 1
    ds_add_rtn_u32 v8, v10, v8
    s_mov_b64 exec, -1
    v_lshlrev_b32 v40, 4, v3
    ds_read_b128 v[24:27], v40 offset:0
    v_mov_b32 v36, 0xff7fffff
    v_mov_b32 v37, 0
    v_mov_b32 v16, 0
    v_mov_b32 v17, 0
    v_mov_b32 v18, 0
    v_mov_b32 v19, 0
    v_mov_b32 v20, 0
    v_mov_b32 v21, 0
    v_mov_b32 v22, 0
    v_mov_b32 v23, 0
    v_lshlrev_b32 v6, 5, v3
    v_lshl_add_u32 v6, v2, 3, v6
    s_lshl_b32 s61, s56, 9
    v_add_u32 v7, s61, v6
    s_lshl_b32 s77, s56, 3
    s_mov_b32 s76, 33554432
    s_waitcnt lgkmcnt(0)
    v_readfirstlane_b32 s84, v8
    s_mov_b64 exec, 1
    v_lshlrev_b32 v8, 2, v8
    ds_read_b32 v9, v8 offset:1024
    s_mov_b64 exec, -1
    s_waitcnt lgkmcnt(0)
    v_readfirstlane_b32 s73, v9
    s_nop 0
    s_cmp_lg_u32 s73, -1
    s_cbranch_scc1 Lg_47
    s_mov_b32 s92, 0
Lgs_48:
    s_sleep 1
    s_mov_b64 exec, 1
    ds_read_b32 v9, v8 offset:1024
    s_mov_b64 exec, -1
    s_waitcnt lgkmcnt(0)
    v_readfirstlane_b32 s73, v9
    s_add_u32 s92, s92, 1
    s_cmp_lg_u32 s73, -1
    s_cbranch_scc1 Lg_47
    s_cmp_lt_u32 s92, 400000
    s_cbranch_scc1 Lgs_48
Lg_47:
    s_cmp_ge_u32 s73, 67108864
    s_cbranch_scc1 LBfin_27
    s_mov_b32 s71, s73
    s_mov_b64 exec, 1
    v_mov_b32 v8, 1
    ds_add_rtn_u32 v8, v10, v8
    s_mov_b64 exec, -1
    buffer_load_dwordx4 v[64:67], v4, s[44:47], s71 offen offset:0 nt
    buffer_load_dwordx4 v[68:71], v4, s[44:47], s71 offen offset:1024 nt
    buffer_load_dwordx4 v[72:75], v4, s[44:47], s71 offen offset:2048 nt
    buffer_load_dwordx4 v[76:79], v4, s[44:47], s71 offen offset:3072 nt
    buffer_load_dwordx4 v[80:83], v4, s[48:51], s71 offen offset:0 nt
    buffer_load_dwordx4 v[84:87], v4, s[48:51], s71 offen offset:1024 nt
    buffer_load_dwordx4 v[88:91], v4, s[48:51], s71 offen offset:2048 nt
    buffer_load_dwordx4 v[92:95], v4, s[48:51], s71 offen offset:3072 nt
    s_waitcnt lgkmcnt(0)
    v_readfirstlane_b32 s84, v8
    s_mov_b64 exec, 1
    v_lshlrev_b32 v8, 2, v8
    ds_read_b32 v9, v8 offset:1024
    s_mov_b64 exec, -1
    s_waitcnt lgkmcnt(0)
    v_readfirstlane_b32 s73, v9
    s_nop 0
    s_cmp_lg_u32 s73, -1
    s_cbranch_scc1 Lg_49
    s_mov_b32 s92, 0
Lgs_50:
    s_sleep 1
    s_mov_b64 exec, 1
    ds_read_b32 v9, v8 offset:1024
    s_mov_b64 exec, -1
    s_waitcnt lgkmcnt(0)
    v_readfirstlane_b32 s73, v9
    s_add_u32 s92, s92, 1
    s_cmp_lg_u32 s73, -1
    s_cbranch_scc1 Lg_49
    s_cmp_lt_u32 s92, 400000
    s_cbranch_scc1 Lgs_50
Lg_49:
    s_branch LBloop2_23
LBfin_27:
    v_mov_b32 v38, v36
    v_mov_b32 v40, v38
    s_nop 1
    v_permlane32_swap_b32 v38, v40
    s_nop 1
    v_max_f32 v38, v38, v40
    v_mov_b32 v40, v38
    s_nop 1
    v_permlane16_swap_b32 v38, v40
    s_nop 1
    v_max_f32 v38, v38, v40
    v_sub_f32 v39, v36, v38
    v_mul_f32 v39, s70, v39
    v_exp_f32 v39, v39
    s_nop 0
    v_mul_f32 v37, v37, v39
    v_mul_f32 v16, v16, v39
    v_mul_f32 v17, v17, v39
    v_mul_f32 v18, v18, v39
    v_mul_f32 v19, v19, v39
    v_mul_f32 v20, v20, v39
    v_mul_f32 v21, v21, v39
    v_mul_f32 v22, v22, v39
    v_mul_f32 v23, v23, v39
    v_mov_b32 v40, v37
    s_nop 1
    v_permlane32_swap_b32 v37, v40
    s_nop 1
    v_add_f32 v37, v37, v40
    v_mov_b32 v40, v37
    s_nop 1
    v_permlane16_swap_b32 v37, v40
    s_nop 1
    v_add_f32 v37, v37, v40
    s_nop 2
    v_permlane32_swap_b32 v16, v20
    v_permlane32_swap_b32 v17, v21
    v_permlane32_swap_b32 v18, v22
    v_permlane32_swap_b32 v19, v23
    s_nop 1
    v_add_f32 v16, v16, v20
    v_add_f32 v17, v17, v21
    v_add_f32 v18, v18, v22
    v_add_f32 v19, v19, v23
    s_nop 1
    v_permlane16_swap_b32 v16, v18
    v_permlane16_swap_b32 v17, v19
    s_nop 1
    v_add_f32 v16, v16, v18
    v_add_f32 v17, v17, v19
    ds_write_b64 v7, v[16:17] offset:4096
    v_mov_b32 v40, v38
    v_mov_b32 v41, v37
    v_mov_b32 v42, s77
    ds_write_b64 v42, v[40:41] offset:12288
    s_cmp_eq_u32 s76, -1
    s_cbranch_scc1 Lns_51
    v_mov_b32 v40, 0xff7fffff
    v_mov_b32 v41, 0
    v_mov_b32 v42, s77
    ds_write_b64 v42, v[40:41] offset:12352
    v_mov_b32 v40, 0
    ds_write_b64 v7, v[40:41] offset:8192
Lns_51:
    s_waitcnt lgkmcnt(0)
L_bend:
    s_barrier
    s_cmp_lt_u32 s56, 2
    s_cbranch_scc1 Lpub_52
    s_cmp_eq_u32 s74, 2
    s_cbranch_scc1 L_t2_head
    s_branch L_end
Lpub_52:
    s_lshl_b32 s62, s56, 6
    v_mov_b32 v42, s62
    ds_read_b128 v[28:31], v42 offset:12288
    ds_read_b128 v[32:35], v42 offset:12304
    ds_read_b128 v[48:51], v42 offset:12320
    ds_read_b128 v[52:55], v42 offset:12336
    v_and_b32 v43, 31, v1
    v_lshlrev_b32 v43, 4, v43
    s_lshl_b32 s62, s56, 12
    v_add_u32 v43, s62, v43
    ds_read_b128 v[64:67], v43 offset:4096
    ds_read_b128 v[68:71], v43 offset:4608
    ds_read_b128 v[72:75], v43 offset:5120
    ds_read_b128 v[76:79], v43 offset:5632
    ds_read_b128 v[80:83], v43 offset:6144
    ds_read_b128 v[84:87], v43 offset:6656
    ds_read_b128 v[88:91], v43 offset:7168
    ds_read_b128 v[92:95], v43 offset:7680
    s_waitcnt lgkmcnt(8)
    v_max3_f32 v38, v28, v30, v32
    v_max3_f32 v38, v38, v34, v48
    v_max3_f32 v38, v38, v50, v52
    v_max_f32 v38, v38, v54
    v_mul_f32 v56, s70, v38
    v_fma_f32 v28, v28, s70, -v56
    v_fma_f32 v30, v30, s70, -v56
    v_fma_f32 v32, v32, s70, -v56
    v_fma_f32 v34, v34, s70, -v56
    v_fma_f32 v48, v48, s70, -v56
    v_fma_f32 v50, v50, s70, -v56
    v_fma_f32 v52, v52, s70, -v56
    v_fma_f32 v54, v54, s70, -v56
    v_exp_f32 v28, v28
    v_exp_f32 v30, v30
    v_exp_f32 v32, v32
    v_exp_f32 v34, v34
    v_exp_f32 v48, v48
    v_exp_f32 v50, v50
    v_exp_f32 v52, v52
    v_exp_f32 v54, v54
    s_nop 0
    v_mul_f32 v37, v28, v29
    v_fmac_f32 v37, v30, v31
    v_fmac_f32 v37, v32, v33
    v_fmac_f32 v37, v34, v35
    v_fmac_f32 v37, v48, v49
    v_fmac_f32 v37, v50, v51
    v_fmac_f32 v37, v52, v53
    v_fmac_f32 v37, v54, v55
    s_waitcnt lgkmcnt(0)
    v_mul_f32 v40, v64, v28
    v_mul_f32 v41, v65, v28
    v_mul_f32 v42, v66, v28
    v_mul_f32 v43, v67, v28
    v_fmac_f32 v40, v68, v30
    v_fmac_f32 v41, v69, v30
    v_fmac_f32 v42, v70, v30
    v_fmac_f32 v43, v71, v30
    v_fmac_f32 v40, v72, v32
    v_fmac_f32 v41, v73, v32
    v_fmac_f32 v42, v74, v32
    v_fmac_f32 v43, v75, v32
    v_fmac_f32 v40, v76, v34
    v_fmac_f32 v41, v77, v34
    v_fmac_f32 v42, v78, v34
    v_fmac_f32 v43, v79, v34
    v_fmac_f32 v40, v80, v48
    v_fmac_f32 v41, v81, v48
    v_fmac_f32 v42, v82, v48
    v_fmac_f32 v43, v83, v48
    v_fmac_f32 v40, v84, v50
    v_fmac_f32 v41, v85, v50
    v_fmac_f32 v42, v86, v50
    v_fmac_f32 v43, v87, v50
    v_fmac_f32 v40, v88, v52
    v_fmac_f32 v41, v89, v52
    v_fmac_f32 v42, v90, v52
    v_fmac_f32 v43, v91, v52
    v_fmac_f32 v40, v92, v54
    v_fmac_f32 v41, v93, v54
    v_fmac_f32 v42, v94, v54
    v_fmac_f32 v43, v95, v54
    v_cmp_eq_u32 vcc, 32, v1
    v_mov_b32 v45, 0
    s_nop 0
    v_cndmask_b32 v40, v40, v38, vcc
    v_cndmask_b32 v41, v41, v37, vcc
    v_cndmask_b32 v42, v42, v45, vcc
    v_cndmask_b32 v43, v43, v45, vcc
    s_lshl_b32 s64, s56, 3
    s_add_u32 s64, s64, s67
    v_lshlrev_b32 v44, 4, v1
    s_lshl_b32 s61, s64, 9
    s_add_u32 s61, s61, 512
    v_add_u32 v44, s61, v44
    s_lshl_b32 s61, s64, 4
    s_add_u32 s61, s61, 128
    v_mov_b32 v46, s61
    v_cndmask_b32 v44, v44, v46, vcc
    s_add_u32 s61, s65, 32
    s_mul_i32 s61, s61, 16384
    s_mov_b32 exec_lo, -1
    s_mov_b32 exec_hi, 1
    buffer_store_dwordx4 v[40:43], v44, s[32:35], s61 offen sc0 sc1
    s_mov_b64 exec, -1
    s_cmp_eq_u32 s74, 0
    s_cbranch_scc1 L_end
    s_cmp_eq_u32 s74, 2
    s_cbranch_scc1 L_t2_head
    s_branch L_final
Lsw_36:
    v_mov_b32 v38, v36
    v_mov_b32 v40, v38
    s_nop 1
    v_permlane32_swap_b32 v38, v40
    s_nop 1
    v_max_f32 v38, v38, v40
    v_mov_b32 v40, v38
    s_nop 1
    v_permlane16_swap_b32 v38, v40
    s_nop 1
    v_max_f32 v38, v38, v40
    v_sub_f32 v39, v36, v38
    v_mul_f32 v39, s70, v39
    v_exp_f32 v39, v39
    s_nop 0
    v_mul_f32 v37, v37, v39
    v_mul_f32 v16, v16, v39
    v_mul_f32 v17, v17, v39
    v_mul_f32 v18, v18, v39
    v_mul_f32 v19, v19, v39
    v_mul_f32 v20, v20, v39
    v_mul_f32 v21, v21, v39
    v_mul_f32 v22, v22, v39
    v_mul_f32 v23, v23, v39
    v_mov_b32 v40, v37
    s_nop 1
    v_permlane32_swap_b32 v37, v40
    s_nop 1
    v_add_f32 v37, v37, v40
    v_mov_b32 v40, v37
    s_nop 1
    v_permlane16_swap_b32 v37, v40
    s_nop 1
    v_add_f32 v37, v37, v40
    s_nop 2
    v_permlane32_swap_b32 v16, v20
    v_permlane32_swap_b32 v17, v21
    v_permlane32_swap_b32 v18, v22
    v_permlane32_swap_b32 v19, v23
    s_nop 1
    v_add_f32 v16, v16, v20
    v_add_f32 v17, v17, v21
    v_add_f32 v18, v18, v22
    v_add_f32 v19, v19, v23
    s_nop 1
    v_permlane16_swap_b32 v16, v18
    v_permlane16_swap_b32 v17, v19
    s_nop 1
    v_add_f32 v16, v16, v18
    v_add_f32 v17, v17, v19
    ds_write_b64 v7, v[16:17] offset:4096
    v_mov_b32 v40, v38
    v_mov_b32 v41, v37
    v_mov_b32 v42, s77
    ds_write_b64 v42, v[40:41] offset:12288
    v_lshlrev_b32 v44, 4, v3
    ds_read_b128 v[24:27], v44 offset:256
    v_mov_b32 v36, 0xff7fffff
    v_mov_b32 v37, 0
    v_mov_b32 v16, 0
    v_mov_b32 v17, 0
    v_mov_b32 v18, 0
    v_mov_b32 v19, 0
    v_mov_b32 v20, 0
    v_mov_b32 v21, 0
    v_mov_b32 v22, 0
    v_mov_b32 v23, 0
    v_add_u32 v7, 4096, v7
    s_add_u32 s77, s77, 64
    s_mov_b32 s76, -1
    s_waitcnt lgkmcnt(0)
    s_branch Lswb_37
Lsw_40:
    v_mov_b32 v38, v36
    v_mov_b32 v40, v38
    s_nop 1
    v_permlane32_swap_b32 v38, v40
    s_nop 1
    v_max_f32 v38, v38, v40
    v_mov_b32 v40, v38
    s_nop 1
    v_permlane16_swap_b32 v38, v40
    s_nop 1
    v_max_f32 v38, v38, v40
    v_sub_f32 v39, v36, v38
    v_mul_f32 v39, s70, v39
    v_exp_f32 v39, v39
    s_nop 0
    v_mul_f32 v37, v37, v39
    v_mul_f32 v16, v16, v39
    v_mul_f32 v17, v17, v39
    v_mul_f32 v18, v18, v39
    v_mul_f32 v19, v19, v39
    v_mul_f32 v20, v20, v39
    v_mul_f32 v21, v21, v39
    v_mul_f32 v22, v22, v39
    v_mul_f32 v23, v23, v39
    v_mov_b32 v40, v37
    s_nop 1
    v_permlane32_swap_b32 v37, v40
    s_nop 1
    v_add_f32 v37, v37, v40
    v_mov_b32 v40, v37
    s_nop 1
    v_permlane16_swap_b32 v37, v40
    s_nop 1
    v_add_f32 v37, v37, v40
    s_nop 2
    v_permlane32_swap_b32 v16, v20
    v_permlane32_swap_b32 v17, v21
    v_permlane32_swap_b32 v18, v22
    v_permlane32_swap_b32 v19, v23
    s_nop 1
    v_add_f32 v16, v16, v20
    v_add_f32 v17, v17, v21
    v_add_f32 v18, v18, v22
    v_add_f32 v19, v19, v23
    s_nop 1
    v_permlane16_swap_b32 v16, v18
    v_permlane16_swap_b32 v17, v19
    s_nop 1
    v_add_f32 v16, v16, v18
    v_add_f32 v17, v17, v19
    ds_write_b64 v7, v[16:17] offset:4096
    v_mov_b32 v40, v38
    v_mov_b32 v41, v37
    v_mov_b32 v42, s77
    ds_write_b64 v42, v[40:41] offset:12288
    v_lshlrev_b32 v44, 4, v3
    ds_read_b128 v[24:27], v44 offset:256
    v_mov_b32 v36, 0xff7fffff
    v_mov_b32 v37, 0
    v_mov_b32 v16, 0
    v_mov_b32 v17, 0
    v_mov_b32 v18, 0
    v_mov_b32 v19, 0
    v_mov_b32 v20, 0
    v_mov_b32 v21, 0
    v_mov_b32 v22, 0
    v_mov_b32 v23, 0
    v_add_u32 v7, 4096, v7
    s_add_u32 s77, s77, 64
    s_mov_b32 s76, -1
    s_waitcnt lgkmcnt(0)
    s_branch Lswb_41
Lsw_44:
    v_mov_b32 v38, v36
    v_mov_b32 v40, v38
    s_nop 1
    v_permlane32_swap_b32 v38, v40
    s_nop 1
    v_max_f32 v38, v38, v40
    v_mov_b32 v40, v38
    s_nop 1
    v_permlane16_swap_b32 v38, v40
    s_nop 1
    v_max_f32 v38, v38, v40
    v_sub_f32 v39, v36, v38
    v_mul_f32 v39, s70, v39
    v_exp_f32 v39, v39
    s_nop 0
    v_mul_f32 v37, v37, v39
    v_mul_f32 v16, v16, v39
    v_mul_f32 v17, v17, v39
    v_mul_f32 v18, v18, v39
    v_mul_f32 v19, v19, v39
    v_mul_f32 v20, v20, v39
    v_mul_f32 v21, v21, v39
    v_mul_f32 v22, v22, v39
    v_mul_f32 v23, v23, v39
    v_mov_b32 v40, v37
    s_nop 1
    v_permlane32_swap_b32 v37, v40
    s_nop 1
    v_add_f32 v37, v37, v40
    v_mov_b32 v40, v37
    s_nop 1
    v_permlane16_swap_b32 v37, v40
    s_nop 1
    v_add_f32 v37, v37, v40
    s_nop 2
    v_permlane32_swap_b32 v16, v20
    v_permlane32_swap_b32 v17, v21
    v_permlane32_swap_b32 v18, v22
    v_permlane32_swap_b32 v19, v23
    s_nop 1
    v_add_f32 v16, v16, v20
    v_add_f32 v17, v17, v21
    v_add_f32 v18, v18, v22
    v_add_f32 v19, v19, v23
    s_nop 1
    v_permlane16_swap_b32 v16, v18
    v_permlane16_swap_b32 v17, v19
    s_nop 1
    v_add_f32 v16, v16, v18
    v_add_f32 v17, v17, v19
    ds_write_b64 v7, v[16:17] offset:4096
    v_mov_b32 v40, v38
    v_mov_b32 v41, v37
    v_mov_b32 v42, s77
    ds_write_b64 v42, v[40:41] offset:12288
    v_lshlrev_b32 v44, 4, v3
    ds_read_b128 v[24:27], v44 offset:256
    v_mov_b32 v36, 0xff7fffff
    v_mov_b32 v37, 0
    v_mov_b32 v16, 0
    v_mov_b32 v17, 0
    v_mov_b32 v18, 0
    v_mov_b32 v19, 0
    v_mov_b32 v20, 0
    v_mov_b32 v21, 0
    v_mov_b32 v22, 0
    v_mov_b32 v23, 0
    v_add_u32 v7, 4096, v7
    s_add_u32 s77, s77, 64
    s_mov_b32 s76, -1
    s_waitcnt lgkmcnt(0)
    s_branch Lswb_45
L_join:
    s_mov_b32 s78, 0
    s_mov_b32 s79, 0
    s_mov_b32 s80, 0
    s_mov_b32 s81, 0
    v_and_b32 v1, 63, v0
    v_lshrrev_b32 v2, 4, v1
    v_and_b32 v3, 15, v1
    s_lshl_b32 s61, s65, 20
    s_add_u32 s44, s18, s61
    s_addc_u32 s45, s19, 0
    s_and_b32 s45, s45, 0xffff
    s_mov_b32 s46, 34603008
    s_mov_b32 s47, 0x00020000
    s_add_u32 s48, s20, s61
    s_addc_u32 s49, s21, 0
    s_and_b32 s49, s49, 0xffff
    s_mov_b32 s50, 34603008
    s_mov_b32 s51, 0x00020000
    s_lshl_b32 s83, s65, 8
    s_add_u32 s83, s83, 1507328
    v_lshlrev_b32 v4, 4, v1
    s_mov_b32 s70, 1040356334
    v_mov_b32 v60, 0
    v_mov_b32 v10, 512
    s_mul_i32 s88, s65, 252
    s_and_b32 s88, s88, 255
    s_cmp_eq_u32 s56, 7
    s_cbranch_scc1 Lj7_53
    s_barrier
    s_branch L_join_go
Lj7_53:
    s_setprio 3
    s_branch L_svc_q
L_roleA2:
    s_add_u32 s75, s65, 32
    s_branch L_roleA
L_roleA1:
    s_mov_b32 s75, s65
L_roleA:
    v_and_b32 v1, 63, v0
    v_lshrrev_b32 v2, 4, v1
    v_and_b32 v3, 15, v1
    v_lshlrev_b32 v5, 4, v1
    v_lshlrev_b32 v4, 17, v2
    v_lshl_add_u32 v4, v3, 4, v4
    s_mov_b32 s68, 0x05040100
    s_mov_b32 s69, 0x07060302
    s_mul_i32 s93, s75, 16384
    v_mov_b32 v40, -1
    v_mov_b32 v41, -1
    v_mov_b32 v42, -1
    v_mov_b32 v43, -1
    v_lshlrev_b32 v44, 4, v0
    buffer_store_dwordx4 v[40:43], v44, s[32:35], s93 offen sc0 sc1
    v_cmp_gt_u32 vcc, 4608, v44
    s_and_saveexec_b64 s[94:95], vcc
    s_cbranch_execz Lci_54
    s_add_u32 s61, s93, 8192
    buffer_store_dwordx4 v[40:43], v44, s[32:35], s61 offen sc0 sc1
Lci_54:
    s_mov_b64 exec, s[94:95]
    s_cmp_lg_u32 s56, 5
    s_cbranch_scc1 Lcq_55
    v_mov_b32 v46, 0
    v_mov_b32 v47, 65536
    s_lshl_b32 s61, s75, 8
    s_add_u32 s61, s61, 1507328
    s_mov_b64 exec, 1
    buffer_store_dword v47, v46, s[32:35], s61 offen sc0 sc1
    s_mov_b64 exec, -1
Lcq_55:
    s_cmp_lg_u32 s56, 6
    s_cbranch_scc1 Lcq_56
    s_lshl_b32 s61, s75, 10
    s_add_u32 s61, s61, 1146880
    buffer_store_dwordx4 v[40:43], v5, s[32:35], s61 offen sc0 sc1
Lcq_56:
    s_mov_b32 s59, s65
    s_and_b32 s60, s58, 1
    s_bfe_u32 s62, s58, 0x10001
    s_lshr_b32 s61, s58, 2
    s_lshl_b32 s3, s61, 5
    s_add_u32 s3, s3, s59
    s_lshl_b32 s3, s3, 2
    s_add_u32 s3, s3, s62
    s_lshl_b32 s3, s3, 1
    s_add_u32 s3, s3, s60
    s_lshl_b32 s3, s3, 8
    s_add_u32 s3, s3, 1310720
    s_and_b32 s91, s59, 0xfc
    s_cmp_eq_u32 s61, 0
    s_cselect_b32 s36, s8, s22
    s_cselect_b32 s37, s9, s23
    s_cselect_b32 s40, s4, s16
    s_cselect_b32 s41, s5, s17
    s_and_b32 s37, s37, 0xffff
    s_and_b32 s41, s41, 0xffff
    s_mov_b32 s38, 4194304
    s_mov_b32 s39, 0x00020000
    s_mov_b32 s42, 2048
    s_mov_b32 s43, 0x00020000
    v_and_b32 v228, 63, v0
    v_lshrrev_b32 v229, 3, v228
    v_and_b32 v230, 7, v228
    v_lshlrev_b32 v231, 3, v229
    s_lshl_b32 s61, s56, 6
    s_lshl_b32 s62, s62, 9
    s_add_u32 s61, s61, s62
    buffer_load_dwordx2 v[208:209], v231, s[40:43], s61 offen offset:0
    buffer_load_dwordx2 v[210:211], v231, s[40:43], s61 offen offset:1024
    v_lshlrev_b32 v231, 15, v229
    v_lshl_add_u32 v231, v230, 4, v231
    s_lshl_b32 s61, s61, 12
    s_lshl_b32 s59, s59, 8
    s_lshl_b32 s60, s60, 7
    s_add_u32 s61, s61, s59
    s_add_u32 s61, s61, s60
    buffer_load_dwordx4 v[192:195], v231, s[36:39], s61 offen
    s_add_u32 s61, s61, 8192
    buffer_load_dwordx4 v[196:199], v231, s[36:39], s61 offen
    s_add_u32 s61, s61, 8192
    buffer_load_dwordx4 v[200:203], v231, s[36:39], s61 offen
    s_add_u32 s61, s61, 8192
    buffer_load_dwordx4 v[204:207], v231, s[36:39], s61 offen
    s_mov_b32 s68, 0x05040100
    s_mov_b32 s69, 0x07060302
    s_barrier
    s_cmp_lt_u32 s75, 32
    s_cbranch_scc1 L_roleT1
    s_sub_u32 s65, s75, 32
    s_lshl_b32 s61, s65, 18
    s_add_u32 s44, s6, s61
    s_addc_u32 s45, s7, 0
    s_and_b32 s45, s45, 0xffff
    s_mov_b32 s46, 262144
    s_mov_b32 s47, 0x00020000
    s_mul_i32 s89, s56, 2
    s_mul_i32 s61, s65, 5
    s_add_u32 s89, s89, s61
    s_cmp_eq_u32 s56, 7
    s_cbranch_scc1 Lt2s_57
    s_lshl_b32 s85, s56, 14
    s_add_u32 m0, s85, 0
    v_xor_b32 v52, 0, v5
    s_add_u32 s86, s89, 0
    s_and_b32 s86, s86, 15
    s_lshl_b32 s86, s86, 10
    s_add_u32 s86, s86, s85
    buffer_load_dwordx4 v52, s[44:47], s86 offen nt lds
    s_add_u32 m0, s85, 1024
    v_xor_b32 v53, 64, v5
    s_add_u32 s86, s89, 1
    s_and_b32 s86, s86, 15
    s_lshl_b32 s86, s86, 10
    s_add_u32 s86, s86, s85
    buffer_load_dwordx4 v53, s[44:47], s86 offen nt lds
    s_add_u32 m0, s85, 2048
    v_xor_b32 v52, 128, v5
    s_add_u32 s86, s89, 2
    s_and_b32 s86, s86, 15
    s_lshl_b32 s86, s86, 10
    s_add_u32 s86, s86, s85
    buffer_load_dwordx4 v52, s[44:47], s86 offen nt lds
    s_add_u32 m0, s85, 3072
    v_xor_b32 v53, 192, v5
    s_add_u32 s86, s89, 3
    s_and_b32 s86, s86, 15
    s_lshl_b32 s86, s86, 10
    s_add_u32 s86, s86, s85
    buffer_load_dwordx4 v53, s[44:47], s86 offen nt lds
    s_waitcnt vmcnt(4)
    v_perm_b32 v232, v196, v192, s68
    v_perm_b32 v233, v196, v192, s69
    v_perm_b32 v234, v197, v193, s68
    v_perm_b32 v235, v197, v193, s69
    v_perm_b32 v236, v198, v194, s68
    v_perm_b32 v237, v198, v194, s69
    v_perm_b32 v238, v199, v195, s68
    v_perm_b32 v239, v199, v195, s69
    v_dot2_f32_bf16 v212, v232, v208, 0
    v_dot2_f32_bf16 v213, v233, v208, 0
    v_dot2_f32_bf16 v214, v234, v208, 0
    v_dot2_f32_bf16 v215, v235, v208, 0
    v_dot2_f32_bf16 v216, v236, v208, 0
    v_dot2_f32_bf16 v217, v237, v208, 0
    v_dot2_f32_bf16 v218, v238, v208, 0
    v_dot2_f32_bf16 v219, v239, v208, 0
    v_dot2_f32_bf16 v220, v232, v210, 0
    v_dot2_f32_bf16 v221, v233, v210, 0
    v_dot2_f32_bf16 v222, v234, v210, 0
    v_dot2_f32_bf16 v223, v235, v210, 0
    v_dot2_f32_bf16 v224, v236, v210, 0
    v_dot2_f32_bf16 v225, v237, v210, 0
    v_dot2_f32_bf16 v226, v238, v210, 0
    v_dot2_f32_bf16 v227, v239, v210, 0
    v_perm_b32 v232, v204, v200, s68
    v_perm_b32 v233, v204, v200, s69
    v_perm_b32 v234, v205, v201, s68
    v_perm_b32 v235, v205, v201, s69
    v_perm_b32 v236, v206, v202, s68
    v_perm_b32 v237, v206, v202, s69
    v_perm_b32 v238, v207, v203, s68
    v_perm_b32 v239, v207, v203, s69
    v_dot2_f32_bf16 v212, v232, v209, v212
    v_dot2_f32_bf16 v213, v233, v209, v213
    v_dot2_f32_bf16 v214, v234, v209, v214
    v_dot2_f32_bf16 v215, v235, v209, v215
    v_dot2_f32_bf16 v216, v236, v209, v216
    v_dot2_f32_bf16 v217, v237, v209, v217
    v_dot2_f32_bf16 v218, v238, v209, v218
    v_dot2_f32_bf16 v219, v239, v209, v219
    v_dot2_f32_bf16 v220, v232, v211, v220
    v_dot2_f32_bf16 v221, v233, v211, v221
    v_dot2_f32_bf16 v222, v234, v211, v222
    v_dot2_f32_bf16 v223, v235, v211, v223
    v_dot2_f32_bf16 v224, v236, v211, v224
    v_dot2_f32_bf16 v225, v237, v211, v225
    v_dot2_f32_bf16 v226, v238, v211, v226
    v_dot2_f32_bf16 v227, v239, v211, v227
    s_nop 2
    v_permlane32_swap_b32 v212, v220
    v_permlane32_swap_b32 v213, v221
    v_permlane32_swap_b32 v214, v222
    v_permlane32_swap_b32 v215, v223
    v_permlane32_swap_b32 v216, v224
    v_permlane32_swap_b32 v217, v225
    v_permlane32_swap_b32 v218, v226
    v_permlane32_swap_b32 v219, v227
    s_nop 1
    v_add_f32 v212, v212, v220
    v_add_f32 v213, v213, v221
    v_add_f32 v214, v214, v222
    v_add_f32 v215, v215, v223
    v_add_f32 v216, v216, v224
    v_add_f32 v217, v217, v225
    v_add_f32 v218, v218, v226
    v_add_f32 v219, v219, v227
    s_nop 1
    v_permlane16_swap_b32 v212, v216
    v_permlane16_swap_b32 v213, v217
    v_permlane16_swap_b32 v214, v218
    v_permlane16_swap_b32 v215, v219
    s_nop 1
    v_add_f32 v212, v212, v216
    v_add_f32 v213, v213, v217
    v_add_f32 v214, v214, v218
    v_add_f32 v215, v215, v219
    s_nop 1
    v_add_f32_dpp v212, v212, v212 row_ror:8 row_mask:0xf bank_mask:0xf
    v_add_f32_dpp v213, v213, v213 row_ror:8 row_mask:0xf bank_mask:0xf
    v_add_f32_dpp v214, v214, v214 row_ror:8 row_mask:0xf bank_mask:0xf
    v_add_f32_dpp v215, v215, v215 row_ror:8 row_mask:0xf bank_mask:0xf
    v_lshrrev_b32 v232, 5, v228
    v_lshlrev_b32 v232, 8, v232
    v_bfe_u32 v233, v228, 4, 1
    v_lshl_add_u32 v232, v233, 4, v232
    v_lshl_add_u32 v232, v230, 5, v232
    s_lshl_b32 s61, s56, 9
    s_add_u32 s61, s61, 147456
    v_add_u32 v232, s61, v232
    ds_write_b128 v232, v[212:215]
    s_waitcnt lgkmcnt(0)
    s_barrier
    s_waitcnt vmcnt(4)
    s_add_u32 m0, s85, 4096
    v_xor_b32 v52, 0, v5
    s_add_u32 s86, s89, 4
    s_and_b32 s86, s86, 15
    s_lshl_b32 s86, s86, 10
    s_add_u32 s86, s86, s85
    buffer_load_dwordx4 v52, s[44:47], s86 offen nt lds
    s_waitcnt vmcnt(4)
    s_add_u32 m0, s85, 5120
    v_xor_b32 v53, 64, v5
    s_add_u32 s86, s89, 5
    s_and_b32 s86, s86, 15
    s_lshl_b32 s86, s86, 10
    s_add_u32 s86, s86, s85
    buffer_load_dwordx4 v53, s[44:47], s86 offen nt lds
    s_waitcnt vmcnt(4)
    s_add_u32 m0, s85, 6144
    v_xor_b32 v52, 128, v5
    s_add_u32 s86, s89, 6
    s_and_b32 s86, s86, 15
    s_lshl_b32 s86, s86, 10
    s_add_u32 s86, s86, s85
    buffer_load_dwordx4 v52, s[44:47], s86 offen nt lds
    s_waitcnt vmcnt(4)
    s_add_u32 m0, s85, 7168
    v_xor_b32 v53, 192, v5
    s_add_u32 s86, s89, 7
    s_and_b32 s86, s86, 15
    s_lshl_b32 s86, s86, 10
    s_add_u32 s86, s86, s85
    buffer_load_dwordx4 v53, s[44:47], s86 offen nt lds
    s_waitcnt vmcnt(4)
    s_add_u32 m0, s85, 8192
    v_xor_b32 v52, 32, v5
    s_add_u32 s86, s89, 8
    s_and_b32 s86, s86, 15
    s_lshl_b32 s86, s86, 10
    s_add_u32 s86, s86, s85
    buffer_load_dwordx4 v52, s[44:47], s86 offen nt lds
    s_waitcnt vmcnt(4)
    s_add_u32 m0, s85, 9216
    v_xor_b32 v53, 96, v5
    s_add_u32 s86, s89, 9
    s_and_b32 s86, s86, 15
    s_lshl_b32 s86, s86, 10
    s_add_u32 s86, s86, s85
    buffer_load_dwordx4 v53, s[44:47], s86 offen nt lds
    s_waitcnt vmcnt(4)
    s_add_u32 m0, s85, 10240
    v_xor_b32 v52, 160, v5
    s_add_u32 s86, s89, 10
    s_and_b32 s86, s86, 15
    s_lshl_b32 s86, s86, 10
    s_add_u32 s86, s86, s85
    buffer_load_dwordx4 v52, s[44:47], s86 offen nt lds
    s_waitcnt vmcnt(4)
    s_add_u32 m0, s85, 11264
    v_xor_b32 v53, 224, v5
    s_add_u32 s86, s89, 11
    s_and_b32 s86, s86, 15
    s_lshl_b32 s86, s86, 10
    s_add_u32 s86, s86, s85
    buffer_load_dwordx4 v53, s[44:47], s86 offen nt lds
    s_waitcnt vmcnt(4)
    s_add_u32 m0, s85, 12288
    v_xor_b32 v52, 32, v5
    s_add_u32 s86, s89, 12
    s_and_b32 s86, s86, 15
    s_lshl_b32 s86, s86, 10
    s_add_u32 s86, s86, s85
    buffer_load_dwordx4 v52, s[44:47], s86 offen nt lds
    s_waitcnt vmcnt(4)
    s_add_u32 m0, s85, 13312
    v_xor_b32 v53, 96, v5
    s_add_u32 s86, s89, 13
    s_and_b32 s86, s86, 15
    s_lshl_b32 s86, s86, 10
    s_add_u32 s86, s86, s85
    buffer_load_dwordx4 v53, s[44:47], s86 offen nt lds
    s_waitcnt vmcnt(4)
    s_add_u32 m0, s85, 14336
    v_xor_b32 v52, 160, v5
    s_add_u32 s86, s89, 14
    s_and_b32 s86, s86, 15
    s_lshl_b32 s86, s86, 10
    s_add_u32 s86, s86, s85
    buffer_load_dwordx4 v52, s[44:47], s86 offen nt lds
    s_waitcnt vmcnt(4)
    s_add_u32 m0, s85, 15360
    v_xor_b32 v53, 224, v5
    s_add_u32 s86, s89, 15
    s_and_b32 s86, s86, 15
    s_lshl_b32 s86, s86, 10
    s_add_u32 s86, s86, s85
    buffer_load_dwordx4 v53, s[44:47], s86 offen nt lds
    s_branch Lt2j_58
Lt2s_57:
    s_setprio 3
    s_waitcnt vmcnt(0)
    v_perm_b32 v232, v196, v192, s68
    v_perm_b32 v233, v196, v192, s69
    v_perm_b32 v234, v197, v193, s68
    v_perm_b32 v235, v197, v193, s69
    v_perm_b32 v236, v198, v194, s68
    v_perm_b32 v237, v198, v194, s69
    v_perm_b32 v238, v199, v195, s68
    v_perm_b32 v239, v199, v195, s69
    v_dot2_f32_bf16 v212, v232, v208, 0
    v_dot2_f32_bf16 v213, v233, v208, 0
    v_dot2_f32_bf16 v214, v234, v208, 0
    v_dot2_f32_bf16 v215, v235, v208, 0
    v_dot2_f32_bf16 v216, v236, v208, 0
    v_dot2_f32_bf16 v217, v237, v208, 0
    v_dot2_f32_bf16 v218, v238, v208, 0
    v_dot2_f32_bf16 v219, v239, v208, 0
    v_dot2_f32_bf16 v220, v232, v210, 0
    v_dot2_f32_bf16 v221, v233, v210, 0
    v_dot2_f32_bf16 v222, v234, v210, 0
    v_dot2_f32_bf16 v223, v235, v210, 0
    v_dot2_f32_bf16 v224, v236, v210, 0
    v_dot2_f32_bf16 v225, v237, v210, 0
    v_dot2_f32_bf16 v226, v238, v210, 0
    v_dot2_f32_bf16 v227, v239, v210, 0
    v_perm_b32 v232, v204, v200, s68
    v_perm_b32 v233, v204, v200, s69
    v_perm_b32 v234, v205, v201, s68
    v_perm_b32 v235, v205, v201, s69
    v_perm_b32 v236, v206, v202, s68
    v_perm_b32 v237, v206, v202, s69
    v_perm_b32 v238, v207, v203, s68
    v_perm_b32 v239, v207, v203, s69
    v_dot2_f32_bf16 v212, v232, v209, v212
    v_dot2_f32_bf16 v213, v233, v209, v213
    v_dot2_f32_bf16 v214, v234, v209, v214
    v_dot2_f32_bf16 v215, v235, v209, v215
    v_dot2_f32_bf16 v216, v236, v209, v216
    v_dot2_f32_bf16 v217, v237, v209, v217
    v_dot2_f32_bf16 v218, v238, v209, v218
    v_dot2_f32_bf16 v219, v239, v209, v219
    v_dot2_f32_bf16 v220, v232, v211, v220
    v_dot2_f32_bf16 v221, v233, v211, v221
    v_dot2_f32_bf16 v222, v234, v211, v222
    v_dot2_f32_bf16 v223, v235, v211, v223
    v_dot2_f32_bf16 v224, v236, v211, v224
    v_dot2_f32_bf16 v225, v237, v211, v225
    v_dot2_f32_bf16 v226, v238, v211, v226
    v_dot2_f32_bf16 v227, v239, v211, v227
    s_nop 2
    v_permlane32_swap_b32 v212, v220
    v_permlane32_swap_b32 v213, v221
    v_permlane32_swap_b32 v214, v222
    v_permlane32_swap_b32 v215, v223
    v_permlane32_swap_b32 v216, v224
    v_permlane32_swap_b32 v217, v225
    v_permlane32_swap_b32 v218, v226
    v_permlane32_swap_b32 v219, v227
    s_nop 1
    v_add_f32 v212, v212, v220
    v_add_f32 v213, v213, v221
    v_add_f32 v214, v214, v222
    v_add_f32 v215, v215, v223
    v_add_f32 v216, v216, v224
    v_add_f32 v217, v217, v225
    v_add_f32 v218, v218, v226
    v_add_f32 v219, v219, v227
    s_nop 1
    v_permlane16_swap_b32 v212, v216
    v_permlane16_swap_b32 v213, v217
    v_permlane16_swap_b32 v214, v218
    v_permlane16_swap_b32 v215, v219
    s_nop 1
    v_add_f32 v212, v212, v216
    v_add_f32 v213, v213, v217
    v_add_f32 v214, v214, v218
    v_add_f32 v215, v215, v219
    s_nop 1
    v_add_f32_dpp v212, v212, v212 row_ror:8 row_mask:0xf bank_mask:0xf
    v_add_f32_dpp v213, v213, v213 row_ror:8 row_mask:0xf bank_mask:0xf
    v_add_f32_dpp v214, v214, v214 row_ror:8 row_mask:0xf bank_mask:0xf
    v_add_f32_dpp v215, v215, v215 row_ror:8 row_mask:0xf bank_mask:0xf
    v_lshrrev_b32 v232, 5, v228
    v_lshlrev_b32 v232, 8, v232
    v_bfe_u32 v233, v228, 4, 1
    v_lshl_add_u32 v232, v233, 4, v232
    v_lshl_add_u32 v232, v230, 5, v232
    s_lshl_b32 s61, s56, 9
    s_add_u32 s61, s61, 147456
    v_add_u32 v232, s61, v232
    ds_write_b128 v232, v[212:215]
    s_waitcnt lgkmcnt(0)
    s_barrier
    v_mov_b32 v48, 1
    v_mov_b32 v49, 0
    s_mov_b64 exec, 1
    buffer_atomic_add v48, v49, s[52:55], 0 offen offset:128 sc1
    s_mov_b64 exec, -1
    v_mov_b32 v234, 0
    buffer_load_dword v235, v234, s[52:55], s91 offen offset:0 sc0 sc1
    v_and_b32 v232, 31, v228
    v_lshlrev_b32 v233, 4, v232
    v_add_u32 v233, 147456, v233
    ds_read_b128 v[192:195], v233 offset:0
    ds_read_b128 v[196:199], v233 offset:512
    ds_read_b128 v[200:203], v233 offset:1024
    ds_read_b128 v[204:207], v233 offset:1536
    ds_read_b128 v[208:211], v233 offset:2048
    ds_read_b128 v[212:215], v233 offset:2560
    ds_read_b128 v[216:219], v233 offset:3072
    ds_read_b128 v[220:223], v233 offset:3584
    s_waitcnt lgkmcnt(6)
    v_add_f32 v192, v192, v196
    v_add_f32 v193, v193, v197
    v_add_f32 v194, v194, v198
    v_add_f32 v195, v195, v199
    s_waitcnt lgkmcnt(5)
    v_add_f32 v192, v192, v200
    v_add_f32 v193, v193, v201
    v_add_f32 v194, v194, v202
    v_add_f32 v195, v195, v203
    s_waitcnt lgkmcnt(4)
    v_add_f32 v192, v192, v204
    v_add_f32 v193, v193, v205
    v_add_f32 v194, v194, v206
    v_add_f32 v195, v195, v207
    s_waitcnt lgkmcnt(3)
    v_add_f32 v192, v192, v208
    v_add_f32 v193, v193, v209
    v_add_f32 v194, v194, v210
    v_add_f32 v195, v195, v211
    s_waitcnt lgkmcnt(2)
    v_add_f32 v192, v192, v212
    v_add_f32 v193, v193, v213
    v_add_f32 v194, v194, v214
    v_add_f32 v195, v195, v215
    s_waitcnt lgkmcnt(1)
    v_add_f32 v192, v192, v216
    v_add_f32 v193, v193, v217
    v_add_f32 v194, v194, v218
    v_add_f32 v195, v195, v219
    s_waitcnt lgkmcnt(0)
    v_add_f32 v192, v192, v220
    v_add_f32 v193, v193, v221
    v_add_f32 v194, v194, v222
    v_add_f32 v195, v195, v223
    v_lshrrev_b32 v233, 4, v232
    v_lshlrev_b32 v233, 10, v233
    v_and_b32 v232, 15, v232
    v_lshl_add_u32 v233, v232, 4, v233
    s_waitcnt vmcnt(0)
    s_mov_b32 s92, 0
Lcf_59:
    v_readfirstlane_b32 s57, v235
    s_nop 3
    s_cmp_lg_u32 s57, 0
    s_cbranch_scc1 Lcfd_60
    s_sleep 2
    buffer_load_dword v235, v234, s[52:55], s91 offen offset:0 sc0 sc1
    s_waitcnt vmcnt(0)
    s_add_u32 s92, s92, 1
    s_cmp_lt_u32 s92, 400000
    s_cbranch_scc1 Lcf_59
Lcfd_60:
    s_mov_b64 exec, 0xffffffff
    buffer_store_dwordx4 v[192:195], v233, s[32:35], s3 offen sc0 sc1
    s_mov_b64 exec, -1
    s_setprio 0
    s_lshl_b32 s85, s56, 14
    s_add_u32 m0, s85, 0
    v_xor_b32 v52, 0, v5
    s_add_u32 s86, s89, 0
    s_and_b32 s86, s86, 15
    s_lshl_b32 s86, s86, 10
    s_add_u32 s86, s86, s85
    buffer_load_dwordx4 v52, s[44:47], s86 offen nt lds
    s_add_u32 m0, s85, 1024
    v_xor_b32 v53, 64, v5
    s_add_u32 s86, s89, 1
    s_and_b32 s86, s86, 15
    s_lshl_b32 s86, s86, 10
    s_add_u32 s86, s86, s85
    buffer_load_dwordx4 v53, s[44:47], s86 offen nt lds
    s_add_u32 m0, s85, 2048
    v_xor_b32 v52, 128, v5
    s_add_u32 s86, s89, 2
    s_and_b32 s86, s86, 15
    s_lshl_b32 s86, s86, 10
    s_add_u32 s86, s86, s85
    buffer_load_dwordx4 v52, s[44:47], s86 offen nt lds
    s_add_u32 m0, s85, 3072
    v_xor_b32 v53, 192, v5
    s_add_u32 s86, s89, 3
    s_and_b32 s86, s86, 15
    s_lshl_b32 s86, s86, 10
    s_add_u32 s86, s86, s85
    buffer_load_dwordx4 v53, s[44:47], s86 offen nt lds
    s_add_u32 m0, s85, 4096
    v_xor_b32 v52, 0, v5
    s_add_u32 s86, s89, 4
    s_and_b32 s86, s86, 15
    s_lshl_b32 s86, s86, 10
    s_add_u32 s86, s86, s85
    buffer_load_dwordx4 v52, s[44:47], s86 offen nt lds
    s_add_u32 m0, s85, 5120
    v_xor_b32 v53, 64, v5
    s_add_u32 s86, s89, 5
    s_and_b32 s86, s86, 15
    s_lshl_b32 s86, s86, 10
    s_add_u32 s86, s86, s85
    buffer_load_dwordx4 v53, s[44:47], s86 offen nt lds
    s_add_u32 m0, s85, 6144
    v_xor_b32 v52, 128, v5
    s_add_u32 s86, s89, 6
    s_and_b32 s86, s86, 15
    s_lshl_b32 s86, s86, 10
    s_add_u32 s86, s86, s85
    buffer_load_dwordx4 v52, s[44:47], s86 offen nt lds
    s_add_u32 m0, s85, 7168
    v_xor_b32 v53, 192, v5
    s_add_u32 s86, s89, 7
    s_and_b32 s86, s86, 15
    s_lshl_b32 s86, s86, 10
    s_add_u32 s86, s86, s85
    buffer_load_dwordx4 v53, s[44:47], s86 offen nt lds
    s_add_u32 m0, s85, 8192
    v_xor_b32 v52, 32, v5
    s_add_u32 s86, s89, 8
    s_and_b32 s86, s86, 15
    s_lshl_b32 s86, s86, 10
    s_add_u32 s86, s86, s85
    buffer_load_dwordx4 v52, s[44:47], s86 offen nt lds
    s_add_u32 m0, s85, 9216
    v_xor_b32 v53, 96, v5
    s_add_u32 s86, s89, 9
    s_and_b32 s86, s86, 15
    s_lshl_b32 s86, s86, 10
    s_add_u32 s86, s86, s85
    buffer_load_dwordx4 v53, s[44:47], s86 offen nt lds
    s_add_u32 m0, s85, 10240
    v_xor_b32 v52, 160, v5
    s_add_u32 s86, s89, 10
    s_and_b32 s86, s86, 15
    s_lshl_b32 s86, s86, 10
    s_add_u32 s86, s86, s85
    buffer_load_dwordx4 v52, s[44:47], s86 offen nt lds
    s_add_u32 m0, s85, 11264
    v_xor_b32 v53, 224, v5
    s_add_u32 s86, s89, 11
    s_and_b32 s86, s86, 15
    s_lshl_b32 s86, s86, 10
    s_add_u32 s86, s86, s85
    buffer_load_dwordx4 v53, s[44:47], s86 offen nt lds
    s_add_u32 m0, s85, 12288
    v_xor_b32 v52, 32, v5
    s_add_u32 s86, s89, 12
    s_and_b32 s86, s86, 15
    s_lshl_b32 s86, s86, 10
    s_add_u32 s86, s86, s85
    buffer_load_dwordx4 v52, s[44:47], s86 offen nt lds
    s_add_u32 m0, s85, 13312
    v_xor_b32 v53, 96, v5
    s_add_u32 s86, s89, 13
    s_and_b32 s86, s86, 15
    s_lshl_b32 s86, s86, 10
    s_add_u32 s86, s86, s85
    buffer_load_dwordx4 v53, s[44:47], s86 offen nt lds
    s_add_u32 m0, s85, 14336
    v_xor_b32 v52, 160, v5
    s_add_u32 s86, s89, 14
    s_and_b32 s86, s86, 15
    s_lshl_b32 s86, s86, 10
    s_add_u32 s86, s86, s85
    buffer_load_dwordx4 v52, s[44:47], s86 offen nt lds
    s_add_u32 m0, s85, 15360
    v_xor_b32 v53, 224, v5
    s_add_u32 s86, s89, 15
    s_and_b32 s86, s86, 15
    s_lshl_b32 s86, s86, 10
    s_add_u32 s86, s86, s85
    buffer_load_dwordx4 v53, s[44:47], s86 offen nt lds
Lt2j_58:
    s_barrier
    s_lshl_b32 s85, s56, 14
    s_add_u32 s85, s85, 131072
    s_add_u32 s86, s89, 0
    s_and_b32 s86, s86, 15
    s_lshl_b32 s86, s86, 10
    s_add_u32 s86, s86, s85
    buffer_load_dwordx4 v[128:131], v5, s[44:47], s86 offen nt
    s_add_u32 s86, s89, 1
    s_and_b32 s86, s86, 15
    s_lshl_b32 s86, s86, 10
    s_add_u32 s86, s86, s85
    buffer_load_dwordx4 v[132:135], v5, s[44:47], s86 offen nt
    s_add_u32 s86, s89, 2
    s_and_b32 s86, s86, 15
    s_lshl_b32 s86, s86, 10
    s_add_u32 s86, s86, s85
    buffer_load_dwordx4 v[136:139], v5, s[44:47], s86 offen nt
    s_add_u32 s86, s89, 3
    s_and_b32 s86, s86, 15
    s_lshl_b32 s86, s86, 10
    s_add_u32 s86, s86, s85
    buffer_load_dwordx4 v[140:143], v5, s[44:47], s86 offen nt
    s_add_u32 s86, s89, 4
    s_and_b32 s86, s86, 15
    s_lshl_b32 s86, s86, 10
    s_add_u32 s86, s86, s85
    buffer_load_dwordx4 v[144:147], v5, s[44:47], s86 offen nt
    s_add_u32 s86, s89, 5
    s_and_b32 s86, s86, 15
    s_lshl_b32 s86, s86, 10
    s_add_u32 s86, s86, s85
    buffer_load_dwordx4 v[148:151], v5, s[44:47], s86 offen nt
    s_add_u32 s86, s89, 6
    s_and_b32 s86, s86, 15
    s_lshl_b32 s86, s86, 10
    s_add_u32 s86, s86, s85
    buffer_load_dwordx4 v[152:155], v5, s[44:47], s86 offen nt
    s_add_u32 s86, s89, 7
    s_and_b32 s86, s86, 15
    s_lshl_b32 s86, s86, 10
    s_add_u32 s86, s86, s85
    buffer_load_dwordx4 v[156:159], v5, s[44:47], s86 offen nt
    s_add_u32 s86, s89, 8
    s_and_b32 s86, s86, 15
    s_lshl_b32 s86, s86, 10
    s_add_u32 s86, s86, s85
    buffer_load_dwordx4 v[160:163], v5, s[44:47], s86 offen nt
    s_add_u32 s86, s89, 9
    s_and_b32 s86, s86, 15
    s_lshl_b32 s86, s86, 10
    s_add_u32 s86, s86, s85
    buffer_load_dwordx4 v[164:167], v5, s[44:47], s86 offen nt
    s_add_u32 s86, s89, 10
    s_and_b32 s86, s86, 15
    s_lshl_b32 s86, s86, 10
    s_add_u32 s86, s86, s85
    buffer_load_dwordx4 v[168:171], v5, s[44:47], s86 offen nt
    s_add_u32 s86, s89, 11
    s_and_b32 s86, s86, 15
    s_lshl_b32 s86, s86, 10
    s_add_u32 s86, s86, s85
    buffer_load_dwordx4 v[172:175], v5, s[44:47], s86 offen nt
    s_add_u32 s86, s89, 12
    s_and_b32 s86, s86, 15
    s_lshl_b32 s86, s86, 10
    s_add_u32 s86, s86, s85
    buffer_load_dwordx4 v[176:179], v5, s[44:47], s86 offen nt
    s_add_u32 s86, s89, 13
    s_and_b32 s86, s86, 15
    s_lshl_b32 s86, s86, 10
    s_add_u32 s86, s86, s85
    buffer_load_dwordx4 v[180:183], v5, s[44:47], s86 offen nt
    s_add_u32 s86, s89, 14
    s_and_b32 s86, s86, 15
    s_lshl_b32 s86, s86, 10
    s_add_u32 s86, s86, s85
    buffer_load_dwordx4 v[184:187], v5, s[44:47], s86 offen nt
    s_add_u32 s86, s89, 15
    s_and_b32 s86, s86, 15
    s_lshl_b32 s86, s86, 10
    s_add_u32 s86, s86, s85
    buffer_load_dwordx4 v[188:191], v5, s[44:47], s86 offen nt
    v_mov_b32 v55, 0
    buffer_load_dword v54, v55, s[52:55], 0 offen offset:128 sc0 sc1
    s_lshr_b32 s66, s65, 4
    s_and_b32 s67, s65, 15
    s_and_b32 s63, s56, 3
    s_lshr_b32 s64, s56, 2
    v_and_b32 v40, 3, v3
    v_lshlrev_b32 v40, 2, v40
    v_lshrrev_b32 v41, 3, v3
    v_lshl_or_b32 v40, v41, 1, v40
    s_lshl_b32 s61, s63, 15
    v_lshlrev_b32 v41, 10, v3
    v_add_u32 v41, s61, v41
    v_add_u32 v42, 0, v2
    v_xor_b32 v42, v42, v40
    v_lshl_add_u32 v8, v42, 4, v41
    v_add_u32 v42, 4, v2
    v_xor_b32 v42, v42, v40
    v_lshl_add_u32 v9, v42, 4, v41
    v_add_u32 v42, 8, v2
    v_xor_b32 v42, v42, v40
    v_lshl_add_u32 v10, v42, 4, v41
    v_add_u32 v42, 12, v2
    v_xor_b32 v42, v42, v40
    v_lshl_add_u32 v11, v42, 4, v41
    s_lshl_b32 s61, s64, 14
    s_add_u32 s61, s61, 131072
    s_lshl_b32 s62, s63, 15
    s_sub_u32 s61, s61, s62
    v_lshrrev_b32 v43, 1, v2
    v_and_b32 v44, 1, v2
    v_lshrrev_b32 v45, 2, v3
    v_lshl_add_u32 v46, v43, 3, v45
    v_lshlrev_b32 v47, 2, v45
    v_lshl_or_b32 v47, v43, 1, v47
    v_bfe_u32 v48, v3, 1, 1
    v_lshl_add_u32 v48, v44, 1, v48
    s_lshl_b32 s62, s56, 3
    s_add_u32 s62, s62, 0
    v_add_u32 v48, s62, v48
    v_xor_b32 v48, v48, v47
    v_lshlrev_b32 v48, 4, v48
    v_lshl_add_u32 v48, v46, 10, v48
    v_and_b32 v49, 1, v3
    v_lshl_add_u32 v12, v49, 3, v48
    v_bfe_u32 v48, v3, 1, 1
    v_lshl_add_u32 v48, v44, 1, v48
    s_lshl_b32 s62, s56, 3
    s_add_u32 s62, s62, 4
    v_add_u32 v48, s62, v48
    v_xor_b32 v48, v48, v47
    v_lshlrev_b32 v48, 4, v48
    v_lshl_add_u32 v48, v46, 10, v48
    v_and_b32 v49, 1, v3
    v_lshl_add_u32 v13, v49, 3, v48
    v_lshl_add_u32 v46, v43, 3, v45
    v_add_u32 v46, 4, v46
    v_lshlrev_b32 v47, 2, v45
    v_lshl_or_b32 v47, v43, 1, v47
    v_bfe_u32 v48, v3, 1, 1
    v_lshl_add_u32 v48, v44, 1, v48
    s_lshl_b32 s62, s56, 3
    s_add_u32 s62, s62, 0
    v_add_u32 v48, s62, v48
    v_xor_b32 v48, v48, v47
    v_lshlrev_b32 v48, 4, v48
    v_lshl_add_u32 v48, v46, 10, v48
    v_and_b32 v49, 1, v3
    v_lshl_add_u32 v14, v49, 3, v48
    v_bfe_u32 v48, v3, 1, 1
    v_lshl_add_u32 v48, v44, 1, v48
    s_lshl_b32 s62, s56, 3
    s_add_u32 s62, s62, 4
    v_add_u32 v48, s62, v48
    v_xor_b32 v48, v48, v47
    v_lshlrev_b32 v48, 4, v48
    v_lshl_add_u32 v48, v46, 10, v48
    v_and_b32 v49, 1, v3
    v_lshl_add_u32 v15, v49, 3, v48
    v_and_b32 v43, 31, v1
    v_lshrrev_b32 v44, 5, v1
    v_mul_u32_u24 v16, 272, v43
    v_lshl_add_u32 v16, v44, 4, v16
    v_add_u32 v16, 131072, v16
    v_lshlrev_b32 v23, 4, v43
    v_add_u32 v23, 139776, v23
    s_lshl_b32 s62, s64, 4
    v_add_u32 v43, s62, v3
    v_mul_u32_u24 v17, 272, v43
    v_lshl_add_u32 v17, v2, 3, v17
    s_lshl_b32 s62, s63, 6
    s_add_u32 s62, s62, 131072
    v_add_u32 v17, s62, v17
    v_lshlrev_b32 v22, 4, v43
    v_add_u32 v22, 139776, v22
    s_lshl_b32 s62, s63, 2
    v_add_u32 v21, s62, v22
    v_add_u32 v33, s61, v8
    v_mov_b32 v18, 0xff7fffff
    v_mov_b32 v20, 0xff7fffff
    v_mov_b32 v19, 0
    s_mov_b32 s100, s61
    s_cmp_lt_u32 s56, 4
    s_cbranch_scc1 Lqa0_61
    s_waitcnt vmcnt(17)
    s_branch Lqaj_62
Lqa0_61:
    s_waitcnt vmcnt(0)
    s_mov_b32 s92, 0
Lcf_63:
    v_readfirstlane_b32 s57, v54
    s_nop 3
    s_cmp_ge_u32 s57, 64
    s_cbranch_scc1 Lcfd_64
    s_sleep 8
    v_mov_b32 v55, 0
    buffer_load_dword v54, v55, s[52:55], 0 offen offset:128 sc0 sc1
    s_waitcnt vmcnt(0)
    s_add_u32 s92, s92, 1
    s_cmp_lt_u32 s92, 400000
    s_cbranch_scc1 Lcf_63
Lcfd_64:
    s_lshl_b32 s61, s66, 15
    s_lshl_b32 s62, s56, 13
    s_add_u32 s61, s61, s62
    s_add_u32 s61, s61, 1147900
    v_lshlrev_b32 v41, 10, v1
    s_mov_b64 exec, 0xff
    s_mov_b32 s92, 0
Lpoll_65:
    buffer_load_dword v42, v41, s[32:35], s61 offen sc0 sc1
    s_waitcnt vmcnt(0)
    v_mov_b32 v43, v42
    v_cmpx_eq_u32 vcc, -1, v43
    s_cbranch_execz Lpolld_66
    s_sleep 4
    s_add_u32 s92, s92, 1
    s_cmp_lt_u32 s92, 400000
    s_cbranch_scc1 Lpoll_65
Lpolld_66:
    s_mov_b64 exec, -1
    s_lshl_b32 s61, s66, 15
    s_lshl_b32 s62, s56, 13
    s_add_u32 s61, s61, s62
    s_add_u32 s61, s61, 1146880
    s_add_u32 s62, s61, 4096
    s_mov_b32 s92, 0
Lpoll_67:
    buffer_load_dwordx4 v[64:67], v5, s[32:35], s61 offen offset:0 sc0 sc1
    buffer_load_dwordx4 v[68:71], v5, s[32:35], s61 offen offset:1024 sc0 sc1
    buffer_load_dwordx4 v[72:75], v5, s[32:35], s61 offen offset:2048 sc0 sc1
    buffer_load_dwordx4 v[76:79], v5, s[32:35], s61 offen offset:3072 sc0 sc1
    buffer_load_dwordx4 v[80:83], v5, s[32:35], s62 offen offset:0 sc0 sc1
    buffer_load_dwordx4 v[84:87], v5, s[32:35], s62 offen offset:1024 sc0 sc1
    buffer_load_dwordx4 v[88:91], v5, s[32:35], s62 offen offset:2048 sc0 sc1
    buffer_load_dwordx4 v[92:95], v5, s[32:35], s62 offen offset:3072 sc0 sc1
    s_waitcnt vmcnt(0)
    v_mov_b32 v40, v64
    v_max3_u32 v40, v40, v65, v66
    v_max3_u32 v40, v40, v67, v68
    v_max3_u32 v40, v40, v69, v70
    v_max3_u32 v40, v40, v71, v72
    v_max3_u32 v40, v40, v73, v74
    v_max3_u32 v40, v40, v75, v76
    v_max3_u32 v40, v40, v77, v78
    v_max3_u32 v40, v40, v79, v80
    v_max3_u32 v40, v40, v81, v82
    v_max3_u32 v40, v40, v83, v84
    v_max3_u32 v40, v40, v85, v86
    v_max3_u32 v40, v40, v87, v88
    v_max3_u32 v40, v40, v89, v90
    v_max3_u32 v40, v40, v91, v92
    v_max3_u32 v40, v40, v93, v94
    v_max_u32 v40, v40, v95
    v_cmpx_eq_u32 vcc, -1, v40
    s_cbranch_execz Lpolld_68
    s_sleep 4
    s_add_u32 s92, s92, 1
    s_cmp_lt_u32 s92, 400000
    s_cbranch_scc1 Lpoll_67
Lpolld_68:
    s_mov_b64 exec, -1
    s_and_b32 s62, s56, 1
    s_lshl_b32 s62, s62, 5
    s_lshl_b32 s61, s56, 13
    s_add_u32 s61, s61, 131072
    s_add_u32 s57, s62, 0
    v_xor_b32 v40, s57, v5
    v_add_u32 v40, s61, v40
    ds_write_b128 v40, v[64:67] offset:0
    s_add_u32 s57, s62, 64
    v_xor_b32 v41, s57, v5
    v_add_u32 v41, s61, v41
    ds_write_b128 v41, v[68:71] offset:1024
    s_add_u32 s57, s62, 128
    v_xor_b32 v42, s57, v5
    v_add_u32 v42, s61, v42
    ds_write_b128 v42, v[72:75] offset:2048
    s_add_u32 s57, s62, 192
    v_xor_b32 v43, s57, v5
    v_add_u32 v43, s61, v43
    ds_write_b128 v43, v[76:79] offset:3072
    s_add_u32 s57, s62, 0
    v_xor_b32 v40, s57, v5
    v_add_u32 v40, s61, v40
    ds_write_b128 v40, v[80:83] offset:4096
    s_add_u32 s57, s62, 64
    v_xor_b32 v41, s57, v5
    v_add_u32 v41, s61, v41
    ds_write_b128 v41, v[84:87] offset:5120
    s_add_u32 s57, s62, 128
    v_xor_b32 v42, s57, v5
    v_add_u32 v42, s61, v42
    ds_write_b128 v42, v[88:91] offset:6144
    s_add_u32 s57, s62, 192
    v_xor_b32 v43, s57, v5
    v_add_u32 v43, s61, v43
    ds_write_b128 v43, v[92:95] offset:7168
    s_waitcnt lgkmcnt(0)
Lqaj_62:
    s_barrier
    v_add_u32 v40, s100, v8
    v_add_u32 v41, s100, v9
    v_add_u32 v42, s100, v10
    v_add_u32 v43, s100, v11
    ds_read_b128 v[192:195], v40 offset:0
    ds_read_b128 v[196:199], v41 offset:0
    ds_read_b128 v[200:203], v42 offset:0
    ds_read_b128 v[204:207], v43 offset:0
    ds_read_b128 v[208:211], v40 offset:256
    ds_read_b128 v[212:215], v41 offset:256
    ds_read_b128 v[216:219], v42 offset:256
    ds_read_b128 v[220:223], v43 offset:256
    ds_read_b128 v[224:227], v40 offset:512
    ds_read_b128 v[228:231], v41 offset:512
    ds_read_b128 v[232:235], v42 offset:512
    ds_read_b128 v[236:239], v43 offset:512
    ds_read_b128 v[240:243], v40 offset:768
    ds_read_b128 v[244:247], v41 offset:768
    ds_read_b128 v[248:251], v42 offset:768
    ds_read_b128 v[252:255], v43 offset:768
    s_waitcnt lgkmcnt(0)
    s_barrier
    ds_read_b128 v[96:99], v8 offset:0
    ds_read_b128 v[100:103], v8 offset:16384
    ds_read_b128 v[104:107], v9 offset:0
    ds_read_b128 v[108:111], v9 offset:16384
    ds_read_b128 v[112:115], v10 offset:0
    ds_read_b128 v[116:119], v10 offset:16384
    ds_read_b128 v[120:123], v11 offset:0
    ds_read_b128 v[124:127], v11 offset:16384
    s_waitcnt lgkmcnt(7)
    v_mfma_f32_16x16x32_bf16 v[24:27], v[96:99], v[192:195], 0
    ds_read_b128 v[96:99], v8 offset:256
    s_waitcnt lgkmcnt(7)
    v_mfma_f32_16x16x32_bf16 v[28:31], v[100:103], v[192:195], 0
    ds_read_b128 v[100:103], v8 offset:16640
    s_waitcnt lgkmcnt(7)
    v_mfma_f32_16x16x32_bf16 v[24:27], v[104:107], v[196:199], v[24:27]
    ds_read_b128 v[104:107], v9 offset:256
    s_waitcnt lgkmcnt(7)
    v_mfma_f32_16x16x32_bf16 v[28:31], v[108:111], v[196:199], v[28:31]
    ds_read_b128 v[108:111], v9 offset:16640
    s_waitcnt lgkmcnt(7)
    v_mfma_f32_16x16x32_bf16 v[24:27], v[112:115], v[200:203], v[24:27]
    ds_read_b128 v[112:115], v10 offset:256
    s_waitcnt lgkmcnt(7)
    v_mfma_f32_16x16x32_bf16 v[28:31], v[116:119], v[200:203], v[28:31]
    ds_read_b128 v[116:119], v10 offset:16640
    s_waitcnt lgkmcnt(7)
    v_mfma_f32_16x16x32_bf16 v[24:27], v[120:123], v[204:207], v[24:27]
    ds_read_b128 v[120:123], v11 offset:256
    s_waitcnt lgkmcnt(7)
    v_mfma_f32_16x16x32_bf16 v[28:31], v[124:127], v[204:207], v[28:31]
    ds_read_b128 v[124:127], v11 offset:16640
    s_waitcnt lgkmcnt(7)
    v_mfma_f32_16x16x32_bf16 v[24:27], v[96:99], v[208:211], v[24:27]
    ds_read_b128 v[96:99], v8 offset:512
    s_waitcnt lgkmcnt(7)
    v_mfma_f32_16x16x32_bf16 v[28:31], v[100:103], v[208:211], v[28:31]
    ds_read_b128 v[100:103], v8 offset:16896
    s_waitcnt lgkmcnt(7)
    v_mfma_f32_16x16x32_bf16 v[24:27], v[104:107], v[212:215], v[24:27]
    ds_read_b128 v[104:107], v9 offset:512
    s_waitcnt lgkmcnt(7)
    v_mfma_f32_16x16x32_bf16 v[28:31], v[108:111], v[212:215], v[28:31]
    ds_read_b128 v[108:111], v9 offset:16896
    s_waitcnt lgkmcnt(7)
    v_mfma_f32_16x16x32_bf16 v[24:27], v[112:115], v[216:219], v[24:27]
    ds_read_b128 v[112:115], v10 offset:512
    s_waitcnt lgkmcnt(7)
    v_mfma_f32_16x16x32_bf16 v[28:31], v[116:119], v[216:219], v[28:31]
    ds_read_b128 v[116:119], v10 offset:16896
    s_waitcnt lgkmcnt(7)
    v_mfma_f32_16x16x32_bf16 v[24:27], v[120:123], v[220:223], v[24:27]
    ds_read_b128 v[120:123], v11 offset:512
    s_waitcnt lgkmcnt(7)
    v_mfma_f32_16x16x32_bf16 v[28:31], v[124:127], v[220:223], v[28:31]
    ds_read_b128 v[124:127], v11 offset:16896
    s_waitcnt lgkmcnt(7)
    v_mfma_f32_16x16x32_bf16 v[24:27], v[96:99], v[224:227], v[24:27]
    ds_read_b128 v[96:99], v8 offset:768
    s_waitcnt lgkmcnt(7)
    v_mfma_f32_16x16x32_bf16 v[28:31], v[100:103], v[224:227], v[28:31]
    ds_read_b128 v[100:103], v8 offset:17152
    s_waitcnt lgkmcnt(7)
    v_mfma_f32_16x16x32_bf16 v[24:27], v[104:107], v[228:231], v[24:27]
    ds_read_b128 v[104:107], v9 offset:768
    s_waitcnt lgkmcnt(7)
    v_mfma_f32_16x16x32_bf16 v[28:31], v[108:111], v[228:231], v[28:31]
    ds_read_b128 v[108:111], v9 offset:17152
    s_waitcnt lgkmcnt(7)
    v_mfma_f32_16x16x32_bf16 v[24:27], v[112:115], v[232:235], v[24:27]
    ds_read_b128 v[112:115], v10 offset:768
    s_waitcnt lgkmcnt(7)
    v_mfma_f32_16x16x32_bf16 v[28:31], v[116:119], v[232:235], v[28:31]
    ds_read_b128 v[116:119], v10 offset:17152
    s_waitcnt lgkmcnt(7)
    v_mfma_f32_16x16x32_bf16 v[24:27], v[120:123], v[236:239], v[24:27]
    ds_read_b128 v[120:123], v11 offset:768
    s_waitcnt lgkmcnt(7)
    v_mfma_f32_16x16x32_bf16 v[28:31], v[124:127], v[236:239], v[28:31]
    ds_read_b128 v[124:127], v11 offset:17152
    s_waitcnt lgkmcnt(7)
    v_mfma_f32_16x16x32_bf16 v[24:27], v[96:99], v[240:243], v[24:27]
    s_waitcnt lgkmcnt(6)
    v_mfma_f32_16x16x32_bf16 v[28:31], v[100:103], v[240:243], v[28:31]
    s_waitcnt lgkmcnt(5)
    v_mfma_f32_16x16x32_bf16 v[24:27], v[104:107], v[244:247], v[24:27]
    s_waitcnt lgkmcnt(4)
    v_mfma_f32_16x16x32_bf16 v[28:31], v[108:111], v[244:247], v[28:31]
    s_waitcnt lgkmcnt(3)
    v_mfma_f32_16x16x32_bf16 v[24:27], v[112:115], v[248:251], v[24:27]
    s_waitcnt lgkmcnt(2)
    v_mfma_f32_16x16x32_bf16 v[28:31], v[116:119], v[248:251], v[28:31]
    s_waitcnt lgkmcnt(1)
    v_mfma_f32_16x16x32_bf16 v[24:27], v[120:123], v[252:255], v[24:27]
    s_waitcnt lgkmcnt(0)
    v_mfma_f32_16x16x32_bf16 v[28:31], v[124:127], v[252:255], v[28:31]
    s_nop 7
    s_nop 1
    v_max3_f32 v40, v24, v25, v26
    v_max3_f32 v40, v40, v27, v28
    v_max3_f32 v40, v40, v29, v30
    v_max_f32 v40, v40, v31
    v_mov_b32 v41, v40
    s_nop 1
    v_permlane32_swap_b32 v40, v41
    s_nop 1
    v_max_f32 v40, v40, v41
    v_mov_b32 v41, v40
    s_nop 1
    v_permlane16_swap_b32 v40, v41
    s_nop 1
    v_max_f32 v40, v40, v41
    ds_write_b32 v21, v40
    s_waitcnt lgkmcnt(0)
    s_barrier
    ds_read_b128 v[40:43], v22
    ds_read_b128 v[44:47], v23
    s_waitcnt lgkmcnt(1)
    v_max3_f32 v40, v40, v41, v42
    v_max3_f32 v20, v40, v43, v20
    v_sub_f32 v24, v24, v20
    v_sub_f32 v25, v25, v20
    v_sub_f32 v26, v26, v20
    v_sub_f32 v27, v27, v20
    v_sub_f32 v28, v28, v20
    v_sub_f32 v29, v29, v20
    v_sub_f32 v30, v30, v20
    v_sub_f32 v31, v31, v20
    v_exp_f32 v24, v24
    v_exp_f32 v25, v25
    v_exp_f32 v26, v26
    v_exp_f32 v27, v27
    v_exp_f32 v28, v28
    v_exp_f32 v29, v29
    v_exp_f32 v30, v30
    v_exp_f32 v31, v31
    s_waitcnt lgkmcnt(0)
    v_max3_f32 v44, v44, v45, v46
    v_max3_f32 v44, v44, v47, v18
    v_sub_f32 v32, v18, v44
    v_exp_f32 v32, v32
    v_mov_b32 v18, v44
    v_add_f32 v40, v24, v25
    v_add_f32 v40, v40, v26
    v_add_f32 v40, v40, v27
    v_add_f32 v40, v40, v28
    v_add_f32 v40, v40, v29
    v_add_f32 v40, v40, v30
    v_add_f32 v40, v40, v31
    v_cvt_pk_bf16_f32 v48, v24, v25
    v_cvt_pk_bf16_f32 v49, v26, v27
    v_cvt_pk_bf16_f32 v50, v28, v29
    v_cvt_pk_bf16_f32 v51, v30, v31
    ds_write_b64 v17, v[48:49] offset:0
    ds_write_b64 v17, v[50:51] offset:32
    v_mov_b32 v41, v40
    s_nop 1
    v_permlane32_swap_b32 v40, v41
    s_nop 1
    v_add_f32 v40, v40, v41
    v_mov_b32 v41, v40
    s_nop 1
    v_permlane16_swap_b32 v40, v41
    s_nop 1
    v_add_f32 v40, v40, v41
    ds_write_b32 v21, v40 offset:512
    s_waitcnt lgkmcnt(0)
    s_barrier
    ds_read_b128 v[40:43], v23 offset:512
    ds_read_b128 v[96:99], v16 offset:0
    ds_read_b64_tr_b16 v[100:101], v12 offset:0
    ds_read_b64_tr_b16 v[102:103], v14 offset:0
    ds_read_b64_tr_b16 v[104:105], v13 offset:0
    ds_read_b64_tr_b16 v[106:107], v15 offset:0
    ds_read_b128 v[108:111], v16 offset:32
    ds_read_b64_tr_b16 v[112:113], v12 offset:16384
    ds_read_b64_tr_b16 v[114:115], v14 offset:16384
    ds_read_b64_tr_b16 v[116:117], v13 offset:16384
    ds_read_b64_tr_b16 v[118:119], v15 offset:16384
    s_waitcnt lgkmcnt(5)
    v_mfma_f32_32x32x16_bf16 v[64:79], v[100:103], v[96:99], 0
    v_mfma_f32_32x32x16_bf16 v[80:95], v[104:107], v[96:99], 0
    ds_read_b128 v[96:99], v16 offset:64
    ds_read_b64_tr_b16 v[100:101], v12 offset:32768
    ds_read_b64_tr_b16 v[102:103], v14 offset:32768
    ds_read_b64_tr_b16 v[104:105], v13 offset:32768
    ds_read_b64_tr_b16 v[106:107], v15 offset:32768
    s_waitcnt lgkmcnt(5)
    v_mfma_f32_32x32x16_bf16 v[64:79], v[112:115], v[108:111], v[64:79]
    v_mfma_f32_32x32x16_bf16 v[80:95], v[116:119], v[108:111], v[80:95]
    ds_read_b128 v[108:111], v16 offset:96
    ds_read_b64_tr_b16 v[112:113], v12 offset:49152
    ds_read_b64_tr_b16 v[114:115], v14 offset:49152
    ds_read_b64_tr_b16 v[116:117], v13 offset:49152
    ds_read_b64_tr_b16 v[118:119], v15 offset:49152
    s_waitcnt lgkmcnt(5)
    v_mfma_f32_32x32x16_bf16 v[64:79], v[100:103], v[96:99], v[64:79]
    v_mfma_f32_32x32x16_bf16 v[80:95], v[104:107], v[96:99], v[80:95]
    v_add_u32 v12, 0x10000, v12
    v_add_u32 v13, 0x10000, v13
    v_add_u32 v14, 0x10000, v14
    v_add_u32 v15, 0x10000, v15
    ds_read_b128 v[96:99], v16 offset:128
    ds_read_b64_tr_b16 v[100:101], v12 offset:0
    ds_read_b64_tr_b16 v[102:103], v14 offset:0
    ds_read_b64_tr_b16 v[104:105], v13 offset:0
    ds_read_b64_tr_b16 v[106:107], v15 offset:0
    s_waitcnt lgkmcnt(5)
    v_mfma_f32_32x32x16_bf16 v[64:79], v[112:115], v[108:111], v[64:79]
    v_mfma_f32_32x32x16_bf16 v[80:95], v[116:119], v[108:111], v[80:95]
    ds_read_b128 v[108:111], v16 offset:160
    ds_read_b64_tr_b16 v[112:113], v12 offset:16384
    ds_read_b64_tr_b16 v[114:115], v14 offset:16384
    ds_read_b64_tr_b16 v[116:117], v13 offset:16384
    ds_read_b64_tr_b16 v[118:119], v15 offset:16384
    s_waitcnt lgkmcnt(5)
    v_mfma_f32_32x32x16_bf16 v[64:79], v[100:103], v[96:99], v[64:79]
    v_mfma_f32_32x32x16_bf16 v[80:95], v[104:107], v[96:99], v[80:95]
    ds_read_b128 v[96:99], v16 offset:192
    ds_read_b64_tr_b16 v[100:101], v12 offset:32768
    ds_read_b64_tr_b16 v[102:103], v14 offset:32768
    ds_read_b64_tr_b16 v[104:105], v13 offset:32768
    ds_read_b64_tr_b16 v[106:107], v15 offset:32768
    s_waitcnt lgkmcnt(5)
    v_mfma_f32_32x32x16_bf16 v[64:79], v[112:115], v[108:111], v[64:79]
    v_mfma_f32_32x32x16_bf16 v[80:95], v[116:119], v[108:111], v[80:95]
    ds_read_b128 v[108:111], v16 offset:224
    ds_read_b64_tr_b16 v[112:113], v12 offset:49152
    ds_read_b64_tr_b16 v[114:115], v14 offset:49152
    ds_read_b64_tr_b16 v[116:117], v13 offset:49152
    ds_read_b64_tr_b16 v[118:119], v15 offset:49152
    s_waitcnt lgkmcnt(5)
    v_mfma_f32_32x32x16_bf16 v[64:79], v[100:103], v[96:99], v[64:79]
    v_mfma_f32_32x32x16_bf16 v[80:95], v[104:107], v[96:99], v[80:95]
    s_waitcnt lgkmcnt(0)
    v_mfma_f32_32x32x16_bf16 v[64:79], v[112:115], v[108:111], v[64:79]
    v_mfma_f32_32x32x16_bf16 v[80:95], v[116:119], v[108:111], v[80:95]
    v_subrev_u32 v12, 0x10000, v12
    v_subrev_u32 v13, 0x10000, v13
    v_subrev_u32 v14, 0x10000, v14
    v_subrev_u32 v15, 0x10000, v15
    v_add_f32 v40, v40, v41
    v_add_f32 v42, v42, v43
    v_add_f32 v40, v40, v42
    v_fma_f32 v19, v19, v32, v40
    s_barrier
    s_waitcnt vmcnt(0)
    s_lshl_b32 s61, s56, 14
    v_xor_b32 v40, 0, v5
    v_add_u32 v40, s61, v40
    ds_write_b128 v40, v[128:131] offset:0
    v_xor_b32 v41, 64, v5
    v_add_u32 v41, s61, v41
    ds_write_b128 v41, v[132:135] offset:1024
    v_xor_b32 v42, 128, v5
    v_add_u32 v42, s61, v42
    ds_write_b128 v42, v[136:139] offset:2048
    v_xor_b32 v43, 192, v5
    v_add_u32 v43, s61, v43
    ds_write_b128 v43, v[140:143] offset:3072
    v_xor_b32 v40, 0, v5
    v_add_u32 v40, s61, v40
    ds_write_b128 v40, v[144:147] offset:4096
    v_xor_b32 v41, 64, v5
    v_add_u32 v41, s61, v41
    ds_write_b128 v41, v[148:151] offset:5120
    v_xor_b32 v42, 128, v5
    v_add_u32 v42, s61, v42
    ds_write_b128 v42, v[152:155] offset:6144
    v_xor_b32 v43, 192, v5
    v_add_u32 v43, s61, v43
    ds_write_b128 v43, v[156:159] offset:7168
    v_xor_b32 v40, 32, v5
    v_add_u32 v40, s61, v40
    ds_write_b128 v40, v[160:163] offset:8192
    v_xor_b32 v41, 96, v5
    v_add_u32 v41, s61, v41
    ds_write_b128 v41, v[164:167] offset:9216
    v_xor_b32 v42, 160, v5
    v_add_u32 v42, s61, v42
    ds_write_b128 v42, v[168:171] offset:10240
    v_xor_b32 v43, 224, v5
    v_add_u32 v43, s61, v43
    ds_write_b128 v43, v[172:175] offset:11264
    v_xor_b32 v40, 32, v5
    v_add_u32 v40, s61, v40
    ds_write_b128 v40, v[176:179] offset:12288
    v_xor_b32 v41, 96, v5
    v_add_u32 v41, s61, v41
    ds_write_b128 v41, v[180:183] offset:13312
    v_xor_b32 v42, 160, v5
    v_add_u32 v42, s61, v42
    ds_write_b128 v42, v[184:187] offset:14336
    v_xor_b32 v43, 224, v5
    v_add_u32 v43, s61, v43
    ds_write_b128 v43, v[188:191] offset:15360
    s_waitcnt lgkmcnt(0)
    s_barrier
    ds_read_b128 v[96:99], v8 offset:0
    ds_read_b128 v[100:103], v8 offset:16384
    ds_read_b128 v[104:107], v9 offset:0
    ds_read_b128 v[108:111], v9 offset:16384
    ds_read_b128 v[112:115], v10 offset:0
    ds_read_b128 v[116:119], v10 offset:16384
    ds_read_b128 v[120:123], v11 offset:0
    ds_read_b128 v[124:127], v11 offset:16384
    s_waitcnt lgkmcnt(7)
    v_mfma_f32_16x16x32_bf16 v[24:27], v[96:99], v[192:195], 0
    ds_read_b128 v[96:99], v8 offset:256
    s_waitcnt lgkmcnt(7)
    v_mfma_f32_16x16x32_bf16 v[28:31], v[100:103], v[192:195], 0
    ds_read_b128 v[100:103], v8 offset:16640
    s_waitcnt lgkmcnt(7)
    v_mfma_f32_16x16x32_bf16 v[24:27], v[104:107], v[196:199], v[24:27]
    ds_read_b128 v[104:107], v9 offset:256
    s_waitcnt lgkmcnt(7)
    v_mfma_f32_16x16x32_bf16 v[28:31], v[108:111], v[196:199], v[28:31]
    ds_read_b128 v[108:111], v9 offset:16640
    s_waitcnt lgkmcnt(7)
    v_mfma_f32_16x16x32_bf16 v[24:27], v[112:115], v[200:203], v[24:27]
    ds_read_b128 v[112:115], v10 offset:256
    s_waitcnt lgkmcnt(7)
    v_mfma_f32_16x16x32_bf16 v[28:31], v[116:119], v[200:203], v[28:31]
    ds_read_b128 v[116:119], v10 offset:16640
    s_waitcnt lgkmcnt(7)
    v_mfma_f32_16x16x32_bf16 v[24:27], v[120:123], v[204:207], v[24:27]
    ds_read_b128 v[120:123], v11 offset:256
    s_waitcnt lgkmcnt(7)
    v_mfma_f32_16x16x32_bf16 v[28:31], v[124:127], v[204:207], v[28:31]
    ds_read_b128 v[124:127], v11 offset:16640
    s_waitcnt lgkmcnt(7)
    v_mfma_f32_16x16x32_bf16 v[24:27], v[96:99], v[208:211], v[24:27]
    ds_read_b128 v[96:99], v8 offset:512
    s_waitcnt lgkmcnt(7)
    v_mfma_f32_16x16x32_bf16 v[28:31], v[100:103], v[208:211], v[28:31]
    ds_read_b128 v[100:103], v8 offset:16896
    s_waitcnt lgkmcnt(7)
    v_mfma_f32_16x16x32_bf16 v[24:27], v[104:107], v[212:215], v[24:27]
    ds_read_b128 v[104:107], v9 offset:512
    s_waitcnt lgkmcnt(7)
    v_mfma_f32_16x16x32_bf16 v[28:31], v[108:111], v[212:215], v[28:31]
    ds_read_b128 v[108:111], v9 offset:16896
    s_waitcnt lgkmcnt(7)
    v_mfma_f32_16x16x32_bf16 v[24:27], v[112:115], v[216:219], v[24:27]
    ds_read_b128 v[112:115], v10 offset:512
    s_waitcnt lgkmcnt(7)
    v_mfma_f32_16x16x32_bf16 v[28:31], v[116:119], v[216:219], v[28:31]
    ds_read_b128 v[116:119], v10 offset:16896
    s_waitcnt lgkmcnt(7)
    v_mfma_f32_16x16x32_bf16 v[24:27], v[120:123], v[220:223], v[24:27]
    ds_read_b128 v[120:123], v11 offset:512
    s_waitcnt lgkmcnt(7)
    v_mfma_f32_16x16x32_bf16 v[28:31], v[124:127], v[220:223], v[28:31]
    ds_read_b128 v[124:127], v11 offset:16896
    s_waitcnt lgkmcnt(7)
    v_mfma_f32_16x16x32_bf16 v[24:27], v[96:99], v[224:227], v[24:27]
    ds_read_b128 v[96:99], v8 offset:768
    s_waitcnt lgkmcnt(7)
    v_mfma_f32_16x16x32_bf16 v[28:31], v[100:103], v[224:227], v[28:31]
    ds_read_b128 v[100:103], v8 offset:17152
    s_waitcnt lgkmcnt(7)
    v_mfma_f32_16x16x32_bf16 v[24:27], v[104:107], v[228:231], v[24:27]
    ds_read_b128 v[104:107], v9 offset:768
    s_waitcnt lgkmcnt(7)
    v_mfma_f32_16x16x32_bf16 v[28:31], v[108:111], v[228:231], v[28:31]
    ds_read_b128 v[108:111], v9 offset:17152
    s_waitcnt lgkmcnt(7)
    v_mfma_f32_16x16x32_bf16 v[24:27], v[112:115], v[232:235], v[24:27]
    ds_read_b128 v[112:115], v10 offset:768
    s_waitcnt lgkmcnt(7)
    v_mfma_f32_16x16x32_bf16 v[28:31], v[116:119], v[232:235], v[28:31]
    ds_read_b128 v[116:119], v10 offset:17152
    s_waitcnt lgkmcnt(7)
    v_mfma_f32_16x16x32_bf16 v[24:27], v[120:123], v[236:239], v[24:27]
    ds_read_b128 v[120:123], v11 offset:768
    s_waitcnt lgkmcnt(7)
    v_mfma_f32_16x16x32_bf16 v[28:31], v[124:127], v[236:239], v[28:31]
    ds_read_b128 v[124:127], v11 offset:17152
    s_waitcnt lgkmcnt(7)
    v_mfma_f32_16x16x32_bf16 v[24:27], v[96:99], v[240:243], v[24:27]
    s_waitcnt lgkmcnt(6)
    v_mfma_f32_16x16x32_bf16 v[28:31], v[100:103], v[240:243], v[28:31]
    s_waitcnt lgkmcnt(5)
    v_mfma_f32_16x16x32_bf16 v[24:27], v[104:107], v[244:247], v[24:27]
    s_waitcnt lgkmcnt(4)
    v_mfma_f32_16x16x32_bf16 v[28:31], v[108:111], v[244:247], v[28:31]
    s_waitcnt lgkmcnt(3)
    v_mfma_f32_16x16x32_bf16 v[24:27], v[112:115], v[248:251], v[24:27]
    s_waitcnt lgkmcnt(2)
    v_mfma_f32_16x16x32_bf16 v[28:31], v[116:119], v[248:251], v[28:31]
    s_waitcnt lgkmcnt(1)
    v_mfma_f32_16x16x32_bf16 v[24:27], v[120:123], v[252:255], v[24:27]
    s_waitcnt lgkmcnt(0)
    v_mfma_f32_16x16x32_bf16 v[28:31], v[124:127], v[252:255], v[28:31]
    s_nop 7
    s_nop 1
    v_max3_f32 v40, v24, v25, v26
    v_max3_f32 v40, v40, v27, v28
    v_max3_f32 v40, v40, v29, v30
    v_max_f32 v40, v40, v31
    v_mov_b32 v41, v40
    s_nop 1
    v_permlane32_swap_b32 v40, v41
    s_nop 1
    v_max_f32 v40, v40, v41
    v_mov_b32 v41, v40
    s_nop 1
    v_permlane16_swap_b32 v40, v41
    s_nop 1
    v_max_f32 v40, v40, v41
    ds_write_b32 v21, v40
    s_waitcnt lgkmcnt(0)
    s_barrier
    ds_read_b128 v[40:43], v22
    ds_read_b128 v[44:47], v23
    s_waitcnt lgkmcnt(1)
    v_max3_f32 v40, v40, v41, v42
    v_max3_f32 v20, v40, v43, v20
    v_sub_f32 v24, v24, v20
    v_sub_f32 v25, v25, v20
    v_sub_f32 v26, v26, v20
    v_sub_f32 v27, v27, v20
    v_sub_f32 v28, v28, v20
    v_sub_f32 v29, v29, v20
    v_sub_f32 v30, v30, v20
    v_sub_f32 v31, v31, v20
    v_exp_f32 v24, v24
    v_exp_f32 v25, v25
    v_exp_f32 v26, v26
    v_exp_f32 v27, v27
    v_exp_f32 v28, v28
    v_exp_f32 v29, v29
    v_exp_f32 v30, v30
    v_exp_f32 v31, v31
    s_waitcnt lgkmcnt(0)
    v_max3_f32 v44, v44, v45, v46
    v_max3_f32 v44, v44, v47, v18
    v_sub_f32 v32, v18, v44
    v_exp_f32 v32, v32
    v_mov_b32 v18, v44
    v_add_f32 v40, v24, v25
    v_add_f32 v40, v40, v26
    v_add_f32 v40, v40, v27
    v_add_f32 v40, v40, v28
    v_add_f32 v40, v40, v29
    v_add_f32 v40, v40, v30
    v_add_f32 v40, v40, v31
    v_cvt_pk_bf16_f32 v48, v24, v25
    v_cvt_pk_bf16_f32 v49, v26, v27
    v_cvt_pk_bf16_f32 v50, v28, v29
    v_cvt_pk_bf16_f32 v51, v30, v31
    ds_write_b64 v17, v[48:49] offset:0
    ds_write_b64 v17, v[50:51] offset:32
    v_mov_b32 v41, v40
    s_nop 1
    v_permlane32_swap_b32 v40, v41
    s_nop 1
    v_add_f32 v40, v40, v41
    v_mov_b32 v41, v40
    s_nop 1
    v_permlane16_swap_b32 v40, v41
    s_nop 1
    v_add_f32 v40, v40, v41
    ds_write_b32 v21, v40 offset:512
    s_waitcnt lgkmcnt(0)
    s_barrier
    ds_read_b128 v[40:43], v23 offset:512
    v_mul_f32 v64, v64, v32
    v_mul_f32 v65, v65, v32
    v_mul_f32 v66, v66, v32
    v_mul_f32 v67, v67, v32
    v_mul_f32 v68, v68, v32
    v_mul_f32 v69, v69, v32
    v_mul_f32 v70, v70, v32
    v_mul_f32 v71, v71, v32
    v_mul_f32 v72, v72, v32
    v_mul_f32 v73, v73, v32
    v_mul_f32 v74, v74, v32
    v_mul_f32 v75, v75, v32
    v_mul_f32 v76, v76, v32
    v_mul_f32 v77, v77, v32
    v_mul_f32 v78, v78, v32
    v_mul_f32 v79, v79, v32
    v_mul_f32 v80, v80, v32
    v_mul_f32 v81, v81, v32
    v_mul_f32 v82, v82, v32
    v_mul_f32 v83, v83, v32
    v_mul_f32 v84, v84, v32
    v_mul_f32 v85, v85, v32
    v_mul_f32 v86, v86, v32
    v_mul_f32 v87, v87, v32
    v_mul_f32 v88, v88, v32
    v_mul_f32 v89, v89, v32
    v_mul_f32 v90, v90, v32
    v_mul_f32 v91, v91, v32
    v_mul_f32 v92, v92, v32
    v_mul_f32 v93, v93, v32
    v_mul_f32 v94, v94, v32
    v_mul_f32 v95, v95, v32
    ds_read_b128 v[96:99], v16 offset:0
    ds_read_b64_tr_b16 v[100:101], v12 offset:0
    ds_read_b64_tr_b16 v[102:103], v14 offset:0
    ds_read_b64_tr_b16 v[104:105], v13 offset:0
    ds_read_b64_tr_b16 v[106:107], v15 offset:0
    ds_read_b128 v[108:111], v16 offset:32
    ds_read_b64_tr_b16 v[112:113], v12 offset:16384
    ds_read_b64_tr_b16 v[114:115], v14 offset:16384
    ds_read_b64_tr_b16 v[116:117], v13 offset:16384
    ds_read_b64_tr_b16 v[118:119], v15 offset:16384
    s_waitcnt lgkmcnt(5)
    v_mfma_f32_32x32x16_bf16 v[64:79], v[100:103], v[96:99], v[64:79]
    v_mfma_f32_32x32x16_bf16 v[80:95], v[104:107], v[96:99], v[80:95]
    ds_read_b128 v[96:99], v16 offset:64
    ds_read_b64_tr_b16 v[100:101], v12 offset:32768
    ds_read_b64_tr_b16 v[102:103], v14 offset:32768
    ds_read_b64_tr_b16 v[104:105], v13 offset:32768
    ds_read_b64_tr_b16 v[106:107], v15 offset:32768
    s_waitcnt lgkmcnt(5)
    v_mfma_f32_32x32x16_bf16 v[64:79], v[112:115], v[108:111], v[64:79]
    v_mfma_f32_32x32x16_bf16 v[80:95], v[116:119], v[108:111], v[80:95]
    ds_read_b128 v[108:111], v16 offset:96
    ds_read_b64_tr_b16 v[112:113], v12 offset:49152
    ds_read_b64_tr_b16 v[114:115], v14 offset:49152
    ds_read_b64_tr_b16 v[116:117], v13 offset:49152
    ds_read_b64_tr_b16 v[118:119], v15 offset:49152
    s_waitcnt lgkmcnt(5)
    v_mfma_f32_32x32x16_bf16 v[64:79], v[100:103], v[96:99], v[64:79]
    v_mfma_f32_32x32x16_bf16 v[80:95], v[104:107], v[96:99], v[80:95]
    v_add_u32 v12, 0x10000, v12
    v_add_u32 v13, 0x10000, v13
    v_add_u32 v14, 0x10000, v14
    v_add_u32 v15, 0x10000, v15
    ds_read_b128 v[96:99], v16 offset:128
    ds_read_b64_tr_b16 v[100:101], v12 offset:0
    ds_read_b64_tr_b16 v[102:103], v14 offset:0
    ds_read_b64_tr_b16 v[104:105], v13 offset:0
    ds_read_b64_tr_b16 v[106:107], v15 offset:0
    s_waitcnt lgkmcnt(5)
    v_mfma_f32_32x32x16_bf16 v[64:79], v[112:115], v[108:111], v[64:79]
    v_mfma_f32_32x32x16_bf16 v[80:95], v[116:119], v[108:111], v[80:95]
    ds_read_b128 v[108:111], v16 offset:160
    ds_read_b64_tr_b16 v[112:113], v12 offset:16384
    ds_read_b64_tr_b16 v[114:115], v14 offset:16384
    ds_read_b64_tr_b16 v[116:117], v13 offset:16384
    ds_read_b64_tr_b16 v[118:119], v15 offset:16384
    s_waitcnt lgkmcnt(5)
    v_mfma_f32_32x32x16_bf16 v[64:79], v[100:103], v[96:99], v[64:79]
    v_mfma_f32_32x32x16_bf16 v[80:95], v[104:107], v[96:99], v[80:95]
    ds_read_b128 v[96:99], v16 offset:192
    ds_read_b64_tr_b16 v[100:101], v12 offset:32768
    ds_read_b64_tr_b16 v[102:103], v14 offset:32768
    ds_read_b64_tr_b16 v[104:105], v13 offset:32768
    ds_read_b64_tr_b16 v[106:107], v15 offset:32768
    s_waitcnt lgkmcnt(5)
    v_mfma_f32_32x32x16_bf16 v[64:79], v[112:115], v[108:111], v[64:79]
    v_mfma_f32_32x32x16_bf16 v[80:95], v[116:119], v[108:111], v[80:95]
    ds_read_b128 v[108:111], v16 offset:224
    ds_read_b64_tr_b16 v[112:113], v12 offset:49152
    ds_read_b64_tr_b16 v[114:115], v14 offset:49152
    ds_read_b64_tr_b16 v[116:117], v13 offset:49152
    ds_read_b64_tr_b16 v[118:119], v15 offset:49152
    s_waitcnt lgkmcnt(5)
    v_mfma_f32_32x32x16_bf16 v[64:79], v[100:103], v[96:99], v[64:79]
    v_mfma_f32_32x32x16_bf16 v[80:95], v[104:107], v[96:99], v[80:95]
    s_waitcnt lgkmcnt(0)
    v_mfma_f32_32x32x16_bf16 v[64:79], v[112:115], v[108:111], v[64:79]
    v_mfma_f32_32x32x16_bf16 v[80:95], v[116:119], v[108:111], v[80:95]
    v_subrev_u32 v12, 0x10000, v12
    v_subrev_u32 v13, 0x10000, v13
    v_subrev_u32 v14, 0x10000, v14
    v_subrev_u32 v15, 0x10000, v15
    v_add_f32 v40, v40, v41
    v_add_f32 v42, v42, v43
    v_add_f32 v40, v40, v42
    v_fma_f32 v19, v19, v32, v40
    s_barrier
    s_nop 7
    s_nop 3
    v_and_b32 v43, 31, v1
    v_lshrrev_b32 v44, 5, v1
    v_mul_u32_u24 v40, 1040, v43
    v_lshl_add_u32 v40, v44, 3, v40
    s_lshl_b32 s61, s56, 7
    v_add_u32 v40, s61, v40
    v_cvt_pk_bf16_f32 v64, v64, v65
    v_cvt_pk_bf16_f32 v65, v66, v67
    ds_write_b64 v40, v[64:65] offset:0
    v_cvt_pk_bf16_f32 v68, v68, v69
    v_cvt_pk_bf16_f32 v69, v70, v71
    ds_write_b64 v40, v[68:69] offset:16
    v_cvt_pk_bf16_f32 v72, v72, v73
    v_cvt_pk_bf16_f32 v73, v74, v75
    ds_write_b64 v40, v[72:73] offset:32
    v_cvt_pk_bf16_f32 v76, v76, v77
    v_cvt_pk_bf16_f32 v77, v78, v79
    ds_write_b64 v40, v[76:77] offset:48
    v_cvt_pk_bf16_f32 v80, v80, v81
    v_cvt_pk_bf16_f32 v81, v82, v83
    ds_write_b64 v40, v[80:81] offset:64
    v_cvt_pk_bf16_f32 v84, v84, v85
    v_cvt_pk_bf16_f32 v85, v86, v87
    ds_write_b64 v40, v[84:85] offset:80
    v_cvt_pk_bf16_f32 v88, v88, v89
    v_cvt_pk_bf16_f32 v89, v90, v91
    ds_write_b64 v40, v[88:89] offset:96
    v_cvt_pk_bf16_f32 v92, v92, v93
    v_cvt_pk_bf16_f32 v93, v94, v95
    ds_write_b64 v40, v[92:93] offset:112
    v_mov_b32 v46, v18
    v_mov_b32 v47, v19
    v_lshlrev_b32 v45, 8, v43
    s_lshl_b32 s62, s65, 3
    s_add_u32 s62, s62, 1245184
    s_cmp_lg_u32 s56, 0
    s_cbranch_scc1 Lml_69
    s_mov_b64 exec, 0xffffffff
    buffer_store_dwordx2 v[46:47], v45, s[32:35], s62 offen sc0 sc1
    s_mov_b64 exec, -1
Lml_69:
    s_waitcnt lgkmcnt(0)
    s_barrier
    s_mul_i32 s61, s56, 4160
    v_add_u32 v40, s61, v5
    ds_read_b128 v[96:99], v40 offset:0
    ds_read_b128 v[100:103], v40 offset:1040
    ds_read_b128 v[104:107], v40 offset:2080
    ds_read_b128 v[108:111], v40 offset:3120
    s_lshl_b32 s61, s65, 15
    s_lshl_b32 s62, s56, 12
    s_add_u32 s61, s61, s62
    s_add_u32 s61, s61, 2097152
    s_waitcnt lgkmcnt(3)
    buffer_store_dwordx4 v[96:99], v5, s[32:35], s61 offen offset:0 sc0 sc1
    s_waitcnt lgkmcnt(2)
    buffer_store_dwordx4 v[100:103], v5, s[32:35], s61 offen offset:1024 sc0 sc1
    s_waitcnt lgkmcnt(1)
    buffer_store_dwordx4 v[104:107], v5, s[32:35], s61 offen offset:2048 sc0 sc1
    s_waitcnt lgkmcnt(0)
    buffer_store_dwordx4 v[108:111], v5, s[32:35], s61 offen offset:3072 sc0 sc1
    s_waitcnt vmcnt(0)
    s_barrier
    s_cmp_lg_u32 s56, 0
    s_cbranch_scc1 Lpf_70
    v_lshlrev_b32 v40, 14, v1
    v_mov_b32 v41, 0
    s_lshl_b32 s61, s65, 2
    s_add_u32 s61, s61, 0
    s_mov_b64 exec, 0xffffffff
    buffer_store_dword v41, v40, s[32:35], s61 offen sc0 sc1
    s_mov_b64 exec, -1
Lpf_70:
    s_mov_b32 s36, s24
    s_mov_b32 s37, s25
    s_and_b32 s37, s37, 0xffff
    s_mov_b32 s38, 4194304
    s_mov_b32 s39, 0x00020000
    s_lshl_b32 s61, s56, 14
    s_lshl_b32 s62, s65, 17
    s_add_u32 s62, s62, s61
    s_mul_i32 s63, s65, 5
    s_lshl_b32 s64, s56, 1
    s_add_u32 s63, s63, s64
    s_add_u32 s64, s63, 0
    s_and_b32 s64, s64, 15
    s_and_b32 s100, s64, 3
    s_lshl_b32 s100, s100, 6
    s_lshr_b32 s101, s64, 3
    s_lshl_b32 s101, s101, 5
    s_or_b32 s100, s100, s101
    s_lshl_b32 s64, s64, 10
    s_add_u32 m0, s61, s64
    v_xor_b32 v52, s100, v5
    s_add_u32 s64, s64, s62
    buffer_load_dwordx4 v52, s[36:39], s64 offen nt lds
    s_add_u32 s64, s63, 1
    s_and_b32 s64, s64, 15
    s_and_b32 s100, s64, 3
    s_lshl_b32 s100, s100, 6
    s_lshr_b32 s101, s64, 3
    s_lshl_b32 s101, s101, 5
    s_or_b32 s100, s100, s101
    s_lshl_b32 s64, s64, 10
    s_add_u32 m0, s61, s64
    v_xor_b32 v53, s100, v5
    s_add_u32 s64, s64, s62
    buffer_load_dwordx4 v53, s[36:39], s64 offen nt lds
    s_add_u32 s64, s63, 2
    s_and_b32 s64, s64, 15
    s_and_b32 s100, s64, 3
    s_lshl_b32 s100, s100, 6
    s_lshr_b32 s101, s64, 3
    s_lshl_b32 s101, s101, 5
    s_or_b32 s100, s100, s101
    s_lshl_b32 s64, s64, 10
    s_add_u32 m0, s61, s64
    v_xor_b32 v52, s100, v5
    s_add_u32 s64, s64, s62
    buffer_load_dwordx4 v52, s[36:39], s64 offen nt lds
    s_add_u32 s64, s63, 3
    s_and_b32 s64, s64, 15
    s_and_b32 s100, s64, 3
    s_lshl_b32 s100, s100, 6
    s_lshr_b32 s101, s64, 3
    s_lshl_b32 s101, s101, 5
    s_or_b32 s100, s100, s101
    s_lshl_b32 s64, s64, 10
    s_add_u32 m0, s61, s64
    v_xor_b32 v53, s100, v5
    s_add_u32 s64, s64, s62
    buffer_load_dwordx4 v53, s[36:39], s64 offen nt lds
    s_add_u32 s64, s63, 4
    s_and_b32 s64, s64, 15
    s_and_b32 s100, s64, 3
    s_lshl_b32 s100, s100, 6
    s_lshr_b32 s101, s64, 3
    s_lshl_b32 s101, s101, 5
    s_or_b32 s100, s100, s101
    s_lshl_b32 s64, s64, 10
    s_add_u32 m0, s61, s64
    v_xor_b32 v52, s100, v5
    s_add_u32 s64, s64, s62
    buffer_load_dwordx4 v52, s[36:39], s64 offen nt lds
    s_add_u32 s64, s63, 5
    s_and_b32 s64, s64, 15
    s_and_b32 s100, s64, 3
    s_lshl_b32 s100, s100, 6
    s_lshr_b32 s101, s64, 3
    s_lshl_b32 s101, s101, 5
    s_or_b32 s100, s100, s101
    s_lshl_b32 s64, s64, 10
    s_add_u32 m0, s61, s64
    v_xor_b32 v53, s100, v5
    s_add_u32 s64, s64, s62
    buffer_load_dwordx4 v53, s[36:39], s64 offen nt lds
    s_add_u32 s64, s63, 6
    s_and_b32 s64, s64, 15
    s_and_b32 s100, s64, 3
    s_lshl_b32 s100, s100, 6
    s_lshr_b32 s101, s64, 3
    s_lshl_b32 s101, s101, 5
    s_or_b32 s100, s100, s101
    s_lshl_b32 s64, s64, 10
    s_add_u32 m0, s61, s64
    v_xor_b32 v52, s100, v5
    s_add_u32 s64, s64, s62
    buffer_load_dwordx4 v52, s[36:39], s64 offen nt lds
    s_add_u32 s64, s63, 7
    s_and_b32 s64, s64, 15
    s_and_b32 s100, s64, 3
    s_lshl_b32 s100, s100, 6
    s_lshr_b32 s101, s64, 3
    s_lshl_b32 s101, s101, 5
    s_or_b32 s100, s100, s101
    s_lshl_b32 s64, s64, 10
    s_add_u32 m0, s61, s64
    v_xor_b32 v53, s100, v5
    s_add_u32 s64, s64, s62
    buffer_load_dwordx4 v53, s[36:39], s64 offen nt lds
    s_add_u32 s64, s63, 8
    s_and_b32 s64, s64, 15
    s_and_b32 s100, s64, 3
    s_lshl_b32 s100, s100, 6
    s_lshr_b32 s101, s64, 3
    s_lshl_b32 s101, s101, 5
    s_or_b32 s100, s100, s101
    s_lshl_b32 s64, s64, 10
    s_add_u32 m0, s61, s64
    v_xor_b32 v52, s100, v5
    s_add_u32 s64, s64, s62
    buffer_load_dwordx4 v52, s[36:39], s64 offen nt lds
    s_add_u32 s64, s63, 9
    s_and_b32 s64, s64, 15
    s_and_b32 s100, s64, 3
    s_lshl_b32 s100, s100, 6
    s_lshr_b32 s101, s64, 3
    s_lshl_b32 s101, s101, 5
    s_or_b32 s100, s100, s101
    s_lshl_b32 s64, s64, 10
    s_add_u32 m0, s61, s64
    v_xor_b32 v53, s100, v5
    s_add_u32 s64, s64, s62
    buffer_load_dwordx4 v53, s[36:39], s64 offen nt lds
    s_add_u32 s64, s63, 10
    s_and_b32 s64, s64, 15
    s_and_b32 s100, s64, 3
    s_lshl_b32 s100, s100, 6
    s_lshr_b32 s101, s64, 3
    s_lshl_b32 s101, s101, 5
    s_or_b32 s100, s100, s101
    s_lshl_b32 s64, s64, 10
    s_add_u32 m0, s61, s64
    v_xor_b32 v52, s100, v5
    s_add_u32 s64, s64, s62
    buffer_load_dwordx4 v52, s[36:39], s64 offen nt lds
    s_add_u32 s64, s63, 11
    s_and_b32 s64, s64, 15
    s_and_b32 s100, s64, 3
    s_lshl_b32 s100, s100, 6
    s_lshr_b32 s101, s64, 3
    s_lshl_b32 s101, s101, 5
    s_or_b32 s100, s100, s101
    s_lshl_b32 s64, s64, 10
    s_add_u32 m0, s61, s64
    v_xor_b32 v53, s100, v5
    s_add_u32 s64, s64, s62
    buffer_load_dwordx4 v53, s[36:39], s64 offen nt lds
    s_add_u32 s64, s63, 12
    s_and_b32 s64, s64, 15
    s_and_b32 s100, s64, 3
    s_lshl_b32 s100, s100, 6
    s_lshr_b32 s101, s64, 3
    s_lshl_b32 s101, s101, 5
    s_or_b32 s100, s100, s101
    s_lshl_b32 s64, s64, 10
    s_add_u32 m0, s61, s64
    v_xor_b32 v52, s100, v5
    s_add_u32 s64, s64, s62
    buffer_load_dwordx4 v52, s[36:39], s64 offen nt lds
    s_add_u32 s64, s63, 13
    s_and_b32 s64, s64, 15
    s_and_b32 s100, s64, 3
    s_lshl_b32 s100, s100, 6
    s_lshr_b32 s101, s64, 3
    s_lshl_b32 s101, s101, 5
    s_or_b32 s100, s100, s101
    s_lshl_b32 s64, s64, 10
    s_add_u32 m0, s61, s64
    v_xor_b32 v53, s100, v5
    s_add_u32 s64, s64, s62
    buffer_load_dwordx4 v53, s[36:39], s64 offen nt lds
    s_add_u32 s64, s63, 14
    s_and_b32 s64, s64, 15
    s_and_b32 s100, s64, 3
    s_lshl_b32 s100, s100, 6
    s_lshr_b32 s101, s64, 3
    s_lshl_b32 s101, s101, 5
    s_or_b32 s100, s100, s101
    s_lshl_b32 s64, s64, 10
    s_add_u32 m0, s61, s64
    v_xor_b32 v52, s100, v5
    s_add_u32 s64, s64, s62
    buffer_load_dwordx4 v52, s[36:39], s64 offen nt lds
    s_add_u32 s64, s63, 15
    s_and_b32 s64, s64, 15
    s_and_b32 s100, s64, 3
    s_lshl_b32 s100, s100, 6
    s_lshr_b32 s101, s64, 3
    s_lshl_b32 s101, s101, 5
    s_or_b32 s100, s100, s101
    s_lshl_b32 s64, s64, 10
    s_add_u32 m0, s61, s64
    v_xor_b32 v53, s100, v5
    s_add_u32 s64, s64, s62
    buffer_load_dwordx4 v53, s[36:39], s64 offen nt lds
    s_waitcnt vmcnt(0)
    s_barrier
    v_lshrrev_b32 v40, 2, v3
    v_and_b32 v41, 1, v2
    v_lshlrev_b32 v42, 2, v40
    v_lshl_or_b32 v42, v41, 1, v42
    v_lshl_add_u32 v43, v2, 3, v40
    v_lshlrev_b32 v43, 10, v43
    v_and_b32 v44, 1, v3
    v_lshl_add_u32 v43, v44, 3, v43
    v_bfe_u32 v44, v3, 1, 1
    s_lshl_b32 s61, s56, 3
    s_add_u32 s62, s61, 0
    v_add_u32 v45, s62, v44
    v_xor_b32 v45, v45, v42
    v_lshl_add_u32 v48, v45, 4, v43
    s_add_u32 s62, s61, 2
    v_add_u32 v45, s62, v44
    v_xor_b32 v45, v45, v42
    v_lshl_add_u32 v49, v45, 4, v43
    s_add_u32 s62, s61, 4
    v_add_u32 v45, s62, v44
    v_xor_b32 v45, v45, v42
    v_lshl_add_u32 v50, v45, 4, v43
    s_add_u32 s62, s61, 6
    v_add_u32 v45, s62, v44
    v_xor_b32 v45, v45, v42
    v_lshl_add_u32 v51, v45, 4, v43
    ds_read_b64_tr_b16 v[128:129], v48 offset:0
    ds_read_b64_tr_b16 v[130:131], v48 offset:4096
    ds_read_b64_tr_b16 v[144:145], v49 offset:0
    ds_read_b64_tr_b16 v[146:147], v49 offset:4096
    ds_read_b64_tr_b16 v[160:161], v50 offset:0
    ds_read_b64_tr_b16 v[162:163], v50 offset:4096
    ds_read_b64_tr_b16 v[176:177], v51 offset:0
    ds_read_b64_tr_b16 v[178:179], v51 offset:4096
    s_waitcnt lgkmcnt(0)
    ds_read_b64_tr_b16 v[132:133], v48 offset:32768
    ds_read_b64_tr_b16 v[134:135], v48 offset:36864
    ds_read_b64_tr_b16 v[148:149], v49 offset:32768
    ds_read_b64_tr_b16 v[150:151], v49 offset:36864
    ds_read_b64_tr_b16 v[164:165], v50 offset:32768
    ds_read_b64_tr_b16 v[166:167], v50 offset:36864
    ds_read_b64_tr_b16 v[180:181], v51 offset:32768
    ds_read_b64_tr_b16 v[182:183], v51 offset:36864
    s_waitcnt lgkmcnt(0)
    v_add_u32 v48, 0x10000, v48
    v_add_u32 v49, 0x10000, v49
    v_add_u32 v50, 0x10000, v50
    v_add_u32 v51, 0x10000, v51
    ds_read_b64_tr_b16 v[136:137], v48 offset:0
    ds_read_b64_tr_b16 v[138:139], v48 offset:4096
    ds_read_b64_tr_b16 v[152:153], v49 offset:0
    ds_read_b64_tr_b16 v[154:155], v49 offset:4096
    ds_read_b64_tr_b16 v[168:169], v50 offset:0
    ds_read_b64_tr_b16 v[170:171], v50 offset:4096
    ds_read_b64_tr_b16 v[184:185], v51 offset:0
    ds_read_b64_tr_b16 v[186:187], v51 offset:4096
    s_waitcnt lgkmcnt(0)
    ds_read_b64_tr_b16 v[140:141], v48 offset:32768
    ds_read_b64_tr_b16 v[142:143], v48 offset:36864
    ds_read_b64_tr_b16 v[156:157], v49 offset:32768
    ds_read_b64_tr_b16 v[158:159], v49 offset:36864
    ds_read_b64_tr_b16 v[172:173], v50 offset:32768
    ds_read_b64_tr_b16 v[174:175], v50 offset:36864
    ds_read_b64_tr_b16 v[188:189], v51 offset:32768
    ds_read_b64_tr_b16 v[190:191], v51 offset:36864
    s_waitcnt lgkmcnt(0)
L_t2_head:
    v_lshrrev_b32 v40, 5, v1
    v_lshlrev_b32 v41, 12, v40
    v_and_b32 v42, 31, v1
    v_lshl_add_u32 v41, v42, 4, v41
    v_add_u32 v41, 512, v41
    v_lshlrev_b32 v43, 7, v40
    s_lshl_b32 s61, s56, 9
    s_add_u32 s61, s61, 131072
    v_lshlrev_b32 v46, 3, v1
    v_add_u32 v46, s61, v46
    v_and_b32 v47, 1, v3
    v_lshlrev_b32 v47, 8, v47
    v_lshl_add_u32 v47, v2, 4, v47
    v_add_u32 v47, s61, v47
    s_mov_b32 s70, 1040356334
    v_lshlrev_b32 v48, 4, v1
    v_add_u32 v48, 135168, v48
    v_lshlrev_b32 v49, 3, v40
    v_add_u32 v49, 143360, v49
    s_cmp_ge_u32 s56, 6
    s_cbranch_scc1 Lhnp_71
    s_mov_b32 s62, s56
    s_lshl_b32 s63, s62, 9
    s_add_u32 s63, s63, s93
    s_lshl_b32 s64, s62, 4
    s_add_u32 s64, s64, s93
    s_mov_b32 s92, 0
Lpoll_72:
    buffer_load_dwordx4 v[64:67], v41, s[32:35], s63 offen sc0 sc1
    buffer_load_dwordx2 v[68:69], v43, s[32:35], s64 offen offset:128 sc0 sc1
    s_waitcnt vmcnt(0)
    v_mov_b32 v45, v64
    v_max3_u32 v45, v45, v65, v66
    v_max3_u32 v45, v45, v67, v68
    v_max_u32 v45, v45, v69
    v_cmpx_eq_u32 vcc, -1, v45
    s_cbranch_execz Lpolld_73
    s_sleep 1
    s_add_u32 s92, s92, 1
    s_cmp_lt_u32 s92, 400000
    s_cbranch_scc1 Lpoll_72
Lpolld_73:
    s_mov_b64 exec, -1
    s_lshl_b32 s62, s56, 10
    v_add_u32 v44, s62, v48
    ds_write_b128 v44, v[64:67]
    s_lshl_b32 s62, s56, 4
    v_add_u32 v44, s62, v49
    ds_write_b64 v44, v[68:69]
    s_waitcnt lgkmcnt(0)
Lhnp_71:
    s_barrier
    ds_read_b64 v[88:89], v49 offset:0
    ds_read_b64 v[90:91], v49 offset:16
    ds_read_b64 v[92:93], v49 offset:32
    ds_read_b64 v[94:95], v49 offset:48
    ds_read_b64 v[96:97], v49 offset:64
    ds_read_b64 v[98:99], v49 offset:80
    ds_read_b128 v[64:67], v48 offset:0
    ds_read_b128 v[68:71], v48 offset:1024
    ds_read_b128 v[72:75], v48 offset:2048
    ds_read_b128 v[76:79], v48 offset:3072
    ds_read_b128 v[80:83], v48 offset:4096
    ds_read_b128 v[84:87], v48 offset:5120
    s_waitcnt lgkmcnt(6)
    v_max3_f32 v45, v88, v90, v92
    v_max3_f32 v45, v45, v94, v96
    v_max_f32 v45, v45, v98
    v_mul_f32 v44, s70, v45
    v_fma_f32 v88, v88, s70, -v44
    v_fma_f32 v90, v90, s70, -v44
    v_fma_f32 v92, v92, s70, -v44
    v_fma_f32 v94, v94, s70, -v44
    v_fma_f32 v96, v96, s70, -v44
    v_fma_f32 v98, v98, s70, -v44
    v_exp_f32 v88, v88
    v_exp_f32 v90, v90
    v_exp_f32 v92, v92
    v_exp_f32 v94, v94
    v_exp_f32 v96, v96
    v_exp_f32 v98, v98
    s_nop 0
    v_mul_f32 v45, v88, v89
    v_fmac_f32 v45, v90, v91
    v_fmac_f32 v45, v92, v93
    v_fmac_f32 v45, v94, v95
    v_fmac_f32 v45, v96, v97
    v_fmac_f32 v45, v98, v99
    v_rcp_f32 v45, v45
    s_waitcnt lgkmcnt(0)
    v_mul_f32 v64, v64, v88
    v_mul_f32 v65, v65, v88
    v_mul_f32 v66, v66, v88
    v_mul_f32 v67, v67, v88
    v_fmac_f32 v64, v68, v90
    v_fmac_f32 v65, v69, v90
    v_fmac_f32 v66, v70, v90
    v_fmac_f32 v67, v71, v90
    v_fmac_f32 v64, v72, v92
    v_fmac_f32 v65, v73, v92
    v_fmac_f32 v66, v74, v92
    v_fmac_f32 v67, v75, v92
    v_fmac_f32 v64, v76, v94
    v_fmac_f32 v65, v77, v94
    v_fmac_f32 v66, v78, v94
    v_fmac_f32 v67, v79, v94
    v_fmac_f32 v64, v80, v96
    v_fmac_f32 v65, v81, v96
    v_fmac_f32 v66, v82, v96
    v_fmac_f32 v67, v83, v96
    v_fmac_f32 v64, v84, v98
    v_fmac_f32 v65, v85, v98
    v_fmac_f32 v66, v86, v98
    v_fmac_f32 v67, v87, v98
    v_mul_f32 v64, v64, v45
    v_mul_f32 v65, v65, v45
    v_mul_f32 v66, v66, v45
    v_mul_f32 v67, v67, v45
    v_cvt_pk_bf16_f32 v64, v64, v65
    v_cvt_pk_bf16_f32 v65, v66, v67
    ds_write_b64 v46, v[64:65]
    s_waitcnt lgkmcnt(0)
    ds_read_b128 v[24:27], v47 offset:0
    ds_read_b128 v[28:31], v47 offset:64
    ds_read_b128 v[32:35], v47 offset:128
    ds_read_b128 v[36:39], v47 offset:192
    v_and_b32 v40, 1, v1
    v_lshlrev_b32 v40, 19, v40
    v_lshl_add_u32 v40, v2, 4, v40
    s_lshl_b32 s61, s56, 16
    s_lshl_b32 s62, s65, 6
    s_add_u32 s61, s61, s62
    s_add_u32 s61, s61, 8704
    s_waitcnt lgkmcnt(3)
    v_mfma_f32_16x16x32_bf16 v[8:11], v[128:131], v[24:27], 0
    v_mfma_f32_16x16x32_bf16 v[12:15], v[144:147], v[24:27], 0
    v_mfma_f32_16x16x32_bf16 v[16:19], v[160:163], v[24:27], 0
    v_mfma_f32_16x16x32_bf16 v[20:23], v[176:179], v[24:27], 0
    s_waitcnt lgkmcnt(2)
    v_mfma_f32_16x16x32_bf16 v[8:11], v[132:135], v[28:31], v[8:11]
    v_mfma_f32_16x16x32_bf16 v[12:15], v[148:151], v[28:31], v[12:15]
    v_mfma_f32_16x16x32_bf16 v[16:19], v[164:167], v[28:31], v[16:19]
    v_mfma_f32_16x16x32_bf16 v[20:23], v[180:183], v[28:31], v[20:23]
    s_waitcnt lgkmcnt(1)
    v_mfma_f32_16x16x32_bf16 v[8:11], v[136:139], v[32:35], v[8:11]
    v_mfma_f32_16x16x32_bf16 v[12:15], v[152:155], v[32:35], v[12:15]
    v_mfma_f32_16x16x32_bf16 v[16:19], v[168:171], v[32:35], v[16:19]
    v_mfma_f32_16x16x32_bf16 v[20:23], v[184:187], v[32:35], v[20:23]
    s_waitcnt lgkmcnt(0)
    v_mfma_f32_16x16x32_bf16 v[8:11], v[140:143], v[36:39], v[8:11]
    v_mfma_f32_16x16x32_bf16 v[12:15], v[156:159], v[36:39], v[12:15]
    v_mfma_f32_16x16x32_bf16 v[16:19], v[172:175], v[36:39], v[16:19]
    v_mfma_f32_16x16x32_bf16 v[20:23], v[188:191], v[36:39], v[20:23]
    s_mov_b32 exec_lo, 0x00030003
    s_mov_b32 exec_hi, 0x00030003
    s_nop 2
    s_nop 1
    buffer_store_dwordx4 v[8:11], v40, s[32:35], s61 offen sc0 sc1
    s_add_u32 s61, s61, 16384
    buffer_store_dwordx4 v[12:15], v40, s[32:35], s61 offen sc0 sc1
    s_add_u32 s61, s61, 16384
    buffer_store_dwordx4 v[16:19], v40, s[32:35], s61 offen sc0 sc1
    s_add_u32 s61, s61, 16384
    s_nop 3
    buffer_store_dwordx4 v[20:23], v40, s[32:35], s61 offen sc0 sc1
    s_mov_b64 exec, -1
    s_branch L_final
L_roleT1:
    s_mov_b32 s65, s75
    s_mov_b32 s44, s10
    s_mov_b32 s45, s11
    s_and_b32 s45, s45, 0xffff
    s_mov_b32 s46, 4194304
    s_mov_b32 s47, 0x00020000
    s_cmp_eq_u32 s56, 7
    s_cbranch_scc1 Lt1s_74
    s_lshl_b32 s85, s56, 19
    s_lshl_b32 s86, s65, 8
    s_add_u32 s85, s85, s86
    buffer_load_dwordx4 v[128:131], v4, s[44:47], s85 offen nt
    s_add_u32 s85, s85, 8192
    buffer_load_dwordx4 v[132:135], v4, s[44:47], s85 offen nt
    s_add_u32 s85, s85, 8192
    buffer_load_dwordx4 v[136:139], v4, s[44:47], s85 offen nt
    s_add_u32 s85, s85, 8192
    buffer_load_dwordx4 v[140:143], v4, s[44:47], s85 offen nt
    s_add_u32 s85, s85, 8192
    s_waitcnt vmcnt(4)
    v_perm_b32 v232, v196, v192, s68
    v_perm_b32 v233, v196, v192, s69
    v_perm_b32 v234, v197, v193, s68
    v_perm_b32 v235, v197, v193, s69
    v_perm_b32 v236, v198, v194, s68
    v_perm_b32 v237, v198, v194, s69
    v_perm_b32 v238, v199, v195, s68
    v_perm_b32 v239, v199, v195, s69
    v_dot2_f32_bf16 v212, v232, v208, 0
    v_dot2_f32_bf16 v213, v233, v208, 0
    v_dot2_f32_bf16 v214, v234, v208, 0
    v_dot2_f32_bf16 v215, v235, v208, 0
    v_dot2_f32_bf16 v216, v236, v208, 0
    v_dot2_f32_bf16 v217, v237, v208, 0
    v_dot2_f32_bf16 v218, v238, v208, 0
    v_dot2_f32_bf16 v219, v239, v208, 0
    v_dot2_f32_bf16 v220, v232, v210, 0
    v_dot2_f32_bf16 v221, v233, v210, 0
    v_dot2_f32_bf16 v222, v234, v210, 0
    v_dot2_f32_bf16 v223, v235, v210, 0
    v_dot2_f32_bf16 v224, v236, v210, 0
    v_dot2_f32_bf16 v225, v237, v210, 0
    v_dot2_f32_bf16 v226, v238, v210, 0
    v_dot2_f32_bf16 v227, v239, v210, 0
    v_perm_b32 v232, v204, v200, s68
    v_perm_b32 v233, v204, v200, s69
    v_perm_b32 v234, v205, v201, s68
    v_perm_b32 v235, v205, v201, s69
    v_perm_b32 v236, v206, v202, s68
    v_perm_b32 v237, v206, v202, s69
    v_perm_b32 v238, v207, v203, s68
    v_perm_b32 v239, v207, v203, s69
    v_dot2_f32_bf16 v212, v232, v209, v212
    v_dot2_f32_bf16 v213, v233, v209, v213
    v_dot2_f32_bf16 v214, v234, v209, v214
    v_dot2_f32_bf16 v215, v235, v209, v215
    v_dot2_f32_bf16 v216, v236, v209, v216
    v_dot2_f32_bf16 v217, v237, v209, v217
    v_dot2_f32_bf16 v218, v238, v209, v218
    v_dot2_f32_bf16 v219, v239, v209, v219
    v_dot2_f32_bf16 v220, v232, v211, v220
    v_dot2_f32_bf16 v221, v233, v211, v221
    v_dot2_f32_bf16 v222, v234, v211, v222
    v_dot2_f32_bf16 v223, v235, v211, v223
    v_dot2_f32_bf16 v224, v236, v211, v224
    v_dot2_f32_bf16 v225, v237, v211, v225
    v_dot2_f32_bf16 v226, v238, v211, v226
    v_dot2_f32_bf16 v227, v239, v211, v227
    s_nop 2
    v_permlane32_swap_b32 v212, v220
    v_permlane32_swap_b32 v213, v221
    v_permlane32_swap_b32 v214, v222
    v_permlane32_swap_b32 v215, v223
    v_permlane32_swap_b32 v216, v224
    v_permlane32_swap_b32 v217, v225
    v_permlane32_swap_b32 v218, v226
    v_permlane32_swap_b32 v219, v227
    s_nop 1
    v_add_f32 v212, v212, v220
    v_add_f32 v213, v213, v221
    v_add_f32 v214, v214, v222
    v_add_f32 v215, v215, v223
    v_add_f32 v216, v216, v224
    v_add_f32 v217, v217, v225
    v_add_f32 v218, v218, v226
    v_add_f32 v219, v219, v227
    s_nop 1
    v_permlane16_swap_b32 v212, v216
    v_permlane16_swap_b32 v213, v217
    v_permlane16_swap_b32 v214, v218
    v_permlane16_swap_b32 v215, v219
    s_nop 1
    v_add_f32 v212, v212, v216
    v_add_f32 v213, v213, v217
    v_add_f32 v214, v214, v218
    v_add_f32 v215, v215, v219
    s_nop 1
    v_add_f32_dpp v212, v212, v212 row_ror:8 row_mask:0xf bank_mask:0xf
    v_add_f32_dpp v213, v213, v213 row_ror:8 row_mask:0xf bank_mask:0xf
    v_add_f32_dpp v214, v214, v214 row_ror:8 row_mask:0xf bank_mask:0xf
    v_add_f32_dpp v215, v215, v215 row_ror:8 row_mask:0xf bank_mask:0xf
    v_lshrrev_b32 v232, 5, v228
    v_lshlrev_b32 v232, 8, v232
    v_bfe_u32 v233, v228, 4, 1
    v_lshl_add_u32 v232, v233, 4, v232
    v_lshl_add_u32 v232, v230, 5, v232
    s_lshl_b32 s61, s56, 9
    s_add_u32 s61, s61, 131072
    v_add_u32 v232, s61, v232
    ds_write_b128 v232, v[212:215]
    s_waitcnt lgkmcnt(0)
    s_barrier
    s_waitcnt vmcnt(4)
    buffer_load_dwordx4 v[144:147], v4, s[44:47], s85 offen nt
    s_add_u32 s85, s85, 8192
    s_waitcnt vmcnt(4)
    buffer_load_dwordx4 v[148:151], v4, s[44:47], s85 offen nt
    s_add_u32 s85, s85, 8192
    s_waitcnt vmcnt(4)
    buffer_load_dwordx4 v[152:155], v4, s[44:47], s85 offen nt
    s_add_u32 s85, s85, 8192
    s_waitcnt vmcnt(4)
    buffer_load_dwordx4 v[156:159], v4, s[44:47], s85 offen nt
    s_add_u32 s85, s85, 8192
    s_waitcnt vmcnt(4)
    buffer_load_dwordx4 v[160:163], v4, s[44:47], s85 offen nt
    s_add_u32 s85, s85, 8192
    s_waitcnt vmcnt(4)
    buffer_load_dwordx4 v[164:167], v4, s[44:47], s85 offen nt
    s_add_u32 s85, s85, 8192
    s_waitcnt vmcnt(4)
    buffer_load_dwordx4 v[168:171], v4, s[44:47], s85 offen nt
    s_add_u32 s85, s85, 8192
    s_waitcnt vmcnt(4)
    buffer_load_dwordx4 v[172:175], v4, s[44:47], s85 offen nt
    s_add_u32 s85, s85, 8192
    s_waitcnt vmcnt(4)
    buffer_load_dwordx4 v[176:179], v4, s[44:47], s85 offen nt
    s_add_u32 s85, s85, 8192
    s_waitcnt vmcnt(4)
    buffer_load_dwordx4 v[180:183], v4, s[44:47], s85 offen nt
    s_add_u32 s85, s85, 8192
    s_waitcnt vmcnt(4)
    buffer_load_dwordx4 v[184:187], v4, s[44:47], s85 offen nt
    s_add_u32 s85, s85, 8192
    s_waitcnt vmcnt(4)
    buffer_load_dwordx4 v[188:191], v4, s[44:47], s85 offen nt
    s_branch Lt1j_75
Lt1s_74:
    s_setprio 3
    s_waitcnt vmcnt(0)
    v_perm_b32 v232, v196, v192, s68
    v_perm_b32 v233, v196, v192, s69
    v_perm_b32 v234, v197, v193, s68
    v_perm_b32 v235, v197, v193, s69
    v_perm_b32 v236, v198, v194, s68
    v_perm_b32 v237, v198, v194, s69
    v_perm_b32 v238, v199, v195, s68
    v_perm_b32 v239, v199, v195, s69
    v_dot2_f32_bf16 v212, v232, v208, 0
    v_dot2_f32_bf16 v213, v233, v208, 0
    v_dot2_f32_bf16 v214, v234, v208, 0
    v_dot2_f32_bf16 v215, v235, v208, 0
    v_dot2_f32_bf16 v216, v236, v208, 0
    v_dot2_f32_bf16 v217, v237, v208, 0
    v_dot2_f32_bf16 v218, v238, v208, 0
    v_dot2_f32_bf16 v219, v239, v208, 0
    v_dot2_f32_bf16 v220, v232, v210, 0
    v_dot2_f32_bf16 v221, v233, v210, 0
    v_dot2_f32_bf16 v222, v234, v210, 0
    v_dot2_f32_bf16 v223, v235, v210, 0
    v_dot2_f32_bf16 v224, v236, v210, 0
    v_dot2_f32_bf16 v225, v237, v210, 0
    v_dot2_f32_bf16 v226, v238, v210, 0
    v_dot2_f32_bf16 v227, v239, v210, 0
    v_perm_b32 v232, v204, v200, s68
    v_perm_b32 v233, v204, v200, s69
    v_perm_b32 v234, v205, v201, s68
    v_perm_b32 v235, v205, v201, s69
    v_perm_b32 v236, v206, v202, s68
    v_perm_b32 v237, v206, v202, s69
    v_perm_b32 v238, v207, v203, s68
    v_perm_b32 v239, v207, v203, s69
    v_dot2_f32_bf16 v212, v232, v209, v212
    v_dot2_f32_bf16 v213, v233, v209, v213
    v_dot2_f32_bf16 v214, v234, v209, v214
    v_dot2_f32_bf16 v215, v235, v209, v215
    v_dot2_f32_bf16 v216, v236, v209, v216
    v_dot2_f32_bf16 v217, v237, v209, v217
    v_dot2_f32_bf16 v218, v238, v209, v218
    v_dot2_f32_bf16 v219, v239, v209, v219
    v_dot2_f32_bf16 v220, v232, v211, v220
    v_dot2_f32_bf16 v221, v233, v211, v221
    v_dot2_f32_bf16 v222, v234, v211, v222
    v_dot2_f32_bf16 v223, v235, v211, v223
    v_dot2_f32_bf16 v224, v236, v211, v224
    v_dot2_f32_bf16 v225, v237, v211, v225
    v_dot2_f32_bf16 v226, v238, v211, v226
    v_dot2_f32_bf16 v227, v239, v211, v227
    s_nop 2
    v_permlane32_swap_b32 v212, v220
    v_permlane32_swap_b32 v213, v221
    v_permlane32_swap_b32 v214, v222
    v_permlane32_swap_b32 v215, v223
    v_permlane32_swap_b32 v216, v224
    v_permlane32_swap_b32 v217, v225
    v_permlane32_swap_b32 v218, v226
    v_permlane32_swap_b32 v219, v227
    s_nop 1
    v_add_f32 v212, v212, v220
    v_add_f32 v213, v213, v221
    v_add_f32 v214, v214, v222
    v_add_f32 v215, v215, v223
    v_add_f32 v216, v216, v224
    v_add_f32 v217, v217, v225
    v_add_f32 v218, v218, v226
    v_add_f32 v219, v219, v227
    s_nop 1
    v_permlane16_swap_b32 v212, v216
    v_permlane16_swap_b32 v213, v217
    v_permlane16_swap_b32 v214, v218
    v_permlane16_swap_b32 v215, v219
    s_nop 1
    v_add_f32 v212, v212, v216
    v_add_f32 v213, v213, v217
    v_add_f32 v214, v214, v218
    v_add_f32 v215, v215, v219
    s_nop 1
    v_add_f32_dpp v212, v212, v212 row_ror:8 row_mask:0xf bank_mask:0xf
    v_add_f32_dpp v213, v213, v213 row_ror:8 row_mask:0xf bank_mask:0xf
    v_add_f32_dpp v214, v214, v214 row_ror:8 row_mask:0xf bank_mask:0xf
    v_add_f32_dpp v215, v215, v215 row_ror:8 row_mask:0xf bank_mask:0xf
    v_lshrrev_b32 v232, 5, v228
    v_lshlrev_b32 v232, 8, v232
    v_bfe_u32 v233, v228, 4, 1
    v_lshl_add_u32 v232, v233, 4, v232
    v_lshl_add_u32 v232, v230, 5, v232
    s_lshl_b32 s61, s56, 9
    s_add_u32 s61, s61, 131072
    v_add_u32 v232, s61, v232
    ds_write_b128 v232, v[212:215]
    s_waitcnt lgkmcnt(0)
    s_barrier
    v_mov_b32 v48, 1
    v_mov_b32 v49, 0
    s_mov_b64 exec, 1
    buffer_atomic_add v48, v49, s[52:55], 0 offen offset:128 sc1
    s_mov_b64 exec, -1
    v_mov_b32 v234, 0
    buffer_load_dword v235, v234, s[52:55], s91 offen offset:0 sc0 sc1
    v_and_b32 v232, 31, v228
    v_lshlrev_b32 v233, 4, v232
    v_add_u32 v233, 131072, v233
    ds_read_b128 v[192:195], v233 offset:0
    ds_read_b128 v[196:199], v233 offset:512
    ds_read_b128 v[200:203], v233 offset:1024
    ds_read_b128 v[204:207], v233 offset:1536
    ds_read_b128 v[208:211], v233 offset:2048
    ds_read_b128 v[212:215], v233 offset:2560
    ds_read_b128 v[216:219], v233 offset:3072
    ds_read_b128 v[220:223], v233 offset:3584
    s_waitcnt lgkmcnt(6)
    v_add_f32 v192, v192, v196
    v_add_f32 v193, v193, v197
    v_add_f32 v194, v194, v198
    v_add_f32 v195, v195, v199
    s_waitcnt lgkmcnt(5)
    v_add_f32 v192, v192, v200
    v_add_f32 v193, v193, v201
    v_add_f32 v194, v194, v202
    v_add_f32 v195, v195, v203
    s_waitcnt lgkmcnt(4)
    v_add_f32 v192, v192, v204
    v_add_f32 v193, v193, v205
    v_add_f32 v194, v194, v206
    v_add_f32 v195, v195, v207
    s_waitcnt lgkmcnt(3)
    v_add_f32 v192, v192, v208
    v_add_f32 v193, v193, v209
    v_add_f32 v194, v194, v210
    v_add_f32 v195, v195, v211
    s_waitcnt lgkmcnt(2)
    v_add_f32 v192, v192, v212
    v_add_f32 v193, v193, v213
    v_add_f32 v194, v194, v214
    v_add_f32 v195, v195, v215
    s_waitcnt lgkmcnt(1)
    v_add_f32 v192, v192, v216
    v_add_f32 v193, v193, v217
    v_add_f32 v194, v194, v218
    v_add_f32 v195, v195, v219
    s_waitcnt lgkmcnt(0)
    v_add_f32 v192, v192, v220
    v_add_f32 v193, v193, v221
    v_add_f32 v194, v194, v222
    v_add_f32 v195, v195, v223
    v_lshrrev_b32 v233, 4, v232
    v_lshlrev_b32 v233, 10, v233
    v_and_b32 v232, 15, v232
    v_lshl_add_u32 v233, v232, 4, v233
    s_waitcnt vmcnt(0)
    s_mov_b32 s92, 0
Lcf_76:
    v_readfirstlane_b32 s57, v235
    s_nop 3
    s_cmp_lg_u32 s57, 0
    s_cbranch_scc1 Lcfd_77
    s_sleep 2
    buffer_load_dword v235, v234, s[52:55], s91 offen offset:0 sc0 sc1
    s_waitcnt vmcnt(0)
    s_add_u32 s92, s92, 1
    s_cmp_lt_u32 s92, 400000
    s_cbranch_scc1 Lcf_76
Lcfd_77:
    s_mov_b64 exec, 0xffffffff
    buffer_store_dwordx4 v[192:195], v233, s[32:35], s3 offen sc0 sc1
    s_mov_b64 exec, -1
    s_lshl_b32 s85, s56, 19
    s_lshl_b32 s86, s65, 8
    s_add_u32 s85, s85, s86
    buffer_load_dwordx4 v[128:131], v4, s[44:47], s85 offen nt
    s_add_u32 s85, s85, 8192
    buffer_load_dwordx4 v[132:135], v4, s[44:47], s85 offen nt
    s_add_u32 s85, s85, 8192
    buffer_load_dwordx4 v[136:139], v4, s[44:47], s85 offen nt
    s_add_u32 s85, s85, 8192
    buffer_load_dwordx4 v[140:143], v4, s[44:47], s85 offen nt
    s_add_u32 s85, s85, 8192
    buffer_load_dwordx4 v[144:147], v4, s[44:47], s85 offen nt
    s_add_u32 s85, s85, 8192
    buffer_load_dwordx4 v[148:151], v4, s[44:47], s85 offen nt
    s_add_u32 s85, s85, 8192
    buffer_load_dwordx4 v[152:155], v4, s[44:47], s85 offen nt
    s_add_u32 s85, s85, 8192
    buffer_load_dwordx4 v[156:159], v4, s[44:47], s85 offen nt
    s_add_u32 s85, s85, 8192
    buffer_load_dwordx4 v[160:163], v4, s[44:47], s85 offen nt
    s_add_u32 s85, s85, 8192
    buffer_load_dwordx4 v[164:167], v4, s[44:47], s85 offen nt
    s_add_u32 s85, s85, 8192
    buffer_load_dwordx4 v[168:171], v4, s[44:47], s85 offen nt
    s_add_u32 s85, s85, 8192
    buffer_load_dwordx4 v[172:175], v4, s[44:47], s85 offen nt
    s_add_u32 s85, s85, 8192
    buffer_load_dwordx4 v[176:179], v4, s[44:47], s85 offen nt
    s_add_u32 s85, s85, 8192
    buffer_load_dwordx4 v[180:183], v4, s[44:47], s85 offen nt
    s_add_u32 s85, s85, 8192
    buffer_load_dwordx4 v[184:187], v4, s[44:47], s85 offen nt
    s_add_u32 s85, s85, 8192
    buffer_load_dwordx4 v[188:191], v4, s[44:47], s85 offen nt
    v_mov_b32 v7, 0
    buffer_load_dword v6, v7, s[52:55], 0 offen offset:128 sc0 sc1
    v_lshlrev_b32 v40, 4, v1
    s_lshl_b32 s61, s65, 11
    s_add_u32 s61, s61, 1310720
    s_mov_b32 s92, 0
Lpoll_78:
    buffer_load_dwordx4 v[24:27], v40, s[32:35], s61 offen offset:0 sc0 sc1
    buffer_load_dwordx4 v[32:35], v40, s[32:35], s61 offen offset:1024 sc0 sc1
    s_waitcnt vmcnt(0)
    v_mov_b32 v41, v24
    v_max3_u32 v41, v41, v25, v26
    v_max3_u32 v41, v41, v27, v32
    v_max3_u32 v41, v41, v33, v34
    v_max_u32 v41, v41, v35
    v_cmpx_eq_u32 vcc, -1, v41
    s_cbranch_execz Lpolld_79
    s_sleep 4
    s_add_u32 s92, s92, 1
    s_cmp_lt_u32 s92, 400000
    s_cbranch_scc1 Lpoll_78
Lpolld_79:
    s_mov_b64 exec, -1
    v_mov_b32 v28, v24
    v_mov_b32 v29, v25
    v_mov_b32 v30, v26
    v_mov_b32 v31, v27
    v_mov_b32 v36, v32
    v_mov_b32 v37, v33
    v_mov_b32 v38, v34
    v_mov_b32 v39, v35
    s_nop 1
    v_permlane32_swap_b32 v24, v28
    v_permlane32_swap_b32 v25, v29
    v_permlane32_swap_b32 v26, v30
    v_permlane32_swap_b32 v27, v31
    v_permlane32_swap_b32 v32, v36
    v_permlane32_swap_b32 v33, v37
    v_permlane32_swap_b32 v34, v38
    v_permlane32_swap_b32 v35, v39
    s_nop 1
    v_add_f32 v24, v24, v28
    v_add_f32 v25, v25, v29
    v_add_f32 v26, v26, v30
    v_add_f32 v27, v27, v31
    v_cvt_pk_bf16_f32 v24, v24, v25
    v_cvt_pk_bf16_f32 v25, v26, v27
    v_add_f32 v32, v32, v36
    v_add_f32 v33, v33, v37
    v_add_f32 v34, v34, v38
    v_add_f32 v35, v35, v39
    v_cvt_pk_bf16_f32 v32, v32, v33
    v_cvt_pk_bf16_f32 v33, v34, v35
    s_mov_b32 s92, 0
Lcf_80:
    v_readfirstlane_b32 s57, v6
    s_nop 3
    s_cmp_ge_u32 s57, 64
    s_cbranch_scc1 Lcfd_81
    s_sleep 8
    v_mov_b32 v7, 0
    buffer_load_dword v6, v7, s[52:55], 0 offen offset:128 sc0 sc1
    s_waitcnt vmcnt(0)
    s_add_u32 s92, s92, 1
    s_cmp_lt_u32 s92, 400000
    s_cbranch_scc1 Lcf_80
Lcfd_81:
    v_and_b32 v42, 31, v1
    v_lshlrev_b32 v42, 3, v42
    v_add_u32 v42, 135168, v42
    ds_write_b64 v42, v[24:25] offset:0
    ds_write_b64 v42, v[32:33] offset:256
    s_waitcnt lgkmcnt(0)
    s_setprio 0
Lt1j_75:
    s_barrier
    v_lshlrev_b32 v40, 4, v3
    v_add_u32 v40, 135168, v40
    ds_read_b128 v[56:59], v40
    ds_read_b128 v[60:63], v40 offset:256
    s_waitcnt lgkmcnt(0)
    s_waitcnt vmcnt(15)
    v_dot2_f32_bf16 v192, v128, v56, 0
    v_dot2_f32_bf16 v192, v129, v57, v192
    v_dot2_f32_bf16 v192, v130, v58, v192
    v_dot2_f32_bf16 v192, v131, v59, v192
    v_dot2_f32_bf16 v208, v128, v60, 0
    v_dot2_f32_bf16 v208, v129, v61, v208
    v_dot2_f32_bf16 v208, v130, v62, v208
    v_dot2_f32_bf16 v208, v131, v63, v208
    s_waitcnt vmcnt(14)
    v_dot2_f32_bf16 v193, v132, v56, 0
    v_dot2_f32_bf16 v193, v133, v57, v193
    v_dot2_f32_bf16 v193, v134, v58, v193
    v_dot2_f32_bf16 v193, v135, v59, v193
    v_dot2_f32_bf16 v209, v132, v60, 0
    v_dot2_f32_bf16 v209, v133, v61, v209
    v_dot2_f32_bf16 v209, v134, v62, v209
    v_dot2_f32_bf16 v209, v135, v63, v209
    s_waitcnt vmcnt(13)
    v_dot2_f32_bf16 v194, v136, v56, 0
    v_dot2_f32_bf16 v194, v137, v57, v194
    v_dot2_f32_bf16 v194, v138, v58, v194
    v_dot2_f32_bf16 v194, v139, v59, v194
    v_dot2_f32_bf16 v210, v136, v60, 0
    v_dot2_f32_bf16 v210, v137, v61, v210
    v_dot2_f32_bf16 v210, v138, v62, v210
    v_dot2_f32_bf16 v210, v139, v63, v210
    s_waitcnt vmcnt(12)
    v_dot2_f32_bf16 v195, v140, v56, 0
    v_dot2_f32_bf16 v195, v141, v57, v195
    v_dot2_f32_bf16 v195, v142, v58, v195
    v_dot2_f32_bf16 v195, v143, v59, v195
    v_dot2_f32_bf16 v211, v140, v60, 0
    v_dot2_f32_bf16 v211, v141, v61, v211
    v_dot2_f32_bf16 v211, v142, v62, v211
    v_dot2_f32_bf16 v211, v143, v63, v211
    s_waitcnt vmcnt(11)
    v_dot2_f32_bf16 v196, v144, v56, 0
    v_dot2_f32_bf16 v196, v145, v57, v196
    v_dot2_f32_bf16 v196, v146, v58, v196
    v_dot2_f32_bf16 v196, v147, v59, v196
    v_dot2_f32_bf16 v212, v144, v60, 0
    v_dot2_f32_bf16 v212, v145, v61, v212
    v_dot2_f32_bf16 v212, v146, v62, v212
    v_dot2_f32_bf16 v212, v147, v63, v212
    s_waitcnt vmcnt(10)
    v_dot2_f32_bf16 v197, v148, v56, 0
    v_dot2_f32_bf16 v197, v149, v57, v197
    v_dot2_f32_bf16 v197, v150, v58, v197
    v_dot2_f32_bf16 v197, v151, v59, v197
    v_dot2_f32_bf16 v213, v148, v60, 0
    v_dot2_f32_bf16 v213, v149, v61, v213
    v_dot2_f32_bf16 v213, v150, v62, v213
    v_dot2_f32_bf16 v213, v151, v63, v213
    s_waitcnt vmcnt(9)
    v_dot2_f32_bf16 v198, v152, v56, 0
    v_dot2_f32_bf16 v198, v153, v57, v198
    v_dot2_f32_bf16 v198, v154, v58, v198
    v_dot2_f32_bf16 v198, v155, v59, v198
    v_dot2_f32_bf16 v214, v152, v60, 0
    v_dot2_f32_bf16 v214, v153, v61, v214
    v_dot2_f32_bf16 v214, v154, v62, v214
    v_dot2_f32_bf16 v214, v155, v63, v214
    s_waitcnt vmcnt(8)
    v_dot2_f32_bf16 v199, v156, v56, 0
    v_dot2_f32_bf16 v199, v157, v57, v199
    v_dot2_f32_bf16 v199, v158, v58, v199
    v_dot2_f32_bf16 v199, v159, v59, v199
    v_dot2_f32_bf16 v215, v156, v60, 0
    v_dot2_f32_bf16 v215, v157, v61, v215
    v_dot2_f32_bf16 v215, v158, v62, v215
    v_dot2_f32_bf16 v215, v159, v63, v215
    s_waitcnt vmcnt(7)
    v_dot2_f32_bf16 v200, v160, v56, 0
    v_dot2_f32_bf16 v200, v161, v57, v200
    v_dot2_f32_bf16 v200, v162, v58, v200
    v_dot2_f32_bf16 v200, v163, v59, v200
    v_dot2_f32_bf16 v216, v160, v60, 0
    v_dot2_f32_bf16 v216, v161, v61, v216
    v_dot2_f32_bf16 v216, v162, v62, v216
    v_dot2_f32_bf16 v216, v163, v63, v216
    s_waitcnt vmcnt(6)
    v_dot2_f32_bf16 v201, v164, v56, 0
    v_dot2_f32_bf16 v201, v165, v57, v201
    v_dot2_f32_bf16 v201, v166, v58, v201
    v_dot2_f32_bf16 v201, v167, v59, v201
    v_dot2_f32_bf16 v217, v164, v60, 0
    v_dot2_f32_bf16 v217, v165, v61, v217
    v_dot2_f32_bf16 v217, v166, v62, v217
    v_dot2_f32_bf16 v217, v167, v63, v217
    s_waitcnt vmcnt(5)
    v_dot2_f32_bf16 v202, v168, v56, 0
    v_dot2_f32_bf16 v202, v169, v57, v202
    v_dot2_f32_bf16 v202, v170, v58, v202
    v_dot2_f32_bf16 v202, v171, v59, v202
    v_dot2_f32_bf16 v218, v168, v60, 0
    v_dot2_f32_bf16 v218, v169, v61, v218
    v_dot2_f32_bf16 v218, v170, v62, v218
    v_dot2_f32_bf16 v218, v171, v63, v218
    s_waitcnt vmcnt(4)
    v_dot2_f32_bf16 v203, v172, v56, 0
    v_dot2_f32_bf16 v203, v173, v57, v203
    v_dot2_f32_bf16 v203, v174, v58, v203
    v_dot2_f32_bf16 v203, v175, v59, v203
    v_dot2_f32_bf16 v219, v172, v60, 0
    v_dot2_f32_bf16 v219, v173, v61, v219
    v_dot2_f32_bf16 v219, v174, v62, v219
    v_dot2_f32_bf16 v219, v175, v63, v219
    s_waitcnt vmcnt(3)
    v_dot2_f32_bf16 v204, v176, v56, 0
    v_dot2_f32_bf16 v204, v177, v57, v204
    v_dot2_f32_bf16 v204, v178, v58, v204
    v_dot2_f32_bf16 v204, v179, v59, v204
    v_dot2_f32_bf16 v220, v176, v60, 0
    v_dot2_f32_bf16 v220, v177, v61, v220
    v_dot2_f32_bf16 v220, v178, v62, v220
    v_dot2_f32_bf16 v220, v179, v63, v220
    s_waitcnt vmcnt(2)
    v_dot2_f32_bf16 v205, v180, v56, 0
    v_dot2_f32_bf16 v205, v181, v57, v205
    v_dot2_f32_bf16 v205, v182, v58, v205
    v_dot2_f32_bf16 v205, v183, v59, v205
    v_dot2_f32_bf16 v221, v180, v60, 0
    v_dot2_f32_bf16 v221, v181, v61, v221
    v_dot2_f32_bf16 v221, v182, v62, v221
    v_dot2_f32_bf16 v221, v183, v63, v221
    s_waitcnt vmcnt(1)
    v_dot2_f32_bf16 v206, v184, v56, 0
    v_dot2_f32_bf16 v206, v185, v57, v206
    v_dot2_f32_bf16 v206, v186, v58, v206
    v_dot2_f32_bf16 v206, v187, v59, v206
    v_dot2_f32_bf16 v222, v184, v60, 0
    v_dot2_f32_bf16 v222, v185, v61, v222
    v_dot2_f32_bf16 v222, v186, v62, v222
    v_dot2_f32_bf16 v222, v187, v63, v222
    s_waitcnt vmcnt(0)
    v_dot2_f32_bf16 v207, v188, v56, 0
    v_dot2_f32_bf16 v207, v189, v57, v207
    v_dot2_f32_bf16 v207, v190, v58, v207
    v_dot2_f32_bf16 v207, v191, v59, v207
    v_dot2_f32_bf16 v223, v188, v60, 0
    v_dot2_f32_bf16 v223, v189, v61, v223
    v_dot2_f32_bf16 v223, v190, v62, v223
    v_dot2_f32_bf16 v223, v191, v63, v223
    s_nop 2
    v_add_f32_dpp v192, v192, v192 row_ror:8 row_mask:0xf bank_mask:0xf
    v_add_f32_dpp v193, v193, v193 row_ror:8 row_mask:0xf bank_mask:0xf
    v_add_f32_dpp v194, v194, v194 row_ror:8 row_mask:0xf bank_mask:0xf
    v_add_f32_dpp v195, v195, v195 row_ror:8 row_mask:0xf bank_mask:0xf
    v_add_f32_dpp v196, v196, v196 row_ror:8 row_mask:0xf bank_mask:0xf
    v_add_f32_dpp v197, v197, v197 row_ror:8 row_mask:0xf bank_mask:0xf
    v_add_f32_dpp v198, v198, v198 row_ror:8 row_mask:0xf bank_mask:0xf
    v_add_f32_dpp v199, v199, v199 row_ror:8 row_mask:0xf bank_mask:0xf
    v_add_f32_dpp v200, v200, v200 row_ror:8 row_mask:0xf bank_mask:0xf
    v_add_f32_dpp v201, v201, v201 row_ror:8 row_mask:0xf bank_mask:0xf
    v_add_f32_dpp v202, v202, v202 row_ror:8 row_mask:0xf bank_mask:0xf
    v_add_f32_dpp v203, v203, v203 row_ror:8 row_mask:0xf bank_mask:0xf
    v_add_f32_dpp v204, v204, v204 row_ror:8 row_mask:0xf bank_mask:0xf
    v_add_f32_dpp v205, v205, v205 row_ror:8 row_mask:0xf bank_mask:0xf
    v_add_f32_dpp v206, v206, v206 row_ror:8 row_mask:0xf bank_mask:0xf
    v_add_f32_dpp v207, v207, v207 row_ror:8 row_mask:0xf bank_mask:0xf
    v_add_f32_dpp v208, v208, v208 row_ror:8 row_mask:0xf bank_mask:0xf
    v_add_f32_dpp v209, v209, v209 row_ror:8 row_mask:0xf bank_mask:0xf
    v_add_f32_dpp v210, v210, v210 row_ror:8 row_mask:0xf bank_mask:0xf
    v_add_f32_dpp v211, v211, v211 row_ror:8 row_mask:0xf bank_mask:0xf
    v_add_f32_dpp v212, v212, v212 row_ror:8 row_mask:0xf bank_mask:0xf
    v_add_f32_dpp v213, v213, v213 row_ror:8 row_mask:0xf bank_mask:0xf
    v_add_f32_dpp v214, v214, v214 row_ror:8 row_mask:0xf bank_mask:0xf
    v_add_f32_dpp v215, v215, v215 row_ror:8 row_mask:0xf bank_mask:0xf
    v_add_f32_dpp v216, v216, v216 row_ror:8 row_mask:0xf bank_mask:0xf
    v_add_f32_dpp v217, v217, v217 row_ror:8 row_mask:0xf bank_mask:0xf
    v_add_f32_dpp v218, v218, v218 row_ror:8 row_mask:0xf bank_mask:0xf
    v_add_f32_dpp v219, v219, v219 row_ror:8 row_mask:0xf bank_mask:0xf
    v_add_f32_dpp v220, v220, v220 row_ror:8 row_mask:0xf bank_mask:0xf
    v_add_f32_dpp v221, v221, v221 row_ror:8 row_mask:0xf bank_mask:0xf
    v_add_f32_dpp v222, v222, v222 row_ror:8 row_mask:0xf bank_mask:0xf
    v_add_f32_dpp v223, v223, v223 row_ror:8 row_mask:0xf bank_mask:0xf
    v_add_f32_dpp v192, v192, v192 row_ror:4 row_mask:0xf bank_mask:0xf
    v_add_f32_dpp v193, v193, v193 row_ror:4 row_mask:0xf bank_mask:0xf
    v_add_f32_dpp v194, v194, v194 row_ror:4 row_mask:0xf bank_mask:0xf
    v_add_f32_dpp v195, v195, v195 row_ror:4 row_mask:0xf bank_mask:0xf
    v_add_f32_dpp v196, v196, v196 row_ror:4 row_mask:0xf bank_mask:0xf
    v_add_f32_dpp v197, v197, v197 row_ror:4 row_mask:0xf bank_mask:0xf
    v_add_f32_dpp v198, v198, v198 row_ror:4 row_mask:0xf bank_mask:0xf
    v_add_f32_dpp v199, v199, v199 row_ror:4 row_mask:0xf bank_mask:0xf
    v_add_f32_dpp v200, v200, v200 row_ror:4 row_mask:0xf bank_mask:0xf
    v_add_f32_dpp v201, v201, v201 row_ror:4 row_mask:0xf bank_mask:0xf
    v_add_f32_dpp v202, v202, v202 row_ror:4 row_mask:0xf bank_mask:0xf
    v_add_f32_dpp v203, v203, v203 row_ror:4 row_mask:0xf bank_mask:0xf
    v_add_f32_dpp v204, v204, v204 row_ror:4 row_mask:0xf bank_mask:0xf
    v_add_f32_dpp v205, v205, v205 row_ror:4 row_mask:0xf bank_mask:0xf
    v_add_f32_dpp v206, v206, v206 row_ror:4 row_mask:0xf bank_mask:0xf
    v_add_f32_dpp v207, v207, v207 row_ror:4 row_mask:0xf bank_mask:0xf
    v_add_f32_dpp v208, v208, v208 row_ror:4 row_mask:0xf bank_mask:0xf
    v_add_f32_dpp v209, v209, v209 row_ror:4 row_mask:0xf bank_mask:0xf
    v_add_f32_dpp v210, v210, v210 row_ror:4 row_mask:0xf bank_mask:0xf
    v_add_f32_dpp v211, v211, v211 row_ror:4 row_mask:0xf bank_mask:0xf
    v_add_f32_dpp v212, v212, v212 row_ror:4 row_mask:0xf bank_mask:0xf
    v_add_f32_dpp v213, v213, v213 row_ror:4 row_mask:0xf bank_mask:0xf
    v_add_f32_dpp v214, v214, v214 row_ror:4 row_mask:0xf bank_mask:0xf
    v_add_f32_dpp v215, v215, v215 row_ror:4 row_mask:0xf bank_mask:0xf
    v_add_f32_dpp v216, v216, v216 row_ror:4 row_mask:0xf bank_mask:0xf
    v_add_f32_dpp v217, v217, v217 row_ror:4 row_mask:0xf bank_mask:0xf
    v_add_f32_dpp v218, v218, v218 row_ror:4 row_mask:0xf bank_mask:0xf
    v_add_f32_dpp v219, v219, v219 row_ror:4 row_mask:0xf bank_mask:0xf
    v_add_f32_dpp v220, v220, v220 row_ror:4 row_mask:0xf bank_mask:0xf
    v_add_f32_dpp v221, v221, v221 row_ror:4 row_mask:0xf bank_mask:0xf
    v_add_f32_dpp v222, v222, v222 row_ror:4 row_mask:0xf bank_mask:0xf
    v_add_f32_dpp v223, v223, v223 row_ror:4 row_mask:0xf bank_mask:0xf
    v_add_f32_dpp v192, v192, v192 row_ror:2 row_mask:0xf bank_mask:0xf
    v_add_f32_dpp v193, v193, v193 row_ror:2 row_mask:0xf bank_mask:0xf
    v_add_f32_dpp v194, v194, v194 row_ror:2 row_mask:0xf bank_mask:0xf
    v_add_f32_dpp v195, v195, v195 row_ror:2 row_mask:0xf bank_mask:0xf
    v_add_f32_dpp v196, v196, v196 row_ror:2 row_mask:0xf bank_mask:0xf
    v_add_f32_dpp v197, v197, v197 row_ror:2 row_mask:0xf bank_mask:0xf
    v_add_f32_dpp v198, v198, v198 row_ror:2 row_mask:0xf bank_mask:0xf
    v_add_f32_dpp v199, v199, v199 row_ror:2 row_mask:0xf bank_mask:0xf
    v_add_f32_dpp v200, v200, v200 row_ror:2 row_mask:0xf bank_mask:0xf
    v_add_f32_dpp v201, v201, v201 row_ror:2 row_mask:0xf bank_mask:0xf
    v_add_f32_dpp v202, v202, v202 row_ror:2 row_mask:0xf bank_mask:0xf
    v_add_f32_dpp v203, v203, v203 row_ror:2 row_mask:0xf bank_mask:0xf
    v_add_f32_dpp v204, v204, v204 row_ror:2 row_mask:0xf bank_mask:0xf
    v_add_f32_dpp v205, v205, v205 row_ror:2 row_mask:0xf bank_mask:0xf
    v_add_f32_dpp v206, v206, v206 row_ror:2 row_mask:0xf bank_mask:0xf
    v_add_f32_dpp v207, v207, v207 row_ror:2 row_mask:0xf bank_mask:0xf
    v_add_f32_dpp v208, v208, v208 row_ror:2 row_mask:0xf bank_mask:0xf
    v_add_f32_dpp v209, v209, v209 row_ror:2 row_mask:0xf bank_mask:0xf
    v_add_f32_dpp v210, v210, v210 row_ror:2 row_mask:0xf bank_mask:0xf
    v_add_f32_dpp v211, v211, v211 row_ror:2 row_mask:0xf bank_mask:0xf
    v_add_f32_dpp v212, v212, v212 row_ror:2 row_mask:0xf bank_mask:0xf
    v_add_f32_dpp v213, v213, v213 row_ror:2 row_mask:0xf bank_mask:0xf
    v_add_f32_dpp v214, v214, v214 row_ror:2 row_mask:0xf bank_mask:0xf
    v_add_f32_dpp v215, v215, v215 row_ror:2 row_mask:0xf bank_mask:0xf
    v_add_f32_dpp v216, v216, v216 row_ror:2 row_mask:0xf bank_mask:0xf
    v_add_f32_dpp v217, v217, v217 row_ror:2 row_mask:0xf bank_mask:0xf
    v_add_f32_dpp v218, v218, v218 row_ror:2 row_mask:0xf bank_mask:0xf
    v_add_f32_dpp v219, v219, v219 row_ror:2 row_mask:0xf bank_mask:0xf
    v_add_f32_dpp v220, v220, v220 row_ror:2 row_mask:0xf bank_mask:0xf
    v_add_f32_dpp v221, v221, v221 row_ror:2 row_mask:0xf bank_mask:0xf
    v_add_f32_dpp v222, v222, v222 row_ror:2 row_mask:0xf bank_mask:0xf
    v_add_f32_dpp v223, v223, v223 row_ror:2 row_mask:0xf bank_mask:0xf
    v_add_f32_dpp v192, v192, v192 row_ror:1 row_mask:0xf bank_mask:0xf
    v_add_f32_dpp v193, v193, v193 row_ror:1 row_mask:0xf bank_mask:0xf
    v_add_f32_dpp v194, v194, v194 row_ror:1 row_mask:0xf bank_mask:0xf
    v_add_f32_dpp v195, v195, v195 row_ror:1 row_mask:0xf bank_mask:0xf
    v_add_f32_dpp v196, v196, v196 row_ror:1 row_mask:0xf bank_mask:0xf
    v_add_f32_dpp v197, v197, v197 row_ror:1 row_mask:0xf bank_mask:0xf
    v_add_f32_dpp v198, v198, v198 row_ror:1 row_mask:0xf bank_mask:0xf
    v_add_f32_dpp v199, v199, v199 row_ror:1 row_mask:0xf bank_mask:0xf
    v_add_f32_dpp v200, v200, v200 row_ror:1 row_mask:0xf bank_mask:0xf
    v_add_f32_dpp v201, v201, v201 row_ror:1 row_mask:0xf bank_mask:0xf
    v_add_f32_dpp v202, v202, v202 row_ror:1 row_mask:0xf bank_mask:0xf
    v_add_f32_dpp v203, v203, v203 row_ror:1 row_mask:0xf bank_mask:0xf
    v_add_f32_dpp v204, v204, v204 row_ror:1 row_mask:0xf bank_mask:0xf
    v_add_f32_dpp v205, v205, v205 row_ror:1 row_mask:0xf bank_mask:0xf
    v_add_f32_dpp v206, v206, v206 row_ror:1 row_mask:0xf bank_mask:0xf
    v_add_f32_dpp v207, v207, v207 row_ror:1 row_mask:0xf bank_mask:0xf
    v_add_f32_dpp v208, v208, v208 row_ror:1 row_mask:0xf bank_mask:0xf
    v_add_f32_dpp v209, v209, v209 row_ror:1 row_mask:0xf bank_mask:0xf
    v_add_f32_dpp v210, v210, v210 row_ror:1 row_mask:0xf bank_mask:0xf
    v_add_f32_dpp v211, v211, v211 row_ror:1 row_mask:0xf bank_mask:0xf
    v_add_f32_dpp v212, v212, v212 row_ror:1 row_mask:0xf bank_mask:0xf
    v_add_f32_dpp v213, v213, v213 row_ror:1 row_mask:0xf bank_mask:0xf
    v_add_f32_dpp v214, v214, v214 row_ror:1 row_mask:0xf bank_mask:0xf
    v_add_f32_dpp v215, v215, v215 row_ror:1 row_mask:0xf bank_mask:0xf
    v_add_f32_dpp v216, v216, v216 row_ror:1 row_mask:0xf bank_mask:0xf
    v_add_f32_dpp v217, v217, v217 row_ror:1 row_mask:0xf bank_mask:0xf
    v_add_f32_dpp v218, v218, v218 row_ror:1 row_mask:0xf bank_mask:0xf
    v_add_f32_dpp v219, v219, v219 row_ror:1 row_mask:0xf bank_mask:0xf
    v_add_f32_dpp v220, v220, v220 row_ror:1 row_mask:0xf bank_mask:0xf
    v_add_f32_dpp v221, v221, v221 row_ror:1 row_mask:0xf bank_mask:0xf
    v_add_f32_dpp v222, v222, v222 row_ror:1 row_mask:0xf bank_mask:0xf
    v_add_f32_dpp v223, v223, v223 row_ror:1 row_mask:0xf bank_mask:0xf
    s_mov_b32 s70, 1040356334
    v_mul_f32 v192, s70, v192
    v_mul_f32 v193, s70, v193
    v_mul_f32 v194, s70, v194
    v_mul_f32 v195, s70, v195
    v_mul_f32 v196, s70, v196
    v_mul_f32 v197, s70, v197
    v_mul_f32 v198, s70, v198
    v_mul_f32 v199, s70, v199
    v_mul_f32 v200, s70, v200
    v_mul_f32 v201, s70, v201
    v_mul_f32 v202, s70, v202
    v_mul_f32 v203, s70, v203
    v_mul_f32 v204, s70, v204
    v_mul_f32 v205, s70, v205
    v_mul_f32 v206, s70, v206
    v_mul_f32 v207, s70, v207
    v_mul_f32 v208, s70, v208
    v_mul_f32 v209, s70, v209
    v_mul_f32 v210, s70, v210
    v_mul_f32 v211, s70, v211
    v_mul_f32 v212, s70, v212
    v_mul_f32 v213, s70, v213
    v_mul_f32 v214, s70, v214
    v_mul_f32 v215, s70, v215
    v_mul_f32 v216, s70, v216
    v_mul_f32 v217, s70, v217
    v_mul_f32 v218, s70, v218
    v_mul_f32 v219, s70, v219
    v_mul_f32 v220, s70, v220
    v_mul_f32 v221, s70, v221
    v_mul_f32 v222, s70, v222
    v_mul_f32 v223, s70, v223
    s_lshl_b32 s61, s56, 8
    s_add_u32 s61, s61, 139264
    v_lshlrev_b32 v40, 6, v2
    v_add_u32 v40, s61, v40
    s_mov_b64 s[94:95], exec
    s_mov_b32 exec_lo, 0x00010001
    s_mov_b32 exec_hi, 0x00010001
    ds_write_b128 v40, v[192:195] offset:0
    ds_write_b128 v40, v[196:199] offset:16
    ds_write_b128 v40, v[200:203] offset:32
    ds_write_b128 v40, v[204:207] offset:48
    ds_write_b128 v40, v[208:211] offset:2048
    ds_write_b128 v40, v[212:215] offset:2064
    ds_write_b128 v40, v[216:219] offset:2080
    ds_write_b128 v40, v[220:223] offset:2096
    s_mov_b64 exec, s[94:95]
    s_waitcnt lgkmcnt(0)
    s_barrier
    s_cmp_eq_u32 s56, 0
    s_cbranch_scc1 Lqa0_82
    s_barrier
    s_mov_b32 s44, s12
    s_mov_b32 s45, s13
    s_and_b32 s45, s45, 0xffff
    s_mov_b32 s46, 4194304
    s_mov_b32 s47, 0x00020000
    s_lshl_b32 s61, s56, 19
    s_lshl_b32 s62, s65, 8
    s_add_u32 s61, s61, s62
    buffer_load_dwordx4 v[64:67], v4, s[44:47], s61 offen nt
    s_add_u32 s61, s61, 8192
    buffer_load_dwordx4 v[68:71], v4, s[44:47], s61 offen nt
    s_add_u32 s61, s61, 8192
    buffer_load_dwordx4 v[72:75], v4, s[44:47], s61 offen nt
    s_add_u32 s61, s61, 8192
    buffer_load_dwordx4 v[76:79], v4, s[44:47], s61 offen nt
    s_add_u32 s61, s61, 8192
    buffer_load_dwordx4 v[80:83], v4, s[44:47], s61 offen nt
    s_add_u32 s61, s61, 8192
    buffer_load_dwordx4 v[84:87], v4, s[44:47], s61 offen nt
    s_add_u32 s61, s61, 8192
    buffer_load_dwordx4 v[88:91], v4, s[44:47], s61 offen nt
    s_add_u32 s61, s61, 8192
    buffer_load_dwordx4 v[92:95], v4, s[44:47], s61 offen nt
    s_add_u32 s61, s61, 8192
    buffer_load_dwordx4 v[96:99], v4, s[44:47], s61 offen nt
    s_add_u32 s61, s61, 8192
    buffer_load_dwordx4 v[100:103], v4, s[44:47], s61 offen nt
    s_add_u32 s61, s61, 8192
    buffer_load_dwordx4 v[104:107], v4, s[44:47], s61 offen nt
    s_add_u32 s61, s61, 8192
    buffer_load_dwordx4 v[108:111], v4, s[44:47], s61 offen nt
    s_add_u32 s61, s61, 8192
    buffer_load_dwordx4 v[112:115], v4, s[44:47], s61 offen nt
    s_add_u32 s61, s61, 8192
    buffer_load_dwordx4 v[116:119], v4, s[44:47], s61 offen nt
    s_add_u32 s61, s61, 8192
    buffer_load_dwordx4 v[120:123], v4, s[44:47], s61 offen nt
    s_add_u32 s61, s61, 8192
    buffer_load_dwordx4 v[124:127], v4, s[44:47], s61 offen nt
    s_mov_b32 s36, s14
    s_mov_b32 s37, s15
    s_and_b32 s37, s37, 0xffff
    s_mov_b32 s38, 4194304
    s_mov_b32 s39, 0x00020000
    s_lshl_b32 s61, s56, 14
    s_lshl_b32 s62, s65, 17
    s_add_u32 s62, s62, s61
    s_mul_i32 s63, s65, 5
    s_lshl_b32 s64, s56, 1
    s_add_u32 s63, s63, s64
    s_add_u32 s64, s63, 0
    s_and_b32 s64, s64, 15
    s_and_b32 s100, s64, 3
    s_lshl_b32 s100, s100, 6
    s_lshr_b32 s101, s64, 3
    s_lshl_b32 s101, s101, 5
    s_or_b32 s100, s100, s101
    s_lshl_b32 s64, s64, 10
    s_add_u32 m0, s61, s64
    v_xor_b32 v52, s100, v5
    s_add_u32 s64, s64, s62
    buffer_load_dwordx4 v52, s[36:39], s64 offen nt lds
    s_add_u32 s64, s63, 1
    s_and_b32 s64, s64, 15
    s_and_b32 s100, s64, 3
    s_lshl_b32 s100, s100, 6
    s_lshr_b32 s101, s64, 3
    s_lshl_b32 s101, s101, 5
    s_or_b32 s100, s100, s101
    s_lshl_b32 s64, s64, 10
    s_add_u32 m0, s61, s64
    v_xor_b32 v53, s100, v5
    s_add_u32 s64, s64, s62
    buffer_load_dwordx4 v53, s[36:39], s64 offen nt lds
    s_add_u32 s64, s63, 2
    s_and_b32 s64, s64, 15
    s_and_b32 s100, s64, 3
    s_lshl_b32 s100, s100, 6
    s_lshr_b32 s101, s64, 3
    s_lshl_b32 s101, s101, 5
    s_or_b32 s100, s100, s101
    s_lshl_b32 s64, s64, 10
    s_add_u32 m0, s61, s64
    v_xor_b32 v52, s100, v5
    s_add_u32 s64, s64, s62
    buffer_load_dwordx4 v52, s[36:39], s64 offen nt lds
    s_add_u32 s64, s63, 3
    s_and_b32 s64, s64, 15
    s_and_b32 s100, s64, 3
    s_lshl_b32 s100, s100, 6
    s_lshr_b32 s101, s64, 3
    s_lshl_b32 s101, s101, 5
    s_or_b32 s100, s100, s101
    s_lshl_b32 s64, s64, 10
    s_add_u32 m0, s61, s64
    v_xor_b32 v53, s100, v5
    s_add_u32 s64, s64, s62
    buffer_load_dwordx4 v53, s[36:39], s64 offen nt lds
    s_add_u32 s64, s63, 4
    s_and_b32 s64, s64, 15
    s_and_b32 s100, s64, 3
    s_lshl_b32 s100, s100, 6
    s_lshr_b32 s101, s64, 3
    s_lshl_b32 s101, s101, 5
    s_or_b32 s100, s100, s101
    s_lshl_b32 s64, s64, 10
    s_add_u32 m0, s61, s64
    v_xor_b32 v52, s100, v5
    s_add_u32 s64, s64, s62
    buffer_load_dwordx4 v52, s[36:39], s64 offen nt lds
    s_add_u32 s64, s63, 5
    s_and_b32 s64, s64, 15
    s_and_b32 s100, s64, 3
    s_lshl_b32 s100, s100, 6
    s_lshr_b32 s101, s64, 3
    s_lshl_b32 s101, s101, 5
    s_or_b32 s100, s100, s101
    s_lshl_b32 s64, s64, 10
    s_add_u32 m0, s61, s64
    v_xor_b32 v53, s100, v5
    s_add_u32 s64, s64, s62
    buffer_load_dwordx4 v53, s[36:39], s64 offen nt lds
    s_add_u32 s64, s63, 6
    s_and_b32 s64, s64, 15
    s_and_b32 s100, s64, 3
    s_lshl_b32 s100, s100, 6
    s_lshr_b32 s101, s64, 3
    s_lshl_b32 s101, s101, 5
    s_or_b32 s100, s100, s101
    s_lshl_b32 s64, s64, 10
    s_add_u32 m0, s61, s64
    v_xor_b32 v52, s100, v5
    s_add_u32 s64, s64, s62
    buffer_load_dwordx4 v52, s[36:39], s64 offen nt lds
    s_add_u32 s64, s63, 7
    s_and_b32 s64, s64, 15
    s_and_b32 s100, s64, 3
    s_lshl_b32 s100, s100, 6
    s_lshr_b32 s101, s64, 3
    s_lshl_b32 s101, s101, 5
    s_or_b32 s100, s100, s101
    s_lshl_b32 s64, s64, 10
    s_add_u32 m0, s61, s64
    v_xor_b32 v53, s100, v5
    s_add_u32 s64, s64, s62
    buffer_load_dwordx4 v53, s[36:39], s64 offen nt lds
    s_add_u32 s64, s63, 8
    s_and_b32 s64, s64, 15
    s_and_b32 s100, s64, 3
    s_lshl_b32 s100, s100, 6
    s_lshr_b32 s101, s64, 3
    s_lshl_b32 s101, s101, 5
    s_or_b32 s100, s100, s101
    s_lshl_b32 s64, s64, 10
    s_add_u32 m0, s61, s64
    v_xor_b32 v52, s100, v5
    s_add_u32 s64, s64, s62
    buffer_load_dwordx4 v52, s[36:39], s64 offen nt lds
    s_add_u32 s64, s63, 9
    s_and_b32 s64, s64, 15
    s_and_b32 s100, s64, 3
    s_lshl_b32 s100, s100, 6
    s_lshr_b32 s101, s64, 3
    s_lshl_b32 s101, s101, 5
    s_or_b32 s100, s100, s101
    s_lshl_b32 s64, s64, 10
    s_add_u32 m0, s61, s64
    v_xor_b32 v53, s100, v5
    s_add_u32 s64, s64, s62
    buffer_load_dwordx4 v53, s[36:39], s64 offen nt lds
    s_add_u32 s64, s63, 10
    s_and_b32 s64, s64, 15
    s_and_b32 s100, s64, 3
    s_lshl_b32 s100, s100, 6
    s_lshr_b32 s101, s64, 3
    s_lshl_b32 s101, s101, 5
    s_or_b32 s100, s100, s101
    s_lshl_b32 s64, s64, 10
    s_add_u32 m0, s61, s64
    v_xor_b32 v52, s100, v5
    s_add_u32 s64, s64, s62
    buffer_load_dwordx4 v52, s[36:39], s64 offen nt lds
    s_add_u32 s64, s63, 11
    s_and_b32 s64, s64, 15
    s_and_b32 s100, s64, 3
    s_lshl_b32 s100, s100, 6
    s_lshr_b32 s101, s64, 3
    s_lshl_b32 s101, s101, 5
    s_or_b32 s100, s100, s101
    s_lshl_b32 s64, s64, 10
    s_add_u32 m0, s61, s64
    v_xor_b32 v53, s100, v5
    s_add_u32 s64, s64, s62
    buffer_load_dwordx4 v53, s[36:39], s64 offen nt lds
    s_add_u32 s64, s63, 12
    s_and_b32 s64, s64, 15
    s_and_b32 s100, s64, 3
    s_lshl_b32 s100, s100, 6
    s_lshr_b32 s101, s64, 3
    s_lshl_b32 s101, s101, 5
    s_or_b32 s100, s100, s101
    s_lshl_b32 s64, s64, 10
    s_add_u32 m0, s61, s64
    v_xor_b32 v52, s100, v5
    s_add_u32 s64, s64, s62
    buffer_load_dwordx4 v52, s[36:39], s64 offen nt lds
    s_add_u32 s64, s63, 13
    s_and_b32 s64, s64, 15
    s_and_b32 s100, s64, 3
    s_lshl_b32 s100, s100, 6
    s_lshr_b32 s101, s64, 3
    s_lshl_b32 s101, s101, 5
    s_or_b32 s100, s100, s101
    s_lshl_b32 s64, s64, 10
    s_add_u32 m0, s61, s64
    v_xor_b32 v53, s100, v5
    s_add_u32 s64, s64, s62
    buffer_load_dwordx4 v53, s[36:39], s64 offen nt lds
    s_add_u32 s64, s63, 14
    s_and_b32 s64, s64, 15
    s_and_b32 s100, s64, 3
    s_lshl_b32 s100, s100, 6
    s_lshr_b32 s101, s64, 3
    s_lshl_b32 s101, s101, 5
    s_or_b32 s100, s100, s101
    s_lshl_b32 s64, s64, 10
    s_add_u32 m0, s61, s64
    v_xor_b32 v52, s100, v5
    s_add_u32 s64, s64, s62
    buffer_load_dwordx4 v52, s[36:39], s64 offen nt lds
    s_add_u32 s64, s63, 15
    s_and_b32 s64, s64, 15
    s_and_b32 s100, s64, 3
    s_lshl_b32 s100, s100, 6
    s_lshr_b32 s101, s64, 3
    s_lshl_b32 s101, s101, 5
    s_or_b32 s100, s100, s101
    s_lshl_b32 s64, s64, 10
    s_add_u32 m0, s61, s64
    v_xor_b32 v53, s100, v5
    s_add_u32 s64, s64, s62
    buffer_load_dwordx4 v53, s[36:39], s64 offen nt lds
    s_branch Lqaj_83
Lqa0_82:
    v_lshlrev_b32 v40, 5, v1
    v_add_u32 v40, 139264, v40
    ds_read_b128 v[192:195], v40 offset:0
    ds_read_b128 v[196:199], v40 offset:16
    ds_read_b128 v[200:203], v40 offset:2048
    ds_read_b128 v[204:207], v40 offset:2064
    s_waitcnt lgkmcnt(0)
    s_lshl_b32 s61, s65, 10
    s_add_u32 s61, s61, 1146880
    v_cvt_pk_bf16_f32 v208, v192, v193
    v_cvt_pk_bf16_f32 v209, v194, v195
    v_cvt_pk_bf16_f32 v210, v196, v197
    v_cvt_pk_bf16_f32 v211, v198, v199
    buffer_store_dwordx4 v[208:211], v5, s[32:35], s61 offen sc0 sc1
    s_add_u32 s61, s61, 32768
    v_cvt_pk_bf16_f32 v212, v200, v201
    v_cvt_pk_bf16_f32 v213, v202, v203
    v_cvt_pk_bf16_f32 v214, v204, v205
    v_cvt_pk_bf16_f32 v215, v206, v207
    buffer_store_dwordx4 v[212:215], v5, s[32:35], s61 offen sc0 sc1
    s_barrier
    s_mov_b32 s44, s12
    s_mov_b32 s45, s13
    s_and_b32 s45, s45, 0xffff
    s_mov_b32 s46, 4194304
    s_mov_b32 s47, 0x00020000
    s_lshl_b32 s61, s56, 19
    s_lshl_b32 s62, s65, 8
    s_add_u32 s61, s61, s62
    buffer_load_dwordx4 v[64:67], v4, s[44:47], s61 offen nt
    s_add_u32 s61, s61, 8192
    buffer_load_dwordx4 v[68:71], v4, s[44:47], s61 offen nt
    s_add_u32 s61, s61, 8192
    buffer_load_dwordx4 v[72:75], v4, s[44:47], s61 offen nt
    s_add_u32 s61, s61, 8192
    buffer_load_dwordx4 v[76:79], v4, s[44:47], s61 offen nt
    s_add_u32 s61, s61, 8192
    buffer_load_dwordx4 v[80:83], v4, s[44:47], s61 offen nt
    s_add_u32 s61, s61, 8192
    buffer_load_dwordx4 v[84:87], v4, s[44:47], s61 offen nt
    s_add_u32 s61, s61, 8192
    buffer_load_dwordx4 v[88:91], v4, s[44:47], s61 offen nt
    s_add_u32 s61, s61, 8192
    buffer_load_dwordx4 v[92:95], v4, s[44:47], s61 offen nt
    s_add_u32 s61, s61, 8192
    buffer_load_dwordx4 v[96:99], v4, s[44:47], s61 offen nt
    s_add_u32 s61, s61, 8192
    buffer_load_dwordx4 v[100:103], v4, s[44:47], s61 offen nt
    s_add_u32 s61, s61, 8192
    buffer_load_dwordx4 v[104:107], v4, s[44:47], s61 offen nt
    s_add_u32 s61, s61, 8192
    buffer_load_dwordx4 v[108:111], v4, s[44:47], s61 offen nt
    s_add_u32 s61, s61, 8192
    buffer_load_dwordx4 v[112:115], v4, s[44:47], s61 offen nt
    s_add_u32 s61, s61, 8192
    buffer_load_dwordx4 v[116:119], v4, s[44:47], s61 offen nt
    s_add_u32 s61, s61, 8192
    buffer_load_dwordx4 v[120:123], v4, s[44:47], s61 offen nt
    s_add_u32 s61, s61, 8192
    buffer_load_dwordx4 v[124:127], v4, s[44:47], s61 offen nt
    s_mov_b32 s36, s14
    s_mov_b32 s37, s15
    s_and_b32 s37, s37, 0xffff
    s_mov_b32 s38, 4194304
    s_mov_b32 s39, 0x00020000
    s_lshl_b32 s61, s56, 14
    s_lshl_b32 s62, s65, 17
    s_add_u32 s62, s62, s61
    s_mul_i32 s63, s65, 5
    s_lshl_b32 s64, s56, 1
    s_add_u32 s63, s63, s64
    s_add_u32 s64, s63, 0
    s_and_b32 s64, s64, 15
    s_and_b32 s100, s64, 3
    s_lshl_b32 s100, s100, 6
    s_lshr_b32 s101, s64, 3
    s_lshl_b32 s101, s101, 5
    s_or_b32 s100, s100, s101
    s_lshl_b32 s64, s64, 10
    s_add_u32 m0, s61, s64
    v_xor_b32 v52, s100, v5
    s_add_u32 s64, s64, s62
    buffer_load_dwordx4 v52, s[36:39], s64 offen nt lds
    s_add_u32 s64, s63, 1
    s_and_b32 s64, s64, 15
    s_and_b32 s100, s64, 3
    s_lshl_b32 s100, s100, 6
    s_lshr_b32 s101, s64, 3
    s_lshl_b32 s101, s101, 5
    s_or_b32 s100, s100, s101
    s_lshl_b32 s64, s64, 10
    s_add_u32 m0, s61, s64
    v_xor_b32 v53, s100, v5
    s_add_u32 s64, s64, s62
    buffer_load_dwordx4 v53, s[36:39], s64 offen nt lds
    s_add_u32 s64, s63, 2
    s_and_b32 s64, s64, 15
    s_and_b32 s100, s64, 3
    s_lshl_b32 s100, s100, 6
    s_lshr_b32 s101, s64, 3
    s_lshl_b32 s101, s101, 5
    s_or_b32 s100, s100, s101
    s_lshl_b32 s64, s64, 10
    s_add_u32 m0, s61, s64
    v_xor_b32 v52, s100, v5
    s_add_u32 s64, s64, s62
    buffer_load_dwordx4 v52, s[36:39], s64 offen nt lds
    s_add_u32 s64, s63, 3
    s_and_b32 s64, s64, 15
    s_and_b32 s100, s64, 3
    s_lshl_b32 s100, s100, 6
    s_lshr_b32 s101, s64, 3
    s_lshl_b32 s101, s101, 5
    s_or_b32 s100, s100, s101
    s_lshl_b32 s64, s64, 10
    s_add_u32 m0, s61, s64
    v_xor_b32 v53, s100, v5
    s_add_u32 s64, s64, s62
    buffer_load_dwordx4 v53, s[36:39], s64 offen nt lds
    s_add_u32 s64, s63, 4
    s_and_b32 s64, s64, 15
    s_and_b32 s100, s64, 3
    s_lshl_b32 s100, s100, 6
    s_lshr_b32 s101, s64, 3
    s_lshl_b32 s101, s101, 5
    s_or_b32 s100, s100, s101
    s_lshl_b32 s64, s64, 10
    s_add_u32 m0, s61, s64
    v_xor_b32 v52, s100, v5
    s_add_u32 s64, s64, s62
    buffer_load_dwordx4 v52, s[36:39], s64 offen nt lds
    s_add_u32 s64, s63, 5
    s_and_b32 s64, s64, 15
    s_and_b32 s100, s64, 3
    s_lshl_b32 s100, s100, 6
    s_lshr_b32 s101, s64, 3
    s_lshl_b32 s101, s101, 5
    s_or_b32 s100, s100, s101
    s_lshl_b32 s64, s64, 10
    s_add_u32 m0, s61, s64
    v_xor_b32 v53, s100, v5
    s_add_u32 s64, s64, s62
    buffer_load_dwordx4 v53, s[36:39], s64 offen nt lds
    s_add_u32 s64, s63, 6
    s_and_b32 s64, s64, 15
    s_and_b32 s100, s64, 3
    s_lshl_b32 s100, s100, 6
    s_lshr_b32 s101, s64, 3
    s_lshl_b32 s101, s101, 5
    s_or_b32 s100, s100, s101
    s_lshl_b32 s64, s64, 10
    s_add_u32 m0, s61, s64
    v_xor_b32 v52, s100, v5
    s_add_u32 s64, s64, s62
    buffer_load_dwordx4 v52, s[36:39], s64 offen nt lds
    s_add_u32 s64, s63, 7
    s_and_b32 s64, s64, 15
    s_and_b32 s100, s64, 3
    s_lshl_b32 s100, s100, 6
    s_lshr_b32 s101, s64, 3
    s_lshl_b32 s101, s101, 5
    s_or_b32 s100, s100, s101
    s_lshl_b32 s64, s64, 10
    s_add_u32 m0, s61, s64
    v_xor_b32 v53, s100, v5
    s_add_u32 s64, s64, s62
    buffer_load_dwordx4 v53, s[36:39], s64 offen nt lds
    s_add_u32 s64, s63, 8
    s_and_b32 s64, s64, 15
    s_and_b32 s100, s64, 3
    s_lshl_b32 s100, s100, 6
    s_lshr_b32 s101, s64, 3
    s_lshl_b32 s101, s101, 5
    s_or_b32 s100, s100, s101
    s_lshl_b32 s64, s64, 10
    s_add_u32 m0, s61, s64
    v_xor_b32 v52, s100, v5
    s_add_u32 s64, s64, s62
    buffer_load_dwordx4 v52, s[36:39], s64 offen nt lds
    s_add_u32 s64, s63, 9
    s_and_b32 s64, s64, 15
    s_and_b32 s100, s64, 3
    s_lshl_b32 s100, s100, 6
    s_lshr_b32 s101, s64, 3
    s_lshl_b32 s101, s101, 5
    s_or_b32 s100, s100, s101
    s_lshl_b32 s64, s64, 10
    s_add_u32 m0, s61, s64
    v_xor_b32 v53, s100, v5
    s_add_u32 s64, s64, s62
    buffer_load_dwordx4 v53, s[36:39], s64 offen nt lds
    s_add_u32 s64, s63, 10
    s_and_b32 s64, s64, 15
    s_and_b32 s100, s64, 3
    s_lshl_b32 s100, s100, 6
    s_lshr_b32 s101, s64, 3
    s_lshl_b32 s101, s101, 5
    s_or_b32 s100, s100, s101
    s_lshl_b32 s64, s64, 10
    s_add_u32 m0, s61, s64
    v_xor_b32 v52, s100, v5
    s_add_u32 s64, s64, s62
    buffer_load_dwordx4 v52, s[36:39], s64 offen nt lds
    s_add_u32 s64, s63, 11
    s_and_b32 s64, s64, 15
    s_and_b32 s100, s64, 3
    s_lshl_b32 s100, s100, 6
    s_lshr_b32 s101, s64, 3
    s_lshl_b32 s101, s101, 5
    s_or_b32 s100, s100, s101
    s_lshl_b32 s64, s64, 10
    s_add_u32 m0, s61, s64
    v_xor_b32 v53, s100, v5
    s_add_u32 s64, s64, s62
    buffer_load_dwordx4 v53, s[36:39], s64 offen nt lds
    s_add_u32 s64, s63, 12
    s_and_b32 s64, s64, 15
    s_and_b32 s100, s64, 3
    s_lshl_b32 s100, s100, 6
    s_lshr_b32 s101, s64, 3
    s_lshl_b32 s101, s101, 5
    s_or_b32 s100, s100, s101
    s_lshl_b32 s64, s64, 10
    s_add_u32 m0, s61, s64
    v_xor_b32 v52, s100, v5
    s_add_u32 s64, s64, s62
    buffer_load_dwordx4 v52, s[36:39], s64 offen nt lds
    s_add_u32 s64, s63, 13
    s_and_b32 s64, s64, 15
    s_and_b32 s100, s64, 3
    s_lshl_b32 s100, s100, 6
    s_lshr_b32 s101, s64, 3
    s_lshl_b32 s101, s101, 5
    s_or_b32 s100, s100, s101
    s_lshl_b32 s64, s64, 10
    s_add_u32 m0, s61, s64
    v_xor_b32 v53, s100, v5
    s_add_u32 s64, s64, s62
    buffer_load_dwordx4 v53, s[36:39], s64 offen nt lds
    s_add_u32 s64, s63, 14
    s_and_b32 s64, s64, 15
    s_and_b32 s100, s64, 3
    s_lshl_b32 s100, s100, 6
    s_lshr_b32 s101, s64, 3
    s_lshl_b32 s101, s101, 5
    s_or_b32 s100, s100, s101
    s_lshl_b32 s64, s64, 10
    s_add_u32 m0, s61, s64
    v_xor_b32 v52, s100, v5
    s_add_u32 s64, s64, s62
    buffer_load_dwordx4 v52, s[36:39], s64 offen nt lds
    s_add_u32 s64, s63, 15
    s_and_b32 s64, s64, 15
    s_and_b32 s100, s64, 3
    s_lshl_b32 s100, s100, 6
    s_lshr_b32 s101, s64, 3
    s_lshl_b32 s101, s101, 5
    s_or_b32 s100, s100, s101
    s_lshl_b32 s64, s64, 10
    s_add_u32 m0, s61, s64
    v_xor_b32 v53, s100, v5
    s_add_u32 s64, s64, s62
    buffer_load_dwordx4 v53, s[36:39], s64 offen nt lds
Lqaj_83:
    s_waitcnt vmcnt(0)
    s_barrier
    v_lshrrev_b32 v40, 2, v3
    v_and_b32 v41, 1, v2
    v_lshlrev_b32 v42, 2, v40
    v_lshl_or_b32 v42, v41, 1, v42
    v_lshl_add_u32 v43, v2, 3, v40
    v_lshlrev_b32 v43, 10, v43
    v_and_b32 v44, 1, v3
    v_lshl_add_u32 v43, v44, 3, v43
    v_bfe_u32 v44, v3, 1, 1
    s_lshl_b32 s61, s56, 3
    s_add_u32 s62, s61, 0
    v_add_u32 v45, s62, v44
    v_xor_b32 v45, v45, v42
    v_lshl_add_u32 v48, v45, 4, v43
    s_add_u32 s62, s61, 2
    v_add_u32 v45, s62, v44
    v_xor_b32 v45, v45, v42
    v_lshl_add_u32 v49, v45, 4, v43
    s_add_u32 s62, s61, 4
    v_add_u32 v45, s62, v44
    v_xor_b32 v45, v45, v42
    v_lshl_add_u32 v50, v45, 4, v43
    s_add_u32 s62, s61, 6
    v_add_u32 v45, s62, v44
    v_xor_b32 v45, v45, v42
    v_lshl_add_u32 v51, v45, 4, v43
    ds_read_b64_tr_b16 v[128:129], v48 offset:0
    ds_read_b64_tr_b16 v[130:131], v48 offset:4096
    ds_read_b64_tr_b16 v[144:145], v49 offset:0
    ds_read_b64_tr_b16 v[146:147], v49 offset:4096
    ds_read_b64_tr_b16 v[160:161], v50 offset:0
    ds_read_b64_tr_b16 v[162:163], v50 offset:4096
    ds_read_b64_tr_b16 v[176:177], v51 offset:0
    ds_read_b64_tr_b16 v[178:179], v51 offset:4096
    s_waitcnt lgkmcnt(0)
    ds_read_b64_tr_b16 v[132:133], v48 offset:32768
    ds_read_b64_tr_b16 v[134:135], v48 offset:36864
    ds_read_b64_tr_b16 v[148:149], v49 offset:32768
    ds_read_b64_tr_b16 v[150:151], v49 offset:36864
    ds_read_b64_tr_b16 v[164:165], v50 offset:32768
    ds_read_b64_tr_b16 v[166:167], v50 offset:36864
    ds_read_b64_tr_b16 v[180:181], v51 offset:32768
    ds_read_b64_tr_b16 v[182:183], v51 offset:36864
    s_waitcnt lgkmcnt(0)
    v_add_u32 v48, 0x10000, v48
    v_add_u32 v49, 0x10000, v49
    v_add_u32 v50, 0x10000, v50
    v_add_u32 v51, 0x10000, v51
    ds_read_b64_tr_b16 v[136:137], v48 offset:0
    ds_read_b64_tr_b16 v[138:139], v48 offset:4096
    ds_read_b64_tr_b16 v[152:153], v49 offset:0
    ds_read_b64_tr_b16 v[154:155], v49 offset:4096
    ds_read_b64_tr_b16 v[168:169], v50 offset:0
    ds_read_b64_tr_b16 v[170:171], v50 offset:4096
    ds_read_b64_tr_b16 v[184:185], v51 offset:0
    ds_read_b64_tr_b16 v[186:187], v51 offset:4096
    s_waitcnt lgkmcnt(0)
    ds_read_b64_tr_b16 v[140:141], v48 offset:32768
    ds_read_b64_tr_b16 v[142:143], v48 offset:36864
    ds_read_b64_tr_b16 v[156:157], v49 offset:32768
    ds_read_b64_tr_b16 v[158:159], v49 offset:36864
    ds_read_b64_tr_b16 v[172:173], v50 offset:32768
    ds_read_b64_tr_b16 v[174:175], v50 offset:36864
    ds_read_b64_tr_b16 v[188:189], v51 offset:32768
    ds_read_b64_tr_b16 v[190:191], v51 offset:36864
    s_waitcnt lgkmcnt(0)
    s_barrier
    s_cmp_lg_u32 s56, 0
    s_cbranch_scc1 Lwf_84
    v_lshlrev_b32 v40, 2, v1
    s_mov_b64 exec, 0xffffffff
    s_mov_b32 s92, 0
Lpoll_85:
    buffer_load_dword v41, v40, s[32:35], s93 offen offset:0 sc0 sc1
    s_waitcnt vmcnt(0)
    v_mov_b32 v42, v41
    v_cmpx_eq_u32 vcc, -1, v42
    s_cbranch_execz Lpolld_86
    s_sleep 8
    s_add_u32 s92, s92, 1
    s_cmp_lt_u32 s92, 400000
    s_cbranch_scc1 Lpoll_85
Lpolld_86:
    s_mov_b64 exec, -1
Lwf_84:
    s_barrier
    s_lshr_b32 s66, s56, 2
    s_and_b32 s63, s56, 3
    s_lshl_b32 s61, s56, 17
    s_lshl_b32 s62, s65, 10
    s_add_u32 s61, s61, s62
    s_add_u32 s61, s61, 2097152
    v_lshlrev_b32 v40, 3, v3
    s_lshl_b32 s62, s65, 8
    s_lshl_b32 s64, s66, 7
    s_add_u32 s62, s62, s64
    s_add_u32 s62, s62, 1245184
    buffer_load_dwordx2 v[42:43], v40, s[32:35], s62 offen sc0 sc1
    buffer_load_dwordx4 v[192:195], v5, s[32:35], s61 offen sc0 sc1
    s_add_u32 s61, s61, 32768
    buffer_load_dwordx4 v[196:199], v5, s[32:35], s61 offen sc0 sc1
    s_add_u32 s61, s61, 32768
    buffer_load_dwordx4 v[200:203], v5, s[32:35], s61 offen sc0 sc1
    s_add_u32 s61, s61, 32768
    buffer_load_dwordx4 v[204:207], v5, s[32:35], s61 offen sc0 sc1
    s_waitcnt vmcnt(4)
    v_mov_b32 v44, v42
    s_nop 1
    v_max_f32_dpp v44, v44, v44 row_ror:8 row_mask:0xf bank_mask:0xf
    s_nop 1
    v_max_f32_dpp v44, v44, v44 row_ror:4 row_mask:0xf bank_mask:0xf
    s_nop 1
    v_max_f32_dpp v44, v44, v44 row_ror:2 row_mask:0xf bank_mask:0xf
    s_nop 1
    v_max_f32_dpp v44, v44, v44 row_ror:1 row_mask:0xf bank_mask:0xf
    v_sub_f32 v42, v42, v44
    v_exp_f32 v42, v42
    s_nop 0
    v_mul_f32 v43, v43, v42
    s_nop 1
    v_add_f32_dpp v43, v43, v43 row_ror:8 row_mask:0xf bank_mask:0xf
    s_nop 1
    v_add_f32_dpp v43, v43, v43 row_ror:4 row_mask:0xf bank_mask:0xf
    s_nop 1
    v_add_f32_dpp v43, v43, v43 row_ror:2 row_mask:0xf bank_mask:0xf
    s_nop 1
    v_add_f32_dpp v43, v43, v43 row_ror:1 row_mask:0xf bank_mask:0xf
    v_rcp_f32 v43, v43
    s_nop 0
    v_mul_f32 v42, v42, v43
    s_lshl_b32 s63, s63, 2
    s_nop 1
    s_add_u32 s64, s63, 0
    v_readlane_b32 s76, v42, s64
    s_add_u32 s64, s63, 1
    v_readlane_b32 s77, v42, s64
    s_add_u32 s64, s63, 2
    v_readlane_b32 s78, v42, s64
    s_add_u32 s64, s63, 3
    v_readlane_b32 s79, v42, s64
    s_nop 1
    s_waitcnt vmcnt(3)
    v_lshlrev_b32 v48, 16, v192
    v_and_b32 v49, 0xffff0000, v192
    v_lshlrev_b32 v50, 16, v193
    v_and_b32 v51, 0xffff0000, v193
    v_lshlrev_b32 v52, 16, v194
    v_and_b32 v53, 0xffff0000, v194
    v_lshlrev_b32 v54, 16, v195
    v_and_b32 v55, 0xffff0000, v195
    v_mul_f32 v24, s76, v48
    v_mul_f32 v25, s76, v49
    v_mul_f32 v26, s76, v50
    v_mul_f32 v27, s76, v51
    v_mul_f32 v28, s76, v52
    v_mul_f32 v29, s76, v53
    v_mul_f32 v30, s76, v54
    v_mul_f32 v31, s76, v55
    s_waitcnt vmcnt(2)
    v_lshlrev_b32 v48, 16, v196
    v_and_b32 v49, 0xffff0000, v196
    v_lshlrev_b32 v50, 16, v197
    v_and_b32 v51, 0xffff0000, v197
    v_lshlrev_b32 v52, 16, v198
    v_and_b32 v53, 0xffff0000, v198
    v_lshlrev_b32 v54, 16, v199
    v_and_b32 v55, 0xffff0000, v199
    v_fmac_f32 v24, s77, v48
    v_fmac_f32 v25, s77, v49
    v_fmac_f32 v26, s77, v50
    v_fmac_f32 v27, s77, v51
    v_fmac_f32 v28, s77, v52
    v_fmac_f32 v29, s77, v53
    v_fmac_f32 v30, s77, v54
    v_fmac_f32 v31, s77, v55
    s_waitcnt vmcnt(1)
    v_lshlrev_b32 v48, 16, v200
    v_and_b32 v49, 0xffff0000, v200
    v_lshlrev_b32 v50, 16, v201
    v_and_b32 v51, 0xffff0000, v201
    v_lshlrev_b32 v52, 16, v202
    v_and_b32 v53, 0xffff0000, v202
    v_lshlrev_b32 v54, 16, v203
    v_and_b32 v55, 0xffff0000, v203
    v_fmac_f32 v24, s78, v48
    v_fmac_f32 v25, s78, v49
    v_fmac_f32 v26, s78, v50
    v_fmac_f32 v27, s78, v51
    v_fmac_f32 v28, s78, v52
    v_fmac_f32 v29, s78, v53
    v_fmac_f32 v30, s78, v54
    v_fmac_f32 v31, s78, v55
    s_waitcnt vmcnt(0)
    v_lshlrev_b32 v48, 16, v204
    v_and_b32 v49, 0xffff0000, v204
    v_lshlrev_b32 v50, 16, v205
    v_and_b32 v51, 0xffff0000, v205
    v_lshlrev_b32 v52, 16, v206
    v_and_b32 v53, 0xffff0000, v206
    v_lshlrev_b32 v54, 16, v207
    v_and_b32 v55, 0xffff0000, v207
    v_fmac_f32 v24, s79, v48
    v_fmac_f32 v25, s79, v49
    v_fmac_f32 v26, s79, v50
    v_fmac_f32 v27, s79, v51
    v_fmac_f32 v28, s79, v52
    v_fmac_f32 v29, s79, v53
    v_fmac_f32 v30, s79, v54
    v_fmac_f32 v31, s79, v55
    s_lshl_b32 s61, s56, 11
    v_lshlrev_b32 v40, 5, v1
    v_add_u32 v40, s61, v40
    ds_write_b128 v40, v[24:27] offset:16384
    ds_write_b128 v40, v[28:31] offset:16400
    s_waitcnt lgkmcnt(0)
    s_barrier
    v_and_b32 v40, 255, v0
    v_lshlrev_b32 v40, 3, v40
    s_lshl_b32 s61, s66, 13
    v_add_u32 v40, s61, v40
    ds_read_b64 v[24:25], v40 offset:16384
    ds_read_b64 v[26:27], v40 offset:18432
    ds_read_b64 v[28:29], v40 offset:20480
    ds_read_b64 v[30:31], v40 offset:22528
    s_waitcnt lgkmcnt(0)
    v_add_f32 v24, v24, v26
    v_add_f32 v25, v25, v27
    v_add_f32 v24, v24, v28
    v_add_f32 v25, v25, v29
    v_add_f32 v24, v24, v30
    v_add_f32 v25, v25, v31
    v_cvt_pk_bf16_f32 v24, v24, v25
    v_lshlrev_b32 v40, 2, v0
    ds_write_b32 v40, v24 offset:32768
    s_waitcnt lgkmcnt(0)
    s_barrier
    s_lshl_b32 s61, s56, 7
    v_lshlrev_b32 v40, 5, v2
    v_add_u32 v40, s61, v40
    ds_read_b128 v[8:11], v40 offset:32768
    ds_read_b128 v[12:15], v40 offset:32784
    ds_read_b128 v[16:19], v40 offset:33792
    ds_read_b128 v[20:23], v40 offset:33808
    s_waitcnt lgkmcnt(0)
    v_mov_b32 v24, 0
    v_mov_b32 v25, 0
    v_mov_b32 v26, 0
    v_mov_b32 v27, 0
    v_mov_b32 v28, 0
    v_mov_b32 v29, 0
    v_mov_b32 v30, 0
    v_mov_b32 v31, 0
    v_mov_b32 v32, 0
    v_mov_b32 v33, 0
    v_mov_b32 v34, 0
    v_mov_b32 v35, 0
    v_mov_b32 v36, 0
    v_mov_b32 v37, 0
    v_mov_b32 v38, 0
    v_mov_b32 v39, 0
    v_perm_b32 v40, v68, v64, s68
    v_perm_b32 v41, v68, v64, s69
    v_perm_b32 v42, v69, v65, s68
    v_perm_b32 v43, v69, v65, s69
    v_perm_b32 v44, v70, v66, s68
    v_perm_b32 v45, v70, v66, s69
    v_perm_b32 v46, v71, v67, s68
    v_perm_b32 v47, v71, v67, s69
    v_dot2_f32_bf16 v24, v40, v8, v24
    v_dot2_f32_bf16 v25, v41, v8, v25
    v_dot2_f32_bf16 v26, v42, v8, v26
    v_dot2_f32_bf16 v27, v43, v8, v27
    v_dot2_f32_bf16 v28, v44, v8, v28
    v_dot2_f32_bf16 v29, v45, v8, v29
    v_dot2_f32_bf16 v30, v46, v8, v30
    v_dot2_f32_bf16 v31, v47, v8, v31
    v_dot2_f32_bf16 v32, v40, v16, v32
    v_dot2_f32_bf16 v33, v41, v16, v33
    v_dot2_f32_bf16 v34, v42, v16, v34
    v_dot2_f32_bf16 v35, v43, v16, v35
    v_dot2_f32_bf16 v36, v44, v16, v36
    v_dot2_f32_bf16 v37, v45, v16, v37
    v_dot2_f32_bf16 v38, v46, v16, v38
    v_dot2_f32_bf16 v39, v47, v16, v39
    v_perm_b32 v40, v76, v72, s68
    v_perm_b32 v41, v76, v72, s69
    v_perm_b32 v42, v77, v73, s68
    v_perm_b32 v43, v77, v73, s69
    v_perm_b32 v44, v78, v74, s68
    v_perm_b32 v45, v78, v74, s69
    v_perm_b32 v46, v79, v75, s68
    v_perm_b32 v47, v79, v75, s69
    v_dot2_f32_bf16 v24, v40, v9, v24
    v_dot2_f32_bf16 v25, v41, v9, v25
    v_dot2_f32_bf16 v26, v42, v9, v26
    v_dot2_f32_bf16 v27, v43, v9, v27
    v_dot2_f32_bf16 v28, v44, v9, v28
    v_dot2_f32_bf16 v29, v45, v9, v29
    v_dot2_f32_bf16 v30, v46, v9, v30
    v_dot2_f32_bf16 v31, v47, v9, v31
    v_dot2_f32_bf16 v32, v40, v17, v32
    v_dot2_f32_bf16 v33, v41, v17, v33
    v_dot2_f32_bf16 v34, v42, v17, v34
    v_dot2_f32_bf16 v35, v43, v17, v35
    v_dot2_f32_bf16 v36, v44, v17, v36
    v_dot2_f32_bf16 v37, v45, v17, v37
    v_dot2_f32_bf16 v38, v46, v17, v38
    v_dot2_f32_bf16 v39, v47, v17, v39
    v_perm_b32 v40, v84, v80, s68
    v_perm_b32 v41, v84, v80, s69
    v_perm_b32 v42, v85, v81, s68
    v_perm_b32 v43, v85, v81, s69
    v_perm_b32 v44, v86, v82, s68
    v_perm_b32 v45, v86, v82, s69
    v_perm_b32 v46, v87, v83, s68
    v_perm_b32 v47, v87, v83, s69
    v_dot2_f32_bf16 v24, v40, v10, v24
    v_dot2_f32_bf16 v25, v41, v10, v25
    v_dot2_f32_bf16 v26, v42, v10, v26
    v_dot2_f32_bf16 v27, v43, v10, v27
    v_dot2_f32_bf16 v28, v44, v10, v28
    v_dot2_f32_bf16 v29, v45, v10, v29
    v_dot2_f32_bf16 v30, v46, v10, v30
    v_dot2_f32_bf16 v31, v47, v10, v31
    v_dot2_f32_bf16 v32, v40, v18, v32
    v_dot2_f32_bf16 v33, v41, v18, v33
    v_dot2_f32_bf16 v34, v42, v18, v34
    v_dot2_f32_bf16 v35, v43, v18, v35
    v_dot2_f32_bf16 v36, v44, v18, v36
    v_dot2_f32_bf16 v37, v45, v18, v37
    v_dot2_f32_bf16 v38, v46, v18, v38
    v_dot2_f32_bf16 v39, v47, v18, v39
    v_perm_b32 v40, v92, v88, s68
    v_perm_b32 v41, v92, v88, s69
    v_perm_b32 v42, v93, v89, s68
    v_perm_b32 v43, v93, v89, s69
    v_perm_b32 v44, v94, v90, s68
    v_perm_b32 v45, v94, v90, s69
    v_perm_b32 v46, v95, v91, s68
    v_perm_b32 v47, v95, v91, s69
    v_dot2_f32_bf16 v24, v40, v11, v24
    v_dot2_f32_bf16 v25, v41, v11, v25
    v_dot2_f32_bf16 v26, v42, v11, v26
    v_dot2_f32_bf16 v27, v43, v11, v27
    v_dot2_f32_bf16 v28, v44, v11, v28
    v_dot2_f32_bf16 v29, v45, v11, v29
    v_dot2_f32_bf16 v30, v46, v11, v30
    v_dot2_f32_bf16 v31, v47, v11, v31
    v_dot2_f32_bf16 v32, v40, v19, v32
    v_dot2_f32_bf16 v33, v41, v19, v33
    v_dot2_f32_bf16 v34, v42, v19, v34
    v_dot2_f32_bf16 v35, v43, v19, v35
    v_dot2_f32_bf16 v36, v44, v19, v36
    v_dot2_f32_bf16 v37, v45, v19, v37
    v_dot2_f32_bf16 v38, v46, v19, v38
    v_dot2_f32_bf16 v39, v47, v19, v39
    v_perm_b32 v40, v100, v96, s68
    v_perm_b32 v41, v100, v96, s69
    v_perm_b32 v42, v101, v97, s68
    v_perm_b32 v43, v101, v97, s69
    v_perm_b32 v44, v102, v98, s68
    v_perm_b32 v45, v102, v98, s69
    v_perm_b32 v46, v103, v99, s68
    v_perm_b32 v47, v103, v99, s69
    v_dot2_f32_bf16 v24, v40, v12, v24
    v_dot2_f32_bf16 v25, v41, v12, v25
    v_dot2_f32_bf16 v26, v42, v12, v26
    v_dot2_f32_bf16 v27, v43, v12, v27
    v_dot2_f32_bf16 v28, v44, v12, v28
    v_dot2_f32_bf16 v29, v45, v12, v29
    v_dot2_f32_bf16 v30, v46, v12, v30
    v_dot2_f32_bf16 v31, v47, v12, v31
    v_dot2_f32_bf16 v32, v40, v20, v32
    v_dot2_f32_bf16 v33, v41, v20, v33
    v_dot2_f32_bf16 v34, v42, v20, v34
    v_dot2_f32_bf16 v35, v43, v20, v35
    v_dot2_f32_bf16 v36, v44, v20, v36
    v_dot2_f32_bf16 v37, v45, v20, v37
    v_dot2_f32_bf16 v38, v46, v20, v38
    v_dot2_f32_bf16 v39, v47, v20, v39
    v_perm_b32 v40, v108, v104, s68
    v_perm_b32 v41, v108, v104, s69
    v_perm_b32 v42, v109, v105, s68
    v_perm_b32 v43, v109, v105, s69
    v_perm_b32 v44, v110, v106, s68
    v_perm_b32 v45, v110, v106, s69
    v_perm_b32 v46, v111, v107, s68
    v_perm_b32 v47, v111, v107, s69
    v_dot2_f32_bf16 v24, v40, v13, v24
    v_dot2_f32_bf16 v25, v41, v13, v25
    v_dot2_f32_bf16 v26, v42, v13, v26
    v_dot2_f32_bf16 v27, v43, v13, v27
    v_dot2_f32_bf16 v28, v44, v13, v28
    v_dot2_f32_bf16 v29, v45, v13, v29
    v_dot2_f32_bf16 v30, v46, v13, v30
    v_dot2_f32_bf16 v31, v47, v13, v31
    v_dot2_f32_bf16 v32, v40, v21, v32
    v_dot2_f32_bf16 v33, v41, v21, v33
    v_dot2_f32_bf16 v34, v42, v21, v34
    v_dot2_f32_bf16 v35, v43, v21, v35
    v_dot2_f32_bf16 v36, v44, v21, v36
    v_dot2_f32_bf16 v37, v45, v21, v37
    v_dot2_f32_bf16 v38, v46, v21, v38
    v_dot2_f32_bf16 v39, v47, v21, v39
    v_perm_b32 v40, v116, v112, s68
    v_perm_b32 v41, v116, v112, s69
    v_perm_b32 v42, v117, v113, s68
    v_perm_b32 v43, v117, v113, s69
    v_perm_b32 v44, v118, v114, s68
    v_perm_b32 v45, v118, v114, s69
    v_perm_b32 v46, v119, v115, s68
    v_perm_b32 v47, v119, v115, s69
    v_dot2_f32_bf16 v24, v40, v14, v24
    v_dot2_f32_bf16 v25, v41, v14, v25
    v_dot2_f32_bf16 v26, v42, v14, v26
    v_dot2_f32_bf16 v27, v43, v14, v27
    v_dot2_f32_bf16 v28, v44, v14, v28
    v_dot2_f32_bf16 v29, v45, v14, v29
    v_dot2_f32_bf16 v30, v46, v14, v30
    v_dot2_f32_bf16 v31, v47, v14, v31
    v_dot2_f32_bf16 v32, v40, v22, v32
    v_dot2_f32_bf16 v33, v41, v22, v33
    v_dot2_f32_bf16 v34, v42, v22, v34
    v_dot2_f32_bf16 v35, v43, v22, v35
    v_dot2_f32_bf16 v36, v44, v22, v36
    v_dot2_f32_bf16 v37, v45, v22, v37
    v_dot2_f32_bf16 v38, v46, v22, v38
    v_dot2_f32_bf16 v39, v47, v22, v39
    v_perm_b32 v40, v124, v120, s68
    v_perm_b32 v41, v124, v120, s69
    v_perm_b32 v42, v125, v121, s68
    v_perm_b32 v43, v125, v121, s69
    v_perm_b32 v44, v126, v122, s68
    v_perm_b32 v45, v126, v122, s69
    v_perm_b32 v46, v127, v123, s68
    v_perm_b32 v47, v127, v123, s69
    v_dot2_f32_bf16 v24, v40, v15, v24
    v_dot2_f32_bf16 v25, v41, v15, v25
    v_dot2_f32_bf16 v26, v42, v15, v26
    v_dot2_f32_bf16 v27, v43, v15, v27
    v_dot2_f32_bf16 v28, v44, v15, v28
    v_dot2_f32_bf16 v29, v45, v15, v29
    v_dot2_f32_bf16 v30, v46, v15, v30
    v_dot2_f32_bf16 v31, v47, v15, v31
    v_dot2_f32_bf16 v32, v40, v23, v32
    v_dot2_f32_bf16 v33, v41, v23, v33
    v_dot2_f32_bf16 v34, v42, v23, v34
    v_dot2_f32_bf16 v35, v43, v23, v35
    v_dot2_f32_bf16 v36, v44, v23, v36
    v_dot2_f32_bf16 v37, v45, v23, v37
    v_dot2_f32_bf16 v38, v46, v23, v38
    v_dot2_f32_bf16 v39, v47, v23, v39
    s_nop 2
    v_permlane32_swap_b32 v24, v28
    v_permlane32_swap_b32 v25, v29
    v_permlane32_swap_b32 v26, v30
    v_permlane32_swap_b32 v27, v31
    v_permlane32_swap_b32 v32, v36
    v_permlane32_swap_b32 v33, v37
    v_permlane32_swap_b32 v34, v38
    v_permlane32_swap_b32 v35, v39
    s_nop 1
    v_add_f32 v24, v24, v28
    v_add_f32 v25, v25, v29
    v_add_f32 v26, v26, v30
    v_add_f32 v27, v27, v31
    v_add_f32 v32, v32, v36
    v_add_f32 v33, v33, v37
    v_add_f32 v34, v34, v38
    v_add_f32 v35, v35, v39
    s_nop 1
    v_permlane16_swap_b32 v24, v26
    v_permlane16_swap_b32 v25, v27
    v_permlane16_swap_b32 v32, v34
    v_permlane16_swap_b32 v33, v35
    s_nop 1
    v_add_f32 v24, v24, v26
    v_add_f32 v25, v25, v27
    v_add_f32 v32, v32, v34
    v_add_f32 v33, v33, v35
    v_lshlrev_b32 v48, 5, v3
    v_lshl_add_u32 v48, v2, 3, v48
    s_lshl_b32 s61, s56, 9
    v_add_u32 v49, s61, v48
    ds_write_b64 v49, v[24:25] offset:0
    ds_write_b64 v49, v[32:33] offset:4096
    s_waitcnt lgkmcnt(0)
    s_barrier
    v_lshrrev_b32 v40, 5, v1
    v_lshlrev_b32 v40, 12, v40
    v_and_b32 v41, 31, v1
    v_lshl_add_u32 v40, v41, 4, v40
    ds_read_b128 v[192:195], v40 offset:0
    ds_read_b128 v[196:199], v40 offset:512
    ds_read_b128 v[200:203], v40 offset:1024
    ds_read_b128 v[204:207], v40 offset:1536
    ds_read_b128 v[208:211], v40 offset:2048
    ds_read_b128 v[212:215], v40 offset:2560
    ds_read_b128 v[216:219], v40 offset:3072
    ds_read_b128 v[220:223], v40 offset:3584
    s_lshl_b32 s61, s56, 9
    s_add_u32 s61, s61, 131072
    v_lshlrev_b32 v46, 3, v1
    v_add_u32 v46, s61, v46
    v_and_b32 v47, 1, v3
    v_lshlrev_b32 v47, 8, v47
    v_lshl_add_u32 v47, v2, 4, v47
    v_add_u32 v47, s61, v47
    s_waitcnt lgkmcnt(6)
    v_add_f32 v192, v192, v196
    v_add_f32 v193, v193, v197
    v_add_f32 v194, v194, v198
    v_add_f32 v195, v195, v199
    s_waitcnt lgkmcnt(5)
    v_add_f32 v192, v192, v200
    v_add_f32 v193, v193, v201
    v_add_f32 v194, v194, v202
    v_add_f32 v195, v195, v203
    s_waitcnt lgkmcnt(4)
    v_add_f32 v192, v192, v204
    v_add_f32 v193, v193, v205
    v_add_f32 v194, v194, v206
    v_add_f32 v195, v195, v207
    s_waitcnt lgkmcnt(3)
    v_add_f32 v192, v192, v208
    v_add_f32 v193, v193, v209
    v_add_f32 v194, v194, v210
    v_add_f32 v195, v195, v211
    s_waitcnt lgkmcnt(2)
    v_add_f32 v192, v192, v212
    v_add_f32 v193, v193, v213
    v_add_f32 v194, v194, v214
    v_add_f32 v195, v195, v215
    s_waitcnt lgkmcnt(1)
    v_add_f32 v192, v192, v216
    v_add_f32 v193, v193, v217
    v_add_f32 v194, v194, v218
    v_add_f32 v195, v195, v219
    s_waitcnt lgkmcnt(0)
    v_add_f32 v192, v192, v220
    v_add_f32 v193, v193, v221
    v_add_f32 v194, v194, v222
    v_add_f32 v195, v195, v223
    v_cvt_pk_bf16_f32 v192, v192, v193
    v_cvt_pk_bf16_f32 v193, v194, v195
    ds_write_b64 v46, v[192:193]
    s_waitcnt lgkmcnt(0)
    ds_read_b128 v[24:27], v47 offset:0
    ds_read_b128 v[28:31], v47 offset:64
    ds_read_b128 v[32:35], v47 offset:128
    ds_read_b128 v[36:39], v47 offset:192
    v_and_b32 v40, 1, v1
    v_lshlrev_b32 v40, 19, v40
    v_lshl_add_u32 v40, v2, 4, v40
    s_lshl_b32 s61, s56, 16
    s_lshl_b32 s62, s65, 6
    s_add_u32 s61, s61, s62
    s_add_u32 s61, s61, 10752
    s_waitcnt lgkmcnt(3)
    v_mfma_f32_16x16x32_bf16 v[8:11], v[128:131], v[24:27], 0
    v_mfma_f32_16x16x32_bf16 v[12:15], v[144:147], v[24:27], 0
    v_mfma_f32_16x16x32_bf16 v[16:19], v[160:163], v[24:27], 0
    v_mfma_f32_16x16x32_bf16 v[20:23], v[176:179], v[24:27], 0
    s_waitcnt lgkmcnt(2)
    v_mfma_f32_16x16x32_bf16 v[8:11], v[132:135], v[28:31], v[8:11]
    v_mfma_f32_16x16x32_bf16 v[12:15], v[148:151], v[28:31], v[12:15]
    v_mfma_f32_16x16x32_bf16 v[16:19], v[164:167], v[28:31], v[16:19]
    v_mfma_f32_16x16x32_bf16 v[20:23], v[180:183], v[28:31], v[20:23]
    s_waitcnt lgkmcnt(1)
    v_mfma_f32_16x16x32_bf16 v[8:11], v[136:139], v[32:35], v[8:11]
    v_mfma_f32_16x16x32_bf16 v[12:15], v[152:155], v[32:35], v[12:15]
    v_mfma_f32_16x16x32_bf16 v[16:19], v[168:171], v[32:35], v[16:19]
    v_mfma_f32_16x16x32_bf16 v[20:23], v[184:187], v[32:35], v[20:23]
    s_waitcnt lgkmcnt(0)
    v_mfma_f32_16x16x32_bf16 v[8:11], v[140:143], v[36:39], v[8:11]
    v_mfma_f32_16x16x32_bf16 v[12:15], v[156:159], v[36:39], v[12:15]
    v_mfma_f32_16x16x32_bf16 v[16:19], v[172:175], v[36:39], v[16:19]
    v_mfma_f32_16x16x32_bf16 v[20:23], v[188:191], v[36:39], v[20:23]
    s_mov_b32 exec_lo, 0x00030003
    s_mov_b32 exec_hi, 0x00030003
    s_nop 2
    s_nop 1
    buffer_store_dwordx4 v[8:11], v40, s[32:35], s61 offen sc0 sc1
    s_add_u32 s61, s61, 16384
    buffer_store_dwordx4 v[12:15], v40, s[32:35], s61 offen sc0 sc1
    s_add_u32 s61, s61, 16384
    buffer_store_dwordx4 v[16:19], v40, s[32:35], s61 offen sc0 sc1
    s_add_u32 s61, s61, 16384
    s_nop 3
    buffer_store_dwordx4 v[20:23], v40, s[32:35], s61 offen sc0 sc1
    s_mov_b64 exec, -1
    s_branch L_final
L_final:
    s_cmp_ge_u32 s56, 2
    s_cbranch_scc1 L_end
    s_lshr_b32 s66, s75, 5
    s_and_b32 s64, s75, 31
    v_lshlrev_b32 v8, 5, v1
    s_lshl_b32 s61, s56, 11
    s_add_u32 s61, s61, 8704
    s_add_u32 s61, s61, s93
    s_mov_b32 s92, 0
Lpoll_89:
    buffer_load_dwordx4 v[12:15], v8, s[32:35], s61 offen sc0 sc1
    buffer_load_dwordx4 v[16:19], v8, s[32:35], s61 offen offset:16 sc0 sc1
    s_waitcnt vmcnt(0)
    v_mov_b32 v22, v12
    v_max3_u32 v22, v22, v13, v14
    v_max3_u32 v22, v22, v15, v16
    v_max3_u32 v22, v22, v17, v18
    v_max_u32 v22, v22, v19
    v_cmpx_eq_u32 vcc, -1, v22
    s_cbranch_execz Lpolld_90
    s_sleep 2
    s_add_u32 s92, s92, 1
    s_cmp_lt_u32 s92, 400000
    s_cbranch_scc1 Lpoll_89
Lpolld_90:
    s_mov_b64 exec, -1
Lfsk_87:
    s_nop 1
    v_permlane32_swap_b32 v12, v16
    v_permlane32_swap_b32 v13, v17
    v_permlane32_swap_b32 v14, v18
    v_permlane32_swap_b32 v15, v19
    s_nop 1
    v_add_f32 v12, v12, v16
    v_add_f32 v13, v13, v17
    v_add_f32 v14, v14, v18
    v_add_f32 v15, v15, v19
    s_nop 1
    v_permlane16_swap_b32 v12, v14
    v_permlane16_swap_b32 v13, v15
    s_nop 1
    v_add_f32 v12, v12, v14
    v_add_f32 v13, v13, v15
    s_nop 0
    v_add_f32_dpp v12, v12, v12 row_ror:8 row_mask:0xf bank_mask:0xf
    v_add_f32_dpp v13, v13, v13 row_ror:8 row_mask:0xf bank_mask:0xf
    s_nop 0
    v_add_f32_dpp v12, v12, v12 row_ror:4 row_mask:0xf bank_mask:0xf
    v_add_f32_dpp v13, v13, v13 row_ror:4 row_mask:0xf bank_mask:0xf
    s_nop 0
    v_add_f32_dpp v12, v12, v12 quad_perm:[2,3,0,1] row_mask:0xf bank_mask:0xf
    v_add_f32_dpp v13, v13, v13 quad_perm:[2,3,0,1] row_mask:0xf bank_mask:0xf
    v_cvt_pk_bf16_f32 v12, v12, v13
    v_and_b32 v6, 1, v1
    v_lshlrev_b32 v6, 4, v6
    v_lshl_add_u32 v6, v2, 2, v6
    s_lshl_b32 s57, s66, 11
    s_lshl_b32 s58, s64, 5
    s_add_u32 s57, s57, s58
    s_xor_b32 s58, s56, 1
    s_lshl_b32 s58, s58, 10
    s_add_u32 s57, s57, s58
    s_mov_b32 s36, s26
    s_mov_b32 s37, s27
    s_and_b32 s37, s37, 0xffff
    s_mov_b32 s38, 4096
    s_mov_b32 s39, 0x00020000
    s_mov_b32 exec_lo, 0x00030003
    s_mov_b32 exec_hi, 0x00030003
    buffer_store_dword v12, v6, s[36:39], s57 offen
    s_mov_b64 exec, -1
    s_branch L_end
L_end:
    s_endpgm
.section .rodata,"a"
.p2align 6
.amdhsa_kernel concat_heads__compressed_kv_cla__gqa_block_cached__decode_kernel
  .amdhsa_next_free_vgpr 256
  .amdhsa_next_free_sgpr 102
  .amdhsa_accum_offset 256
  .amdhsa_group_segment_fixed_size 0
  .amdhsa_kernarg_size 112
  .amdhsa_user_sgpr_count 2
  .amdhsa_user_sgpr_kernarg_segment_ptr 1
  .amdhsa_system_sgpr_workgroup_id_x 1
.end_amdhsa_kernel
```

```asm
; @launch grid=(256,1,1) block=(512,1,1) lds=163840
.amdgcn_target "amdgcn-amd-amdhsa--gfx950"
.text
.globl concat_heads__compressed_kv_cla__gqa_block_cached__decode_kernel
.p2align 8
.type concat_heads__compressed_kv_cla__gqa_block_cached__decode_kernel,@function
concat_heads__compressed_kv_cla__gqa_block_cached__decode_kernel:
    s_cmp_ge_u32 s2, 256
    s_cbranch_scc1 L_end
    s_load_dwordx16 s[4:19], s[0:1], 0
    s_load_dwordx8 s[20:27], s[0:1], 64
    s_load_dwordx4 s[28:31], s[0:1], 96
    v_lshrrev_b32 v1, 6, v0
    s_lshr_b32 s57, s2, 3
    v_readfirstlane_b32 s56, v1
    s_and_b32 s58, s2, 7
    s_mul_i32 s59, s58, 8
    s_add_u32 s57, s57, s59
    s_and_b32 s57, s57, 31
    s_mov_b32 s65, s57
    s_and_b32 s59, s57, 7
    s_xor_b32 s60, s59, 5
    s_mov_b32 s67, s58
    s_cmp_gt_u32 s58, s59
    s_subb_u32 s67, s67, 0
    s_cmp_gt_u32 s58, s60
    s_subb_u32 s67, s67, 0
    s_cmp_eq_u32 s58, s59
    s_cselect_b32 s74, 1, 0
    s_cmp_eq_u32 s58, s60
    s_cselect_b32 s74, 2, s74
    s_and_b32 s59, s58, 1
    s_bfe_u32 s62, s58, 0x10001
    s_lshr_b32 s60, s58, 2
    s_lshl_b32 s3, s60, 5
    s_add_u32 s3, s3, s65
    s_lshl_b32 s3, s3, 2
    s_add_u32 s3, s3, s62
    s_lshl_b32 s3, s3, 1
    s_add_u32 s3, s3, s59
    s_lshl_b32 s3, s3, 8
    s_add_u32 s3, s3, 1310720
    s_and_b32 s91, s65, 0xfc
    v_and_b32 v228, 63, v0
    v_lshrrev_b32 v229, 3, v228
    v_and_b32 v230, 7, v228
    v_lshlrev_b32 v231, 3, v229
    v_lshlrev_b32 v233, 15, v229
    v_lshl_add_u32 v233, v230, 4, v233
    s_lshl_b32 s61, s56, 6
    s_lshl_b32 s62, s62, 9
    s_add_u32 s61, s61, s62
    s_lshl_b32 s62, s61, 12
    s_lshl_b32 s63, s65, 8
    s_add_u32 s62, s62, s63
    s_lshl_b32 s59, s59, 7
    s_add_u32 s62, s62, s59
    s_mov_b32 s68, 0x05040100
    s_mov_b32 s69, 0x07060302
    s_mov_b32 s38, 4194304
    s_mov_b32 s39, 0x00020000
    s_mov_b32 s42, 2048
    s_mov_b32 s43, 0x00020000
    s_mov_b32 s34, 268435456
    s_mov_b32 s35, 0x00020000
    s_mov_b32 s54, 256
    s_mov_b32 s55, 0x00020000
    s_waitcnt lgkmcnt(0)
    s_mov_b32 s32, s30
    s_and_b32 s33, s31, 0xffff
    s_mov_b32 s52, s28
    s_and_b32 s53, s29, 0xffff
    s_cmp_ge_u32 s2, 8
    s_cbranch_scc1 Lcq_1
    v_mov_b32 v40, -1
    v_mov_b32 v41, -1
    v_mov_b32 v42, -1
    v_mov_b32 v43, -1
    v_lshlrev_b32 v45, 4, v0
    s_lshl_b32 s63, s2, 13
    s_add_u32 s63, s63, 1310720
    buffer_store_dwordx4 v[40:43], v45, s[32:35], s63 offen sc0 sc1
    s_add_u32 s63, s63, 65536
    buffer_store_dwordx4 v[40:43], v45, s[32:35], s63 offen sc0 sc1
    s_waitcnt vmcnt(0)
    s_barrier
    s_cmp_lg_u32 s56, 7
    s_cbranch_scc1 Lcq_1
    v_mov_b32 v45, 1
    v_mov_b32 v46, 0
    s_lshl_b32 s63, s2, 2
    s_mov_b64 exec, 1
    buffer_atomic_add v45, v46, s[52:55], s63 offen offset:0 sc1
    s_mov_b64 exec, -1
Lcq_1:
    s_cmp_eq_u32 s60, 0
    s_cselect_b32 s36, s8, s22
    s_cselect_b32 s37, s9, s23
    s_cselect_b32 s40, s4, s16
    s_cselect_b32 s41, s5, s17
    s_and_b32 s37, s37, 0xffff
    s_and_b32 s41, s41, 0xffff
    buffer_load_dwordx4 v[192:195], v233, s[36:39], s62 offen nt
    s_add_u32 s62, s62, 8192
    buffer_load_dwordx4 v[196:199], v233, s[36:39], s62 offen nt
    s_add_u32 s62, s62, 8192
    buffer_load_dwordx4 v[200:203], v233, s[36:39], s62 offen nt
    s_add_u32 s62, s62, 8192
    buffer_load_dwordx4 v[204:207], v233, s[36:39], s62 offen nt
    buffer_load_dwordx2 v[208:209], v231, s[40:43], s61 offen offset:0
    buffer_load_dwordx2 v[210:211], v231, s[40:43], s61 offen offset:1024
    s_cmp_lg_u32 s74, 0
    s_cbranch_scc1 L_roleA
    s_barrier
    s_mul_i32 s80, s67, 43691
    s_add_u32 s78, s80, 43691
    s_lshr_b32 s80, s80, 10
    s_lshr_b32 s78, s78, 10
    s_sub_u32 s78, s78, s80
    s_add_u32 s79, s78, 26
    s_mul_i32 s81, s67, 26
    s_sub_u32 s81, s81, s78
    v_and_b32 v1, 63, v0
    v_lshrrev_b32 v2, 4, v1
    v_and_b32 v3, 15, v1
    s_lshl_b32 s61, s65, 20
    s_add_u32 s44, s18, s61
    s_addc_u32 s45, s19, 0
    s_and_b32 s45, s45, 0xffff
    s_mov_b32 s46, 34603008
    s_mov_b32 s47, 0x00020000
    s_add_u32 s48, s20, s61
    s_addc_u32 s49, s21, 0
    s_and_b32 s49, s49, 0xffff
    s_mov_b32 s50, 34603008
    s_mov_b32 s51, 0x00020000
    s_lshl_b32 s83, s65, 8
    s_add_u32 s83, s83, 1507328
    v_lshlrev_b32 v4, 4, v1
    s_mov_b32 s70, 1040356334
    v_mov_b32 v60, 0
    v_mov_b32 v10, 512
    s_mul_i32 s88, s65, 252
    s_and_b32 s88, s88, 255
    s_cmp_eq_u32 s56, 7
    s_cbranch_scc1 Lsvc_2
    s_add_u32 s62, s80, s56
    s_add_u32 s62, s62, s88
    s_mov_b32 s71, 0
    s_mov_b32 s72, 0
    s_mov_b32 s84, s62
    s_add_u32 s100, s84, 0
    s_and_b32 s100, s100, 255
    s_lshl_b32 s100, s100, 12
    buffer_load_dwordx4 v[64:67], v4, s[44:47], s100 offen offset:0 nt
    buffer_load_dwordx4 v[68:71], v4, s[44:47], s100 offen offset:1024 nt
    buffer_load_dwordx4 v[72:75], v4, s[44:47], s100 offen offset:2048 nt
    buffer_load_dwordx4 v[76:79], v4, s[44:47], s100 offen offset:3072 nt
    buffer_load_dwordx4 v[80:83], v4, s[48:51], s100 offen offset:0 nt
    buffer_load_dwordx4 v[84:87], v4, s[48:51], s100 offen offset:1024 nt
    buffer_load_dwordx4 v[88:91], v4, s[48:51], s100 offen offset:2048 nt
    buffer_load_dwordx4 v[92:95], v4, s[48:51], s100 offen offset:3072 nt
    s_add_u32 s100, s84, 7
    s_and_b32 s100, s100, 255
    s_lshl_b32 s100, s100, 12
    s_waitcnt vmcnt(8)
    v_perm_b32 v232, v196, v192, s68
    v_perm_b32 v233, v196, v192, s69
    v_perm_b32 v234, v197, v193, s68
    v_perm_b32 v235, v197, v193, s69
    v_perm_b32 v236, v198, v194, s68
    v_perm_b32 v237, v198, v194, s69
    v_perm_b32 v238, v199, v195, s68
    v_perm_b32 v239, v199, v195, s69
    v_dot2_f32_bf16 v212, v232, v208, 0
    v_dot2_f32_bf16 v213, v233, v208, 0
    v_dot2_f32_bf16 v214, v234, v208, 0
    v_dot2_f32_bf16 v215, v235, v208, 0
    v_dot2_f32_bf16 v216, v236, v208, 0
    v_dot2_f32_bf16 v217, v237, v208, 0
    v_dot2_f32_bf16 v218, v238, v208, 0
    v_dot2_f32_bf16 v219, v239, v208, 0
    v_dot2_f32_bf16 v220, v232, v210, 0
    v_dot2_f32_bf16 v221, v233, v210, 0
    v_dot2_f32_bf16 v222, v234, v210, 0
    v_dot2_f32_bf16 v223, v235, v210, 0
    v_dot2_f32_bf16 v224, v236, v210, 0
    v_dot2_f32_bf16 v225, v237, v210, 0
    v_dot2_f32_bf16 v226, v238, v210, 0
    v_dot2_f32_bf16 v227, v239, v210, 0
    v_perm_b32 v232, v204, v200, s68
    v_perm_b32 v233, v204, v200, s69
    v_perm_b32 v234, v205, v201, s68
    v_perm_b32 v235, v205, v201, s69
    v_perm_b32 v236, v206, v202, s68
    v_perm_b32 v237, v206, v202, s69
    v_perm_b32 v238, v207, v203, s68
    v_perm_b32 v239, v207, v203, s69
    v_dot2_f32_bf16 v212, v232, v209, v212
    v_dot2_f32_bf16 v213, v233, v209, v213
    v_dot2_f32_bf16 v214, v234, v209, v214
    v_dot2_f32_bf16 v215, v235, v209, v215
    v_dot2_f32_bf16 v216, v236, v209, v216
    v_dot2_f32_bf16 v217, v237, v209, v217
    v_dot2_f32_bf16 v218, v238, v209, v218
    v_dot2_f32_bf16 v219, v239, v209, v219
    v_dot2_f32_bf16 v220, v232, v211, v220
    v_dot2_f32_bf16 v221, v233, v211, v221
    v_dot2_f32_bf16 v222, v234, v211, v222
    v_dot2_f32_bf16 v223, v235, v211, v223
    v_dot2_f32_bf16 v224, v236, v211, v224
    v_dot2_f32_bf16 v225, v237, v211, v225
    v_dot2_f32_bf16 v226, v238, v211, v226
    v_dot2_f32_bf16 v227, v239, v211, v227
    s_nop 2
    v_permlane32_swap_b32 v212, v220
    v_permlane32_swap_b32 v213, v221
    v_permlane32_swap_b32 v214, v222
    v_permlane32_swap_b32 v215, v223
    v_permlane32_swap_b32 v216, v224
    v_permlane32_swap_b32 v217, v225
    v_permlane32_swap_b32 v218, v226
    v_permlane32_swap_b32 v219, v227
    s_nop 1
    v_add_f32 v212, v212, v220
    v_add_f32 v213, v213, v221
    v_add_f32 v214, v214, v222
    v_add_f32 v215, v215, v223
    v_add_f32 v216, v216, v224
    v_add_f32 v217, v217, v225
    v_add_f32 v218, v218, v226
    v_add_f32 v219, v219, v227
    s_nop 1
    v_permlane16_swap_b32 v212, v216
    v_permlane16_swap_b32 v213, v217
    v_permlane16_swap_b32 v214, v218
    v_permlane16_swap_b32 v215, v219
    s_nop 1
    v_add_f32 v212, v212, v216
    v_add_f32 v213, v213, v217
    v_add_f32 v214, v214, v218
    v_add_f32 v215, v215, v219
    s_nop 1
    v_add_f32_dpp v212, v212, v212 row_ror:8 row_mask:0xf bank_mask:0xf
    v_add_f32_dpp v213, v213, v213 row_ror:8 row_mask:0xf bank_mask:0xf
    v_add_f32_dpp v214, v214, v214 row_ror:8 row_mask:0xf bank_mask:0xf
    v_add_f32_dpp v215, v215, v215 row_ror:8 row_mask:0xf bank_mask:0xf
    v_lshrrev_b32 v232, 5, v228
    v_lshlrev_b32 v232, 8, v232
    v_bfe_u32 v233, v228, 4, 1
    v_lshl_add_u32 v232, v233, 4, v232
    v_lshl_add_u32 v232, v230, 5, v232
    s_lshl_b32 s61, s56, 9
    s_add_u32 s61, s61, 16384
    v_add_u32 v232, s61, v232
    ds_write_b128 v232, v[212:215]
    s_waitcnt lgkmcnt(0)
    s_barrier
    s_waitcnt vmcnt(3)
    buffer_load_dwordx4 v[96:99], v4, s[44:47], s100 offen offset:0 nt
    s_waitcnt vmcnt(3)
    buffer_load_dwordx4 v[100:103], v4, s[44:47], s100 offen offset:1024 nt
    s_waitcnt vmcnt(3)
    buffer_load_dwordx4 v[104:107], v4, s[44:47], s100 offen offset:2048 nt
    s_waitcnt vmcnt(3)
    buffer_load_dwordx4 v[108:111], v4, s[44:47], s100 offen offset:3072 nt
    s_waitcnt vmcnt(3)
    buffer_load_dwordx4 v[112:115], v4, s[48:51], s100 offen offset:0 nt
    s_waitcnt vmcnt(3)
    buffer_load_dwordx4 v[116:119], v4, s[48:51], s100 offen offset:1024 nt
    s_waitcnt vmcnt(3)
    buffer_load_dwordx4 v[120:123], v4, s[48:51], s100 offen offset:2048 nt
    s_waitcnt vmcnt(3)
    buffer_load_dwordx4 v[124:127], v4, s[48:51], s100 offen offset:3072 nt
    s_add_u32 s100, s84, 14
    s_and_b32 s100, s100, 255
    s_lshl_b32 s100, s100, 12
    s_waitcnt vmcnt(3)
    buffer_load_dwordx4 v[128:131], v4, s[44:47], s100 offen offset:0 nt
    s_waitcnt vmcnt(3)
    buffer_load_dwordx4 v[132:135], v4, s[44:47], s100 offen offset:1024 nt
    s_waitcnt vmcnt(3)
    buffer_load_dwordx4 v[136:139], v4, s[44:47], s100 offen offset:2048 nt
    s_waitcnt vmcnt(3)
    buffer_load_dwordx4 v[140:143], v4, s[44:47], s100 offen offset:3072 nt
    s_waitcnt vmcnt(3)
    buffer_load_dwordx4 v[144:147], v4, s[48:51], s100 offen offset:0 nt
    s_waitcnt vmcnt(3)
    buffer_load_dwordx4 v[148:151], v4, s[48:51], s100 offen offset:1024 nt
    s_waitcnt vmcnt(3)
    buffer_load_dwordx4 v[152:155], v4, s[48:51], s100 offen offset:2048 nt
    s_waitcnt vmcnt(3)
    buffer_load_dwordx4 v[156:159], v4, s[48:51], s100 offen offset:3072 nt
    s_add_u32 s100, s84, 21
    s_and_b32 s100, s100, 255
    s_lshl_b32 s100, s100, 12
    s_waitcnt vmcnt(3)
    buffer_load_dwordx4 v[160:163], v4, s[44:47], s100 offen offset:0 nt
    s_waitcnt vmcnt(3)
    buffer_load_dwordx4 v[164:167], v4, s[44:47], s100 offen offset:1024 nt
    s_waitcnt vmcnt(3)
    buffer_load_dwordx4 v[168:171], v4, s[44:47], s100 offen offset:2048 nt
    s_waitcnt vmcnt(3)
    buffer_load_dwordx4 v[172:175], v4, s[44:47], s100 offen offset:3072 nt
    s_waitcnt vmcnt(3)
    buffer_load_dwordx4 v[176:179], v4, s[48:51], s100 offen offset:0 nt
    s_waitcnt vmcnt(3)
    buffer_load_dwordx4 v[180:183], v4, s[48:51], s100 offen offset:1024 nt
    s_waitcnt vmcnt(3)
    buffer_load_dwordx4 v[184:187], v4, s[48:51], s100 offen offset:2048 nt
    s_waitcnt vmcnt(3)
    buffer_load_dwordx4 v[188:191], v4, s[48:51], s100 offen offset:3072 nt
    s_branch Lgo_3
Lsvc_2:
    s_setprio 3
    s_waitcnt vmcnt(0)
    v_perm_b32 v232, v196, v192, s68
    v_perm_b32 v233, v196, v192, s69
    v_perm_b32 v234, v197, v193, s68
    v_perm_b32 v235, v197, v193, s69
    v_perm_b32 v236, v198, v194, s68
    v_perm_b32 v237, v198, v194, s69
    v_perm_b32 v238, v199, v195, s68
    v_perm_b32 v239, v199, v195, s69
    v_dot2_f32_bf16 v212, v232, v208, 0
    v_dot2_f32_bf16 v213, v233, v208, 0
    v_dot2_f32_bf16 v214, v234, v208, 0
    v_dot2_f32_bf16 v215, v235, v208, 0
    v_dot2_f32_bf16 v216, v236, v208, 0
    v_dot2_f32_bf16 v217, v237, v208, 0
    v_dot2_f32_bf16 v218, v238, v208, 0
    v_dot2_f32_bf16 v219, v239, v208, 0
    v_dot2_f32_bf16 v220, v232, v210, 0
    v_dot2_f32_bf16 v221, v233, v210, 0
    v_dot2_f32_bf16 v222, v234, v210, 0
    v_dot2_f32_bf16 v223, v235, v210, 0
    v_dot2_f32_bf16 v224, v236, v210, 0
    v_dot2_f32_bf16 v225, v237, v210, 0
    v_dot2_f32_bf16 v226, v238, v210, 0
    v_dot2_f32_bf16 v227, v239, v210, 0
    v_perm_b32 v232, v204, v200, s68
    v_perm_b32 v233, v204, v200, s69
    v_perm_b32 v234, v205, v201, s68
    v_perm_b32 v235, v205, v201, s69
    v_perm_b32 v236, v206, v202, s68
    v_perm_b32 v237, v206, v202, s69
    v_perm_b32 v238, v207, v203, s68
    v_perm_b32 v239, v207, v203, s69
    v_dot2_f32_bf16 v212, v232, v209, v212
    v_dot2_f32_bf16 v213, v233, v209, v213
    v_dot2_f32_bf16 v214, v234, v209, v214
    v_dot2_f32_bf16 v215, v235, v209, v215
    v_dot2_f32_bf16 v216, v236, v209, v216
    v_dot2_f32_bf16 v217, v237, v209, v217
    v_dot2_f32_bf16 v218, v238, v209, v218
    v_dot2_f32_bf16 v219, v239, v209, v219
    v_dot2_f32_bf16 v220, v232, v211, v220
    v_dot2_f32_bf16 v221, v233, v211, v221
    v_dot2_f32_bf16 v222, v234, v211, v222
    v_dot2_f32_bf16 v223, v235, v211, v223
    v_dot2_f32_bf16 v224, v236, v211, v224
    v_dot2_f32_bf16 v225, v237, v211, v225
    v_dot2_f32_bf16 v226, v238, v211, v226
    v_dot2_f32_bf16 v227, v239, v211, v227
    s_nop 2
    v_permlane32_swap_b32 v212, v220
    v_permlane32_swap_b32 v213, v221
    v_permlane32_swap_b32 v214, v222
    v_permlane32_swap_b32 v215, v223
    v_permlane32_swap_b32 v216, v224
    v_permlane32_swap_b32 v217, v225
    v_permlane32_swap_b32 v218, v226
    v_permlane32_swap_b32 v219, v227
    s_nop 1
    v_add_f32 v212, v212, v220
    v_add_f32 v213, v213, v221
    v_add_f32 v214, v214, v222
    v_add_f32 v215, v215, v223
    v_add_f32 v216, v216, v224
    v_add_f32 v217, v217, v225
    v_add_f32 v218, v218, v226
    v_add_f32 v219, v219, v227
    s_nop 1
    v_permlane16_swap_b32 v212, v216
    v_permlane16_swap_b32 v213, v217
    v_permlane16_swap_b32 v214, v218
    v_permlane16_swap_b32 v215, v219
    s_nop 1
    v_add_f32 v212, v212, v216
    v_add_f32 v213, v213, v217
    v_add_f32 v214, v214, v218
    v_add_f32 v215, v215, v219
    s_nop 1
    v_add_f32_dpp v212, v212, v212 row_ror:8 row_mask:0xf bank_mask:0xf
    v_add_f32_dpp v213, v213, v213 row_ror:8 row_mask:0xf bank_mask:0xf
    v_add_f32_dpp v214, v214, v214 row_ror:8 row_mask:0xf bank_mask:0xf
    v_add_f32_dpp v215, v215, v215 row_ror:8 row_mask:0xf bank_mask:0xf
    v_lshrrev_b32 v232, 5, v228
    v_lshlrev_b32 v232, 8, v232
    v_bfe_u32 v233, v228, 4, 1
    v_lshl_add_u32 v232, v233, 4, v232
    v_lshl_add_u32 v232, v230, 5, v232
    s_lshl_b32 s61, s56, 9
    s_add_u32 s61, s61, 16384
    v_add_u32 v232, s61, v232
    ds_write_b128 v232, v[212:215]
    s_waitcnt lgkmcnt(0)
    s_barrier
    v_mov_b32 v234, 0
    buffer_load_dword v235, v234, s[52:55], s91 offen offset:0 sc0 sc1
    v_and_b32 v232, 31, v228
    v_lshlrev_b32 v233, 4, v232
    v_add_u32 v233, 16384, v233
    ds_read_b128 v[192:195], v233 offset:0
    ds_read_b128 v[196:199], v233 offset:512
    ds_read_b128 v[200:203], v233 offset:1024
    ds_read_b128 v[204:207], v233 offset:1536
    ds_read_b128 v[208:211], v233 offset:2048
    ds_read_b128 v[212:215], v233 offset:2560
    ds_read_b128 v[216:219], v233 offset:3072
    ds_read_b128 v[220:223], v233 offset:3584
    s_waitcnt lgkmcnt(6)
    v_add_f32 v192, v192, v196
    v_add_f32 v193, v193, v197
    v_add_f32 v194, v194, v198
    v_add_f32 v195, v195, v199
    s_waitcnt lgkmcnt(5)
    v_add_f32 v192, v192, v200
    v_add_f32 v193, v193, v201
    v_add_f32 v194, v194, v202
    v_add_f32 v195, v195, v203
    s_waitcnt lgkmcnt(4)
    v_add_f32 v192, v192, v204
    v_add_f32 v193, v193, v205
    v_add_f32 v194, v194, v206
    v_add_f32 v195, v195, v207
    s_waitcnt lgkmcnt(3)
    v_add_f32 v192, v192, v208
    v_add_f32 v193, v193, v209
    v_add_f32 v194, v194, v210
    v_add_f32 v195, v195, v211
    s_waitcnt lgkmcnt(2)
    v_add_f32 v192, v192, v212
    v_add_f32 v193, v193, v213
    v_add_f32 v194, v194, v214
    v_add_f32 v195, v195, v215
    s_waitcnt lgkmcnt(1)
    v_add_f32 v192, v192, v216
    v_add_f32 v193, v193, v217
    v_add_f32 v194, v194, v218
    v_add_f32 v195, v195, v219
    s_waitcnt lgkmcnt(0)
    v_add_f32 v192, v192, v220
    v_add_f32 v193, v193, v221
    v_add_f32 v194, v194, v222
    v_add_f32 v195, v195, v223
    v_lshrrev_b32 v233, 4, v232
    v_lshlrev_b32 v233, 10, v233
    v_and_b32 v232, 15, v232
    v_lshl_add_u32 v233, v232, 4, v233
    s_waitcnt vmcnt(0)
    s_mov_b32 s92, 0
Lcf_5:
    v_readfirstlane_b32 s57, v235
    s_nop 3
    s_cmp_lg_u32 s57, 0
    s_cbranch_scc1 Lcfd_6
    s_sleep 2
    buffer_load_dword v235, v234, s[52:55], s91 offen offset:0 sc0 sc1
    s_waitcnt vmcnt(0)
    s_add_u32 s92, s92, 1
    s_cmp_lt_u32 s92, 400000
    s_cbranch_scc1 Lcf_5
Lcfd_6:
    s_mov_b64 exec, 0xffffffff
    buffer_store_dwordx4 v[192:195], v233, s[32:35], s3 offen sc0 sc1
    s_mov_b64 exec, -1
L_svc_q:
    v_lshlrev_b32 v40, 4, v1
    s_lshl_b32 s61, s65, 11
    s_add_u32 s61, s61, 1376256
    s_mov_b32 s92, 0
Lpoll_7:
    buffer_load_dwordx4 v[48:51], v40, s[32:35], s61 offen offset:0 sc0 sc1
    buffer_load_dwordx4 v[56:59], v40, s[32:35], s61 offen offset:1024 sc0 sc1
    s_waitcnt vmcnt(0)
    v_mov_b32 v41, v48
    v_max3_u32 v41, v41, v49, v50
    v_max3_u32 v41, v41, v51, v56
    v_max3_u32 v41, v41, v57, v58
    v_max_u32 v41, v41, v59
    v_cmpx_eq_u32 vcc, -1, v41
    s_cbranch_execz Lpolld_8
    s_sleep 4
    s_add_u32 s92, s92, 1
    s_cmp_lt_u32 s92, 400000
    s_cbranch_scc1 Lpoll_7
Lpolld_8:
    s_mov_b64 exec, -1
    v_mov_b32 v52, v48
    v_mov_b32 v53, v49
    v_mov_b32 v54, v50
    v_mov_b32 v55, v51
    v_mov_b32 v60, v56
    v_mov_b32 v61, v57
    v_mov_b32 v62, v58
    v_mov_b32 v63, v59
    s_nop 1
    v_permlane32_swap_b32 v48, v52
    v_permlane32_swap_b32 v49, v53
    v_permlane32_swap_b32 v50, v54
    v_permlane32_swap_b32 v51, v55
    v_permlane32_swap_b32 v56, v60
    v_permlane32_swap_b32 v57, v61
    v_permlane32_swap_b32 v58, v62
    v_permlane32_swap_b32 v59, v63
    s_nop 1
    v_add_f32 v48, v48, v52
    v_add_f32 v49, v49, v53
    v_add_f32 v50, v50, v54
    v_add_f32 v51, v51, v55
    v_cvt_pk_bf16_f32 v48, v48, v49
    v_cvt_pk_bf16_f32 v49, v50, v51
    v_add_f32 v56, v56, v60
    v_add_f32 v57, v57, v61
    v_add_f32 v58, v58, v62
    v_add_f32 v59, v59, v63
    v_cvt_pk_bf16_f32 v56, v56, v57
    v_cvt_pk_bf16_f32 v57, v58, v59
    v_mov_b32 v60, 0
    v_and_b32 v42, 31, v1
    v_lshlrev_b32 v42, 3, v42
    ds_write_b64 v42, v[48:49] offset:0
    ds_write_b64 v42, v[56:57] offset:256
    v_add_u32 v40, 0, v1
    v_add_u32 v41, s80, v40
    v_add_u32 v41, s88, v41
    v_and_b32 v41, 255, v41
    v_lshlrev_b32 v41, 12, v41
    v_add_u32 v42, s81, v40
    v_add_u32 v42, s88, v42
    v_and_b32 v42, 255, v42
    v_lshlrev_b32 v42, 12, v42
    v_add_u32 v42, 33554432, v42
    v_cmp_gt_u32 vcc, s78, v40
    s_nop 1
    v_cndmask_b32 v41, v42, v41, vcc
    v_cmp_gt_u32 vcc, s79, v40
    v_mov_b32 v42, -1
    v_lshlrev_b32 v43, 2, v40
    v_cndmask_b32 v41, v42, v41, vcc
    ds_write_b32 v43, v41 offset:1024
    v_add_u32 v40, 64, v1
    v_add_u32 v41, s80, v40
    v_add_u32 v41, s88, v41
    v_and_b32 v41, 255, v41
    v_lshlrev_b32 v41, 12, v41
    v_add_u32 v42, s81, v40
    v_add_u32 v42, s88, v42
    v_and_b32 v42, 255, v42
    v_lshlrev_b32 v42, 12, v42
    v_add_u32 v42, 33554432, v42
    v_cmp_gt_u32 vcc, s78, v40
    s_nop 1
    v_cndmask_b32 v41, v42, v41, vcc
    v_cmp_gt_u32 vcc, s79, v40
    v_mov_b32 v42, -1
    v_lshlrev_b32 v43, 2, v40
    v_cndmask_b32 v41, v42, v41, vcc
    ds_write_b32 v43, v41 offset:1024
    v_add_u32 v40, 128, v1
    v_add_u32 v41, s80, v40
    v_add_u32 v41, s88, v41
    v_and_b32 v41, 255, v41
    v_lshlrev_b32 v41, 12, v41
    v_add_u32 v42, s81, v40
    v_add_u32 v42, s88, v42
    v_and_b32 v42, 255, v42
    v_lshlrev_b32 v42, 12, v42
    v_add_u32 v42, 33554432, v42
    v_cmp_gt_u32 vcc, s78, v40
    s_nop 1
    v_cndmask_b32 v41, v42, v41, vcc
    v_cmp_gt_u32 vcc, s79, v40
    v_mov_b32 v42, -1
    v_lshlrev_b32 v43, 2, v40
    v_cndmask_b32 v41, v42, v41, vcc
    ds_write_b32 v43, v41 offset:1024
    v_add_u32 v40, 192, v1
    v_add_u32 v41, s80, v40
    v_add_u32 v41, s88, v41
    v_and_b32 v41, 255, v41
    v_lshlrev_b32 v41, 12, v41
    v_add_u32 v42, s81, v40
    v_add_u32 v42, s88, v42
    v_and_b32 v42, 255, v42
    v_lshlrev_b32 v42, 12, v42
    v_add_u32 v42, 33554432, v42
    v_cmp_gt_u32 vcc, s78, v40
    s_nop 1
    v_cndmask_b32 v41, v42, v41, vcc
    v_cmp_gt_u32 vcc, s79, v40
    v_mov_b32 v42, -1
    v_lshlrev_b32 v43, 2, v40
    v_cndmask_b32 v41, v42, v41, vcc
    ds_write_b32 v43, v41 offset:1024
    v_add_u32 v40, 256, v1
    v_add_u32 v41, s80, v40
    v_add_u32 v41, s88, v41
    v_and_b32 v41, 255, v41
    v_lshlrev_b32 v41, 12, v41
    v_add_u32 v42, s81, v40
    v_add_u32 v42, s88, v42
    v_and_b32 v42, 255, v42
    v_lshlrev_b32 v42, 12, v42
    v_add_u32 v42, 33554432, v42
    v_cmp_gt_u32 vcc, s78, v40
    s_nop 1
    v_cndmask_b32 v41, v42, v41, vcc
    v_cmp_gt_u32 vcc, s79, v40
    v_mov_b32 v42, -1
    v_lshlrev_b32 v43, 2, v40
    v_cndmask_b32 v41, v42, v41, vcc
    ds_write_b32 v43, v41 offset:1024
    v_add_u32 v40, 320, v1
    v_add_u32 v41, s80, v40
    v_add_u32 v41, s88, v41
    v_and_b32 v41, 255, v41
    v_lshlrev_b32 v41, 12, v41
    v_add_u32 v42, s81, v40
    v_add_u32 v42, s88, v42
    v_and_b32 v42, 255, v42
    v_lshlrev_b32 v42, 12, v42
    v_add_u32 v42, 33554432, v42
    v_cmp_gt_u32 vcc, s78, v40
    s_nop 1
    v_cndmask_b32 v41, v42, v41, vcc
    v_cmp_gt_u32 vcc, s79, v40
    v_mov_b32 v42, -1
    v_lshlrev_b32 v43, 2, v40
    v_cndmask_b32 v41, v42, v41, vcc
    ds_write_b32 v43, v41 offset:1024
    v_add_u32 v40, 384, v1
    v_add_u32 v41, s80, v40
    v_add_u32 v41, s88, v41
    v_and_b32 v41, 255, v41
    v_lshlrev_b32 v41, 12, v41
    v_add_u32 v42, s81, v40
    v_add_u32 v42, s88, v42
    v_and_b32 v42, 255, v42
    v_lshlrev_b32 v42, 12, v42
    v_add_u32 v42, 33554432, v42
    v_cmp_gt_u32 vcc, s78, v40
    s_nop 1
    v_cndmask_b32 v41, v42, v41, vcc
    v_cmp_gt_u32 vcc, s79, v40
    v_mov_b32 v42, -1
    v_lshlrev_b32 v43, 2, v40
    v_cndmask_b32 v41, v42, v41, vcc
    ds_write_b32 v43, v41 offset:1024
    v_add_u32 v40, 448, v1
    v_add_u32 v41, s80, v40
    v_add_u32 v41, s88, v41
    v_and_b32 v41, 255, v41
    v_lshlrev_b32 v41, 12, v41
    v_add_u32 v42, s81, v40
    v_add_u32 v42, s88, v42
    v_and_b32 v42, 255, v42
    v_lshlrev_b32 v42, 12, v42
    v_add_u32 v42, 33554432, v42
    v_cmp_gt_u32 vcc, s78, v40
    s_nop 1
    v_cndmask_b32 v41, v42, v41, vcc
    v_cmp_gt_u32 vcc, s79, v40
    v_mov_b32 v42, -1
    v_lshlrev_b32 v43, 2, v40
    v_cndmask_b32 v41, v42, v41, vcc
    ds_write_b32 v43, v41 offset:1024
    s_lshl_b32 s64, s56, 3
    s_add_u32 s64, s64, s67
    v_lshlrev_b32 v11, 4, v1
    s_lshl_b32 s61, s64, 9
    s_add_u32 s61, s61, 512
    v_add_u32 v11, s61, v11
    s_lshl_b32 s61, s64, 4
    s_add_u32 s61, s61, 128
    v_mov_b32 v12, s61
    v_cmp_eq_u32 vcc, 32, v1
    s_add_u32 s89, s65, 32
    s_mul_i32 s89, s89, 16384
    v_cndmask_b32 v11, v11, v12, vcc
    v_mov_b32 v40, 0xff7fffff
    v_mov_b32 v41, 0
    v_mov_b32 v42, 56
    ds_write_b64 v42, v[40:41] offset:12288
    ds_write_b64 v42, v[40:41] offset:12352
    v_mov_b32 v40, 0
    v_lshlrev_b32 v42, 3, v1
    ds_write_b64 v42, v[40:41] offset:7680
    ds_write_b64 v42, v[40:41] offset:11776
    s_mov_b32 s82, s79
    s_cmp_eq_u32 s74, 0
    s_cselect_b32 s61, 28, 0
    v_mov_b32 v40, s61
    ds_write_b32 v10, v40
    s_mov_b32 s62, 0
    s_cbranch_scc1 Lnopre_9
    s_mov_b32 s61, 14
    v_mov_b32 v40, s61
    s_mov_b64 exec, 1
    buffer_atomic_add v40, v60, s[32:35], s83 offen sc0 sc1
    s_mov_b64 exec, -1
    s_waitcnt vmcnt(0)
    v_readfirstlane_b32 s62, v40
    s_nop 0
    s_sub_u32 s62, s62, 65536
    v_add_u32 v40, s62, v1
    v_add_u32 v41, 412, v40
    v_add_u32 v41, s88, v41
    v_and_b32 v41, 255, v41
    v_lshlrev_b32 v41, 12, v41
    v_add_u32 v41, 33554432, v41
    v_mov_b32 v42, 67108864
    v_cmp_gt_u32 vcc, 100, v40
    v_add_u32 v43, s82, v1
    v_lshlrev_b32 v43, 2, v43
    v_cndmask_b32 v41, v42, v41, vcc
    s_bfm_b64 exec, s61, 0
    ds_write_b32 v43, v41 offset:1024
    s_mov_b64 exec, -1
    s_add_u32 s82, s82, s61
    s_add_u32 s62, s62, s61
Lnopre_9:
    s_waitcnt lgkmcnt(0)
    s_barrier
    s_cmp_ge_u32 s62, 100
    s_cbranch_scc1 Lpoolend_11
    s_mov_b32 s92, 0
    s_mov_b32 s84, 0
    s_mov_b32 s87, s74
Lpool_10:
    ds_read_b32 v40, v10
    s_waitcnt lgkmcnt(0)
    v_readfirstlane_b32 s61, v40
    s_nop 0
    s_cmp_lg_u32 s87, 0
    s_cbranch_scc1 Lcfe_13
    s_cmp_lt_u32 s61, 30
    s_cbranch_scc1 Lcfe_13
    s_mov_b32 s87, s61
    v_mov_b32 v44, 0
    s_mov_b32 s92, 0
Lcf_14:
    buffer_load_dword v45, v44, s[52:55], 0 offen offset:128 sc0 sc1
    s_waitcnt vmcnt(0)
    v_readfirstlane_b32 s57, v45
    s_nop 3
    s_cmp_ge_u32 s57, 64
    s_cbranch_scc1 Lcfd_15
    s_sleep 16
    s_add_u32 s92, s92, 1
    s_cmp_lt_u32 s92, 400000
    s_cbranch_scc1 Lcf_14
Lcfd_15:
    s_mov_b32 s61, s87
Lcfe_13:
    s_add_u32 s61, s61, 4
    s_sub_i32 s61, s61, s82
    s_cmp_gt_i32 s61, 0
    s_cbranch_scc0 Lpoolslp_12
    s_min_i32 s61, s61, 7
    s_cmp_lg_u32 s87, 0
    s_cbranch_scc1 Lcfk_16
    s_mov_b32 s87, s61
    v_mov_b32 v44, 0
    s_mov_b32 s92, 0
Lcf_17:
    buffer_load_dword v45, v44, s[52:55], 0 offen offset:128 sc0 sc1
    s_waitcnt vmcnt(0)
    v_readfirstlane_b32 s57, v45
    s_nop 3
    s_cmp_ge_u32 s57, 64
    s_cbranch_scc1 Lcfd_18
    s_sleep 16
    s_add_u32 s92, s92, 1
    s_cmp_lt_u32 s92, 400000
    s_cbranch_scc1 Lcf_17
Lcfd_18:
    s_mov_b32 s61, s87
Lcfk_16:
    v_mov_b32 v40, s61
    s_mov_b64 exec, 1
    buffer_atomic_add v40, v60, s[32:35], s83 offen sc0 sc1
    s_mov_b64 exec, -1
    s_waitcnt vmcnt(0)
    v_readfirstlane_b32 s62, v40
    s_nop 0
    s_sub_u32 s62, s62, 65536
    v_add_u32 v40, s62, v1
    v_add_u32 v41, 412, v40
    v_add_u32 v41, s88, v41
    v_and_b32 v41, 255, v41
    v_lshlrev_b32 v41, 12, v41
    v_add_u32 v41, 33554432, v41
    v_mov_b32 v42, 67108864
    v_cmp_gt_u32 vcc, 100, v40
    v_add_u32 v43, s82, v1
    v_lshlrev_b32 v43, 2, v43
    v_cndmask_b32 v41, v42, v41, vcc
    s_bfm_b64 exec, s61, 0
    ds_write_b32 v43, v41 offset:1024
    s_mov_b64 exec, -1
    s_add_u32 s82, s82, s61
    s_add_u32 s62, s62, s61
    s_cmp_ge_u32 s62, 100
    s_cbranch_scc1 Lpoolend_11
Lpoolslp_12:
    s_sleep 2
    s_add_u32 s92, s92, 1
    s_cmp_lt_u32 s92, 400000
    s_cbranch_scc1 Lpool_10
Lpoolend_11:
    v_add_u32 v43, s82, v1
    v_min_u32 v43, 511, v43
    v_lshlrev_b32 v43, 2, v43
    v_mov_b32 v42, 67108864
    ds_write_b32 v43, v42 offset:1024
    s_waitcnt lgkmcnt(0)
    s_setprio 0
    s_branch L_bend
Lgo_3:
    s_barrier
    s_mov_b64 exec, 1
    v_mov_b32 v8, 1
    ds_add_rtn_u32 v8, v10, v8
    s_mov_b64 exec, -1
    v_lshlrev_b32 v40, 4, v3
    ds_read_b128 v[24:27], v40 offset:0
    v_mov_b32 v36, 0xff7fffff
    v_mov_b32 v37, 0
    v_mov_b32 v16, 0
    v_mov_b32 v17, 0
    v_mov_b32 v18, 0
    v_mov_b32 v19, 0
    v_mov_b32 v20, 0
    v_mov_b32 v21, 0
    v_mov_b32 v22, 0
    v_mov_b32 v23, 0
    v_lshlrev_b32 v6, 5, v3
    v_lshl_add_u32 v6, v2, 3, v6
    s_lshl_b32 s61, s56, 9
    v_add_u32 v7, s61, v6
    s_lshl_b32 s77, s56, 3
    s_mov_b32 s76, 33554432
    s_lshl_b32 s64, s56, 3
    s_add_u32 s64, s64, s67
    v_lshlrev_b32 v11, 4, v1
    s_lshl_b32 s61, s64, 9
    s_add_u32 s61, s61, 512
    v_add_u32 v11, s61, v11
    s_lshl_b32 s61, s64, 4
    s_add_u32 s61, s61, 128
    v_mov_b32 v12, s61
    v_cmp_eq_u32 vcc, 32, v1
    s_add_u32 s89, s65, 32
    s_mul_i32 s89, s89, 16384
    v_cndmask_b32 v11, v11, v12, vcc
    s_waitcnt lgkmcnt(0)
    v_readfirstlane_b32 s84, v8
    s_mov_b64 exec, 1
    v_lshlrev_b32 v8, 2, v8
    ds_read_b32 v9, v8 offset:1024
    s_mov_b64 exec, -1
    s_waitcnt lgkmcnt(0)
    v_readfirstlane_b32 s73, v9
    s_nop 0
    s_cmp_lg_u32 s73, -1
    s_cbranch_scc1 Lg_19
    s_mov_b32 s92, 0
Lgs_20:
    s_sleep 1
    s_mov_b64 exec, 1
    ds_read_b32 v9, v8 offset:1024
    s_mov_b64 exec, -1
    s_waitcnt lgkmcnt(0)
    v_readfirstlane_b32 s73, v9
    s_add_u32 s92, s92, 1
    s_cmp_lg_u32 s73, -1
    s_cbranch_scc1 Lg_19
    s_cmp_lt_u32 s92, 400000
    s_cbranch_scc1 Lgs_20
Lg_19:
    s_cmp_ge_u32 s73, 67108864
    s_cbranch_scc1 LBf0_28
    s_mov_b32 s100, s73
    s_mov_b32 s71, s73
    v_dot2_f32_bf16 v28, v64, v24, 0
    v_dot2_f32_bf16 v28, v65, v25, v28
    v_dot2_f32_bf16 v28, v66, v26, v28
    v_dot2_f32_bf16 v28, v67, v27, v28
    s_waitcnt vmcnt(7)
    buffer_load_dwordx4 v[64:67], v4, s[44:47], s100 offen offset:0 nt
    v_dot2_f32_bf16 v29, v68, v24, 0
    v_dot2_f32_bf16 v29, v69, v25, v29
    v_dot2_f32_bf16 v29, v70, v26, v29
    v_dot2_f32_bf16 v29, v71, v27, v29
    s_waitcnt vmcnt(7)
    buffer_load_dwordx4 v[68:71], v4, s[44:47], s100 offen offset:1024 nt
    v_dot2_f32_bf16 v30, v72, v24, 0
    v_dot2_f32_bf16 v30, v73, v25, v30
    v_dot2_f32_bf16 v30, v74, v26, v30
    v_dot2_f32_bf16 v30, v75, v27, v30
    s_waitcnt vmcnt(7)
    buffer_load_dwordx4 v[72:75], v4, s[44:47], s100 offen offset:2048 nt
    v_dot2_f32_bf16 v31, v76, v24, 0
    v_dot2_f32_bf16 v31, v77, v25, v31
    v_dot2_f32_bf16 v31, v78, v26, v31
    v_dot2_f32_bf16 v31, v79, v27, v31
    s_waitcnt vmcnt(7)
    buffer_load_dwordx4 v[76:79], v4, s[44:47], s100 offen offset:3072 nt
    s_nop 2
    v_add_f32_dpp v28, v28, v28 row_ror:8 row_mask:0xf bank_mask:0xf
    v_add_f32_dpp v29, v29, v29 row_ror:8 row_mask:0xf bank_mask:0xf
    v_add_f32_dpp v30, v30, v30 row_ror:8 row_mask:0xf bank_mask:0xf
    v_add_f32_dpp v31, v31, v31 row_ror:8 row_mask:0xf bank_mask:0xf
    v_add_f32_dpp v28, v28, v28 row_ror:4 row_mask:0xf bank_mask:0xf
    v_add_f32_dpp v29, v29, v29 row_ror:4 row_mask:0xf bank_mask:0xf
    v_add_f32_dpp v30, v30, v30 row_ror:4 row_mask:0xf bank_mask:0xf
    v_add_f32_dpp v31, v31, v31 row_ror:4 row_mask:0xf bank_mask:0xf
    v_add_f32_dpp v28, v28, v28 row_ror:2 row_mask:0xf bank_mask:0xf
    v_add_f32_dpp v29, v29, v29 row_ror:2 row_mask:0xf bank_mask:0xf
    v_add_f32_dpp v30, v30, v30 row_ror:2 row_mask:0xf bank_mask:0xf
    v_add_f32_dpp v31, v31, v31 row_ror:2 row_mask:0xf bank_mask:0xf
    v_add_f32_dpp v28, v28, v28 row_ror:1 row_mask:0xf bank_mask:0xf
    v_add_f32_dpp v29, v29, v29 row_ror:1 row_mask:0xf bank_mask:0xf
    v_add_f32_dpp v30, v30, v30 row_ror:1 row_mask:0xf bank_mask:0xf
    v_add_f32_dpp v31, v31, v31 row_ror:1 row_mask:0xf bank_mask:0xf
    v_max3_f32 v38, v36, v28, v29
    v_max3_f32 v38, v38, v30, v31
    v_sub_f32 v39, v36, v38
    v_mul_f32 v39, s70, v39
    v_exp_f32 v39, v39
    v_mul_f32 v56, s70, v38
    v_mov_b32 v36, v38
    v_fma_f32 v48, v28, s70, -v56
    v_fma_f32 v49, v29, s70, -v56
    v_fma_f32 v50, v30, s70, -v56
    v_fma_f32 v51, v31, s70, -v56
    v_exp_f32 v48, v48
    v_exp_f32 v49, v49
    v_exp_f32 v50, v50
    v_exp_f32 v51, v51
    v_mul_f32 v37, v37, v39
    v_mul_f32 v16, v16, v39
    v_mul_f32 v17, v17, v39
    v_mul_f32 v18, v18, v39
    v_mul_f32 v19, v19, v39
    v_mul_f32 v20, v20, v39
    v_mul_f32 v21, v21, v39
    v_mul_f32 v22, v22, v39
    v_mul_f32 v23, v23, v39
    v_add_f32 v37, v37, v48
    v_add_f32 v37, v37, v49
    v_add_f32 v37, v37, v50
    v_add_f32 v37, v37, v51
    v_lshlrev_b32 v40, 16, v80
    v_and_b32 v41, 0xffff0000, v80
    v_lshlrev_b32 v42, 16, v81
    v_and_b32 v43, 0xffff0000, v81
    v_lshlrev_b32 v44, 16, v82
    v_and_b32 v45, 0xffff0000, v82
    v_lshlrev_b32 v46, 16, v83
    v_and_b32 v47, 0xffff0000, v83
    s_waitcnt vmcnt(7)
    buffer_load_dwordx4 v[80:83], v4, s[48:51], s100 offen offset:0 nt
    v_fmac_f32 v16, v40, v48
    v_fmac_f32 v17, v41, v48
    v_fmac_f32 v18, v42, v48
    v_fmac_f32 v19, v43, v48
    v_fmac_f32 v20, v44, v48
    v_fmac_f32 v21, v45, v48
    v_fmac_f32 v22, v46, v48
    v_fmac_f32 v23, v47, v48
    v_lshlrev_b32 v40, 16, v84
    v_and_b32 v41, 0xffff0000, v84
    v_lshlrev_b32 v42, 16, v85
    v_and_b32 v43, 0xffff0000, v85
    v_lshlrev_b32 v44, 16, v86
    v_and_b32 v45, 0xffff0000, v86
    v_lshlrev_b32 v46, 16, v87
    v_and_b32 v47, 0xffff0000, v87
    s_waitcnt vmcnt(7)
    buffer_load_dwordx4 v[84:87], v4, s[48:51], s100 offen offset:1024 nt
    s_mov_b64 exec, 1
    v_mov_b32 v8, 1
    ds_add_rtn_u32 v8, v10, v8
    s_mov_b64 exec, -1
    v_fmac_f32 v16, v40, v49
    v_fmac_f32 v17, v41, v49
    v_fmac_f32 v18, v42, v49
    v_fmac_f32 v19, v43, v49
    v_fmac_f32 v20, v44, v49
    v_fmac_f32 v21, v45, v49
    v_fmac_f32 v22, v46, v49
    v_fmac_f32 v23, v47, v49
    v_lshlrev_b32 v40, 16, v88
    v_and_b32 v41, 0xffff0000, v88
    v_lshlrev_b32 v42, 16, v89
    v_and_b32 v43, 0xffff0000, v89
    v_lshlrev_b32 v44, 16, v90
    v_and_b32 v45, 0xffff0000, v90
    v_lshlrev_b32 v46, 16, v91
    v_and_b32 v47, 0xffff0000, v91
    s_waitcnt vmcnt(7)
    buffer_load_dwordx4 v[88:91], v4, s[48:51], s100 offen offset:2048 nt
    s_waitcnt lgkmcnt(0)
    v_readfirstlane_b32 s84, v8
    s_mov_b64 exec, 1
    v_lshlrev_b32 v8, 2, v8
    ds_read_b32 v9, v8 offset:1024
    s_mov_b64 exec, -1
    v_fmac_f32 v16, v40, v50
    v_fmac_f32 v17, v41, v50
    v_fmac_f32 v18, v42, v50
    v_fmac_f32 v19, v43, v50
    v_fmac_f32 v20, v44, v50
    v_fmac_f32 v21, v45, v50
    v_fmac_f32 v22, v46, v50
    v_fmac_f32 v23, v47, v50
    v_lshlrev_b32 v40, 16, v92
    v_and_b32 v41, 0xffff0000, v92
    v_lshlrev_b32 v42, 16, v93
    v_and_b32 v43, 0xffff0000, v93
    v_lshlrev_b32 v44, 16, v94
    v_and_b32 v45, 0xffff0000, v94
    v_lshlrev_b32 v46, 16, v95
    v_and_b32 v47, 0xffff0000, v95
    s_waitcnt vmcnt(7)
    buffer_load_dwordx4 v[92:95], v4, s[48:51], s100 offen offset:3072 nt
    v_fmac_f32 v16, v40, v51
    v_fmac_f32 v17, v41, v51
    v_fmac_f32 v18, v42, v51
    v_fmac_f32 v19, v43, v51
    v_fmac_f32 v20, v44, v51
    v_fmac_f32 v21, v45, v51
    v_fmac_f32 v22, v46, v51
    v_fmac_f32 v23, v47, v51
    s_waitcnt lgkmcnt(0)
    v_readfirstlane_b32 s73, v9
    s_nop 0
    s_cmp_lg_u32 s73, -1
    s_cbranch_scc1 Lg_34
    s_mov_b32 s92, 0
Lgs_35:
    s_sleep 1
    s_mov_b64 exec, 1
    ds_read_b32 v9, v8 offset:1024
    s_mov_b64 exec, -1
    s_waitcnt lgkmcnt(0)
    v_readfirstlane_b32 s73, v9
    s_add_u32 s92, s92, 1
    s_cmp_lg_u32 s73, -1
    s_cbranch_scc1 Lg_34
    s_cmp_lt_u32 s92, 400000
    s_cbranch_scc1 Lgs_35
Lg_34:
    v_dot2_f32_bf16 v28, v96, v24, 0
    v_dot2_f32_bf16 v28, v97, v25, v28
    v_dot2_f32_bf16 v28, v98, v26, v28
    v_dot2_f32_bf16 v28, v99, v27, v28
    v_dot2_f32_bf16 v29, v100, v24, 0
    v_dot2_f32_bf16 v29, v101, v25, v29
    v_dot2_f32_bf16 v29, v102, v26, v29
    v_dot2_f32_bf16 v29, v103, v27, v29
    v_dot2_f32_bf16 v30, v104, v24, 0
    v_dot2_f32_bf16 v30, v105, v25, v30
    v_dot2_f32_bf16 v30, v106, v26, v30
    v_dot2_f32_bf16 v30, v107, v27, v30
    v_dot2_f32_bf16 v31, v108, v24, 0
    v_dot2_f32_bf16 v31, v109, v25, v31
    v_dot2_f32_bf16 v31, v110, v26, v31
    v_dot2_f32_bf16 v31, v111, v27, v31
    s_nop 2
    v_add_f32_dpp v28, v28, v28 row_ror:8 row_mask:0xf bank_mask:0xf
    v_add_f32_dpp v29, v29, v29 row_ror:8 row_mask:0xf bank_mask:0xf
    v_add_f32_dpp v30, v30, v30 row_ror:8 row_mask:0xf bank_mask:0xf
    v_add_f32_dpp v31, v31, v31 row_ror:8 row_mask:0xf bank_mask:0xf
    v_add_f32_dpp v28, v28, v28 row_ror:4 row_mask:0xf bank_mask:0xf
    v_add_f32_dpp v29, v29, v29 row_ror:4 row_mask:0xf bank_mask:0xf
    v_add_f32_dpp v30, v30, v30 row_ror:4 row_mask:0xf bank_mask:0xf
    v_add_f32_dpp v31, v31, v31 row_ror:4 row_mask:0xf bank_mask:0xf
    v_add_f32_dpp v28, v28, v28 row_ror:2 row_mask:0xf bank_mask:0xf
    v_add_f32_dpp v29, v29, v29 row_ror:2 row_mask:0xf bank_mask:0xf
    v_add_f32_dpp v30, v30, v30 row_ror:2 row_mask:0xf bank_mask:0xf
    v_add_f32_dpp v31, v31, v31 row_ror:2 row_mask:0xf bank_mask:0xf
    v_add_f32_dpp v28, v28, v28 row_ror:1 row_mask:0xf bank_mask:0xf
    v_add_f32_dpp v29, v29, v29 row_ror:1 row_mask:0xf bank_mask:0xf
    v_add_f32_dpp v30, v30, v30 row_ror:1 row_mask:0xf bank_mask:0xf
    v_add_f32_dpp v31, v31, v31 row_ror:1 row_mask:0xf bank_mask:0xf
    v_max3_f32 v38, v36, v28, v29
    v_max3_f32 v38, v38, v30, v31
    v_sub_f32 v39, v36, v38
    v_mul_f32 v39, s70, v39
    v_exp_f32 v39, v39
    v_mul_f32 v56, s70, v38
    v_mov_b32 v36, v38
    v_fma_f32 v48, v28, s70, -v56
    v_fma_f32 v49, v29, s70, -v56
    v_fma_f32 v50, v30, s70, -v56
    v_fma_f32 v51, v31, s70, -v56
    v_exp_f32 v48, v48
    v_exp_f32 v49, v49
    v_exp_f32 v50, v50
    v_exp_f32 v51, v51
    v_mul_f32 v37, v37, v39
    v_mul_f32 v16, v16, v39
    v_mul_f32 v17, v17, v39
    v_mul_f32 v18, v18, v39
    v_mul_f32 v19, v19, v39
    v_mul_f32 v20, v20, v39
    v_mul_f32 v21, v21, v39
    v_mul_f32 v22, v22, v39
    v_mul_f32 v23, v23, v39
    v_add_f32 v37, v37, v48
    v_add_f32 v37, v37, v49
    v_add_f32 v37, v37, v50
    v_add_f32 v37, v37, v51
    v_lshlrev_b32 v40, 16, v112
    v_and_b32 v41, 0xffff0000, v112
    v_lshlrev_b32 v42, 16, v113
    v_and_b32 v43, 0xffff0000, v113
    v_lshlrev_b32 v44, 16, v114
    v_and_b32 v45, 0xffff0000, v114
    v_lshlrev_b32 v46, 16, v115
    v_and_b32 v47, 0xffff0000, v115
    v_fmac_f32 v16, v40, v48
    v_fmac_f32 v17, v41, v48
    v_fmac_f32 v18, v42, v48
    v_fmac_f32 v19, v43, v48
    v_fmac_f32 v20, v44, v48
    v_fmac_f32 v21, v45, v48
    v_fmac_f32 v22, v46, v48
    v_fmac_f32 v23, v47, v48
    v_lshlrev_b32 v40, 16, v116
    v_and_b32 v41, 0xffff0000, v116
    v_lshlrev_b32 v42, 16, v117
    v_and_b32 v43, 0xffff0000, v117
    v_lshlrev_b32 v44, 16, v118
    v_and_b32 v45, 0xffff0000, v118
    v_lshlrev_b32 v46, 16, v119
    v_and_b32 v47, 0xffff0000, v119
    v_fmac_f32 v16, v40, v49
    v_fmac_f32 v17, v41, v49
    v_fmac_f32 v18, v42, v49
    v_fmac_f32 v19, v43, v49
    v_fmac_f32 v20, v44, v49
    v_fmac_f32 v21, v45, v49
    v_fmac_f32 v22, v46, v49
    v_fmac_f32 v23, v47, v49
    v_lshlrev_b32 v40, 16, v120
    v_and_b32 v41, 0xffff0000, v120
    v_lshlrev_b32 v42, 16, v121
    v_and_b32 v43, 0xffff0000, v121
    v_lshlrev_b32 v44, 16, v122
    v_and_b32 v45, 0xffff0000, v122
    v_lshlrev_b32 v46, 16, v123
    v_and_b32 v47, 0xffff0000, v123
    v_fmac_f32 v16, v40, v50
    v_fmac_f32 v17, v41, v50
    v_fmac_f32 v18, v42, v50
    v_fmac_f32 v19, v43, v50
    v_fmac_f32 v20, v44, v50
    v_fmac_f32 v21, v45, v50
    v_fmac_f32 v22, v46, v50
    v_fmac_f32 v23, v47, v50
    v_lshlrev_b32 v40, 16, v124
    v_and_b32 v41, 0xffff0000, v124
    v_lshlrev_b32 v42, 16, v125
    v_and_b32 v43, 0xffff0000, v125
    v_lshlrev_b32 v44, 16, v126
    v_and_b32 v45, 0xffff0000, v126
    v_lshlrev_b32 v46, 16, v127
    v_and_b32 v47, 0xffff0000, v127
    v_fmac_f32 v16, v40, v51
    v_fmac_f32 v17, v41, v51
    v_fmac_f32 v18, v42, v51
    v_fmac_f32 v19, v43, v51
    v_fmac_f32 v20, v44, v51
    v_fmac_f32 v21, v45, v51
    v_fmac_f32 v22, v46, v51
    v_fmac_f32 v23, v47, v51
    v_dot2_f32_bf16 v28, v128, v24, 0
    v_dot2_f32_bf16 v28, v129, v25, v28
    v_dot2_f32_bf16 v28, v130, v26, v28
    v_dot2_f32_bf16 v28, v131, v27, v28
    v_dot2_f32_bf16 v29, v132, v24, 0
    v_dot2_f32_bf16 v29, v133, v25, v29
    v_dot2_f32_bf16 v29, v134, v26, v29
    v_dot2_f32_bf16 v29, v135, v27, v29
    v_dot2_f32_bf16 v30, v136, v24, 0
    v_dot2_f32_bf16 v30, v137, v25, v30
    v_dot2_f32_bf16 v30, v138, v26, v30
    v_dot2_f32_bf16 v30, v139, v27, v30
    v_dot2_f32_bf16 v31, v140, v24, 0
    v_dot2_f32_bf16 v31, v141, v25, v31
    v_dot2_f32_bf16 v31, v142, v26, v31
    v_dot2_f32_bf16 v31, v143, v27, v31
    s_nop 2
    v_add_f32_dpp v28, v28, v28 row_ror:8 row_mask:0xf bank_mask:0xf
    v_add_f32_dpp v29, v29, v29 row_ror:8 row_mask:0xf bank_mask:0xf
    v_add_f32_dpp v30, v30, v30 row_ror:8 row_mask:0xf bank_mask:0xf
    v_add_f32_dpp v31, v31, v31 row_ror:8 row_mask:0xf bank_mask:0xf
    v_add_f32_dpp v28, v28, v28 row_ror:4 row_mask:0xf bank_mask:0xf
    v_add_f32_dpp v29, v29, v29 row_ror:4 row_mask:0xf bank_mask:0xf
    v_add_f32_dpp v30, v30, v30 row_ror:4 row_mask:0xf bank_mask:0xf
    v_add_f32_dpp v31, v31, v31 row_ror:4 row_mask:0xf bank_mask:0xf
    v_add_f32_dpp v28, v28, v28 row_ror:2 row_mask:0xf bank_mask:0xf
    v_add_f32_dpp v29, v29, v29 row_ror:2 row_mask:0xf bank_mask:0xf
    v_add_f32_dpp v30, v30, v30 row_ror:2 row_mask:0xf bank_mask:0xf
    v_add_f32_dpp v31, v31, v31 row_ror:2 row_mask:0xf bank_mask:0xf
    v_add_f32_dpp v28, v28, v28 row_ror:1 row_mask:0xf bank_mask:0xf
    v_add_f32_dpp v29, v29, v29 row_ror:1 row_mask:0xf bank_mask:0xf
    v_add_f32_dpp v30, v30, v30 row_ror:1 row_mask:0xf bank_mask:0xf
    v_add_f32_dpp v31, v31, v31 row_ror:1 row_mask:0xf bank_mask:0xf
    v_max3_f32 v38, v36, v28, v29
    v_max3_f32 v38, v38, v30, v31
    v_sub_f32 v39, v36, v38
    v_mul_f32 v39, s70, v39
    v_exp_f32 v39, v39
    v_mul_f32 v56, s70, v38
    v_mov_b32 v36, v38
    v_fma_f32 v48, v28, s70, -v56
    v_fma_f32 v49, v29, s70, -v56
    v_fma_f32 v50, v30, s70, -v56
    v_fma_f32 v51, v31, s70, -v56
    v_exp_f32 v48, v48
    v_exp_f32 v49, v49
    v_exp_f32 v50, v50
    v_exp_f32 v51, v51
    v_mul_f32 v37, v37, v39
    v_mul_f32 v16, v16, v39
    v_mul_f32 v17, v17, v39
    v_mul_f32 v18, v18, v39
    v_mul_f32 v19, v19, v39
    v_mul_f32 v20, v20, v39
    v_mul_f32 v21, v21, v39
    v_mul_f32 v22, v22, v39
    v_mul_f32 v23, v23, v39
    v_add_f32 v37, v37, v48
    v_add_f32 v37, v37, v49
    v_add_f32 v37, v37, v50
    v_add_f32 v37, v37, v51
    v_lshlrev_b32 v40, 16, v144
    v_and_b32 v41, 0xffff0000, v144
    v_lshlrev_b32 v42, 16, v145
    v_and_b32 v43, 0xffff0000, v145
    v_lshlrev_b32 v44, 16, v146
    v_and_b32 v45, 0xffff0000, v146
    v_lshlrev_b32 v46, 16, v147
    v_and_b32 v47, 0xffff0000, v147
    v_fmac_f32 v16, v40, v48
    v_fmac_f32 v17, v41, v48
    v_fmac_f32 v18, v42, v48
    v_fmac_f32 v19, v43, v48
    v_fmac_f32 v20, v44, v48
    v_fmac_f32 v21, v45, v48
    v_fmac_f32 v22, v46, v48
    v_fmac_f32 v23, v47, v48
    v_lshlrev_b32 v40, 16, v148
    v_and_b32 v41, 0xffff0000, v148
    v_lshlrev_b32 v42, 16, v149
    v_and_b32 v43, 0xffff0000, v149
    v_lshlrev_b32 v44, 16, v150
    v_and_b32 v45, 0xffff0000, v150
    v_lshlrev_b32 v46, 16, v151
    v_and_b32 v47, 0xffff0000, v151
    v_fmac_f32 v16, v40, v49
    v_fmac_f32 v17, v41, v49
    v_fmac_f32 v18, v42, v49
    v_fmac_f32 v19, v43, v49
    v_fmac_f32 v20, v44, v49
    v_fmac_f32 v21, v45, v49
    v_fmac_f32 v22, v46, v49
    v_fmac_f32 v23, v47, v49
    v_lshlrev_b32 v40, 16, v152
    v_and_b32 v41, 0xffff0000, v152
    v_lshlrev_b32 v42, 16, v153
    v_and_b32 v43, 0xffff0000, v153
    v_lshlrev_b32 v44, 16, v154
    v_and_b32 v45, 0xffff0000, v154
    v_lshlrev_b32 v46, 16, v155
    v_and_b32 v47, 0xffff0000, v155
    v_fmac_f32 v16, v40, v50
    v_fmac_f32 v17, v41, v50
    v_fmac_f32 v18, v42, v50
    v_fmac_f32 v19, v43, v50
    v_fmac_f32 v20, v44, v50
    v_fmac_f32 v21, v45, v50
    v_fmac_f32 v22, v46, v50
    v_fmac_f32 v23, v47, v50
    v_lshlrev_b32 v40, 16, v156
    v_and_b32 v41, 0xffff0000, v156
    v_lshlrev_b32 v42, 16, v157
    v_and_b32 v43, 0xffff0000, v157
    v_lshlrev_b32 v44, 16, v158
    v_and_b32 v45, 0xffff0000, v158
    v_lshlrev_b32 v46, 16, v159
    v_and_b32 v47, 0xffff0000, v159
    v_fmac_f32 v16, v40, v51
    v_fmac_f32 v17, v41, v51
    v_fmac_f32 v18, v42, v51
    v_fmac_f32 v19, v43, v51
    v_fmac_f32 v20, v44, v51
    v_fmac_f32 v21, v45, v51
    v_fmac_f32 v22, v46, v51
    v_fmac_f32 v23, v47, v51
    s_waitcnt vmcnt(8)
    v_dot2_f32_bf16 v28, v160, v24, 0
    v_dot2_f32_bf16 v28, v161, v25, v28
    v_dot2_f32_bf16 v28, v162, v26, v28
    v_dot2_f32_bf16 v28, v163, v27, v28
    v_dot2_f32_bf16 v29, v164, v24, 0
    v_dot2_f32_bf16 v29, v165, v25, v29
    v_dot2_f32_bf16 v29, v166, v26, v29
    v_dot2_f32_bf16 v29, v167, v27, v29
    v_dot2_f32_bf16 v30, v168, v24, 0
    v_dot2_f32_bf16 v30, v169, v25, v30
    v_dot2_f32_bf16 v30, v170, v26, v30
    v_dot2_f32_bf16 v30, v171, v27, v30
    v_dot2_f32_bf16 v31, v172, v24, 0
    v_dot2_f32_bf16 v31, v173, v25, v31
    v_dot2_f32_bf16 v31, v174, v26, v31
    v_dot2_f32_bf16 v31, v175, v27, v31
    s_nop 2
    v_add_f32_dpp v28, v28, v28 row_ror:8 row_mask:0xf bank_mask:0xf
    v_add_f32_dpp v29, v29, v29 row_ror:8 row_mask:0xf bank_mask:0xf
    v_add_f32_dpp v30, v30, v30 row_ror:8 row_mask:0xf bank_mask:0xf
    v_add_f32_dpp v31, v31, v31 row_ror:8 row_mask:0xf bank_mask:0xf
    v_add_f32_dpp v28, v28, v28 row_ror:4 row_mask:0xf bank_mask:0xf
    v_add_f32_dpp v29, v29, v29 row_ror:4 row_mask:0xf bank_mask:0xf
    v_add_f32_dpp v30, v30, v30 row_ror:4 row_mask:0xf bank_mask:0xf
    v_add_f32_dpp v31, v31, v31 row_ror:4 row_mask:0xf bank_mask:0xf
    v_add_f32_dpp v28, v28, v28 row_ror:2 row_mask:0xf bank_mask:0xf
    v_add_f32_dpp v29, v29, v29 row_ror:2 row_mask:0xf bank_mask:0xf
    v_add_f32_dpp v30, v30, v30 row_ror:2 row_mask:0xf bank_mask:0xf
    v_add_f32_dpp v31, v31, v31 row_ror:2 row_mask:0xf bank_mask:0xf
    v_add_f32_dpp v28, v28, v28 row_ror:1 row_mask:0xf bank_mask:0xf
    v_add_f32_dpp v29, v29, v29 row_ror:1 row_mask:0xf bank_mask:0xf
    v_add_f32_dpp v30, v30, v30 row_ror:1 row_mask:0xf bank_mask:0xf
    v_add_f32_dpp v31, v31, v31 row_ror:1 row_mask:0xf bank_mask:0xf
    v_max3_f32 v38, v36, v28, v29
    v_max3_f32 v38, v38, v30, v31
    v_sub_f32 v39, v36, v38
    v_mul_f32 v39, s70, v39
    v_exp_f32 v39, v39
    v_mul_f32 v56, s70, v38
    v_mov_b32 v36, v38
    v_fma_f32 v48, v28, s70, -v56
    v_fma_f32 v49, v29, s70, -v56
    v_fma_f32 v50, v30, s70, -v56
    v_fma_f32 v51, v31, s70, -v56
    v_exp_f32 v48, v48
    v_exp_f32 v49, v49
    v_exp_f32 v50, v50
    v_exp_f32 v51, v51
    v_mul_f32 v37, v37, v39
    v_mul_f32 v16, v16, v39
    v_mul_f32 v17, v17, v39
    v_mul_f32 v18, v18, v39
    v_mul_f32 v19, v19, v39
    v_mul_f32 v20, v20, v39
    v_mul_f32 v21, v21, v39
    v_mul_f32 v22, v22, v39
    v_mul_f32 v23, v23, v39
    v_add_f32 v37, v37, v48
    v_add_f32 v37, v37, v49
    v_add_f32 v37, v37, v50
    v_add_f32 v37, v37, v51
    v_lshlrev_b32 v40, 16, v176
    v_and_b32 v41, 0xffff0000, v176
    v_lshlrev_b32 v42, 16, v177
    v_and_b32 v43, 0xffff0000, v177
    v_lshlrev_b32 v44, 16, v178
    v_and_b32 v45, 0xffff0000, v178
    v_lshlrev_b32 v46, 16, v179
    v_and_b32 v47, 0xffff0000, v179
    v_fmac_f32 v16, v40, v48
    v_fmac_f32 v17, v41, v48
    v_fmac_f32 v18, v42, v48
    v_fmac_f32 v19, v43, v48
    v_fmac_f32 v20, v44, v48
    v_fmac_f32 v21, v45, v48
    v_fmac_f32 v22, v46, v48
    v_fmac_f32 v23, v47, v48
    v_lshlrev_b32 v40, 16, v180
    v_and_b32 v41, 0xffff0000, v180
    v_lshlrev_b32 v42, 16, v181
    v_and_b32 v43, 0xffff0000, v181
    v_lshlrev_b32 v44, 16, v182
    v_and_b32 v45, 0xffff0000, v182
    v_lshlrev_b32 v46, 16, v183
    v_and_b32 v47, 0xffff0000, v183
    v_fmac_f32 v16, v40, v49
    v_fmac_f32 v17, v41, v49
    v_fmac_f32 v18, v42, v49
    v_fmac_f32 v19, v43, v49
    v_fmac_f32 v20, v44, v49
    v_fmac_f32 v21, v45, v49
    v_fmac_f32 v22, v46, v49
    v_fmac_f32 v23, v47, v49
    v_lshlrev_b32 v40, 16, v184
    v_and_b32 v41, 0xffff0000, v184
    v_lshlrev_b32 v42, 16, v185
    v_and_b32 v43, 0xffff0000, v185
    v_lshlrev_b32 v44, 16, v186
    v_and_b32 v45, 0xffff0000, v186
    v_lshlrev_b32 v46, 16, v187
    v_and_b32 v47, 0xffff0000, v187
    v_fmac_f32 v16, v40, v50
    v_fmac_f32 v17, v41, v50
    v_fmac_f32 v18, v42, v50
    v_fmac_f32 v19, v43, v50
    v_fmac_f32 v20, v44, v50
    v_fmac_f32 v21, v45, v50
    v_fmac_f32 v22, v46, v50
    v_fmac_f32 v23, v47, v50
    v_lshlrev_b32 v40, 16, v188
    v_and_b32 v41, 0xffff0000, v188
    v_lshlrev_b32 v42, 16, v189
    v_and_b32 v43, 0xffff0000, v189
    v_lshlrev_b32 v44, 16, v190
    v_and_b32 v45, 0xffff0000, v190
    v_lshlrev_b32 v46, 16, v191
    v_and_b32 v47, 0xffff0000, v191
    v_fmac_f32 v16, v40, v51
    v_fmac_f32 v17, v41, v51
    v_fmac_f32 v18, v42, v51
    v_fmac_f32 v19, v43, v51
    v_fmac_f32 v20, v44, v51
    v_fmac_f32 v21, v45, v51
    v_fmac_f32 v22, v46, v51
    v_fmac_f32 v23, v47, v51
LBloop_21:
    s_cmp_ge_u32 s73, 67108864
    s_cbranch_scc1 LBtail0_25
    s_cmp_ge_u32 s84, 42
    s_cbranch_scc1 LBloop2_23
    s_cmp_ge_u32 s71, s76
    s_cbranch_scc1 Lsw_36
Lswb_37:
    s_mov_b32 s100, s73
    s_mov_b32 s71, s73
    s_waitcnt vmcnt(7)
    v_dot2_f32_bf16 v28, v64, v24, 0
    v_dot2_f32_bf16 v28, v65, v25, v28
    v_dot2_f32_bf16 v28, v66, v26, v28
    v_dot2_f32_bf16 v28, v67, v27, v28
    s_waitcnt vmcnt(3)
    buffer_load_dwordx4 v[64:67], v4, s[44:47], s100 offen offset:0 nt
    s_waitcnt vmcnt(7)
    v_dot2_f32_bf16 v29, v68, v24, 0
    v_dot2_f32_bf16 v29, v69, v25, v29
    v_dot2_f32_bf16 v29, v70, v26, v29
    v_dot2_f32_bf16 v29, v71, v27, v29
    s_waitcnt vmcnt(3)
    buffer_load_dwordx4 v[68:71], v4, s[44:47], s100 offen offset:1024 nt
    s_waitcnt vmcnt(7)
    v_dot2_f32_bf16 v30, v72, v24, 0
    v_dot2_f32_bf16 v30, v73, v25, v30
    v_dot2_f32_bf16 v30, v74, v26, v30
    v_dot2_f32_bf16 v30, v75, v27, v30
    s_waitcnt vmcnt(3)
    buffer_load_dwordx4 v[72:75], v4, s[44:47], s100 offen offset:2048 nt
    s_waitcnt vmcnt(7)
    v_dot2_f32_bf16 v31, v76, v24, 0
    v_dot2_f32_bf16 v31, v77, v25, v31
    v_dot2_f32_bf16 v31, v78, v26, v31
    v_dot2_f32_bf16 v31, v79, v27, v31
    s_waitcnt vmcnt(3)
    buffer_load_dwordx4 v[76:79], v4, s[44:47], s100 offen offset:3072 nt
    s_nop 2
    v_add_f32_dpp v28, v28, v28 row_ror:8 row_mask:0xf bank_mask:0xf
    v_add_f32_dpp v29, v29, v29 row_ror:8 row_mask:0xf bank_mask:0xf
    v_add_f32_dpp v30, v30, v30 row_ror:8 row_mask:0xf bank_mask:0xf
    v_add_f32_dpp v31, v31, v31 row_ror:8 row_mask:0xf bank_mask:0xf
    v_add_f32_dpp v28, v28, v28 row_ror:4 row_mask:0xf bank_mask:0xf
    v_add_f32_dpp v29, v29, v29 row_ror:4 row_mask:0xf bank_mask:0xf
    v_add_f32_dpp v30, v30, v30 row_ror:4 row_mask:0xf bank_mask:0xf
    v_add_f32_dpp v31, v31, v31 row_ror:4 row_mask:0xf bank_mask:0xf
    v_add_f32_dpp v28, v28, v28 row_ror:2 row_mask:0xf bank_mask:0xf
    v_add_f32_dpp v29, v29, v29 row_ror:2 row_mask:0xf bank_mask:0xf
    v_add_f32_dpp v30, v30, v30 row_ror:2 row_mask:0xf bank_mask:0xf
    v_add_f32_dpp v31, v31, v31 row_ror:2 row_mask:0xf bank_mask:0xf
    v_add_f32_dpp v28, v28, v28 row_ror:1 row_mask:0xf bank_mask:0xf
    v_add_f32_dpp v29, v29, v29 row_ror:1 row_mask:0xf bank_mask:0xf
    v_add_f32_dpp v30, v30, v30 row_ror:1 row_mask:0xf bank_mask:0xf
    v_add_f32_dpp v31, v31, v31 row_ror:1 row_mask:0xf bank_mask:0xf
    v_max3_f32 v38, v36, v28, v29
    v_max3_f32 v38, v38, v30, v31
    v_sub_f32 v39, v36, v38
    v_mul_f32 v39, s70, v39
    v_exp_f32 v39, v39
    v_mul_f32 v56, s70, v38
    v_mov_b32 v36, v38
    v_fma_f32 v48, v28, s70, -v56
    v_fma_f32 v49, v29, s70, -v56
    v_fma_f32 v50, v30, s70, -v56
    v_fma_f32 v51, v31, s70, -v56
    v_exp_f32 v48, v48
    v_exp_f32 v49, v49
    v_exp_f32 v50, v50
    v_exp_f32 v51, v51
    v_mul_f32 v37, v37, v39
    v_mul_f32 v16, v16, v39
    v_mul_f32 v17, v17, v39
    v_mul_f32 v18, v18, v39
    v_mul_f32 v19, v19, v39
    v_mul_f32 v20, v20, v39
    v_mul_f32 v21, v21, v39
    v_mul_f32 v22, v22, v39
    v_mul_f32 v23, v23, v39
    v_add_f32 v37, v37, v48
    v_add_f32 v37, v37, v49
    v_add_f32 v37, v37, v50
    v_add_f32 v37, v37, v51
    s_waitcnt vmcnt(7)
    v_lshlrev_b32 v40, 16, v80
    v_and_b32 v41, 0xffff0000, v80
    v_lshlrev_b32 v42, 16, v81
    v_and_b32 v43, 0xffff0000, v81
    v_lshlrev_b32 v44, 16, v82
    v_and_b32 v45, 0xffff0000, v82
    v_lshlrev_b32 v46, 16, v83
    v_and_b32 v47, 0xffff0000, v83
    s_waitcnt vmcnt(3)
    buffer_load_dwordx4 v[80:83], v4, s[48:51], s100 offen offset:0 nt
    v_fmac_f32 v16, v40, v48
    v_fmac_f32 v17, v41, v48
    v_fmac_f32 v18, v42, v48
    v_fmac_f32 v19, v43, v48
    v_fmac_f32 v20, v44, v48
    v_fmac_f32 v21, v45, v48
    v_fmac_f32 v22, v46, v48
    v_fmac_f32 v23, v47, v48
    s_waitcnt vmcnt(7)
    v_lshlrev_b32 v40, 16, v84
    v_and_b32 v41, 0xffff0000, v84
    v_lshlrev_b32 v42, 16, v85
    v_and_b32 v43, 0xffff0000, v85
    v_lshlrev_b32 v44, 16, v86
    v_and_b32 v45, 0xffff0000, v86
    v_lshlrev_b32 v46, 16, v87
    v_and_b32 v47, 0xffff0000, v87
    s_waitcnt vmcnt(3)
    buffer_load_dwordx4 v[84:87], v4, s[48:51], s100 offen offset:1024 nt
    s_mov_b64 exec, 1
    v_mov_b32 v8, 1
    ds_add_rtn_u32 v8, v10, v8
    s_mov_b64 exec, -1
    v_fmac_f32 v16, v40, v49
    v_fmac_f32 v17, v41, v49
    v_fmac_f32 v18, v42, v49
    v_fmac_f32 v19, v43, v49
    v_fmac_f32 v20, v44, v49
    v_fmac_f32 v21, v45, v49
    v_fmac_f32 v22, v46, v49
    v_fmac_f32 v23, v47, v49
    s_waitcnt vmcnt(7)
    v_lshlrev_b32 v40, 16, v88
    v_and_b32 v41, 0xffff0000, v88
    v_lshlrev_b32 v42, 16, v89
    v_and_b32 v43, 0xffff0000, v89
    v_lshlrev_b32 v44, 16, v90
    v_and_b32 v45, 0xffff0000, v90
    v_lshlrev_b32 v46, 16, v91
    v_and_b32 v47, 0xffff0000, v91
    s_waitcnt vmcnt(3)
    buffer_load_dwordx4 v[88:91], v4, s[48:51], s100 offen offset:2048 nt
    s_waitcnt lgkmcnt(0)
    v_readfirstlane_b32 s84, v8
    s_mov_b64 exec, 1
    v_lshlrev_b32 v8, 2, v8
    ds_read_b32 v9, v8 offset:1024
    s_mov_b64 exec, -1
    v_fmac_f32 v16, v40, v50
    v_fmac_f32 v17, v41, v50
    v_fmac_f32 v18, v42, v50
    v_fmac_f32 v19, v43, v50
    v_fmac_f32 v20, v44, v50
    v_fmac_f32 v21, v45, v50
    v_fmac_f32 v22, v46, v50
    v_fmac_f32 v23, v47, v50
    s_waitcnt vmcnt(7)
    v_lshlrev_b32 v40, 16, v92
    v_and_b32 v41, 0xffff0000, v92
    v_lshlrev_b32 v42, 16, v93
    v_and_b32 v43, 0xffff0000, v93
    v_lshlrev_b32 v44, 16, v94
    v_and_b32 v45, 0xffff0000, v94
    v_lshlrev_b32 v46, 16, v95
    v_and_b32 v47, 0xffff0000, v95
    s_waitcnt vmcnt(3)
    buffer_load_dwordx4 v[92:95], v4, s[48:51], s100 offen offset:3072 nt
    v_fmac_f32 v16, v40, v51
    v_fmac_f32 v17, v41, v51
    v_fmac_f32 v18, v42, v51
    v_fmac_f32 v19, v43, v51
    v_fmac_f32 v20, v44, v51
    v_fmac_f32 v21, v45, v51
    v_fmac_f32 v22, v46, v51
    v_fmac_f32 v23, v47, v51
    s_waitcnt lgkmcnt(0)
    v_readfirstlane_b32 s73, v9
    s_nop 0
    s_cmp_lg_u32 s73, -1
    s_cbranch_scc1 Lg_38
    s_mov_b32 s92, 0
Lgs_39:
    s_sleep 1
    s_mov_b64 exec, 1
    ds_read_b32 v9, v8 offset:1024
    s_mov_b64 exec, -1
    s_waitcnt lgkmcnt(0)
    v_readfirstlane_b32 s73, v9
    s_add_u32 s92, s92, 1
    s_cmp_lg_u32 s73, -1
    s_cbranch_scc1 Lg_38
    s_cmp_lt_u32 s92, 400000
    s_cbranch_scc1 Lgs_39
Lg_38:
    s_branch LBloop_21
LBloop2_23:
    s_cmp_ge_u32 s73, 67108864
    s_cbranch_scc1 LBtail0_25
    s_cmp_ge_u32 s71, s76
    s_cbranch_scc1 Lsw_40
Lswb_41:
    s_and_b32 s100, s73, 0xfffffffe
    s_mov_b32 s71, s73
    s_waitcnt vmcnt(7)
    v_dot2_f32_bf16 v28, v64, v24, 0
    v_dot2_f32_bf16 v28, v65, v25, v28
    v_dot2_f32_bf16 v28, v66, v26, v28
    v_dot2_f32_bf16 v28, v67, v27, v28
    buffer_load_dwordx4 v[64:67], v4, s[44:47], s100 offen offset:0 nt
    s_waitcnt vmcnt(7)
    v_dot2_f32_bf16 v29, v68, v24, 0
    v_dot2_f32_bf16 v29, v69, v25, v29
    v_dot2_f32_bf16 v29, v70, v26, v29
    v_dot2_f32_bf16 v29, v71, v27, v29
    buffer_load_dwordx4 v[68:71], v4, s[44:47], s100 offen offset:1024 nt
    s_waitcnt vmcnt(7)
    v_dot2_f32_bf16 v30, v72, v24, 0
    v_dot2_f32_bf16 v30, v73, v25, v30
    v_dot2_f32_bf16 v30, v74, v26, v30
    v_dot2_f32_bf16 v30, v75, v27, v30
    buffer_load_dwordx4 v[72:75], v4, s[44:47], s100 offen offset:2048 nt
    s_waitcnt vmcnt(7)
    v_dot2_f32_bf16 v31, v76, v24, 0
    v_dot2_f32_bf16 v31, v77, v25, v31
    v_dot2_f32_bf16 v31, v78, v26, v31
    v_dot2_f32_bf16 v31, v79, v27, v31
    buffer_load_dwordx4 v[76:79], v4, s[44:47], s100 offen offset:3072 nt
    s_nop 2
    v_add_f32_dpp v28, v28, v28 row_ror:8 row_mask:0xf bank_mask:0xf
    v_add_f32_dpp v29, v29, v29 row_ror:8 row_mask:0xf bank_mask:0xf
    v_add_f32_dpp v30, v30, v30 row_ror:8 row_mask:0xf bank_mask:0xf
    v_add_f32_dpp v31, v31, v31 row_ror:8 row_mask:0xf bank_mask:0xf
    v_add_f32_dpp v28, v28, v28 row_ror:4 row_mask:0xf bank_mask:0xf
    v_add_f32_dpp v29, v29, v29 row_ror:4 row_mask:0xf bank_mask:0xf
    v_add_f32_dpp v30, v30, v30 row_ror:4 row_mask:0xf bank_mask:0xf
    v_add_f32_dpp v31, v31, v31 row_ror:4 row_mask:0xf bank_mask:0xf
    v_add_f32_dpp v28, v28, v28 row_ror:2 row_mask:0xf bank_mask:0xf
    v_add_f32_dpp v29, v29, v29 row_ror:2 row_mask:0xf bank_mask:0xf
    v_add_f32_dpp v30, v30, v30 row_ror:2 row_mask:0xf bank_mask:0xf
    v_add_f32_dpp v31, v31, v31 row_ror:2 row_mask:0xf bank_mask:0xf
    v_add_f32_dpp v28, v28, v28 row_ror:1 row_mask:0xf bank_mask:0xf
    v_add_f32_dpp v29, v29, v29 row_ror:1 row_mask:0xf bank_mask:0xf
    v_add_f32_dpp v30, v30, v30 row_ror:1 row_mask:0xf bank_mask:0xf
    v_add_f32_dpp v31, v31, v31 row_ror:1 row_mask:0xf bank_mask:0xf
    v_max3_f32 v38, v36, v28, v29
    v_max3_f32 v38, v38, v30, v31
    v_sub_f32 v39, v36, v38
    v_mul_f32 v39, s70, v39
    v_exp_f32 v39, v39
    v_mul_f32 v56, s70, v38
    v_mov_b32 v36, v38
    v_fma_f32 v48, v28, s70, -v56
    v_fma_f32 v49, v29, s70, -v56
    v_fma_f32 v50, v30, s70, -v56
    v_fma_f32 v51, v31, s70, -v56
    v_exp_f32 v48, v48
    v_exp_f32 v49, v49
    v_exp_f32 v50, v50
    v_exp_f32 v51, v51
    v_mul_f32 v37, v37, v39
    v_mul_f32 v16, v16, v39
    v_mul_f32 v17, v17, v39
    v_mul_f32 v18, v18, v39
    v_mul_f32 v19, v19, v39
    v_mul_f32 v20, v20, v39
    v_mul_f32 v21, v21, v39
    v_mul_f32 v22, v22, v39
    v_mul_f32 v23, v23, v39
    v_add_f32 v37, v37, v48
    v_add_f32 v37, v37, v49
    v_add_f32 v37, v37, v50
    v_add_f32 v37, v37, v51
    s_waitcnt vmcnt(7)
    v_lshlrev_b32 v40, 16, v80
    v_and_b32 v41, 0xffff0000, v80
    v_lshlrev_b32 v42, 16, v81
    v_and_b32 v43, 0xffff0000, v81
    v_lshlrev_b32 v44, 16, v82
    v_and_b32 v45, 0xffff0000, v82
    v_lshlrev_b32 v46, 16, v83
    v_and_b32 v47, 0xffff0000, v83
    buffer_load_dwordx4 v[80:83], v4, s[48:51], s100 offen offset:0 nt
    v_fmac_f32 v16, v40, v48
    v_fmac_f32 v17, v41, v48
    v_fmac_f32 v18, v42, v48
    v_fmac_f32 v19, v43, v48
    v_fmac_f32 v20, v44, v48
    v_fmac_f32 v21, v45, v48
    v_fmac_f32 v22, v46, v48
    v_fmac_f32 v23, v47, v48
    s_waitcnt vmcnt(7)
    v_lshlrev_b32 v40, 16, v84
    v_and_b32 v41, 0xffff0000, v84
    v_lshlrev_b32 v42, 16, v85
    v_and_b32 v43, 0xffff0000, v85
    v_lshlrev_b32 v44, 16, v86
    v_and_b32 v45, 0xffff0000, v86
    v_lshlrev_b32 v46, 16, v87
    v_and_b32 v47, 0xffff0000, v87
    buffer_load_dwordx4 v[84:87], v4, s[48:51], s100 offen offset:1024 nt
    s_mov_b64 exec, 1
    v_mov_b32 v8, 1
    ds_add_rtn_u32 v8, v10, v8
    s_mov_b64 exec, -1
    v_fmac_f32 v16, v40, v49
    v_fmac_f32 v17, v41, v49
    v_fmac_f32 v18, v42, v49
    v_fmac_f32 v19, v43, v49
    v_fmac_f32 v20, v44, v49
    v_fmac_f32 v21, v45, v49
    v_fmac_f32 v22, v46, v49
    v_fmac_f32 v23, v47, v49
    s_waitcnt vmcnt(7)
    v_lshlrev_b32 v40, 16, v88
    v_and_b32 v41, 0xffff0000, v88
    v_lshlrev_b32 v42, 16, v89
    v_and_b32 v43, 0xffff0000, v89
    v_lshlrev_b32 v44, 16, v90
    v_and_b32 v45, 0xffff0000, v90
    v_lshlrev_b32 v46, 16, v91
    v_and_b32 v47, 0xffff0000, v91
    buffer_load_dwordx4 v[88:91], v4, s[48:51], s100 offen offset:2048 nt
    s_waitcnt lgkmcnt(0)
    v_readfirstlane_b32 s84, v8
    s_mov_b64 exec, 1
    v_lshlrev_b32 v8, 2, v8
    ds_read_b32 v9, v8 offset:1024
    s_mov_b64 exec, -1
    v_fmac_f32 v16, v40, v50
    v_fmac_f32 v17, v41, v50
    v_fmac_f32 v18, v42, v50
    v_fmac_f32 v19, v43, v50
    v_fmac_f32 v20, v44, v50
    v_fmac_f32 v21, v45, v50
    v_fmac_f32 v22, v46, v50
    v_fmac_f32 v23, v47, v50
    s_waitcnt vmcnt(7)
    v_lshlrev_b32 v40, 16, v92
    v_and_b32 v41, 0xffff0000, v92
    v_lshlrev_b32 v42, 16, v93
    v_and_b32 v43, 0xffff0000, v93
    v_lshlrev_b32 v44, 16, v94
    v_and_b32 v45, 0xffff0000, v94
    v_lshlrev_b32 v46, 16, v95
    v_and_b32 v47, 0xffff0000, v95
    buffer_load_dwordx4 v[92:95], v4, s[48:51], s100 offen offset:3072 nt
    v_fmac_f32 v16, v40, v51
    v_fmac_f32 v17, v41, v51
    v_fmac_f32 v18, v42, v51
    v_fmac_f32 v19, v43, v51
    v_fmac_f32 v20, v44, v51
    v_fmac_f32 v21, v45, v51
    v_fmac_f32 v22, v46, v51
    v_fmac_f32 v23, v47, v51
    s_waitcnt lgkmcnt(0)
    v_readfirstlane_b32 s73, v9
    s_nop 0
    s_cmp_lg_u32 s73, -1
    s_cbranch_scc1 Lg_42
    s_mov_b32 s92, 0
Lgs_43:
    s_sleep 1
    s_mov_b64 exec, 1
    ds_read_b32 v9, v8 offset:1024
    s_mov_b64 exec, -1
    s_waitcnt lgkmcnt(0)
    v_readfirstlane_b32 s73, v9
    s_add_u32 s92, s92, 1
    s_cmp_lg_u32 s73, -1
    s_cbranch_scc1 Lg_42
    s_cmp_lt_u32 s92, 400000
    s_cbranch_scc1 Lgs_43
Lg_42:
    s_branch LBloop2_23
LBtail0_25:
    s_cmp_ge_u32 s71, s76
    s_cbranch_scc1 Lsw_44
Lswb_45:
    s_waitcnt vmcnt(7)
    v_dot2_f32_bf16 v28, v64, v24, 0
    v_dot2_f32_bf16 v28, v65, v25, v28
    v_dot2_f32_bf16 v28, v66, v26, v28
    v_dot2_f32_bf16 v28, v67, v27, v28
    s_waitcnt vmcnt(6)
    v_dot2_f32_bf16 v29, v68, v24, 0
    v_dot2_f32_bf16 v29, v69, v25, v29
    v_dot2_f32_bf16 v29, v70, v26, v29
    v_dot2_f32_bf16 v29, v71, v27, v29
    s_waitcnt vmcnt(5)
    v_dot2_f32_bf16 v30, v72, v24, 0
    v_dot2_f32_bf16 v30, v73, v25, v30
    v_dot2_f32_bf16 v30, v74, v26, v30
    v_dot2_f32_bf16 v30, v75, v27, v30
    s_waitcnt vmcnt(4)
    v_dot2_f32_bf16 v31, v76, v24, 0
    v_dot2_f32_bf16 v31, v77, v25, v31
    v_dot2_f32_bf16 v31, v78, v26, v31
    v_dot2_f32_bf16 v31, v79, v27, v31
    s_nop 2
    v_add_f32_dpp v28, v28, v28 row_ror:8 row_mask:0xf bank_mask:0xf
    v_add_f32_dpp v29, v29, v29 row_ror:8 row_mask:0xf bank_mask:0xf
    v_add_f32_dpp v30, v30, v30 row_ror:8 row_mask:0xf bank_mask:0xf
    v_add_f32_dpp v31, v31, v31 row_ror:8 row_mask:0xf bank_mask:0xf
    v_add_f32_dpp v28, v28, v28 row_ror:4 row_mask:0xf bank_mask:0xf
    v_add_f32_dpp v29, v29, v29 row_ror:4 row_mask:0xf bank_mask:0xf
    v_add_f32_dpp v30, v30, v30 row_ror:4 row_mask:0xf bank_mask:0xf
    v_add_f32_dpp v31, v31, v31 row_ror:4 row_mask:0xf bank_mask:0xf
    v_add_f32_dpp v28, v28, v28 row_ror:2 row_mask:0xf bank_mask:0xf
    v_add_f32_dpp v29, v29, v29 row_ror:2 row_mask:0xf bank_mask:0xf
    v_add_f32_dpp v30, v30, v30 row_ror:2 row_mask:0xf bank_mask:0xf
    v_add_f32_dpp v31, v31, v31 row_ror:2 row_mask:0xf bank_mask:0xf
    v_add_f32_dpp v28, v28, v28 row_ror:1 row_mask:0xf bank_mask:0xf
    v_add_f32_dpp v29, v29, v29 row_ror:1 row_mask:0xf bank_mask:0xf
    v_add_f32_dpp v30, v30, v30 row_ror:1 row_mask:0xf bank_mask:0xf
    v_add_f32_dpp v31, v31, v31 row_ror:1 row_mask:0xf bank_mask:0xf
    v_max3_f32 v38, v36, v28, v29
    v_max3_f32 v38, v38, v30, v31
    v_sub_f32 v39, v36, v38
    v_mul_f32 v39, s70, v39
    v_exp_f32 v39, v39
    v_mul_f32 v56, s70, v38
    v_mov_b32 v36, v38
    v_fma_f32 v48, v28, s70, -v56
    v_fma_f32 v49, v29, s70, -v56
    v_fma_f32 v50, v30, s70, -v56
    v_fma_f32 v51, v31, s70, -v56
    v_exp_f32 v48, v48
    v_exp_f32 v49, v49
    v_exp_f32 v50, v50
    v_exp_f32 v51, v51
    v_mul_f32 v37, v37, v39
    v_mul_f32 v16, v16, v39
    v_mul_f32 v17, v17, v39
    v_mul_f32 v18, v18, v39
    v_mul_f32 v19, v19, v39
    v_mul_f32 v20, v20, v39
    v_mul_f32 v21, v21, v39
    v_mul_f32 v22, v22, v39
    v_mul_f32 v23, v23, v39
    v_add_f32 v37, v37, v48
    v_add_f32 v37, v37, v49
    v_add_f32 v37, v37, v50
    v_add_f32 v37, v37, v51
    s_waitcnt vmcnt(3)
    v_lshlrev_b32 v40, 16, v80
    v_and_b32 v41, 0xffff0000, v80
    v_lshlrev_b32 v42, 16, v81
    v_and_b32 v43, 0xffff0000, v81
    v_lshlrev_b32 v44, 16, v82
    v_and_b32 v45, 0xffff0000, v82
    v_lshlrev_b32 v46, 16, v83
    v_and_b32 v47, 0xffff0000, v83
    v_fmac_f32 v16, v40, v48
    v_fmac_f32 v17, v41, v48
    v_fmac_f32 v18, v42, v48
    v_fmac_f32 v19, v43, v48
    v_fmac_f32 v20, v44, v48
    v_fmac_f32 v21, v45, v48
    v_fmac_f32 v22, v46, v48
    v_fmac_f32 v23, v47, v48
    s_waitcnt vmcnt(2)
    v_lshlrev_b32 v40, 16, v84
    v_and_b32 v41, 0xffff0000, v84
    v_lshlrev_b32 v42, 16, v85
    v_and_b32 v43, 0xffff0000, v85
    v_lshlrev_b32 v44, 16, v86
    v_and_b32 v45, 0xffff0000, v86
    v_lshlrev_b32 v46, 16, v87
    v_and_b32 v47, 0xffff0000, v87
    v_fmac_f32 v16, v40, v49
    v_fmac_f32 v17, v41, v49
    v_fmac_f32 v18, v42, v49
    v_fmac_f32 v19, v43, v49
    v_fmac_f32 v20, v44, v49
    v_fmac_f32 v21, v45, v49
    v_fmac_f32 v22, v46, v49
    v_fmac_f32 v23, v47, v49
    s_waitcnt vmcnt(1)
    v_lshlrev_b32 v40, 16, v88
    v_and_b32 v41, 0xffff0000, v88
    v_lshlrev_b32 v42, 16, v89
    v_and_b32 v43, 0xffff0000, v89
    v_lshlrev_b32 v44, 16, v90
    v_and_b32 v45, 0xffff0000, v90
    v_lshlrev_b32 v46, 16, v91
    v_and_b32 v47, 0xffff0000, v91
    v_fmac_f32 v16, v40, v50
    v_fmac_f32 v17, v41, v50
    v_fmac_f32 v18, v42, v50
    v_fmac_f32 v19, v43, v50
    v_fmac_f32 v20, v44, v50
    v_fmac_f32 v21, v45, v50
    v_fmac_f32 v22, v46, v50
    v_fmac_f32 v23, v47, v50
    s_waitcnt vmcnt(0)
    v_lshlrev_b32 v40, 16, v92
    v_and_b32 v41, 0xffff0000, v92
    v_lshlrev_b32 v42, 16, v93
    v_and_b32 v43, 0xffff0000, v93
    v_lshlrev_b32 v44, 16, v94
    v_and_b32 v45, 0xffff0000, v94
    v_lshlrev_b32 v46, 16, v95
    v_and_b32 v47, 0xffff0000, v95
    v_fmac_f32 v16, v40, v51
    v_fmac_f32 v17, v41, v51
    v_fmac_f32 v18, v42, v51
    v_fmac_f32 v19, v43, v51
    v_fmac_f32 v20, v44, v51
    v_fmac_f32 v21, v45, v51
    v_fmac_f32 v22, v46, v51
    v_fmac_f32 v23, v47, v51
    s_branch LBfin_27
LBf0_28:
    s_waitcnt vmcnt(0)
    v_dot2_f32_bf16 v28, v64, v24, 0
    v_dot2_f32_bf16 v28, v65, v25, v28
    v_dot2_f32_bf16 v28, v66, v26, v28
    v_dot2_f32_bf16 v28, v67, v27, v28
    v_dot2_f32_bf16 v29, v68, v24, 0
    v_dot2_f32_bf16 v29, v69, v25, v29
    v_dot2_f32_bf16 v29, v70, v26, v29
    v_dot2_f32_bf16 v29, v71, v27, v29
    v_dot2_f32_bf16 v30, v72, v24, 0
    v_dot2_f32_bf16 v30, v73, v25, v30
    v_dot2_f32_bf16 v30, v74, v26, v30
    v_dot2_f32_bf16 v30, v75, v27, v30
    v_dot2_f32_bf16 v31, v76, v24, 0
    v_dot2_f32_bf16 v31, v77, v25, v31
    v_dot2_f32_bf16 v31, v78, v26, v31
    v_dot2_f32_bf16 v31, v79, v27, v31
    s_nop 2
    v_add_f32_dpp v28, v28, v28 row_ror:8 row_mask:0xf bank_mask:0xf
    v_add_f32_dpp v29, v29, v29 row_ror:8 row_mask:0xf bank_mask:0xf
    v_add_f32_dpp v30, v30, v30 row_ror:8 row_mask:0xf bank_mask:0xf
    v_add_f32_dpp v31, v31, v31 row_ror:8 row_mask:0xf bank_mask:0xf
    v_add_f32_dpp v28, v28, v28 row_ror:4 row_mask:0xf bank_mask:0xf
    v_add_f32_dpp v29, v29, v29 row_ror:4 row_mask:0xf bank_mask:0xf
    v_add_f32_dpp v30, v30, v30 row_ror:4 row_mask:0xf bank_mask:0xf
    v_add_f32_dpp v31, v31, v31 row_ror:4 row_mask:0xf bank_mask:0xf
    v_add_f32_dpp v28, v28, v28 row_ror:2 row_mask:0xf bank_mask:0xf
    v_add_f32_dpp v29, v29, v29 row_ror:2 row_mask:0xf bank_mask:0xf
    v_add_f32_dpp v30, v30, v30 row_ror:2 row_mask:0xf bank_mask:0xf
    v_add_f32_dpp v31, v31, v31 row_ror:2 row_mask:0xf bank_mask:0xf
    v_add_f32_dpp v28, v28, v28 row_ror:1 row_mask:0xf bank_mask:0xf
    v_add_f32_dpp v29, v29, v29 row_ror:1 row_mask:0xf bank_mask:0xf
    v_add_f32_dpp v30, v30, v30 row_ror:1 row_mask:0xf bank_mask:0xf
    v_add_f32_dpp v31, v31, v31 row_ror:1 row_mask:0xf bank_mask:0xf
    v_max3_f32 v38, v36, v28, v29
    v_max3_f32 v38, v38, v30, v31
    v_sub_f32 v39, v36, v38
    v_mul_f32 v39, s70, v39
    v_exp_f32 v39, v39
    v_mul_f32 v56, s70, v38
    v_mov_b32 v36, v38
    v_fma_f32 v48, v28, s70, -v56
    v_fma_f32 v49, v29, s70, -v56
    v_fma_f32 v50, v30, s70, -v56
    v_fma_f32 v51, v31, s70, -v56
    v_exp_f32 v48, v48
    v_exp_f32 v49, v49
    v_exp_f32 v50, v50
    v_exp_f32 v51, v51
    v_mul_f32 v37, v37, v39
    v_mul_f32 v16, v16, v39
    v_mul_f32 v17, v17, v39
    v_mul_f32 v18, v18, v39
    v_mul_f32 v19, v19, v39
    v_mul_f32 v20, v20, v39
    v_mul_f32 v21, v21, v39
    v_mul_f32 v22, v22, v39
    v_mul_f32 v23, v23, v39
    v_add_f32 v37, v37, v48
    v_add_f32 v37, v37, v49
    v_add_f32 v37, v37, v50
    v_add_f32 v37, v37, v51
    v_lshlrev_b32 v40, 16, v80
    v_and_b32 v41, 0xffff0000, v80
    v_lshlrev_b32 v42, 16, v81
    v_and_b32 v43, 0xffff0000, v81
    v_lshlrev_b32 v44, 16, v82
    v_and_b32 v45, 0xffff0000, v82
    v_lshlrev_b32 v46, 16, v83
    v_and_b32 v47, 0xffff0000, v83
    v_fmac_f32 v16, v40, v48
    v_fmac_f32 v17, v41, v48
    v_fmac_f32 v18, v42, v48
    v_fmac_f32 v19, v43, v48
    v_fmac_f32 v20, v44, v48
    v_fmac_f32 v21, v45, v48
    v_fmac_f32 v22, v46, v48
    v_fmac_f32 v23, v47, v48
    v_lshlrev_b32 v40, 16, v84
    v_and_b32 v41, 0xffff0000, v84
    v_lshlrev_b32 v42, 16, v85
    v_and_b32 v43, 0xffff0000, v85
    v_lshlrev_b32 v44, 16, v86
    v_and_b32 v45, 0xffff0000, v86
    v_lshlrev_b32 v46, 16, v87
    v_and_b32 v47, 0xffff0000, v87
    v_fmac_f32 v16, v40, v49
    v_fmac_f32 v17, v41, v49
    v_fmac_f32 v18, v42, v49
    v_fmac_f32 v19, v43, v49
    v_fmac_f32 v20, v44, v49
    v_fmac_f32 v21, v45, v49
    v_fmac_f32 v22, v46, v49
    v_fmac_f32 v23, v47, v49
    v_lshlrev_b32 v40, 16, v88
    v_and_b32 v41, 0xffff0000, v88
    v_lshlrev_b32 v42, 16, v89
    v_and_b32 v43, 0xffff0000, v89
    v_lshlrev_b32 v44, 16, v90
    v_and_b32 v45, 0xffff0000, v90
    v_lshlrev_b32 v46, 16, v91
    v_and_b32 v47, 0xffff0000, v91
    v_fmac_f32 v16, v40, v50
    v_fmac_f32 v17, v41, v50
    v_fmac_f32 v18, v42, v50
    v_fmac_f32 v19, v43, v50
    v_fmac_f32 v20, v44, v50
    v_fmac_f32 v21, v45, v50
    v_fmac_f32 v22, v46, v50
    v_fmac_f32 v23, v47, v50
    v_lshlrev_b32 v40, 16, v92
    v_and_b32 v41, 0xffff0000, v92
    v_lshlrev_b32 v42, 16, v93
    v_and_b32 v43, 0xffff0000, v93
    v_lshlrev_b32 v44, 16, v94
    v_and_b32 v45, 0xffff0000, v94
    v_lshlrev_b32 v46, 16, v95
    v_and_b32 v47, 0xffff0000, v95
    v_fmac_f32 v16, v40, v51
    v_fmac_f32 v17, v41, v51
    v_fmac_f32 v18, v42, v51
    v_fmac_f32 v19, v43, v51
    v_fmac_f32 v20, v44, v51
    v_fmac_f32 v21, v45, v51
    v_fmac_f32 v22, v46, v51
    v_fmac_f32 v23, v47, v51
    v_dot2_f32_bf16 v28, v96, v24, 0
    v_dot2_f32_bf16 v28, v97, v25, v28
    v_dot2_f32_bf16 v28, v98, v26, v28
    v_dot2_f32_bf16 v28, v99, v27, v28
    v_dot2_f32_bf16 v29, v100, v24, 0
    v_dot2_f32_bf16 v29, v101, v25, v29
    v_dot2_f32_bf16 v29, v102, v26, v29
    v_dot2_f32_bf16 v29, v103, v27, v29
    v_dot2_f32_bf16 v30, v104, v24, 0
    v_dot2_f32_bf16 v30, v105, v25, v30
    v_dot2_f32_bf16 v30, v106, v26, v30
    v_dot2_f32_bf16 v30, v107, v27, v30
    v_dot2_f32_bf16 v31, v108, v24, 0
    v_dot2_f32_bf16 v31, v109, v25, v31
    v_dot2_f32_bf16 v31, v110, v26, v31
    v_dot2_f32_bf16 v31, v111, v27, v31
    s_nop 2
    v_add_f32_dpp v28, v28, v28 row_ror:8 row_mask:0xf bank_mask:0xf
    v_add_f32_dpp v29, v29, v29 row_ror:8 row_mask:0xf bank_mask:0xf
    v_add_f32_dpp v30, v30, v30 row_ror:8 row_mask:0xf bank_mask:0xf
    v_add_f32_dpp v31, v31, v31 row_ror:8 row_mask:0xf bank_mask:0xf
    v_add_f32_dpp v28, v28, v28 row_ror:4 row_mask:0xf bank_mask:0xf
    v_add_f32_dpp v29, v29, v29 row_ror:4 row_mask:0xf bank_mask:0xf
    v_add_f32_dpp v30, v30, v30 row_ror:4 row_mask:0xf bank_mask:0xf
    v_add_f32_dpp v31, v31, v31 row_ror:4 row_mask:0xf bank_mask:0xf
    v_add_f32_dpp v28, v28, v28 row_ror:2 row_mask:0xf bank_mask:0xf
    v_add_f32_dpp v29, v29, v29 row_ror:2 row_mask:0xf bank_mask:0xf
    v_add_f32_dpp v30, v30, v30 row_ror:2 row_mask:0xf bank_mask:0xf
    v_add_f32_dpp v31, v31, v31 row_ror:2 row_mask:0xf bank_mask:0xf
    v_add_f32_dpp v28, v28, v28 row_ror:1 row_mask:0xf bank_mask:0xf
    v_add_f32_dpp v29, v29, v29 row_ror:1 row_mask:0xf bank_mask:0xf
    v_add_f32_dpp v30, v30, v30 row_ror:1 row_mask:0xf bank_mask:0xf
    v_add_f32_dpp v31, v31, v31 row_ror:1 row_mask:0xf bank_mask:0xf
    v_max3_f32 v38, v36, v28, v29
    v_max3_f32 v38, v38, v30, v31
    v_sub_f32 v39, v36, v38
    v_mul_f32 v39, s70, v39
    v_exp_f32 v39, v39
    v_mul_f32 v56, s70, v38
    v_mov_b32 v36, v38
    v_fma_f32 v48, v28, s70, -v56
    v_fma_f32 v49, v29, s70, -v56
    v_fma_f32 v50, v30, s70, -v56
    v_fma_f32 v51, v31, s70, -v56
    v_exp_f32 v48, v48
    v_exp_f32 v49, v49
    v_exp_f32 v50, v50
    v_exp_f32 v51, v51
    v_mul_f32 v37, v37, v39
    v_mul_f32 v16, v16, v39
    v_mul_f32 v17, v17, v39
    v_mul_f32 v18, v18, v39
    v_mul_f32 v19, v19, v39
    v_mul_f32 v20, v20, v39
    v_mul_f32 v21, v21, v39
    v_mul_f32 v22, v22, v39
    v_mul_f32 v23, v23, v39
    v_add_f32 v37, v37, v48
    v_add_f32 v37, v37, v49
    v_add_f32 v37, v37, v50
    v_add_f32 v37, v37, v51
    v_lshlrev_b32 v40, 16, v112
    v_and_b32 v41, 0xffff0000, v112
    v_lshlrev_b32 v42, 16, v113
    v_and_b32 v43, 0xffff0000, v113
    v_lshlrev_b32 v44, 16, v114
    v_and_b32 v45, 0xffff0000, v114
    v_lshlrev_b32 v46, 16, v115
    v_and_b32 v47, 0xffff0000, v115
    v_fmac_f32 v16, v40, v48
    v_fmac_f32 v17, v41, v48
    v_fmac_f32 v18, v42, v48
    v_fmac_f32 v19, v43, v48
    v_fmac_f32 v20, v44, v48
    v_fmac_f32 v21, v45, v48
    v_fmac_f32 v22, v46, v48
    v_fmac_f32 v23, v47, v48
    v_lshlrev_b32 v40, 16, v116
    v_and_b32 v41, 0xffff0000, v116
    v_lshlrev_b32 v42, 16, v117
    v_and_b32 v43, 0xffff0000, v117
    v_lshlrev_b32 v44, 16, v118
    v_and_b32 v45, 0xffff0000, v118
    v_lshlrev_b32 v46, 16, v119
    v_and_b32 v47, 0xffff0000, v119
    v_fmac_f32 v16, v40, v49
    v_fmac_f32 v17, v41, v49
    v_fmac_f32 v18, v42, v49
    v_fmac_f32 v19, v43, v49
    v_fmac_f32 v20, v44, v49
    v_fmac_f32 v21, v45, v49
    v_fmac_f32 v22, v46, v49
    v_fmac_f32 v23, v47, v49
    v_lshlrev_b32 v40, 16, v120
    v_and_b32 v41, 0xffff0000, v120
    v_lshlrev_b32 v42, 16, v121
    v_and_b32 v43, 0xffff0000, v121
    v_lshlrev_b32 v44, 16, v122
    v_and_b32 v45, 0xffff0000, v122
    v_lshlrev_b32 v46, 16, v123
    v_and_b32 v47, 0xffff0000, v123
    v_fmac_f32 v16, v40, v50
    v_fmac_f32 v17, v41, v50
    v_fmac_f32 v18, v42, v50
    v_fmac_f32 v19, v43, v50
    v_fmac_f32 v20, v44, v50
    v_fmac_f32 v21, v45, v50
    v_fmac_f32 v22, v46, v50
    v_fmac_f32 v23, v47, v50
    v_lshlrev_b32 v40, 16, v124
    v_and_b32 v41, 0xffff0000, v124
    v_lshlrev_b32 v42, 16, v125
    v_and_b32 v43, 0xffff0000, v125
    v_lshlrev_b32 v44, 16, v126
    v_and_b32 v45, 0xffff0000, v126
    v_lshlrev_b32 v46, 16, v127
    v_and_b32 v47, 0xffff0000, v127
    v_fmac_f32 v16, v40, v51
    v_fmac_f32 v17, v41, v51
    v_fmac_f32 v18, v42, v51
    v_fmac_f32 v19, v43, v51
    v_fmac_f32 v20, v44, v51
    v_fmac_f32 v21, v45, v51
    v_fmac_f32 v22, v46, v51
    v_fmac_f32 v23, v47, v51
    v_dot2_f32_bf16 v28, v128, v24, 0
    v_dot2_f32_bf16 v28, v129, v25, v28
    v_dot2_f32_bf16 v28, v130, v26, v28
    v_dot2_f32_bf16 v28, v131, v27, v28
    v_dot2_f32_bf16 v29, v132, v24, 0
    v_dot2_f32_bf16 v29, v133, v25, v29
    v_dot2_f32_bf16 v29, v134, v26, v29
    v_dot2_f32_bf16 v29, v135, v27, v29
    v_dot2_f32_bf16 v30, v136, v24, 0
    v_dot2_f32_bf16 v30, v137, v25, v30
    v_dot2_f32_bf16 v30, v138, v26, v30
    v_dot2_f32_bf16 v30, v139, v27, v30
    v_dot2_f32_bf16 v31, v140, v24, 0
    v_dot2_f32_bf16 v31, v141, v25, v31
    v_dot2_f32_bf16 v31, v142, v26, v31
    v_dot2_f32_bf16 v31, v143, v27, v31
    s_nop 2
    v_add_f32_dpp v28, v28, v28 row_ror:8 row_mask:0xf bank_mask:0xf
    v_add_f32_dpp v29, v29, v29 row_ror:8 row_mask:0xf bank_mask:0xf
    v_add_f32_dpp v30, v30, v30 row_ror:8 row_mask:0xf bank_mask:0xf
    v_add_f32_dpp v31, v31, v31 row_ror:8 row_mask:0xf bank_mask:0xf
    v_add_f32_dpp v28, v28, v28 row_ror:4 row_mask:0xf bank_mask:0xf
    v_add_f32_dpp v29, v29, v29 row_ror:4 row_mask:0xf bank_mask:0xf
    v_add_f32_dpp v30, v30, v30 row_ror:4 row_mask:0xf bank_mask:0xf
    v_add_f32_dpp v31, v31, v31 row_ror:4 row_mask:0xf bank_mask:0xf
    v_add_f32_dpp v28, v28, v28 row_ror:2 row_mask:0xf bank_mask:0xf
    v_add_f32_dpp v29, v29, v29 row_ror:2 row_mask:0xf bank_mask:0xf
    v_add_f32_dpp v30, v30, v30 row_ror:2 row_mask:0xf bank_mask:0xf
    v_add_f32_dpp v31, v31, v31 row_ror:2 row_mask:0xf bank_mask:0xf
    v_add_f32_dpp v28, v28, v28 row_ror:1 row_mask:0xf bank_mask:0xf
    v_add_f32_dpp v29, v29, v29 row_ror:1 row_mask:0xf bank_mask:0xf
    v_add_f32_dpp v30, v30, v30 row_ror:1 row_mask:0xf bank_mask:0xf
    v_add_f32_dpp v31, v31, v31 row_ror:1 row_mask:0xf bank_mask:0xf
    v_max3_f32 v38, v36, v28, v29
    v_max3_f32 v38, v38, v30, v31
    v_sub_f32 v39, v36, v38
    v_mul_f32 v39, s70, v39
    v_exp_f32 v39, v39
    v_mul_f32 v56, s70, v38
    v_mov_b32 v36, v38
    v_fma_f32 v48, v28, s70, -v56
    v_fma_f32 v49, v29, s70, -v56
    v_fma_f32 v50, v30, s70, -v56
    v_fma_f32 v51, v31, s70, -v56
    v_exp_f32 v48, v48
    v_exp_f32 v49, v49
    v_exp_f32 v50, v50
    v_exp_f32 v51, v51
    v_mul_f32 v37, v37, v39
    v_mul_f32 v16, v16, v39
    v_mul_f32 v17, v17, v39
    v_mul_f32 v18, v18, v39
    v_mul_f32 v19, v19, v39
    v_mul_f32 v20, v20, v39
    v_mul_f32 v21, v21, v39
    v_mul_f32 v22, v22, v39
    v_mul_f32 v23, v23, v39
    v_add_f32 v37, v37, v48
    v_add_f32 v37, v37, v49
    v_add_f32 v37, v37, v50
    v_add_f32 v37, v37, v51
    v_lshlrev_b32 v40, 16, v144
    v_and_b32 v41, 0xffff0000, v144
    v_lshlrev_b32 v42, 16, v145
    v_and_b32 v43, 0xffff0000, v145
    v_lshlrev_b32 v44, 16, v146
    v_and_b32 v45, 0xffff0000, v146
    v_lshlrev_b32 v46, 16, v147
    v_and_b32 v47, 0xffff0000, v147
    v_fmac_f32 v16, v40, v48
    v_fmac_f32 v17, v41, v48
    v_fmac_f32 v18, v42, v48
    v_fmac_f32 v19, v43, v48
    v_fmac_f32 v20, v44, v48
    v_fmac_f32 v21, v45, v48
    v_fmac_f32 v22, v46, v48
    v_fmac_f32 v23, v47, v48
    v_lshlrev_b32 v40, 16, v148
    v_and_b32 v41, 0xffff0000, v148
    v_lshlrev_b32 v42, 16, v149
    v_and_b32 v43, 0xffff0000, v149
    v_lshlrev_b32 v44, 16, v150
    v_and_b32 v45, 0xffff0000, v150
    v_lshlrev_b32 v46, 16, v151
    v_and_b32 v47, 0xffff0000, v151
    v_fmac_f32 v16, v40, v49
    v_fmac_f32 v17, v41, v49
    v_fmac_f32 v18, v42, v49
    v_fmac_f32 v19, v43, v49
    v_fmac_f32 v20, v44, v49
    v_fmac_f32 v21, v45, v49
    v_fmac_f32 v22, v46, v49
    v_fmac_f32 v23, v47, v49
    v_lshlrev_b32 v40, 16, v152
    v_and_b32 v41, 0xffff0000, v152
    v_lshlrev_b32 v42, 16, v153
    v_and_b32 v43, 0xffff0000, v153
    v_lshlrev_b32 v44, 16, v154
    v_and_b32 v45, 0xffff0000, v154
    v_lshlrev_b32 v46, 16, v155
    v_and_b32 v47, 0xffff0000, v155
    v_fmac_f32 v16, v40, v50
    v_fmac_f32 v17, v41, v50
    v_fmac_f32 v18, v42, v50
    v_fmac_f32 v19, v43, v50
    v_fmac_f32 v20, v44, v50
    v_fmac_f32 v21, v45, v50
    v_fmac_f32 v22, v46, v50
    v_fmac_f32 v23, v47, v50
    v_lshlrev_b32 v40, 16, v156
    v_and_b32 v41, 0xffff0000, v156
    v_lshlrev_b32 v42, 16, v157
    v_and_b32 v43, 0xffff0000, v157
    v_lshlrev_b32 v44, 16, v158
    v_and_b32 v45, 0xffff0000, v158
    v_lshlrev_b32 v46, 16, v159
    v_and_b32 v47, 0xffff0000, v159
    v_fmac_f32 v16, v40, v51
    v_fmac_f32 v17, v41, v51
    v_fmac_f32 v18, v42, v51
    v_fmac_f32 v19, v43, v51
    v_fmac_f32 v20, v44, v51
    v_fmac_f32 v21, v45, v51
    v_fmac_f32 v22, v46, v51
    v_fmac_f32 v23, v47, v51
    v_dot2_f32_bf16 v28, v160, v24, 0
    v_dot2_f32_bf16 v28, v161, v25, v28
    v_dot2_f32_bf16 v28, v162, v26, v28
    v_dot2_f32_bf16 v28, v163, v27, v28
    v_dot2_f32_bf16 v29, v164, v24, 0
    v_dot2_f32_bf16 v29, v165, v25, v29
    v_dot2_f32_bf16 v29, v166, v26, v29
    v_dot2_f32_bf16 v29, v167, v27, v29
    v_dot2_f32_bf16 v30, v168, v24, 0
    v_dot2_f32_bf16 v30, v169, v25, v30
    v_dot2_f32_bf16 v30, v170, v26, v30
    v_dot2_f32_bf16 v30, v171, v27, v30
    v_dot2_f32_bf16 v31, v172, v24, 0
    v_dot2_f32_bf16 v31, v173, v25, v31
    v_dot2_f32_bf16 v31, v174, v26, v31
    v_dot2_f32_bf16 v31, v175, v27, v31
    s_nop 2
    v_add_f32_dpp v28, v28, v28 row_ror:8 row_mask:0xf bank_mask:0xf
    v_add_f32_dpp v29, v29, v29 row_ror:8 row_mask:0xf bank_mask:0xf
    v_add_f32_dpp v30, v30, v30 row_ror:8 row_mask:0xf bank_mask:0xf
    v_add_f32_dpp v31, v31, v31 row_ror:8 row_mask:0xf bank_mask:0xf
    v_add_f32_dpp v28, v28, v28 row_ror:4 row_mask:0xf bank_mask:0xf
    v_add_f32_dpp v29, v29, v29 row_ror:4 row_mask:0xf bank_mask:0xf
    v_add_f32_dpp v30, v30, v30 row_ror:4 row_mask:0xf bank_mask:0xf
    v_add_f32_dpp v31, v31, v31 row_ror:4 row_mask:0xf bank_mask:0xf
    v_add_f32_dpp v28, v28, v28 row_ror:2 row_mask:0xf bank_mask:0xf
    v_add_f32_dpp v29, v29, v29 row_ror:2 row_mask:0xf bank_mask:0xf
    v_add_f32_dpp v30, v30, v30 row_ror:2 row_mask:0xf bank_mask:0xf
    v_add_f32_dpp v31, v31, v31 row_ror:2 row_mask:0xf bank_mask:0xf
    v_add_f32_dpp v28, v28, v28 row_ror:1 row_mask:0xf bank_mask:0xf
    v_add_f32_dpp v29, v29, v29 row_ror:1 row_mask:0xf bank_mask:0xf
    v_add_f32_dpp v30, v30, v30 row_ror:1 row_mask:0xf bank_mask:0xf
    v_add_f32_dpp v31, v31, v31 row_ror:1 row_mask:0xf bank_mask:0xf
    v_max3_f32 v38, v36, v28, v29
    v_max3_f32 v38, v38, v30, v31
    v_sub_f32 v39, v36, v38
    v_mul_f32 v39, s70, v39
    v_exp_f32 v39, v39
    v_mul_f32 v56, s70, v38
    v_mov_b32 v36, v38
    v_fma_f32 v48, v28, s70, -v56
    v_fma_f32 v49, v29, s70, -v56
    v_fma_f32 v50, v30, s70, -v56
    v_fma_f32 v51, v31, s70, -v56
    v_exp_f32 v48, v48
    v_exp_f32 v49, v49
    v_exp_f32 v50, v50
    v_exp_f32 v51, v51
    v_mul_f32 v37, v37, v39
    v_mul_f32 v16, v16, v39
    v_mul_f32 v17, v17, v39
    v_mul_f32 v18, v18, v39
    v_mul_f32 v19, v19, v39
    v_mul_f32 v20, v20, v39
    v_mul_f32 v21, v21, v39
    v_mul_f32 v22, v22, v39
    v_mul_f32 v23, v23, v39
    v_add_f32 v37, v37, v48
    v_add_f32 v37, v37, v49
    v_add_f32 v37, v37, v50
    v_add_f32 v37, v37, v51
    v_lshlrev_b32 v40, 16, v176
    v_and_b32 v41, 0xffff0000, v176
    v_lshlrev_b32 v42, 16, v177
    v_and_b32 v43, 0xffff0000, v177
    v_lshlrev_b32 v44, 16, v178
    v_and_b32 v45, 0xffff0000, v178
    v_lshlrev_b32 v46, 16, v179
    v_and_b32 v47, 0xffff0000, v179
    v_fmac_f32 v16, v40, v48
    v_fmac_f32 v17, v41, v48
    v_fmac_f32 v18, v42, v48
    v_fmac_f32 v19, v43, v48
    v_fmac_f32 v20, v44, v48
    v_fmac_f32 v21, v45, v48
    v_fmac_f32 v22, v46, v48
    v_fmac_f32 v23, v47, v48
    v_lshlrev_b32 v40, 16, v180
    v_and_b32 v41, 0xffff0000, v180
    v_lshlrev_b32 v42, 16, v181
    v_and_b32 v43, 0xffff0000, v181
    v_lshlrev_b32 v44, 16, v182
    v_and_b32 v45, 0xffff0000, v182
    v_lshlrev_b32 v46, 16, v183
    v_and_b32 v47, 0xffff0000, v183
    v_fmac_f32 v16, v40, v49
    v_fmac_f32 v17, v41, v49
    v_fmac_f32 v18, v42, v49
    v_fmac_f32 v19, v43, v49
    v_fmac_f32 v20, v44, v49
    v_fmac_f32 v21, v45, v49
    v_fmac_f32 v22, v46, v49
    v_fmac_f32 v23, v47, v49
    v_lshlrev_b32 v40, 16, v184
    v_and_b32 v41, 0xffff0000, v184
    v_lshlrev_b32 v42, 16, v185
    v_and_b32 v43, 0xffff0000, v185
    v_lshlrev_b32 v44, 16, v186
    v_and_b32 v45, 0xffff0000, v186
    v_lshlrev_b32 v46, 16, v187
    v_and_b32 v47, 0xffff0000, v187
    v_fmac_f32 v16, v40, v50
    v_fmac_f32 v17, v41, v50
    v_fmac_f32 v18, v42, v50
    v_fmac_f32 v19, v43, v50
    v_fmac_f32 v20, v44, v50
    v_fmac_f32 v21, v45, v50
    v_fmac_f32 v22, v46, v50
    v_fmac_f32 v23, v47, v50
    v_lshlrev_b32 v40, 16, v188
    v_and_b32 v41, 0xffff0000, v188
    v_lshlrev_b32 v42, 16, v189
    v_and_b32 v43, 0xffff0000, v189
    v_lshlrev_b32 v44, 16, v190
    v_and_b32 v45, 0xffff0000, v190
    v_lshlrev_b32 v46, 16, v191
    v_and_b32 v47, 0xffff0000, v191
    v_fmac_f32 v16, v40, v51
    v_fmac_f32 v17, v41, v51
    v_fmac_f32 v18, v42, v51
    v_fmac_f32 v19, v43, v51
    v_fmac_f32 v20, v44, v51
    v_fmac_f32 v21, v45, v51
    v_fmac_f32 v22, v46, v51
    v_fmac_f32 v23, v47, v51
    s_branch LBfin_27
L_join_go:
    s_mov_b64 exec, 1
    v_mov_b32 v8, 1
    ds_add_rtn_u32 v8, v10, v8
    s_mov_b64 exec, -1
    v_lshlrev_b32 v40, 4, v3
    ds_read_b128 v[24:27], v40 offset:0
    v_mov_b32 v36, 0xff7fffff
    v_mov_b32 v37, 0
    v_mov_b32 v16, 0
    v_mov_b32 v17, 0
    v_mov_b32 v18, 0
    v_mov_b32 v19, 0
    v_mov_b32 v20, 0
    v_mov_b32 v21, 0
    v_mov_b32 v22, 0
    v_mov_b32 v23, 0
    v_lshlrev_b32 v6, 5, v3
    v_lshl_add_u32 v6, v2, 3, v6
    s_lshl_b32 s61, s56, 9
    v_add_u32 v7, s61, v6
    s_lshl_b32 s77, s56, 3
    s_mov_b32 s76, 33554432
    s_lshl_b32 s64, s56, 3
    s_add_u32 s64, s64, s67
    v_lshlrev_b32 v11, 4, v1
    s_lshl_b32 s61, s64, 9
    s_add_u32 s61, s61, 512
    v_add_u32 v11, s61, v11
    s_lshl_b32 s61, s64, 4
    s_add_u32 s61, s61, 128
    v_mov_b32 v12, s61
    v_cmp_eq_u32 vcc, 32, v1
    s_add_u32 s89, s65, 32
    s_mul_i32 s89, s89, 16384
    v_cndmask_b32 v11, v11, v12, vcc
    s_waitcnt lgkmcnt(0)
    v_readfirstlane_b32 s84, v8
    s_mov_b64 exec, 1
    v_lshlrev_b32 v8, 2, v8
    ds_read_b32 v9, v8 offset:1024
    s_mov_b64 exec, -1
    s_waitcnt lgkmcnt(0)
    v_readfirstlane_b32 s73, v9
    s_nop 0
    s_cmp_lg_u32 s73, -1
    s_cbranch_scc1 Lg_47
    s_mov_b32 s92, 0
Lgs_48:
    s_sleep 1
    s_mov_b64 exec, 1
    ds_read_b32 v9, v8 offset:1024
    s_mov_b64 exec, -1
    s_waitcnt lgkmcnt(0)
    v_readfirstlane_b32 s73, v9
    s_add_u32 s92, s92, 1
    s_cmp_lg_u32 s73, -1
    s_cbranch_scc1 Lg_47
    s_cmp_lt_u32 s92, 400000
    s_cbranch_scc1 Lgs_48
Lg_47:
    s_cmp_ge_u32 s73, 67108864
    s_cbranch_scc1 LBfin_27
    s_mov_b32 s71, s73
    s_mov_b64 exec, 1
    v_mov_b32 v8, 1
    ds_add_rtn_u32 v8, v10, v8
    s_mov_b64 exec, -1
    buffer_load_dwordx4 v[64:67], v4, s[44:47], s71 offen offset:0 nt
    buffer_load_dwordx4 v[68:71], v4, s[44:47], s71 offen offset:1024 nt
    buffer_load_dwordx4 v[72:75], v4, s[44:47], s71 offen offset:2048 nt
    buffer_load_dwordx4 v[76:79], v4, s[44:47], s71 offen offset:3072 nt
    buffer_load_dwordx4 v[80:83], v4, s[48:51], s71 offen offset:0 nt
    buffer_load_dwordx4 v[84:87], v4, s[48:51], s71 offen offset:1024 nt
    buffer_load_dwordx4 v[88:91], v4, s[48:51], s71 offen offset:2048 nt
    buffer_load_dwordx4 v[92:95], v4, s[48:51], s71 offen offset:3072 nt
    s_waitcnt lgkmcnt(0)
    v_readfirstlane_b32 s84, v8
    s_mov_b64 exec, 1
    v_lshlrev_b32 v8, 2, v8
    ds_read_b32 v9, v8 offset:1024
    s_mov_b64 exec, -1
    s_waitcnt lgkmcnt(0)
    v_readfirstlane_b32 s73, v9
    s_nop 0
    s_cmp_lg_u32 s73, -1
    s_cbranch_scc1 Lg_49
    s_mov_b32 s92, 0
Lgs_50:
    s_sleep 1
    s_mov_b64 exec, 1
    ds_read_b32 v9, v8 offset:1024
    s_mov_b64 exec, -1
    s_waitcnt lgkmcnt(0)
    v_readfirstlane_b32 s73, v9
    s_add_u32 s92, s92, 1
    s_cmp_lg_u32 s73, -1
    s_cbranch_scc1 Lg_49
    s_cmp_lt_u32 s92, 400000
    s_cbranch_scc1 Lgs_50
Lg_49:
    s_branch LBloop2_23
LBfin_27:
    v_mov_b32 v38, v36
    v_mov_b32 v40, v38
    s_nop 1
    v_permlane32_swap_b32 v38, v40
    s_nop 1
    v_max_f32 v38, v38, v40
    v_mov_b32 v40, v38
    s_nop 1
    v_permlane16_swap_b32 v38, v40
    s_nop 1
    v_max_f32 v38, v38, v40
    v_sub_f32 v39, v36, v38
    v_mul_f32 v39, s70, v39
    v_exp_f32 v39, v39
    s_nop 0
    v_mul_f32 v37, v37, v39
    v_mul_f32 v16, v16, v39
    v_mul_f32 v17, v17, v39
    v_mul_f32 v18, v18, v39
    v_mul_f32 v19, v19, v39
    v_mul_f32 v20, v20, v39
    v_mul_f32 v21, v21, v39
    v_mul_f32 v22, v22, v39
    v_mul_f32 v23, v23, v39
    v_mov_b32 v40, v37
    s_nop 1
    v_permlane32_swap_b32 v37, v40
    s_nop 1
    v_add_f32 v37, v37, v40
    v_mov_b32 v40, v37
    s_nop 1
    v_permlane16_swap_b32 v37, v40
    s_nop 1
    v_add_f32 v37, v37, v40
    s_nop 2
    v_permlane32_swap_b32 v16, v20
    v_permlane32_swap_b32 v17, v21
    v_permlane32_swap_b32 v18, v22
    v_permlane32_swap_b32 v19, v23
    s_nop 1
    v_add_f32 v16, v16, v20
    v_add_f32 v17, v17, v21
    v_add_f32 v18, v18, v22
    v_add_f32 v19, v19, v23
    s_nop 1
    v_permlane16_swap_b32 v16, v18
    v_permlane16_swap_b32 v17, v19
    s_nop 1
    v_add_f32 v16, v16, v18
    v_add_f32 v17, v17, v19
    ds_write_b64 v7, v[16:17] offset:4096
    v_mov_b32 v40, v38
    v_mov_b32 v41, v37
    v_mov_b32 v42, s77
    ds_write_b64 v42, v[40:41] offset:12288
    s_cmp_eq_u32 s76, -1
    s_cbranch_scc1 Lns_51
    v_mov_b32 v40, 0xff7fffff
    v_mov_b32 v41, 0
    v_mov_b32 v42, s77
    ds_write_b64 v42, v[40:41] offset:12352
    v_mov_b32 v40, 0
    ds_write_b64 v7, v[40:41] offset:8192
Lns_51:
    s_waitcnt lgkmcnt(0)
L_bend:
    s_barrier
    s_cmp_lt_u32 s56, 2
    s_cbranch_scc1 Lpub_52
    s_cmp_eq_u32 s74, 2
    s_cbranch_scc1 L_t2_head
    s_branch L_end
Lpub_52:
    s_lshl_b32 s62, s56, 6
    v_mov_b32 v42, s62
    ds_read_b128 v[28:31], v42 offset:12288
    ds_read_b128 v[32:35], v42 offset:12304
    ds_read_b128 v[48:51], v42 offset:12320
    ds_read_b128 v[52:55], v42 offset:12336
    v_and_b32 v43, 31, v1
    v_lshlrev_b32 v43, 4, v43
    s_lshl_b32 s62, s56, 12
    v_add_u32 v43, s62, v43
    ds_read_b128 v[64:67], v43 offset:4096
    ds_read_b128 v[68:71], v43 offset:4608
    ds_read_b128 v[72:75], v43 offset:5120
    ds_read_b128 v[76:79], v43 offset:5632
    ds_read_b128 v[80:83], v43 offset:6144
    ds_read_b128 v[84:87], v43 offset:6656
    ds_read_b128 v[88:91], v43 offset:7168
    ds_read_b128 v[92:95], v43 offset:7680
    s_waitcnt lgkmcnt(8)
    v_max3_f32 v38, v28, v30, v32
    v_max3_f32 v38, v38, v34, v48
    v_max3_f32 v38, v38, v50, v52
    v_max_f32 v38, v38, v54
    v_mul_f32 v56, s70, v38
    v_fma_f32 v28, v28, s70, -v56
    v_fma_f32 v30, v30, s70, -v56
    v_fma_f32 v32, v32, s70, -v56
    v_fma_f32 v34, v34, s70, -v56
    v_fma_f32 v48, v48, s70, -v56
    v_fma_f32 v50, v50, s70, -v56
    v_fma_f32 v52, v52, s70, -v56
    v_fma_f32 v54, v54, s70, -v56
    v_exp_f32 v28, v28
    v_exp_f32 v30, v30
    v_exp_f32 v32, v32
    v_exp_f32 v34, v34
    v_exp_f32 v48, v48
    v_exp_f32 v50, v50
    v_exp_f32 v52, v52
    v_exp_f32 v54, v54
    s_nop 0
    v_mul_f32 v37, v28, v29
    v_fmac_f32 v37, v30, v31
    v_fmac_f32 v37, v32, v33
    v_fmac_f32 v37, v34, v35
    v_fmac_f32 v37, v48, v49
    v_fmac_f32 v37, v50, v51
    v_fmac_f32 v37, v52, v53
    v_fmac_f32 v37, v54, v55
    s_waitcnt lgkmcnt(0)
    v_mul_f32 v40, v64, v28
    v_mul_f32 v41, v65, v28
    v_mul_f32 v42, v66, v28
    v_mul_f32 v43, v67, v28
    v_fmac_f32 v40, v68, v30
    v_fmac_f32 v41, v69, v30
    v_fmac_f32 v42, v70, v30
    v_fmac_f32 v43, v71, v30
    v_fmac_f32 v40, v72, v32
    v_fmac_f32 v41, v73, v32
    v_fmac_f32 v42, v74, v32
    v_fmac_f32 v43, v75, v32
    v_fmac_f32 v40, v76, v34
    v_fmac_f32 v41, v77, v34
    v_fmac_f32 v42, v78, v34
    v_fmac_f32 v43, v79, v34
    v_fmac_f32 v40, v80, v48
    v_fmac_f32 v41, v81, v48
    v_fmac_f32 v42, v82, v48
    v_fmac_f32 v43, v83, v48
    v_fmac_f32 v40, v84, v50
    v_fmac_f32 v41, v85, v50
    v_fmac_f32 v42, v86, v50
    v_fmac_f32 v43, v87, v50
    v_fmac_f32 v40, v88, v52
    v_fmac_f32 v41, v89, v52
    v_fmac_f32 v42, v90, v52
    v_fmac_f32 v43, v91, v52
    v_fmac_f32 v40, v92, v54
    v_fmac_f32 v41, v93, v54
    v_fmac_f32 v42, v94, v54
    v_fmac_f32 v43, v95, v54
    v_cmp_eq_u32 vcc, 32, v1
    v_mov_b32 v45, 0
    s_nop 0
    v_cndmask_b32 v40, v40, v38, vcc
    v_cndmask_b32 v41, v41, v37, vcc
    v_cndmask_b32 v42, v42, v45, vcc
    v_cndmask_b32 v43, v43, v45, vcc
    s_mov_b32 exec_lo, -1
    s_mov_b32 exec_hi, 1
    buffer_store_dwordx4 v[40:43], v11, s[32:35], s89 offen sc0 sc1
    s_mov_b64 exec, -1
    s_cmp_eq_u32 s74, 0
    s_cbranch_scc1 L_end
    s_cmp_eq_u32 s74, 2
    s_cbranch_scc1 L_t2_head
    s_branch L_final
Lsw_36:
    v_mov_b32 v38, v36
    v_mov_b32 v40, v38
    s_nop 1
    v_permlane32_swap_b32 v38, v40
    s_nop 1
    v_max_f32 v38, v38, v40
    v_mov_b32 v40, v38
    s_nop 1
    v_permlane16_swap_b32 v38, v40
    s_nop 1
    v_max_f32 v38, v38, v40
    v_sub_f32 v39, v36, v38
    v_mul_f32 v39, s70, v39
    v_exp_f32 v39, v39
    s_nop 0
    v_mul_f32 v37, v37, v39
    v_mul_f32 v16, v16, v39
    v_mul_f32 v17, v17, v39
    v_mul_f32 v18, v18, v39
    v_mul_f32 v19, v19, v39
    v_mul_f32 v20, v20, v39
    v_mul_f32 v21, v21, v39
    v_mul_f32 v22, v22, v39
    v_mul_f32 v23, v23, v39
    v_mov_b32 v40, v37
    s_nop 1
    v_permlane32_swap_b32 v37, v40
    s_nop 1
    v_add_f32 v37, v37, v40
    v_mov_b32 v40, v37
    s_nop 1
    v_permlane16_swap_b32 v37, v40
    s_nop 1
    v_add_f32 v37, v37, v40
    s_nop 2
    v_permlane32_swap_b32 v16, v20
    v_permlane32_swap_b32 v17, v21
    v_permlane32_swap_b32 v18, v22
    v_permlane32_swap_b32 v19, v23
    s_nop 1
    v_add_f32 v16, v16, v20
    v_add_f32 v17, v17, v21
    v_add_f32 v18, v18, v22
    v_add_f32 v19, v19, v23
    s_nop 1
    v_permlane16_swap_b32 v16, v18
    v_permlane16_swap_b32 v17, v19
    s_nop 1
    v_add_f32 v16, v16, v18
    v_add_f32 v17, v17, v19
    ds_write_b64 v7, v[16:17] offset:4096
    v_mov_b32 v40, v38
    v_mov_b32 v41, v37
    v_mov_b32 v42, s77
    ds_write_b64 v42, v[40:41] offset:12288
    v_lshlrev_b32 v44, 4, v3
    ds_read_b128 v[24:27], v44 offset:256
    v_mov_b32 v36, 0xff7fffff
    v_mov_b32 v37, 0
    v_mov_b32 v16, 0
    v_mov_b32 v17, 0
    v_mov_b32 v18, 0
    v_mov_b32 v19, 0
    v_mov_b32 v20, 0
    v_mov_b32 v21, 0
    v_mov_b32 v22, 0
    v_mov_b32 v23, 0
    v_add_u32 v7, 4096, v7
    s_add_u32 s77, s77, 64
    s_mov_b32 s76, -1
    s_waitcnt lgkmcnt(0)
    s_branch Lswb_37
Lsw_40:
    v_mov_b32 v38, v36
    v_mov_b32 v40, v38
    s_nop 1
    v_permlane32_swap_b32 v38, v40
    s_nop 1
    v_max_f32 v38, v38, v40
    v_mov_b32 v40, v38
    s_nop 1
    v_permlane16_swap_b32 v38, v40
    s_nop 1
    v_max_f32 v38, v38, v40
    v_sub_f32 v39, v36, v38
    v_mul_f32 v39, s70, v39
    v_exp_f32 v39, v39
    s_nop 0
    v_mul_f32 v37, v37, v39
    v_mul_f32 v16, v16, v39
    v_mul_f32 v17, v17, v39
    v_mul_f32 v18, v18, v39
    v_mul_f32 v19, v19, v39
    v_mul_f32 v20, v20, v39
    v_mul_f32 v21, v21, v39
    v_mul_f32 v22, v22, v39
    v_mul_f32 v23, v23, v39
    v_mov_b32 v40, v37
    s_nop 1
    v_permlane32_swap_b32 v37, v40
    s_nop 1
    v_add_f32 v37, v37, v40
    v_mov_b32 v40, v37
    s_nop 1
    v_permlane16_swap_b32 v37, v40
    s_nop 1
    v_add_f32 v37, v37, v40
    s_nop 2
    v_permlane32_swap_b32 v16, v20
    v_permlane32_swap_b32 v17, v21
    v_permlane32_swap_b32 v18, v22
    v_permlane32_swap_b32 v19, v23
    s_nop 1
    v_add_f32 v16, v16, v20
    v_add_f32 v17, v17, v21
    v_add_f32 v18, v18, v22
    v_add_f32 v19, v19, v23
    s_nop 1
    v_permlane16_swap_b32 v16, v18
    v_permlane16_swap_b32 v17, v19
    s_nop 1
    v_add_f32 v16, v16, v18
    v_add_f32 v17, v17, v19
    ds_write_b64 v7, v[16:17] offset:4096
    v_mov_b32 v40, v38
    v_mov_b32 v41, v37
    v_mov_b32 v42, s77
    ds_write_b64 v42, v[40:41] offset:12288
    v_lshlrev_b32 v44, 4, v3
    ds_read_b128 v[24:27], v44 offset:256
    v_mov_b32 v36, 0xff7fffff
    v_mov_b32 v37, 0
    v_mov_b32 v16, 0
    v_mov_b32 v17, 0
    v_mov_b32 v18, 0
    v_mov_b32 v19, 0
    v_mov_b32 v20, 0
    v_mov_b32 v21, 0
    v_mov_b32 v22, 0
    v_mov_b32 v23, 0
    v_add_u32 v7, 4096, v7
    s_add_u32 s77, s77, 64
    s_mov_b32 s76, -1
    s_waitcnt lgkmcnt(0)
    s_branch Lswb_41
Lsw_44:
    v_mov_b32 v38, v36
    v_mov_b32 v40, v38
    s_nop 1
    v_permlane32_swap_b32 v38, v40
    s_nop 1
    v_max_f32 v38, v38, v40
    v_mov_b32 v40, v38
    s_nop 1
    v_permlane16_swap_b32 v38, v40
    s_nop 1
    v_max_f32 v38, v38, v40
    v_sub_f32 v39, v36, v38
    v_mul_f32 v39, s70, v39
    v_exp_f32 v39, v39
    s_nop 0
    v_mul_f32 v37, v37, v39
    v_mul_f32 v16, v16, v39
    v_mul_f32 v17, v17, v39
    v_mul_f32 v18, v18, v39
    v_mul_f32 v19, v19, v39
    v_mul_f32 v20, v20, v39
    v_mul_f32 v21, v21, v39
    v_mul_f32 v22, v22, v39
    v_mul_f32 v23, v23, v39
    v_mov_b32 v40, v37
    s_nop 1
    v_permlane32_swap_b32 v37, v40
    s_nop 1
    v_add_f32 v37, v37, v40
    v_mov_b32 v40, v37
    s_nop 1
    v_permlane16_swap_b32 v37, v40
    s_nop 1
    v_add_f32 v37, v37, v40
    s_nop 2
    v_permlane32_swap_b32 v16, v20
    v_permlane32_swap_b32 v17, v21
    v_permlane32_swap_b32 v18, v22
    v_permlane32_swap_b32 v19, v23
    s_nop 1
    v_add_f32 v16, v16, v20
    v_add_f32 v17, v17, v21
    v_add_f32 v18, v18, v22
    v_add_f32 v19, v19, v23
    s_nop 1
    v_permlane16_swap_b32 v16, v18
    v_permlane16_swap_b32 v17, v19
    s_nop 1
    v_add_f32 v16, v16, v18
    v_add_f32 v17, v17, v19
    ds_write_b64 v7, v[16:17] offset:4096
    v_mov_b32 v40, v38
    v_mov_b32 v41, v37
    v_mov_b32 v42, s77
    ds_write_b64 v42, v[40:41] offset:12288
    v_lshlrev_b32 v44, 4, v3
    ds_read_b128 v[24:27], v44 offset:256
    v_mov_b32 v36, 0xff7fffff
    v_mov_b32 v37, 0
    v_mov_b32 v16, 0
    v_mov_b32 v17, 0
    v_mov_b32 v18, 0
    v_mov_b32 v19, 0
    v_mov_b32 v20, 0
    v_mov_b32 v21, 0
    v_mov_b32 v22, 0
    v_mov_b32 v23, 0
    v_add_u32 v7, 4096, v7
    s_add_u32 s77, s77, 64
    s_mov_b32 s76, -1
    s_waitcnt lgkmcnt(0)
    s_branch Lswb_45
L_join:
    s_mov_b32 s78, 0
    s_mov_b32 s79, 0
    s_mov_b32 s80, 0
    s_mov_b32 s81, 0
    v_and_b32 v1, 63, v0
    v_lshrrev_b32 v2, 4, v1
    v_and_b32 v3, 15, v1
    s_lshl_b32 s61, s65, 20
    s_add_u32 s44, s18, s61
    s_addc_u32 s45, s19, 0
    s_and_b32 s45, s45, 0xffff
    s_mov_b32 s46, 34603008
    s_mov_b32 s47, 0x00020000
    s_add_u32 s48, s20, s61
    s_addc_u32 s49, s21, 0
    s_and_b32 s49, s49, 0xffff
    s_mov_b32 s50, 34603008
    s_mov_b32 s51, 0x00020000
    s_lshl_b32 s83, s65, 8
    s_add_u32 s83, s83, 1507328
    v_lshlrev_b32 v4, 4, v1
    s_mov_b32 s70, 1040356334
    v_mov_b32 v60, 0
    v_mov_b32 v10, 512
    s_mul_i32 s88, s65, 252
    s_and_b32 s88, s88, 255
    s_cmp_eq_u32 s56, 7
    s_cbranch_scc1 Lj7_53
    s_barrier
    s_branch L_join_go
Lj7_53:
    s_setprio 3
    s_branch L_svc_q
L_roleA:
    s_cmp_eq_u32 s74, 2
    s_cselect_b32 s75, 32, 0
    s_add_u32 s75, s75, s65
    v_and_b32 v1, 63, v0
    v_lshrrev_b32 v2, 4, v1
    v_and_b32 v3, 15, v1
    v_lshlrev_b32 v5, 4, v1
    v_lshlrev_b32 v4, 17, v2
    v_lshl_add_u32 v4, v3, 4, v4
    s_mov_b32 s68, 0x05040100
    s_mov_b32 s69, 0x07060302
    s_mul_i32 s93, s75, 16384
    v_mov_b32 v40, -1
    v_mov_b32 v41, -1
    v_mov_b32 v42, -1
    v_mov_b32 v43, -1
    v_lshlrev_b32 v44, 4, v0
    buffer_store_dwordx4 v[40:43], v44, s[32:35], s93 offen sc0 sc1
    v_cmp_gt_u32 vcc, 4608, v44
    s_and_saveexec_b64 s[94:95], vcc
    s_cbranch_execz Lci_54
    s_add_u32 s61, s93, 8192
    buffer_store_dwordx4 v[40:43], v44, s[32:35], s61 offen sc0 sc1
Lci_54:
    s_mov_b64 exec, s[94:95]
    s_cmp_lg_u32 s56, 5
    s_cbranch_scc1 Lcq_55
    v_mov_b32 v46, 0
    v_mov_b32 v47, 65536
    s_lshl_b32 s61, s75, 8
    s_add_u32 s61, s61, 1507328
    s_mov_b64 exec, 1
    buffer_store_dword v47, v46, s[32:35], s61 offen sc0 sc1
    s_mov_b64 exec, -1
Lcq_55:
    s_cmp_lg_u32 s56, 6
    s_cbranch_scc1 Lcq_56
    s_lshl_b32 s61, s75, 10
    s_add_u32 s61, s61, 1146880
    buffer_store_dwordx4 v[40:43], v5, s[32:35], s61 offen sc0 sc1
Lcq_56:
    s_barrier
    s_cmp_lt_u32 s75, 32
    s_cbranch_scc1 L_roleT1
    s_sub_u32 s65, s75, 32
    s_lshl_b32 s61, s65, 18
    s_add_u32 s44, s6, s61
    s_addc_u32 s45, s7, 0
    s_and_b32 s45, s45, 0xffff
    s_mov_b32 s46, 262144
    s_mov_b32 s47, 0x00020000
    s_mul_i32 s89, s56, 2
    s_mul_i32 s61, s65, 5
    s_add_u32 s89, s89, s61
    s_cmp_eq_u32 s56, 7
    s_cbranch_scc1 Lt2s_57
    s_lshl_b32 s85, s56, 14
    s_add_u32 m0, s85, 0
    v_xor_b32 v52, 0, v5
    s_add_u32 s86, s89, 0
    s_and_b32 s86, s86, 15
    s_lshl_b32 s86, s86, 10
    s_add_u32 s86, s86, s85
    buffer_load_dwordx4 v52, s[44:47], s86 offen nt lds
    s_add_u32 m0, s85, 1024
    v_xor_b32 v53, 64, v5
    s_add_u32 s86, s89, 1
    s_and_b32 s86, s86, 15
    s_lshl_b32 s86, s86, 10
    s_add_u32 s86, s86, s85
    buffer_load_dwordx4 v53, s[44:47], s86 offen nt lds
    s_add_u32 m0, s85, 2048
    v_xor_b32 v52, 128, v5
    s_add_u32 s86, s89, 2
    s_and_b32 s86, s86, 15
    s_lshl_b32 s86, s86, 10
    s_add_u32 s86, s86, s85
    buffer_load_dwordx4 v52, s[44:47], s86 offen nt lds
    s_add_u32 m0, s85, 3072
    v_xor_b32 v53, 192, v5
    s_add_u32 s86, s89, 3
    s_and_b32 s86, s86, 15
    s_lshl_b32 s86, s86, 10
    s_add_u32 s86, s86, s85
    buffer_load_dwordx4 v53, s[44:47], s86 offen nt lds
    s_waitcnt vmcnt(4)
    v_perm_b32 v232, v196, v192, s68
    v_perm_b32 v233, v196, v192, s69
    v_perm_b32 v234, v197, v193, s68
    v_perm_b32 v235, v197, v193, s69
    v_perm_b32 v236, v198, v194, s68
    v_perm_b32 v237, v198, v194, s69
    v_perm_b32 v238, v199, v195, s68
    v_perm_b32 v239, v199, v195, s69
    v_dot2_f32_bf16 v212, v232, v208, 0
    v_dot2_f32_bf16 v213, v233, v208, 0
    v_dot2_f32_bf16 v214, v234, v208, 0
    v_dot2_f32_bf16 v215, v235, v208, 0
    v_dot2_f32_bf16 v216, v236, v208, 0
    v_dot2_f32_bf16 v217, v237, v208, 0
    v_dot2_f32_bf16 v218, v238, v208, 0
    v_dot2_f32_bf16 v219, v239, v208, 0
    v_dot2_f32_bf16 v220, v232, v210, 0
    v_dot2_f32_bf16 v221, v233, v210, 0
    v_dot2_f32_bf16 v222, v234, v210, 0
    v_dot2_f32_bf16 v223, v235, v210, 0
    v_dot2_f32_bf16 v224, v236, v210, 0
    v_dot2_f32_bf16 v225, v237, v210, 0
    v_dot2_f32_bf16 v226, v238, v210, 0
    v_dot2_f32_bf16 v227, v239, v210, 0
    v_perm_b32 v232, v204, v200, s68
    v_perm_b32 v233, v204, v200, s69
    v_perm_b32 v234, v205, v201, s68
    v_perm_b32 v235, v205, v201, s69
    v_perm_b32 v236, v206, v202, s68
    v_perm_b32 v237, v206, v202, s69
    v_perm_b32 v238, v207, v203, s68
    v_perm_b32 v239, v207, v203, s69
    v_dot2_f32_bf16 v212, v232, v209, v212
    v_dot2_f32_bf16 v213, v233, v209, v213
    v_dot2_f32_bf16 v214, v234, v209, v214
    v_dot2_f32_bf16 v215, v235, v209, v215
    v_dot2_f32_bf16 v216, v236, v209, v216
    v_dot2_f32_bf16 v217, v237, v209, v217
    v_dot2_f32_bf16 v218, v238, v209, v218
    v_dot2_f32_bf16 v219, v239, v209, v219
    v_dot2_f32_bf16 v220, v232, v211, v220
    v_dot2_f32_bf16 v221, v233, v211, v221
    v_dot2_f32_bf16 v222, v234, v211, v222
    v_dot2_f32_bf16 v223, v235, v211, v223
    v_dot2_f32_bf16 v224, v236, v211, v224
    v_dot2_f32_bf16 v225, v237, v211, v225
    v_dot2_f32_bf16 v226, v238, v211, v226
    v_dot2_f32_bf16 v227, v239, v211, v227
    s_nop 2
    v_permlane32_swap_b32 v212, v220
    v_permlane32_swap_b32 v213, v221
    v_permlane32_swap_b32 v214, v222
    v_permlane32_swap_b32 v215, v223
    v_permlane32_swap_b32 v216, v224
    v_permlane32_swap_b32 v217, v225
    v_permlane32_swap_b32 v218, v226
    v_permlane32_swap_b32 v219, v227
    s_nop 1
    v_add_f32 v212, v212, v220
    v_add_f32 v213, v213, v221
    v_add_f32 v214, v214, v222
    v_add_f32 v215, v215, v223
    v_add_f32 v216, v216, v224
    v_add_f32 v217, v217, v225
    v_add_f32 v218, v218, v226
    v_add_f32 v219, v219, v227
    s_nop 1
    v_permlane16_swap_b32 v212, v216
    v_permlane16_swap_b32 v213, v217
    v_permlane16_swap_b32 v214, v218
    v_permlane16_swap_b32 v215, v219
    s_nop 1
    v_add_f32 v212, v212, v216
    v_add_f32 v213, v213, v217
    v_add_f32 v214, v214, v218
    v_add_f32 v215, v215, v219
    s_nop 1
    v_add_f32_dpp v212, v212, v212 row_ror:8 row_mask:0xf bank_mask:0xf
    v_add_f32_dpp v213, v213, v213 row_ror:8 row_mask:0xf bank_mask:0xf
    v_add_f32_dpp v214, v214, v214 row_ror:8 row_mask:0xf bank_mask:0xf
    v_add_f32_dpp v215, v215, v215 row_ror:8 row_mask:0xf bank_mask:0xf
    v_lshrrev_b32 v232, 5, v228
    v_lshlrev_b32 v232, 8, v232
    v_bfe_u32 v233, v228, 4, 1
    v_lshl_add_u32 v232, v233, 4, v232
    v_lshl_add_u32 v232, v230, 5, v232
    s_lshl_b32 s61, s56, 9
    s_add_u32 s61, s61, 147456
    v_add_u32 v232, s61, v232
    ds_write_b128 v232, v[212:215]
    s_waitcnt lgkmcnt(0)
    s_barrier
    s_waitcnt vmcnt(4)
    s_add_u32 m0, s85, 4096
    v_xor_b32 v52, 0, v5
    s_add_u32 s86, s89, 4
    s_and_b32 s86, s86, 15
    s_lshl_b32 s86, s86, 10
    s_add_u32 s86, s86, s85
    buffer_load_dwordx4 v52, s[44:47], s86 offen nt lds
    s_waitcnt vmcnt(4)
    s_add_u32 m0, s85, 5120
    v_xor_b32 v53, 64, v5
    s_add_u32 s86, s89, 5
    s_and_b32 s86, s86, 15
    s_lshl_b32 s86, s86, 10
    s_add_u32 s86, s86, s85
    buffer_load_dwordx4 v53, s[44:47], s86 offen nt lds
    s_waitcnt vmcnt(4)
    s_add_u32 m0, s85, 6144
    v_xor_b32 v52, 128, v5
    s_add_u32 s86, s89, 6
    s_and_b32 s86, s86, 15
    s_lshl_b32 s86, s86, 10
    s_add_u32 s86, s86, s85
    buffer_load_dwordx4 v52, s[44:47], s86 offen nt lds
    s_waitcnt vmcnt(4)
    s_add_u32 m0, s85, 7168
    v_xor_b32 v53, 192, v5
    s_add_u32 s86, s89, 7
    s_and_b32 s86, s86, 15
    s_lshl_b32 s86, s86, 10
    s_add_u32 s86, s86, s85
    buffer_load_dwordx4 v53, s[44:47], s86 offen nt lds
    s_waitcnt vmcnt(4)
    s_add_u32 m0, s85, 8192
    v_xor_b32 v52, 32, v5
    s_add_u32 s86, s89, 8
    s_and_b32 s86, s86, 15
    s_lshl_b32 s86, s86, 10
    s_add_u32 s86, s86, s85
    buffer_load_dwordx4 v52, s[44:47], s86 offen nt lds
    s_waitcnt vmcnt(4)
    s_add_u32 m0, s85, 9216
    v_xor_b32 v53, 96, v5
    s_add_u32 s86, s89, 9
    s_and_b32 s86, s86, 15
    s_lshl_b32 s86, s86, 10
    s_add_u32 s86, s86, s85
    buffer_load_dwordx4 v53, s[44:47], s86 offen nt lds
    s_waitcnt vmcnt(4)
    s_add_u32 m0, s85, 10240
    v_xor_b32 v52, 160, v5
    s_add_u32 s86, s89, 10
    s_and_b32 s86, s86, 15
    s_lshl_b32 s86, s86, 10
    s_add_u32 s86, s86, s85
    buffer_load_dwordx4 v52, s[44:47], s86 offen nt lds
    s_waitcnt vmcnt(4)
    s_add_u32 m0, s85, 11264
    v_xor_b32 v53, 224, v5
    s_add_u32 s86, s89, 11
    s_and_b32 s86, s86, 15
    s_lshl_b32 s86, s86, 10
    s_add_u32 s86, s86, s85
    buffer_load_dwordx4 v53, s[44:47], s86 offen nt lds
    s_waitcnt vmcnt(4)
    s_add_u32 m0, s85, 12288
    v_xor_b32 v52, 32, v5
    s_add_u32 s86, s89, 12
    s_and_b32 s86, s86, 15
    s_lshl_b32 s86, s86, 10
    s_add_u32 s86, s86, s85
    buffer_load_dwordx4 v52, s[44:47], s86 offen nt lds
    s_waitcnt vmcnt(4)
    s_add_u32 m0, s85, 13312
    v_xor_b32 v53, 96, v5
    s_add_u32 s86, s89, 13
    s_and_b32 s86, s86, 15
    s_lshl_b32 s86, s86, 10
    s_add_u32 s86, s86, s85
    buffer_load_dwordx4 v53, s[44:47], s86 offen nt lds
    s_waitcnt vmcnt(4)
    s_add_u32 m0, s85, 14336
    v_xor_b32 v52, 160, v5
    s_add_u32 s86, s89, 14
    s_and_b32 s86, s86, 15
    s_lshl_b32 s86, s86, 10
    s_add_u32 s86, s86, s85
    buffer_load_dwordx4 v52, s[44:47], s86 offen nt lds
    s_waitcnt vmcnt(4)
    s_add_u32 m0, s85, 15360
    v_xor_b32 v53, 224, v5
    s_add_u32 s86, s89, 15
    s_and_b32 s86, s86, 15
    s_lshl_b32 s86, s86, 10
    s_add_u32 s86, s86, s85
    buffer_load_dwordx4 v53, s[44:47], s86 offen nt lds
    s_branch Lt2j_58
Lt2s_57:
    s_setprio 3
    s_waitcnt vmcnt(0)
    v_perm_b32 v232, v196, v192, s68
    v_perm_b32 v233, v196, v192, s69
    v_perm_b32 v234, v197, v193, s68
    v_perm_b32 v235, v197, v193, s69
    v_perm_b32 v236, v198, v194, s68
    v_perm_b32 v237, v198, v194, s69
    v_perm_b32 v238, v199, v195, s68
    v_perm_b32 v239, v199, v195, s69
    v_dot2_f32_bf16 v212, v232, v208, 0
    v_dot2_f32_bf16 v213, v233, v208, 0
    v_dot2_f32_bf16 v214, v234, v208, 0
    v_dot2_f32_bf16 v215, v235, v208, 0
    v_dot2_f32_bf16 v216, v236, v208, 0
    v_dot2_f32_bf16 v217, v237, v208, 0
    v_dot2_f32_bf16 v218, v238, v208, 0
    v_dot2_f32_bf16 v219, v239, v208, 0
    v_dot2_f32_bf16 v220, v232, v210, 0
    v_dot2_f32_bf16 v221, v233, v210, 0
    v_dot2_f32_bf16 v222, v234, v210, 0
    v_dot2_f32_bf16 v223, v235, v210, 0
    v_dot2_f32_bf16 v224, v236, v210, 0
    v_dot2_f32_bf16 v225, v237, v210, 0
    v_dot2_f32_bf16 v226, v238, v210, 0
    v_dot2_f32_bf16 v227, v239, v210, 0
    v_perm_b32 v232, v204, v200, s68
    v_perm_b32 v233, v204, v200, s69
    v_perm_b32 v234, v205, v201, s68
    v_perm_b32 v235, v205, v201, s69
    v_perm_b32 v236, v206, v202, s68
    v_perm_b32 v237, v206, v202, s69
    v_perm_b32 v238, v207, v203, s68
    v_perm_b32 v239, v207, v203, s69
    v_dot2_f32_bf16 v212, v232, v209, v212
    v_dot2_f32_bf16 v213, v233, v209, v213
    v_dot2_f32_bf16 v214, v234, v209, v214
    v_dot2_f32_bf16 v215, v235, v209, v215
    v_dot2_f32_bf16 v216, v236, v209, v216
    v_dot2_f32_bf16 v217, v237, v209, v217
    v_dot2_f32_bf16 v218, v238, v209, v218
    v_dot2_f32_bf16 v219, v239, v209, v219
    v_dot2_f32_bf16 v220, v232, v211, v220
    v_dot2_f32_bf16 v221, v233, v211, v221
    v_dot2_f32_bf16 v222, v234, v211, v222
    v_dot2_f32_bf16 v223, v235, v211, v223
    v_dot2_f32_bf16 v224, v236, v211, v224
    v_dot2_f32_bf16 v225, v237, v211, v225
    v_dot2_f32_bf16 v226, v238, v211, v226
    v_dot2_f32_bf16 v227, v239, v211, v227
    s_nop 2
    v_permlane32_swap_b32 v212, v220
    v_permlane32_swap_b32 v213, v221
    v_permlane32_swap_b32 v214, v222
    v_permlane32_swap_b32 v215, v223
    v_permlane32_swap_b32 v216, v224
    v_permlane32_swap_b32 v217, v225
    v_permlane32_swap_b32 v218, v226
    v_permlane32_swap_b32 v219, v227
    s_nop 1
    v_add_f32 v212, v212, v220
    v_add_f32 v213, v213, v221
    v_add_f32 v214, v214, v222
    v_add_f32 v215, v215, v223
    v_add_f32 v216, v216, v224
    v_add_f32 v217, v217, v225
    v_add_f32 v218, v218, v226
    v_add_f32 v219, v219, v227
    s_nop 1
    v_permlane16_swap_b32 v212, v216
    v_permlane16_swap_b32 v213, v217
    v_permlane16_swap_b32 v214, v218
    v_permlane16_swap_b32 v215, v219
    s_nop 1
    v_add_f32 v212, v212, v216
    v_add_f32 v213, v213, v217
    v_add_f32 v214, v214, v218
    v_add_f32 v215, v215, v219
    s_nop 1
    v_add_f32_dpp v212, v212, v212 row_ror:8 row_mask:0xf bank_mask:0xf
    v_add_f32_dpp v213, v213, v213 row_ror:8 row_mask:0xf bank_mask:0xf
    v_add_f32_dpp v214, v214, v214 row_ror:8 row_mask:0xf bank_mask:0xf
    v_add_f32_dpp v215, v215, v215 row_ror:8 row_mask:0xf bank_mask:0xf
    v_lshrrev_b32 v232, 5, v228
    v_lshlrev_b32 v232, 8, v232
    v_bfe_u32 v233, v228, 4, 1
    v_lshl_add_u32 v232, v233, 4, v232
    v_lshl_add_u32 v232, v230, 5, v232
    s_lshl_b32 s61, s56, 9
    s_add_u32 s61, s61, 147456
    v_add_u32 v232, s61, v232
    ds_write_b128 v232, v[212:215]
    s_waitcnt lgkmcnt(0)
    s_barrier
    v_mov_b32 v48, 1
    v_mov_b32 v49, 0
    s_mov_b64 exec, 1
    buffer_atomic_add v48, v49, s[52:55], 0 offen offset:128 sc1
    s_mov_b64 exec, -1
    v_mov_b32 v234, 0
    buffer_load_dword v235, v234, s[52:55], s91 offen offset:0 sc0 sc1
    v_and_b32 v232, 31, v228
    v_lshlrev_b32 v233, 4, v232
    v_add_u32 v233, 147456, v233
    ds_read_b128 v[192:195], v233 offset:0
    ds_read_b128 v[196:199], v233 offset:512
    ds_read_b128 v[200:203], v233 offset:1024
    ds_read_b128 v[204:207], v233 offset:1536
    ds_read_b128 v[208:211], v233 offset:2048
    ds_read_b128 v[212:215], v233 offset:2560
    ds_read_b128 v[216:219], v233 offset:3072
    ds_read_b128 v[220:223], v233 offset:3584
    s_waitcnt lgkmcnt(6)
    v_add_f32 v192, v192, v196
    v_add_f32 v193, v193, v197
    v_add_f32 v194, v194, v198
    v_add_f32 v195, v195, v199
    s_waitcnt lgkmcnt(5)
    v_add_f32 v192, v192, v200
    v_add_f32 v193, v193, v201
    v_add_f32 v194, v194, v202
    v_add_f32 v195, v195, v203
    s_waitcnt lgkmcnt(4)
    v_add_f32 v192, v192, v204
    v_add_f32 v193, v193, v205
    v_add_f32 v194, v194, v206
    v_add_f32 v195, v195, v207
    s_waitcnt lgkmcnt(3)
    v_add_f32 v192, v192, v208
    v_add_f32 v193, v193, v209
    v_add_f32 v194, v194, v210
    v_add_f32 v195, v195, v211
    s_waitcnt lgkmcnt(2)
    v_add_f32 v192, v192, v212
    v_add_f32 v193, v193, v213
    v_add_f32 v194, v194, v214
    v_add_f32 v195, v195, v215
    s_waitcnt lgkmcnt(1)
    v_add_f32 v192, v192, v216
    v_add_f32 v193, v193, v217
    v_add_f32 v194, v194, v218
    v_add_f32 v195, v195, v219
    s_waitcnt lgkmcnt(0)
    v_add_f32 v192, v192, v220
    v_add_f32 v193, v193, v221
    v_add_f32 v194, v194, v222
    v_add_f32 v195, v195, v223
    v_lshrrev_b32 v233, 4, v232
    v_lshlrev_b32 v233, 10, v233
    v_and_b32 v232, 15, v232
    v_lshl_add_u32 v233, v232, 4, v233
    s_waitcnt vmcnt(0)
    s_mov_b32 s92, 0
Lcf_59:
    v_readfirstlane_b32 s57, v235
    s_nop 3
    s_cmp_lg_u32 s57, 0
    s_cbranch_scc1 Lcfd_60
    s_sleep 2
    buffer_load_dword v235, v234, s[52:55], s91 offen offset:0 sc0 sc1
    s_waitcnt vmcnt(0)
    s_add_u32 s92, s92, 1
    s_cmp_lt_u32 s92, 400000
    s_cbranch_scc1 Lcf_59
Lcfd_60:
    s_mov_b64 exec, 0xffffffff
    buffer_store_dwordx4 v[192:195], v233, s[32:35], s3 offen sc0 sc1
    s_mov_b64 exec, -1
    s_setprio 0
    s_lshl_b32 s85, s56, 14
    s_add_u32 m0, s85, 0
    v_xor_b32 v52, 0, v5
    s_add_u32 s86, s89, 0
    s_and_b32 s86, s86, 15
    s_lshl_b32 s86, s86, 10
    s_add_u32 s86, s86, s85
    buffer_load_dwordx4 v52, s[44:47], s86 offen nt lds
    s_add_u32 m0, s85, 1024
    v_xor_b32 v53, 64, v5
    s_add_u32 s86, s89, 1
    s_and_b32 s86, s86, 15
    s_lshl_b32 s86, s86, 10
    s_add_u32 s86, s86, s85
    buffer_load_dwordx4 v53, s[44:47], s86 offen nt lds
    s_add_u32 m0, s85, 2048
    v_xor_b32 v52, 128, v5
    s_add_u32 s86, s89, 2
    s_and_b32 s86, s86, 15
    s_lshl_b32 s86, s86, 10
    s_add_u32 s86, s86, s85
    buffer_load_dwordx4 v52, s[44:47], s86 offen nt lds
    s_add_u32 m0, s85, 3072
    v_xor_b32 v53, 192, v5
    s_add_u32 s86, s89, 3
    s_and_b32 s86, s86, 15
    s_lshl_b32 s86, s86, 10
    s_add_u32 s86, s86, s85
    buffer_load_dwordx4 v53, s[44:47], s86 offen nt lds
    s_add_u32 m0, s85, 4096
    v_xor_b32 v52, 0, v5
    s_add_u32 s86, s89, 4
    s_and_b32 s86, s86, 15
    s_lshl_b32 s86, s86, 10
    s_add_u32 s86, s86, s85
    buffer_load_dwordx4 v52, s[44:47], s86 offen nt lds
    s_add_u32 m0, s85, 5120
    v_xor_b32 v53, 64, v5
    s_add_u32 s86, s89, 5
    s_and_b32 s86, s86, 15
    s_lshl_b32 s86, s86, 10
    s_add_u32 s86, s86, s85
    buffer_load_dwordx4 v53, s[44:47], s86 offen nt lds
    s_add_u32 m0, s85, 6144
    v_xor_b32 v52, 128, v5
    s_add_u32 s86, s89, 6
    s_and_b32 s86, s86, 15
    s_lshl_b32 s86, s86, 10
    s_add_u32 s86, s86, s85
    buffer_load_dwordx4 v52, s[44:47], s86 offen nt lds
    s_add_u32 m0, s85, 7168
    v_xor_b32 v53, 192, v5
    s_add_u32 s86, s89, 7
    s_and_b32 s86, s86, 15
    s_lshl_b32 s86, s86, 10
    s_add_u32 s86, s86, s85
    buffer_load_dwordx4 v53, s[44:47], s86 offen nt lds
    s_add_u32 m0, s85, 8192
    v_xor_b32 v52, 32, v5
    s_add_u32 s86, s89, 8
    s_and_b32 s86, s86, 15
    s_lshl_b32 s86, s86, 10
    s_add_u32 s86, s86, s85
    buffer_load_dwordx4 v52, s[44:47], s86 offen nt lds
    s_add_u32 m0, s85, 9216
    v_xor_b32 v53, 96, v5
    s_add_u32 s86, s89, 9
    s_and_b32 s86, s86, 15
    s_lshl_b32 s86, s86, 10
    s_add_u32 s86, s86, s85
    buffer_load_dwordx4 v53, s[44:47], s86 offen nt lds
    s_add_u32 m0, s85, 10240
    v_xor_b32 v52, 160, v5
    s_add_u32 s86, s89, 10
    s_and_b32 s86, s86, 15
    s_lshl_b32 s86, s86, 10
    s_add_u32 s86, s86, s85
    buffer_load_dwordx4 v52, s[44:47], s86 offen nt lds
    s_add_u32 m0, s85, 11264
    v_xor_b32 v53, 224, v5
    s_add_u32 s86, s89, 11
    s_and_b32 s86, s86, 15
    s_lshl_b32 s86, s86, 10
    s_add_u32 s86, s86, s85
    buffer_load_dwordx4 v53, s[44:47], s86 offen nt lds
    s_add_u32 m0, s85, 12288
    v_xor_b32 v52, 32, v5
    s_add_u32 s86, s89, 12
    s_and_b32 s86, s86, 15
    s_lshl_b32 s86, s86, 10
    s_add_u32 s86, s86, s85
    buffer_load_dwordx4 v52, s[44:47], s86 offen nt lds
    s_add_u32 m0, s85, 13312
    v_xor_b32 v53, 96, v5
    s_add_u32 s86, s89, 13
    s_and_b32 s86, s86, 15
    s_lshl_b32 s86, s86, 10
    s_add_u32 s86, s86, s85
    buffer_load_dwordx4 v53, s[44:47], s86 offen nt lds
    s_add_u32 m0, s85, 14336
    v_xor_b32 v52, 160, v5
    s_add_u32 s86, s89, 14
    s_and_b32 s86, s86, 15
    s_lshl_b32 s86, s86, 10
    s_add_u32 s86, s86, s85
    buffer_load_dwordx4 v52, s[44:47], s86 offen nt lds
    s_add_u32 m0, s85, 15360
    v_xor_b32 v53, 224, v5
    s_add_u32 s86, s89, 15
    s_and_b32 s86, s86, 15
    s_lshl_b32 s86, s86, 10
    s_add_u32 s86, s86, s85
    buffer_load_dwordx4 v53, s[44:47], s86 offen nt lds
Lt2j_58:
    s_barrier
    s_lshl_b32 s85, s56, 14
    s_add_u32 s85, s85, 131072
    s_add_u32 s86, s89, 0
    s_and_b32 s86, s86, 15
    s_lshl_b32 s86, s86, 10
    s_add_u32 s86, s86, s85
    buffer_load_dwordx4 v[128:131], v5, s[44:47], s86 offen nt
    s_add_u32 s86, s89, 1
    s_and_b32 s86, s86, 15
    s_lshl_b32 s86, s86, 10
    s_add_u32 s86, s86, s85
    buffer_load_dwordx4 v[132:135], v5, s[44:47], s86 offen nt
    s_add_u32 s86, s89, 2
    s_and_b32 s86, s86, 15
    s_lshl_b32 s86, s86, 10
    s_add_u32 s86, s86, s85
    buffer_load_dwordx4 v[136:139], v5, s[44:47], s86 offen nt
    s_add_u32 s86, s89, 3
    s_and_b32 s86, s86, 15
    s_lshl_b32 s86, s86, 10
    s_add_u32 s86, s86, s85
    buffer_load_dwordx4 v[140:143], v5, s[44:47], s86 offen nt
    s_add_u32 s86, s89, 4
    s_and_b32 s86, s86, 15
    s_lshl_b32 s86, s86, 10
    s_add_u32 s86, s86, s85
    buffer_load_dwordx4 v[144:147], v5, s[44:47], s86 offen nt
    s_add_u32 s86, s89, 5
    s_and_b32 s86, s86, 15
    s_lshl_b32 s86, s86, 10
    s_add_u32 s86, s86, s85
    buffer_load_dwordx4 v[148:151], v5, s[44:47], s86 offen nt
    s_add_u32 s86, s89, 6
    s_and_b32 s86, s86, 15
    s_lshl_b32 s86, s86, 10
    s_add_u32 s86, s86, s85
    buffer_load_dwordx4 v[152:155], v5, s[44:47], s86 offen nt
    s_add_u32 s86, s89, 7
    s_and_b32 s86, s86, 15
    s_lshl_b32 s86, s86, 10
    s_add_u32 s86, s86, s85
    buffer_load_dwordx4 v[156:159], v5, s[44:47], s86 offen nt
    s_add_u32 s86, s89, 8
    s_and_b32 s86, s86, 15
    s_lshl_b32 s86, s86, 10
    s_add_u32 s86, s86, s85
    buffer_load_dwordx4 v[160:163], v5, s[44:47], s86 offen nt
    s_add_u32 s86, s89, 9
    s_and_b32 s86, s86, 15
    s_lshl_b32 s86, s86, 10
    s_add_u32 s86, s86, s85
    buffer_load_dwordx4 v[164:167], v5, s[44:47], s86 offen nt
    s_add_u32 s86, s89, 10
    s_and_b32 s86, s86, 15
    s_lshl_b32 s86, s86, 10
    s_add_u32 s86, s86, s85
    buffer_load_dwordx4 v[168:171], v5, s[44:47], s86 offen nt
    s_add_u32 s86, s89, 11
    s_and_b32 s86, s86, 15
    s_lshl_b32 s86, s86, 10
    s_add_u32 s86, s86, s85
    buffer_load_dwordx4 v[172:175], v5, s[44:47], s86 offen nt
    s_add_u32 s86, s89, 12
    s_and_b32 s86, s86, 15
    s_lshl_b32 s86, s86, 10
    s_add_u32 s86, s86, s85
    buffer_load_dwordx4 v[176:179], v5, s[44:47], s86 offen nt
    s_add_u32 s86, s89, 13
    s_and_b32 s86, s86, 15
    s_lshl_b32 s86, s86, 10
    s_add_u32 s86, s86, s85
    buffer_load_dwordx4 v[180:183], v5, s[44:47], s86 offen nt
    s_add_u32 s86, s89, 14
    s_and_b32 s86, s86, 15
    s_lshl_b32 s86, s86, 10
    s_add_u32 s86, s86, s85
    buffer_load_dwordx4 v[184:187], v5, s[44:47], s86 offen nt
    s_add_u32 s86, s89, 15
    s_and_b32 s86, s86, 15
    s_lshl_b32 s86, s86, 10
    s_add_u32 s86, s86, s85
    buffer_load_dwordx4 v[188:191], v5, s[44:47], s86 offen nt
    v_mov_b32 v55, 0
    buffer_load_dword v54, v55, s[52:55], 0 offen offset:128 sc0 sc1
    s_lshr_b32 s66, s65, 4
    s_and_b32 s67, s65, 15
    s_and_b32 s63, s56, 3
    s_lshr_b32 s64, s56, 2
    v_and_b32 v40, 3, v3
    v_lshlrev_b32 v40, 2, v40
    v_lshrrev_b32 v41, 3, v3
    v_lshl_or_b32 v40, v41, 1, v40
    s_lshl_b32 s61, s63, 15
    v_lshlrev_b32 v41, 10, v3
    v_add_u32 v41, s61, v41
    v_add_u32 v42, 0, v2
    v_xor_b32 v42, v42, v40
    v_lshl_add_u32 v8, v42, 4, v41
    v_add_u32 v42, 4, v2
    v_xor_b32 v42, v42, v40
    v_lshl_add_u32 v9, v42, 4, v41
    v_add_u32 v42, 8, v2
    v_xor_b32 v42, v42, v40
    v_lshl_add_u32 v10, v42, 4, v41
    v_add_u32 v42, 12, v2
    v_xor_b32 v42, v42, v40
    v_lshl_add_u32 v11, v42, 4, v41
    s_lshl_b32 s61, s64, 14
    s_add_u32 s61, s61, 131072
    s_lshl_b32 s62, s63, 15
    s_sub_u32 s61, s61, s62
    v_lshrrev_b32 v43, 1, v2
    v_and_b32 v44, 1, v2
    v_lshrrev_b32 v45, 2, v3
    v_lshl_add_u32 v46, v43, 3, v45
    v_lshlrev_b32 v47, 2, v45
    v_lshl_or_b32 v47, v43, 1, v47
    v_bfe_u32 v48, v3, 1, 1
    v_lshl_add_u32 v48, v44, 1, v48
    s_lshl_b32 s62, s56, 3
    s_add_u32 s62, s62, 0
    v_add_u32 v48, s62, v48
    v_xor_b32 v48, v48, v47
    v_lshlrev_b32 v48, 4, v48
    v_lshl_add_u32 v48, v46, 10, v48
    v_and_b32 v49, 1, v3
    v_lshl_add_u32 v12, v49, 3, v48
    v_bfe_u32 v48, v3, 1, 1
    v_lshl_add_u32 v48, v44, 1, v48
    s_lshl_b32 s62, s56, 3
    s_add_u32 s62, s62, 4
    v_add_u32 v48, s62, v48
    v_xor_b32 v48, v48, v47
    v_lshlrev_b32 v48, 4, v48
    v_lshl_add_u32 v48, v46, 10, v48
    v_and_b32 v49, 1, v3
    v_lshl_add_u32 v13, v49, 3, v48
    v_lshl_add_u32 v46, v43, 3, v45
    v_add_u32 v46, 4, v46
    v_lshlrev_b32 v47, 2, v45
    v_lshl_or_b32 v47, v43, 1, v47
    v_bfe_u32 v48, v3, 1, 1
    v_lshl_add_u32 v48, v44, 1, v48
    s_lshl_b32 s62, s56, 3
    s_add_u32 s62, s62, 0
    v_add_u32 v48, s62, v48
    v_xor_b32 v48, v48, v47
    v_lshlrev_b32 v48, 4, v48
    v_lshl_add_u32 v48, v46, 10, v48
    v_and_b32 v49, 1, v3
    v_lshl_add_u32 v14, v49, 3, v48
    v_bfe_u32 v48, v3, 1, 1
    v_lshl_add_u32 v48, v44, 1, v48
    s_lshl_b32 s62, s56, 3
    s_add_u32 s62, s62, 4
    v_add_u32 v48, s62, v48
    v_xor_b32 v48, v48, v47
    v_lshlrev_b32 v48, 4, v48
    v_lshl_add_u32 v48, v46, 10, v48
    v_and_b32 v49, 1, v3
    v_lshl_add_u32 v15, v49, 3, v48
    v_and_b32 v43, 31, v1
    v_lshrrev_b32 v44, 5, v1
    v_mul_u32_u24 v16, 272, v43
    v_lshl_add_u32 v16, v44, 4, v16
    v_add_u32 v16, 131072, v16
    v_lshlrev_b32 v23, 4, v43
    v_add_u32 v23, 139776, v23
    s_lshl_b32 s62, s64, 4
    v_add_u32 v43, s62, v3
    v_mul_u32_u24 v17, 272, v43
    v_lshl_add_u32 v17, v2, 3, v17
    s_lshl_b32 s62, s63, 6
    s_add_u32 s62, s62, 131072
    v_add_u32 v17, s62, v17
    v_lshlrev_b32 v22, 4, v43
    v_add_u32 v22, 139776, v22
    s_lshl_b32 s62, s63, 2
    v_add_u32 v21, s62, v22
    v_add_u32 v33, s61, v8
    v_mov_b32 v18, 0xff7fffff
    v_mov_b32 v20, 0xff7fffff
    v_mov_b32 v19, 0
    s_mov_b32 s100, s61
    s_cmp_lt_u32 s56, 4
    s_cbranch_scc1 Lqa0_61
    s_waitcnt vmcnt(17)
    s_branch Lqaj_62
Lqa0_61:
    s_waitcnt vmcnt(0)
    s_mov_b32 s92, 0
Lcf_63:
    v_readfirstlane_b32 s57, v54
    s_nop 3
    s_cmp_ge_u32 s57, 64
    s_cbranch_scc1 Lcfd_64
    s_sleep 8
    v_mov_b32 v55, 0
    buffer_load_dword v54, v55, s[52:55], 0 offen offset:128 sc0 sc1
    s_waitcnt vmcnt(0)
    s_add_u32 s92, s92, 1
    s_cmp_lt_u32 s92, 400000
    s_cbranch_scc1 Lcf_63
Lcfd_64:
    s_lshl_b32 s61, s66, 15
    s_lshl_b32 s62, s56, 13
    s_add_u32 s61, s61, s62
    s_add_u32 s61, s61, 1147900
    v_lshlrev_b32 v41, 10, v1
    s_mov_b64 exec, 0xff
    s_mov_b32 s92, 0
Lpoll_65:
    buffer_load_dword v42, v41, s[32:35], s61 offen sc0 sc1
    s_waitcnt vmcnt(0)
    v_mov_b32 v43, v42
    v_cmpx_eq_u32 vcc, -1, v43
    s_cbranch_execz Lpolld_66
    s_sleep 4
    s_add_u32 s92, s92, 1
    s_cmp_lt_u32 s92, 400000
    s_cbranch_scc1 Lpoll_65
Lpolld_66:
    s_mov_b64 exec, -1
    s_lshl_b32 s61, s66, 15
    s_lshl_b32 s62, s56, 13
    s_add_u32 s61, s61, s62
    s_add_u32 s61, s61, 1146880
    s_add_u32 s62, s61, 4096
    s_mov_b32 s92, 0
Lpoll_67:
    buffer_load_dwordx4 v[64:67], v5, s[32:35], s61 offen offset:0 sc0 sc1
    buffer_load_dwordx4 v[68:71], v5, s[32:35], s61 offen offset:1024 sc0 sc1
    buffer_load_dwordx4 v[72:75], v5, s[32:35], s61 offen offset:2048 sc0 sc1
    buffer_load_dwordx4 v[76:79], v5, s[32:35], s61 offen offset:3072 sc0 sc1
    buffer_load_dwordx4 v[80:83], v5, s[32:35], s62 offen offset:0 sc0 sc1
    buffer_load_dwordx4 v[84:87], v5, s[32:35], s62 offen offset:1024 sc0 sc1
    buffer_load_dwordx4 v[88:91], v5, s[32:35], s62 offen offset:2048 sc0 sc1
    buffer_load_dwordx4 v[92:95], v5, s[32:35], s62 offen offset:3072 sc0 sc1
    s_waitcnt vmcnt(0)
    v_mov_b32 v40, v64
    v_max3_u32 v40, v40, v65, v66
    v_max3_u32 v40, v40, v67, v68
    v_max3_u32 v40, v40, v69, v70
    v_max3_u32 v40, v40, v71, v72
    v_max3_u32 v40, v40, v73, v74
    v_max3_u32 v40, v40, v75, v76
    v_max3_u32 v40, v40, v77, v78
    v_max3_u32 v40, v40, v79, v80
    v_max3_u32 v40, v40, v81, v82
    v_max3_u32 v40, v40, v83, v84
    v_max3_u32 v40, v40, v85, v86
    v_max3_u32 v40, v40, v87, v88
    v_max3_u32 v40, v40, v89, v90
    v_max3_u32 v40, v40, v91, v92
    v_max3_u32 v40, v40, v93, v94
    v_max_u32 v40, v40, v95
    v_cmpx_eq_u32 vcc, -1, v40
    s_cbranch_execz Lpolld_68
    s_sleep 4
    s_add_u32 s92, s92, 1
    s_cmp_lt_u32 s92, 400000
    s_cbranch_scc1 Lpoll_67
Lpolld_68:
    s_mov_b64 exec, -1
    s_and_b32 s62, s56, 1
    s_lshl_b32 s62, s62, 5
    s_lshl_b32 s61, s56, 13
    s_add_u32 s61, s61, 131072
    s_add_u32 s57, s62, 0
    v_xor_b32 v40, s57, v5
    v_add_u32 v40, s61, v40
    ds_write_b128 v40, v[64:67] offset:0
    s_add_u32 s57, s62, 64
    v_xor_b32 v41, s57, v5
    v_add_u32 v41, s61, v41
    ds_write_b128 v41, v[68:71] offset:1024
    s_add_u32 s57, s62, 128
    v_xor_b32 v42, s57, v5
    v_add_u32 v42, s61, v42
    ds_write_b128 v42, v[72:75] offset:2048
    s_add_u32 s57, s62, 192
    v_xor_b32 v43, s57, v5
    v_add_u32 v43, s61, v43
    ds_write_b128 v43, v[76:79] offset:3072
    s_add_u32 s57, s62, 0
    v_xor_b32 v40, s57, v5
    v_add_u32 v40, s61, v40
    ds_write_b128 v40, v[80:83] offset:4096
    s_add_u32 s57, s62, 64
    v_xor_b32 v41, s57, v5
    v_add_u32 v41, s61, v41
    ds_write_b128 v41, v[84:87] offset:5120
    s_add_u32 s57, s62, 128
    v_xor_b32 v42, s57, v5
    v_add_u32 v42, s61, v42
    ds_write_b128 v42, v[88:91] offset:6144
    s_add_u32 s57, s62, 192
    v_xor_b32 v43, s57, v5
    v_add_u32 v43, s61, v43
    ds_write_b128 v43, v[92:95] offset:7168
    s_waitcnt lgkmcnt(0)
Lqaj_62:
    s_barrier
    v_add_u32 v40, s100, v8
    v_add_u32 v41, s100, v9
    v_add_u32 v42, s100, v10
    v_add_u32 v43, s100, v11
    ds_read_b128 v[192:195], v40 offset:0
    ds_read_b128 v[196:199], v41 offset:0
    ds_read_b128 v[200:203], v42 offset:0
    ds_read_b128 v[204:207], v43 offset:0
    ds_read_b128 v[208:211], v40 offset:256
    ds_read_b128 v[212:215], v41 offset:256
    ds_read_b128 v[216:219], v42 offset:256
    ds_read_b128 v[220:223], v43 offset:256
    ds_read_b128 v[224:227], v40 offset:512
    ds_read_b128 v[228:231], v41 offset:512
    ds_read_b128 v[232:235], v42 offset:512
    ds_read_b128 v[236:239], v43 offset:512
    ds_read_b128 v[240:243], v40 offset:768
    ds_read_b128 v[244:247], v41 offset:768
    ds_read_b128 v[248:251], v42 offset:768
    ds_read_b128 v[252:255], v43 offset:768
    s_waitcnt lgkmcnt(0)
    s_barrier
    ds_read_b128 v[96:99], v8 offset:0
    ds_read_b128 v[100:103], v8 offset:16384
    ds_read_b128 v[104:107], v9 offset:0
    ds_read_b128 v[108:111], v9 offset:16384
    ds_read_b128 v[112:115], v10 offset:0
    ds_read_b128 v[116:119], v10 offset:16384
    ds_read_b128 v[120:123], v11 offset:0
    ds_read_b128 v[124:127], v11 offset:16384
    s_waitcnt lgkmcnt(7)
    v_mfma_f32_16x16x32_bf16 v[24:27], v[96:99], v[192:195], 0
    ds_read_b128 v[96:99], v8 offset:256
    s_waitcnt lgkmcnt(7)
    v_mfma_f32_16x16x32_bf16 v[28:31], v[100:103], v[192:195], 0
    ds_read_b128 v[100:103], v8 offset:16640
    s_waitcnt lgkmcnt(7)
    v_mfma_f32_16x16x32_bf16 v[24:27], v[104:107], v[196:199], v[24:27]
    ds_read_b128 v[104:107], v9 offset:256
    s_waitcnt lgkmcnt(7)
    v_mfma_f32_16x16x32_bf16 v[28:31], v[108:111], v[196:199], v[28:31]
    ds_read_b128 v[108:111], v9 offset:16640
    s_waitcnt lgkmcnt(7)
    v_mfma_f32_16x16x32_bf16 v[24:27], v[112:115], v[200:203], v[24:27]
    ds_read_b128 v[112:115], v10 offset:256
    s_waitcnt lgkmcnt(7)
    v_mfma_f32_16x16x32_bf16 v[28:31], v[116:119], v[200:203], v[28:31]
    ds_read_b128 v[116:119], v10 offset:16640
    s_waitcnt lgkmcnt(7)
    v_mfma_f32_16x16x32_bf16 v[24:27], v[120:123], v[204:207], v[24:27]
    ds_read_b128 v[120:123], v11 offset:256
    s_waitcnt lgkmcnt(7)
    v_mfma_f32_16x16x32_bf16 v[28:31], v[124:127], v[204:207], v[28:31]
    ds_read_b128 v[124:127], v11 offset:16640
    s_waitcnt lgkmcnt(7)
    v_mfma_f32_16x16x32_bf16 v[24:27], v[96:99], v[208:211], v[24:27]
    ds_read_b128 v[96:99], v8 offset:512
    s_waitcnt lgkmcnt(7)
    v_mfma_f32_16x16x32_bf16 v[28:31], v[100:103], v[208:211], v[28:31]
    ds_read_b128 v[100:103], v8 offset:16896
    s_waitcnt lgkmcnt(7)
    v_mfma_f32_16x16x32_bf16 v[24:27], v[104:107], v[212:215], v[24:27]
    ds_read_b128 v[104:107], v9 offset:512
    s_waitcnt lgkmcnt(7)
    v_mfma_f32_16x16x32_bf16 v[28:31], v[108:111], v[212:215], v[28:31]
    ds_read_b128 v[108:111], v9 offset:16896
    s_waitcnt lgkmcnt(7)
    v_mfma_f32_16x16x32_bf16 v[24:27], v[112:115], v[216:219], v[24:27]
    ds_read_b128 v[112:115], v10 offset:512
    s_waitcnt lgkmcnt(7)
    v_mfma_f32_16x16x32_bf16 v[28:31], v[116:119], v[216:219], v[28:31]
    ds_read_b128 v[116:119], v10 offset:16896
    s_waitcnt lgkmcnt(7)
    v_mfma_f32_16x16x32_bf16 v[24:27], v[120:123], v[220:223], v[24:27]
    ds_read_b128 v[120:123], v11 offset:512
    s_waitcnt lgkmcnt(7)
    v_mfma_f32_16x16x32_bf16 v[28:31], v[124:127], v[220:223], v[28:31]
    ds_read_b128 v[124:127], v11 offset:16896
    s_waitcnt lgkmcnt(7)
    v_mfma_f32_16x16x32_bf16 v[24:27], v[96:99], v[224:227], v[24:27]
    ds_read_b128 v[96:99], v8 offset:768
    s_waitcnt lgkmcnt(7)
    v_mfma_f32_16x16x32_bf16 v[28:31], v[100:103], v[224:227], v[28:31]
    ds_read_b128 v[100:103], v8 offset:17152
    s_waitcnt lgkmcnt(7)
    v_mfma_f32_16x16x32_bf16 v[24:27], v[104:107], v[228:231], v[24:27]
    ds_read_b128 v[104:107], v9 offset:768
    s_waitcnt lgkmcnt(7)
    v_mfma_f32_16x16x32_bf16 v[28:31], v[108:111], v[228:231], v[28:31]
    ds_read_b128 v[108:111], v9 offset:17152
    s_waitcnt lgkmcnt(7)
    v_mfma_f32_16x16x32_bf16 v[24:27], v[112:115], v[232:235], v[24:27]
    ds_read_b128 v[112:115], v10 offset:768
    s_waitcnt lgkmcnt(7)
    v_mfma_f32_16x16x32_bf16 v[28:31], v[116:119], v[232:235], v[28:31]
    ds_read_b128 v[116:119], v10 offset:17152
    s_waitcnt lgkmcnt(7)
    v_mfma_f32_16x16x32_bf16 v[24:27], v[120:123], v[236:239], v[24:27]
    ds_read_b128 v[120:123], v11 offset:768
    s_waitcnt lgkmcnt(7)
    v_mfma_f32_16x16x32_bf16 v[28:31], v[124:127], v[236:239], v[28:31]
    ds_read_b128 v[124:127], v11 offset:17152
    s_waitcnt lgkmcnt(7)
    v_mfma_f32_16x16x32_bf16 v[24:27], v[96:99], v[240:243], v[24:27]
    s_waitcnt lgkmcnt(6)
    v_mfma_f32_16x16x32_bf16 v[28:31], v[100:103], v[240:243], v[28:31]
    s_waitcnt lgkmcnt(5)
    v_mfma_f32_16x16x32_bf16 v[24:27], v[104:107], v[244:247], v[24:27]
    s_waitcnt lgkmcnt(4)
    v_mfma_f32_16x16x32_bf16 v[28:31], v[108:111], v[244:247], v[28:31]
    s_waitcnt lgkmcnt(3)
    v_mfma_f32_16x16x32_bf16 v[24:27], v[112:115], v[248:251], v[24:27]
    s_waitcnt lgkmcnt(2)
    v_mfma_f32_16x16x32_bf16 v[28:31], v[116:119], v[248:251], v[28:31]
    s_waitcnt lgkmcnt(1)
    v_mfma_f32_16x16x32_bf16 v[24:27], v[120:123], v[252:255], v[24:27]
    s_waitcnt lgkmcnt(0)
    v_mfma_f32_16x16x32_bf16 v[28:31], v[124:127], v[252:255], v[28:31]
    s_nop 7
    s_nop 1
    v_max3_f32 v40, v24, v25, v26
    v_max3_f32 v40, v40, v27, v28
    v_max3_f32 v40, v40, v29, v30
    v_max_f32 v40, v40, v31
    v_mov_b32 v41, v40
    s_nop 1
    v_permlane32_swap_b32 v40, v41
    s_nop 1
    v_max_f32 v40, v40, v41
    v_mov_b32 v41, v40
    s_nop 1
    v_permlane16_swap_b32 v40, v41
    s_nop 1
    v_max_f32 v40, v40, v41
    ds_write_b32 v21, v40
    s_waitcnt lgkmcnt(0)
    s_barrier
    ds_read_b128 v[40:43], v22
    ds_read_b128 v[44:47], v23
    s_waitcnt lgkmcnt(1)
    v_max3_f32 v40, v40, v41, v42
    v_max3_f32 v20, v40, v43, v20
    v_sub_f32 v24, v24, v20
    v_sub_f32 v25, v25, v20
    v_sub_f32 v26, v26, v20
    v_sub_f32 v27, v27, v20
    v_sub_f32 v28, v28, v20
    v_sub_f32 v29, v29, v20
    v_sub_f32 v30, v30, v20
    v_sub_f32 v31, v31, v20
    v_exp_f32 v24, v24
    v_exp_f32 v25, v25
    v_exp_f32 v26, v26
    v_exp_f32 v27, v27
    v_exp_f32 v28, v28
    v_exp_f32 v29, v29
    v_exp_f32 v30, v30
    v_exp_f32 v31, v31
    s_waitcnt lgkmcnt(0)
    v_max3_f32 v44, v44, v45, v46
    v_max3_f32 v44, v44, v47, v18
    v_sub_f32 v32, v18, v44
    v_exp_f32 v32, v32
    v_mov_b32 v18, v44
    v_add_f32 v40, v24, v25
    v_add_f32 v40, v40, v26
    v_add_f32 v40, v40, v27
    v_add_f32 v40, v40, v28
    v_add_f32 v40, v40, v29
    v_add_f32 v40, v40, v30
    v_add_f32 v40, v40, v31
    v_cvt_pk_bf16_f32 v48, v24, v25
    v_cvt_pk_bf16_f32 v49, v26, v27
    v_cvt_pk_bf16_f32 v50, v28, v29
    v_cvt_pk_bf16_f32 v51, v30, v31
    ds_write_b64 v17, v[48:49] offset:0
    ds_write_b64 v17, v[50:51] offset:32
    v_mov_b32 v41, v40
    s_nop 1
    v_permlane32_swap_b32 v40, v41
    s_nop 1
    v_add_f32 v40, v40, v41
    v_mov_b32 v41, v40
    s_nop 1
    v_permlane16_swap_b32 v40, v41
    s_nop 1
    v_add_f32 v40, v40, v41
    ds_write_b32 v21, v40 offset:512
    s_waitcnt lgkmcnt(0)
    s_barrier
    ds_read_b128 v[40:43], v23 offset:512
    ds_read_b128 v[96:99], v16 offset:0
    ds_read_b64_tr_b16 v[100:101], v12 offset:0
    ds_read_b64_tr_b16 v[102:103], v14 offset:0
    ds_read_b64_tr_b16 v[104:105], v13 offset:0
    ds_read_b64_tr_b16 v[106:107], v15 offset:0
    ds_read_b128 v[108:111], v16 offset:32
    ds_read_b64_tr_b16 v[112:113], v12 offset:16384
    ds_read_b64_tr_b16 v[114:115], v14 offset:16384
    ds_read_b64_tr_b16 v[116:117], v13 offset:16384
    ds_read_b64_tr_b16 v[118:119], v15 offset:16384
    s_waitcnt lgkmcnt(5)
    v_mfma_f32_32x32x16_bf16 v[64:79], v[100:103], v[96:99], 0
    v_mfma_f32_32x32x16_bf16 v[80:95], v[104:107], v[96:99], 0
    ds_read_b128 v[96:99], v16 offset:64
    ds_read_b64_tr_b16 v[100:101], v12 offset:32768
    ds_read_b64_tr_b16 v[102:103], v14 offset:32768
    ds_read_b64_tr_b16 v[104:105], v13 offset:32768
    ds_read_b64_tr_b16 v[106:107], v15 offset:32768
    s_waitcnt lgkmcnt(5)
    v_mfma_f32_32x32x16_bf16 v[64:79], v[112:115], v[108:111], v[64:79]
    v_mfma_f32_32x32x16_bf16 v[80:95], v[116:119], v[108:111], v[80:95]
    ds_read_b128 v[108:111], v16 offset:96
    ds_read_b64_tr_b16 v[112:113], v12 offset:49152
    ds_read_b64_tr_b16 v[114:115], v14 offset:49152
    ds_read_b64_tr_b16 v[116:117], v13 offset:49152
    ds_read_b64_tr_b16 v[118:119], v15 offset:49152
    s_waitcnt lgkmcnt(5)
    v_mfma_f32_32x32x16_bf16 v[64:79], v[100:103], v[96:99], v[64:79]
    v_mfma_f32_32x32x16_bf16 v[80:95], v[104:107], v[96:99], v[80:95]
    v_add_u32 v12, 0x10000, v12
    v_add_u32 v13, 0x10000, v13
    v_add_u32 v14, 0x10000, v14
    v_add_u32 v15, 0x10000, v15
    ds_read_b128 v[96:99], v16 offset:128
    ds_read_b64_tr_b16 v[100:101], v12 offset:0
    ds_read_b64_tr_b16 v[102:103], v14 offset:0
    ds_read_b64_tr_b16 v[104:105], v13 offset:0
    ds_read_b64_tr_b16 v[106:107], v15 offset:0
    s_waitcnt lgkmcnt(5)
    v_mfma_f32_32x32x16_bf16 v[64:79], v[112:115], v[108:111], v[64:79]
    v_mfma_f32_32x32x16_bf16 v[80:95], v[116:119], v[108:111], v[80:95]
    ds_read_b128 v[108:111], v16 offset:160
    ds_read_b64_tr_b16 v[112:113], v12 offset:16384
    ds_read_b64_tr_b16 v[114:115], v14 offset:16384
    ds_read_b64_tr_b16 v[116:117], v13 offset:16384
    ds_read_b64_tr_b16 v[118:119], v15 offset:16384
    s_waitcnt lgkmcnt(5)
    v_mfma_f32_32x32x16_bf16 v[64:79], v[100:103], v[96:99], v[64:79]
    v_mfma_f32_32x32x16_bf16 v[80:95], v[104:107], v[96:99], v[80:95]
    ds_read_b128 v[96:99], v16 offset:192
    ds_read_b64_tr_b16 v[100:101], v12 offset:32768
    ds_read_b64_tr_b16 v[102:103], v14 offset:32768
    ds_read_b64_tr_b16 v[104:105], v13 offset:32768
    ds_read_b64_tr_b16 v[106:107], v15 offset:32768
    s_waitcnt lgkmcnt(5)
    v_mfma_f32_32x32x16_bf16 v[64:79], v[112:115], v[108:111], v[64:79]
    v_mfma_f32_32x32x16_bf16 v[80:95], v[116:119], v[108:111], v[80:95]
    ds_read_b128 v[108:111], v16 offset:224
    ds_read_b64_tr_b16 v[112:113], v12 offset:49152
    ds_read_b64_tr_b16 v[114:115], v14 offset:49152
    ds_read_b64_tr_b16 v[116:117], v13 offset:49152
    ds_read_b64_tr_b16 v[118:119], v15 offset:49152
    s_waitcnt lgkmcnt(5)
    v_mfma_f32_32x32x16_bf16 v[64:79], v[100:103], v[96:99], v[64:79]
    v_mfma_f32_32x32x16_bf16 v[80:95], v[104:107], v[96:99], v[80:95]
    s_waitcnt lgkmcnt(0)
    v_mfma_f32_32x32x16_bf16 v[64:79], v[112:115], v[108:111], v[64:79]
    v_mfma_f32_32x32x16_bf16 v[80:95], v[116:119], v[108:111], v[80:95]
    v_subrev_u32 v12, 0x10000, v12
    v_subrev_u32 v13, 0x10000, v13
    v_subrev_u32 v14, 0x10000, v14
    v_subrev_u32 v15, 0x10000, v15
    v_add_f32 v40, v40, v41
    v_add_f32 v42, v42, v43
    v_add_f32 v40, v40, v42
    v_fma_f32 v19, v19, v32, v40
    s_barrier
    s_waitcnt vmcnt(0)
    s_lshl_b32 s61, s56, 14
    v_xor_b32 v40, 0, v5
    v_add_u32 v40, s61, v40
    ds_write_b128 v40, v[128:131] offset:0
    v_xor_b32 v41, 64, v5
    v_add_u32 v41, s61, v41
    ds_write_b128 v41, v[132:135] offset:1024
    v_xor_b32 v42, 128, v5
    v_add_u32 v42, s61, v42
    ds_write_b128 v42, v[136:139] offset:2048
    v_xor_b32 v43, 192, v5
    v_add_u32 v43, s61, v43
    ds_write_b128 v43, v[140:143] offset:3072
    v_xor_b32 v40, 0, v5
    v_add_u32 v40, s61, v40
    ds_write_b128 v40, v[144:147] offset:4096
    v_xor_b32 v41, 64, v5
    v_add_u32 v41, s61, v41
    ds_write_b128 v41, v[148:151] offset:5120
    v_xor_b32 v42, 128, v5
    v_add_u32 v42, s61, v42
    ds_write_b128 v42, v[152:155] offset:6144
    v_xor_b32 v43, 192, v5
    v_add_u32 v43, s61, v43
    ds_write_b128 v43, v[156:159] offset:7168
    v_xor_b32 v40, 32, v5
    v_add_u32 v40, s61, v40
    ds_write_b128 v40, v[160:163] offset:8192
    v_xor_b32 v41, 96, v5
    v_add_u32 v41, s61, v41
    ds_write_b128 v41, v[164:167] offset:9216
    v_xor_b32 v42, 160, v5
    v_add_u32 v42, s61, v42
    ds_write_b128 v42, v[168:171] offset:10240
    v_xor_b32 v43, 224, v5
    v_add_u32 v43, s61, v43
    ds_write_b128 v43, v[172:175] offset:11264
    v_xor_b32 v40, 32, v5
    v_add_u32 v40, s61, v40
    ds_write_b128 v40, v[176:179] offset:12288
    v_xor_b32 v41, 96, v5
    v_add_u32 v41, s61, v41
    ds_write_b128 v41, v[180:183] offset:13312
    v_xor_b32 v42, 160, v5
    v_add_u32 v42, s61, v42
    ds_write_b128 v42, v[184:187] offset:14336
    v_xor_b32 v43, 224, v5
    v_add_u32 v43, s61, v43
    ds_write_b128 v43, v[188:191] offset:15360
    s_waitcnt lgkmcnt(0)
    s_barrier
    ds_read_b128 v[96:99], v8 offset:0
    ds_read_b128 v[100:103], v8 offset:16384
    ds_read_b128 v[104:107], v9 offset:0
    ds_read_b128 v[108:111], v9 offset:16384
    ds_read_b128 v[112:115], v10 offset:0
    ds_read_b128 v[116:119], v10 offset:16384
    ds_read_b128 v[120:123], v11 offset:0
    ds_read_b128 v[124:127], v11 offset:16384
    s_waitcnt lgkmcnt(7)
    v_mfma_f32_16x16x32_bf16 v[24:27], v[96:99], v[192:195], 0
    ds_read_b128 v[96:99], v8 offset:256
    s_waitcnt lgkmcnt(7)
    v_mfma_f32_16x16x32_bf16 v[28:31], v[100:103], v[192:195], 0
    ds_read_b128 v[100:103], v8 offset:16640
    s_waitcnt lgkmcnt(7)
    v_mfma_f32_16x16x32_bf16 v[24:27], v[104:107], v[196:199], v[24:27]
    ds_read_b128 v[104:107], v9 offset:256
    s_waitcnt lgkmcnt(7)
    v_mfma_f32_16x16x32_bf16 v[28:31], v[108:111], v[196:199], v[28:31]
    ds_read_b128 v[108:111], v9 offset:16640
    s_waitcnt lgkmcnt(7)
    v_mfma_f32_16x16x32_bf16 v[24:27], v[112:115], v[200:203], v[24:27]
    ds_read_b128 v[112:115], v10 offset:256
    s_waitcnt lgkmcnt(7)
    v_mfma_f32_16x16x32_bf16 v[28:31], v[116:119], v[200:203], v[28:31]
    ds_read_b128 v[116:119], v10 offset:16640
    s_waitcnt lgkmcnt(7)
    v_mfma_f32_16x16x32_bf16 v[24:27], v[120:123], v[204:207], v[24:27]
    ds_read_b128 v[120:123], v11 offset:256
    s_waitcnt lgkmcnt(7)
    v_mfma_f32_16x16x32_bf16 v[28:31], v[124:127], v[204:207], v[28:31]
    ds_read_b128 v[124:127], v11 offset:16640
    s_waitcnt lgkmcnt(7)
    v_mfma_f32_16x16x32_bf16 v[24:27], v[96:99], v[208:211], v[24:27]
    ds_read_b128 v[96:99], v8 offset:512
    s_waitcnt lgkmcnt(7)
    v_mfma_f32_16x16x32_bf16 v[28:31], v[100:103], v[208:211], v[28:31]
    ds_read_b128 v[100:103], v8 offset:16896
    s_waitcnt lgkmcnt(7)
    v_mfma_f32_16x16x32_bf16 v[24:27], v[104:107], v[212:215], v[24:27]
    ds_read_b128 v[104:107], v9 offset:512
    s_waitcnt lgkmcnt(7)
    v_mfma_f32_16x16x32_bf16 v[28:31], v[108:111], v[212:215], v[28:31]
    ds_read_b128 v[108:111], v9 offset:16896
    s_waitcnt lgkmcnt(7)
    v_mfma_f32_16x16x32_bf16 v[24:27], v[112:115], v[216:219], v[24:27]
    ds_read_b128 v[112:115], v10 offset:512
    s_waitcnt lgkmcnt(7)
    v_mfma_f32_16x16x32_bf16 v[28:31], v[116:119], v[216:219], v[28:31]
    ds_read_b128 v[116:119], v10 offset:16896
    s_waitcnt lgkmcnt(7)
    v_mfma_f32_16x16x32_bf16 v[24:27], v[120:123], v[220:223], v[24:27]
    ds_read_b128 v[120:123], v11 offset:512
    s_waitcnt lgkmcnt(7)
    v_mfma_f32_16x16x32_bf16 v[28:31], v[124:127], v[220:223], v[28:31]
    ds_read_b128 v[124:127], v11 offset:16896
    s_waitcnt lgkmcnt(7)
    v_mfma_f32_16x16x32_bf16 v[24:27], v[96:99], v[224:227], v[24:27]
    ds_read_b128 v[96:99], v8 offset:768
    s_waitcnt lgkmcnt(7)
    v_mfma_f32_16x16x32_bf16 v[28:31], v[100:103], v[224:227], v[28:31]
    ds_read_b128 v[100:103], v8 offset:17152
    s_waitcnt lgkmcnt(7)
    v_mfma_f32_16x16x32_bf16 v[24:27], v[104:107], v[228:231], v[24:27]
    ds_read_b128 v[104:107], v9 offset:768
    s_waitcnt lgkmcnt(7)
    v_mfma_f32_16x16x32_bf16 v[28:31], v[108:111], v[228:231], v[28:31]
    ds_read_b128 v[108:111], v9 offset:17152
    s_waitcnt lgkmcnt(7)
    v_mfma_f32_16x16x32_bf16 v[24:27], v[112:115], v[232:235], v[24:27]
    ds_read_b128 v[112:115], v10 offset:768
    s_waitcnt lgkmcnt(7)
    v_mfma_f32_16x16x32_bf16 v[28:31], v[116:119], v[232:235], v[28:31]
    ds_read_b128 v[116:119], v10 offset:17152
    s_waitcnt lgkmcnt(7)
    v_mfma_f32_16x16x32_bf16 v[24:27], v[120:123], v[236:239], v[24:27]
    ds_read_b128 v[120:123], v11 offset:768
    s_waitcnt lgkmcnt(7)
    v_mfma_f32_16x16x32_bf16 v[28:31], v[124:127], v[236:239], v[28:31]
    ds_read_b128 v[124:127], v11 offset:17152
    s_waitcnt lgkmcnt(7)
    v_mfma_f32_16x16x32_bf16 v[24:27], v[96:99], v[240:243], v[24:27]
    s_waitcnt lgkmcnt(6)
    v_mfma_f32_16x16x32_bf16 v[28:31], v[100:103], v[240:243], v[28:31]
    s_waitcnt lgkmcnt(5)
    v_mfma_f32_16x16x32_bf16 v[24:27], v[104:107], v[244:247], v[24:27]
    s_waitcnt lgkmcnt(4)
    v_mfma_f32_16x16x32_bf16 v[28:31], v[108:111], v[244:247], v[28:31]
    s_waitcnt lgkmcnt(3)
    v_mfma_f32_16x16x32_bf16 v[24:27], v[112:115], v[248:251], v[24:27]
    s_waitcnt lgkmcnt(2)
    v_mfma_f32_16x16x32_bf16 v[28:31], v[116:119], v[248:251], v[28:31]
    s_waitcnt lgkmcnt(1)
    v_mfma_f32_16x16x32_bf16 v[24:27], v[120:123], v[252:255], v[24:27]
    s_waitcnt lgkmcnt(0)
    v_mfma_f32_16x16x32_bf16 v[28:31], v[124:127], v[252:255], v[28:31]
    s_nop 7
    s_nop 1
    v_max3_f32 v40, v24, v25, v26
    v_max3_f32 v40, v40, v27, v28
    v_max3_f32 v40, v40, v29, v30
    v_max_f32 v40, v40, v31
    v_mov_b32 v41, v40
    s_nop 1
    v_permlane32_swap_b32 v40, v41
    s_nop 1
    v_max_f32 v40, v40, v41
    v_mov_b32 v41, v40
    s_nop 1
    v_permlane16_swap_b32 v40, v41
    s_nop 1
    v_max_f32 v40, v40, v41
    ds_write_b32 v21, v40
    s_waitcnt lgkmcnt(0)
    s_barrier
    ds_read_b128 v[40:43], v22
    ds_read_b128 v[44:47], v23
    s_waitcnt lgkmcnt(1)
    v_max3_f32 v40, v40, v41, v42
    v_max3_f32 v20, v40, v43, v20
    v_sub_f32 v24, v24, v20
    v_sub_f32 v25, v25, v20
    v_sub_f32 v26, v26, v20
    v_sub_f32 v27, v27, v20
    v_sub_f32 v28, v28, v20
    v_sub_f32 v29, v29, v20
    v_sub_f32 v30, v30, v20
    v_sub_f32 v31, v31, v20
    v_exp_f32 v24, v24
    v_exp_f32 v25, v25
    v_exp_f32 v26, v26
    v_exp_f32 v27, v27
    v_exp_f32 v28, v28
    v_exp_f32 v29, v29
    v_exp_f32 v30, v30
    v_exp_f32 v31, v31
    s_waitcnt lgkmcnt(0)
    v_max3_f32 v44, v44, v45, v46
    v_max3_f32 v44, v44, v47, v18
    v_sub_f32 v32, v18, v44
    v_exp_f32 v32, v32
    v_mov_b32 v18, v44
    v_add_f32 v40, v24, v25
    v_add_f32 v40, v40, v26
    v_add_f32 v40, v40, v27
    v_add_f32 v40, v40, v28
    v_add_f32 v40, v40, v29
    v_add_f32 v40, v40, v30
    v_add_f32 v40, v40, v31
    v_cvt_pk_bf16_f32 v48, v24, v25
    v_cvt_pk_bf16_f32 v49, v26, v27
    v_cvt_pk_bf16_f32 v50, v28, v29
    v_cvt_pk_bf16_f32 v51, v30, v31
    ds_write_b64 v17, v[48:49] offset:0
    ds_write_b64 v17, v[50:51] offset:32
    v_mov_b32 v41, v40
    s_nop 1
    v_permlane32_swap_b32 v40, v41
    s_nop 1
    v_add_f32 v40, v40, v41
    v_mov_b32 v41, v40
    s_nop 1
    v_permlane16_swap_b32 v40, v41
    s_nop 1
    v_add_f32 v40, v40, v41
    ds_write_b32 v21, v40 offset:512
    s_waitcnt lgkmcnt(0)
    s_barrier
    ds_read_b128 v[40:43], v23 offset:512
    v_mul_f32 v64, v64, v32
    v_mul_f32 v65, v65, v32
    v_mul_f32 v66, v66, v32
    v_mul_f32 v67, v67, v32
    v_mul_f32 v68, v68, v32
    v_mul_f32 v69, v69, v32
    v_mul_f32 v70, v70, v32
    v_mul_f32 v71, v71, v32
    v_mul_f32 v72, v72, v32
    v_mul_f32 v73, v73, v32
    v_mul_f32 v74, v74, v32
    v_mul_f32 v75, v75, v32
    v_mul_f32 v76, v76, v32
    v_mul_f32 v77, v77, v32
    v_mul_f32 v78, v78, v32
    v_mul_f32 v79, v79, v32
    v_mul_f32 v80, v80, v32
    v_mul_f32 v81, v81, v32
    v_mul_f32 v82, v82, v32
    v_mul_f32 v83, v83, v32
    v_mul_f32 v84, v84, v32
    v_mul_f32 v85, v85, v32
    v_mul_f32 v86, v86, v32
    v_mul_f32 v87, v87, v32
    v_mul_f32 v88, v88, v32
    v_mul_f32 v89, v89, v32
    v_mul_f32 v90, v90, v32
    v_mul_f32 v91, v91, v32
    v_mul_f32 v92, v92, v32
    v_mul_f32 v93, v93, v32
    v_mul_f32 v94, v94, v32
    v_mul_f32 v95, v95, v32
    ds_read_b128 v[96:99], v16 offset:0
    ds_read_b64_tr_b16 v[100:101], v12 offset:0
    ds_read_b64_tr_b16 v[102:103], v14 offset:0
    ds_read_b64_tr_b16 v[104:105], v13 offset:0
    ds_read_b64_tr_b16 v[106:107], v15 offset:0
    ds_read_b128 v[108:111], v16 offset:32
    ds_read_b64_tr_b16 v[112:113], v12 offset:16384
    ds_read_b64_tr_b16 v[114:115], v14 offset:16384
    ds_read_b64_tr_b16 v[116:117], v13 offset:16384
    ds_read_b64_tr_b16 v[118:119], v15 offset:16384
    s_waitcnt lgkmcnt(5)
    v_mfma_f32_32x32x16_bf16 v[64:79], v[100:103], v[96:99], v[64:79]
    v_mfma_f32_32x32x16_bf16 v[80:95], v[104:107], v[96:99], v[80:95]
    ds_read_b128 v[96:99], v16 offset:64
    ds_read_b64_tr_b16 v[100:101], v12 offset:32768
    ds_read_b64_tr_b16 v[102:103], v14 offset:32768
    ds_read_b64_tr_b16 v[104:105], v13 offset:32768
    ds_read_b64_tr_b16 v[106:107], v15 offset:32768
    s_waitcnt lgkmcnt(5)
    v_mfma_f32_32x32x16_bf16 v[64:79], v[112:115], v[108:111], v[64:79]
    v_mfma_f32_32x32x16_bf16 v[80:95], v[116:119], v[108:111], v[80:95]
    ds_read_b128 v[108:111], v16 offset:96
    ds_read_b64_tr_b16 v[112:113], v12 offset:49152
    ds_read_b64_tr_b16 v[114:115], v14 offset:49152
    ds_read_b64_tr_b16 v[116:117], v13 offset:49152
    ds_read_b64_tr_b16 v[118:119], v15 offset:49152
    s_waitcnt lgkmcnt(5)
    v_mfma_f32_32x32x16_bf16 v[64:79], v[100:103], v[96:99], v[64:79]
    v_mfma_f32_32x32x16_bf16 v[80:95], v[104:107], v[96:99], v[80:95]
    v_add_u32 v12, 0x10000, v12
    v_add_u32 v13, 0x10000, v13
    v_add_u32 v14, 0x10000, v14
    v_add_u32 v15, 0x10000, v15
    ds_read_b128 v[96:99], v16 offset:128
    ds_read_b64_tr_b16 v[100:101], v12 offset:0
    ds_read_b64_tr_b16 v[102:103], v14 offset:0
    ds_read_b64_tr_b16 v[104:105], v13 offset:0
    ds_read_b64_tr_b16 v[106:107], v15 offset:0
    s_waitcnt lgkmcnt(5)
    v_mfma_f32_32x32x16_bf16 v[64:79], v[112:115], v[108:111], v[64:79]
    v_mfma_f32_32x32x16_bf16 v[80:95], v[116:119], v[108:111], v[80:95]
    ds_read_b128 v[108:111], v16 offset:160
    ds_read_b64_tr_b16 v[112:113], v12 offset:16384
    ds_read_b64_tr_b16 v[114:115], v14 offset:16384
    ds_read_b64_tr_b16 v[116:117], v13 offset:16384
    ds_read_b64_tr_b16 v[118:119], v15 offset:16384
    s_waitcnt lgkmcnt(5)
    v_mfma_f32_32x32x16_bf16 v[64:79], v[100:103], v[96:99], v[64:79]
    v_mfma_f32_32x32x16_bf16 v[80:95], v[104:107], v[96:99], v[80:95]
    ds_read_b128 v[96:99], v16 offset:192
    ds_read_b64_tr_b16 v[100:101], v12 offset:32768
    ds_read_b64_tr_b16 v[102:103], v14 offset:32768
    ds_read_b64_tr_b16 v[104:105], v13 offset:32768
    ds_read_b64_tr_b16 v[106:107], v15 offset:32768
    s_waitcnt lgkmcnt(5)
    v_mfma_f32_32x32x16_bf16 v[64:79], v[112:115], v[108:111], v[64:79]
    v_mfma_f32_32x32x16_bf16 v[80:95], v[116:119], v[108:111], v[80:95]
    ds_read_b128 v[108:111], v16 offset:224
    ds_read_b64_tr_b16 v[112:113], v12 offset:49152
    ds_read_b64_tr_b16 v[114:115], v14 offset:49152
    ds_read_b64_tr_b16 v[116:117], v13 offset:49152
    ds_read_b64_tr_b16 v[118:119], v15 offset:49152
    s_waitcnt lgkmcnt(5)
    v_mfma_f32_32x32x16_bf16 v[64:79], v[100:103], v[96:99], v[64:79]
    v_mfma_f32_32x32x16_bf16 v[80:95], v[104:107], v[96:99], v[80:95]
    s_waitcnt lgkmcnt(0)
    v_mfma_f32_32x32x16_bf16 v[64:79], v[112:115], v[108:111], v[64:79]
    v_mfma_f32_32x32x16_bf16 v[80:95], v[116:119], v[108:111], v[80:95]
    v_subrev_u32 v12, 0x10000, v12
    v_subrev_u32 v13, 0x10000, v13
    v_subrev_u32 v14, 0x10000, v14
    v_subrev_u32 v15, 0x10000, v15
    v_add_f32 v40, v40, v41
    v_add_f32 v42, v42, v43
    v_add_f32 v40, v40, v42
    v_fma_f32 v19, v19, v32, v40
    s_barrier
    s_nop 7
    s_nop 3
    v_and_b32 v43, 31, v1
    v_lshrrev_b32 v44, 5, v1
    v_mul_u32_u24 v40, 1040, v43
    v_lshl_add_u32 v40, v44, 3, v40
    s_lshl_b32 s61, s56, 7
    v_add_u32 v40, s61, v40
    v_cvt_pk_bf16_f32 v64, v64, v65
    v_cvt_pk_bf16_f32 v65, v66, v67
    ds_write_b64 v40, v[64:65] offset:0
    v_cvt_pk_bf16_f32 v68, v68, v69
    v_cvt_pk_bf16_f32 v69, v70, v71
    ds_write_b64 v40, v[68:69] offset:16
    v_cvt_pk_bf16_f32 v72, v72, v73
    v_cvt_pk_bf16_f32 v73, v74, v75
    ds_write_b64 v40, v[72:73] offset:32
    v_cvt_pk_bf16_f32 v76, v76, v77
    v_cvt_pk_bf16_f32 v77, v78, v79
    ds_write_b64 v40, v[76:77] offset:48
    v_cvt_pk_bf16_f32 v80, v80, v81
    v_cvt_pk_bf16_f32 v81, v82, v83
    ds_write_b64 v40, v[80:81] offset:64
    v_cvt_pk_bf16_f32 v84, v84, v85
    v_cvt_pk_bf16_f32 v85, v86, v87
    ds_write_b64 v40, v[84:85] offset:80
    v_cvt_pk_bf16_f32 v88, v88, v89
    v_cvt_pk_bf16_f32 v89, v90, v91
    ds_write_b64 v40, v[88:89] offset:96
    v_cvt_pk_bf16_f32 v92, v92, v93
    v_cvt_pk_bf16_f32 v93, v94, v95
    ds_write_b64 v40, v[92:93] offset:112
    v_mov_b32 v46, v18
    v_mov_b32 v47, v19
    v_lshlrev_b32 v45, 8, v43
    s_lshl_b32 s62, s65, 3
    s_add_u32 s62, s62, 1245184
    s_cmp_lg_u32 s56, 0
    s_cbranch_scc1 Lml_69
    s_mov_b64 exec, 0xffffffff
    buffer_store_dwordx2 v[46:47], v45, s[32:35], s62 offen sc0 sc1
    s_mov_b64 exec, -1
Lml_69:
    s_waitcnt lgkmcnt(0)
    s_barrier
    s_mul_i32 s61, s56, 4160
    v_add_u32 v40, s61, v5
    ds_read_b128 v[96:99], v40 offset:0
    ds_read_b128 v[100:103], v40 offset:1040
    ds_read_b128 v[104:107], v40 offset:2080
    ds_read_b128 v[108:111], v40 offset:3120
    s_lshl_b32 s61, s65, 15
    s_lshl_b32 s62, s56, 12
    s_add_u32 s61, s61, s62
    s_add_u32 s61, s61, 2097152
    s_waitcnt lgkmcnt(3)
    buffer_store_dwordx4 v[96:99], v5, s[32:35], s61 offen offset:0 sc0 sc1
    s_waitcnt lgkmcnt(2)
    buffer_store_dwordx4 v[100:103], v5, s[32:35], s61 offen offset:1024 sc0 sc1
    s_waitcnt lgkmcnt(1)
    buffer_store_dwordx4 v[104:107], v5, s[32:35], s61 offen offset:2048 sc0 sc1
    s_waitcnt lgkmcnt(0)
    buffer_store_dwordx4 v[108:111], v5, s[32:35], s61 offen offset:3072 sc0 sc1
    s_waitcnt vmcnt(0)
    s_barrier
    s_cmp_lg_u32 s56, 0
    s_cbranch_scc1 Lpf_70
    v_lshlrev_b32 v40, 14, v1
    v_mov_b32 v41, 0
    s_lshl_b32 s61, s65, 2
    s_add_u32 s61, s61, 0
    s_mov_b64 exec, 0xffffffff
    buffer_store_dword v41, v40, s[32:35], s61 offen sc0 sc1
    s_mov_b64 exec, -1
Lpf_70:
    s_mov_b32 s36, s24
    s_mov_b32 s37, s25
    s_and_b32 s37, s37, 0xffff
    s_mov_b32 s38, 4194304
    s_mov_b32 s39, 0x00020000
    s_lshl_b32 s61, s56, 14
    s_lshl_b32 s62, s65, 17
    s_add_u32 s62, s62, s61
    s_mul_i32 s63, s65, 5
    s_lshl_b32 s64, s56, 1
    s_add_u32 s63, s63, s64
    s_add_u32 s64, s63, 0
    s_and_b32 s64, s64, 15
    s_and_b32 s100, s64, 3
    s_lshl_b32 s100, s100, 6
    s_lshr_b32 s101, s64, 3
    s_lshl_b32 s101, s101, 5
    s_or_b32 s100, s100, s101
    s_lshl_b32 s64, s64, 10
    s_add_u32 m0, s61, s64
    v_xor_b32 v52, s100, v5
    s_add_u32 s64, s64, s62
    buffer_load_dwordx4 v52, s[36:39], s64 offen nt lds
    s_add_u32 s64, s63, 1
    s_and_b32 s64, s64, 15
    s_and_b32 s100, s64, 3
    s_lshl_b32 s100, s100, 6
    s_lshr_b32 s101, s64, 3
    s_lshl_b32 s101, s101, 5
    s_or_b32 s100, s100, s101
    s_lshl_b32 s64, s64, 10
    s_add_u32 m0, s61, s64
    v_xor_b32 v53, s100, v5
    s_add_u32 s64, s64, s62
    buffer_load_dwordx4 v53, s[36:39], s64 offen nt lds
    s_add_u32 s64, s63, 2
    s_and_b32 s64, s64, 15
    s_and_b32 s100, s64, 3
    s_lshl_b32 s100, s100, 6
    s_lshr_b32 s101, s64, 3
    s_lshl_b32 s101, s101, 5
    s_or_b32 s100, s100, s101
    s_lshl_b32 s64, s64, 10
    s_add_u32 m0, s61, s64
    v_xor_b32 v52, s100, v5
    s_add_u32 s64, s64, s62
    buffer_load_dwordx4 v52, s[36:39], s64 offen nt lds
    s_add_u32 s64, s63, 3
    s_and_b32 s64, s64, 15
    s_and_b32 s100, s64, 3
    s_lshl_b32 s100, s100, 6
    s_lshr_b32 s101, s64, 3
    s_lshl_b32 s101, s101, 5
    s_or_b32 s100, s100, s101
    s_lshl_b32 s64, s64, 10
    s_add_u32 m0, s61, s64
    v_xor_b32 v53, s100, v5
    s_add_u32 s64, s64, s62
    buffer_load_dwordx4 v53, s[36:39], s64 offen nt lds
    s_add_u32 s64, s63, 4
    s_and_b32 s64, s64, 15
    s_and_b32 s100, s64, 3
    s_lshl_b32 s100, s100, 6
    s_lshr_b32 s101, s64, 3
    s_lshl_b32 s101, s101, 5
    s_or_b32 s100, s100, s101
    s_lshl_b32 s64, s64, 10
    s_add_u32 m0, s61, s64
    v_xor_b32 v52, s100, v5
    s_add_u32 s64, s64, s62
    buffer_load_dwordx4 v52, s[36:39], s64 offen nt lds
    s_add_u32 s64, s63, 5
    s_and_b32 s64, s64, 15
    s_and_b32 s100, s64, 3
    s_lshl_b32 s100, s100, 6
    s_lshr_b32 s101, s64, 3
    s_lshl_b32 s101, s101, 5
    s_or_b32 s100, s100, s101
    s_lshl_b32 s64, s64, 10
    s_add_u32 m0, s61, s64
    v_xor_b32 v53, s100, v5
    s_add_u32 s64, s64, s62
    buffer_load_dwordx4 v53, s[36:39], s64 offen nt lds
    s_add_u32 s64, s63, 6
    s_and_b32 s64, s64, 15
    s_and_b32 s100, s64, 3
    s_lshl_b32 s100, s100, 6
    s_lshr_b32 s101, s64, 3
    s_lshl_b32 s101, s101, 5
    s_or_b32 s100, s100, s101
    s_lshl_b32 s64, s64, 10
    s_add_u32 m0, s61, s64
    v_xor_b32 v52, s100, v5
    s_add_u32 s64, s64, s62
    buffer_load_dwordx4 v52, s[36:39], s64 offen nt lds
    s_add_u32 s64, s63, 7
    s_and_b32 s64, s64, 15
    s_and_b32 s100, s64, 3
    s_lshl_b32 s100, s100, 6
    s_lshr_b32 s101, s64, 3
    s_lshl_b32 s101, s101, 5
    s_or_b32 s100, s100, s101
    s_lshl_b32 s64, s64, 10
    s_add_u32 m0, s61, s64
    v_xor_b32 v53, s100, v5
    s_add_u32 s64, s64, s62
    buffer_load_dwordx4 v53, s[36:39], s64 offen nt lds
    s_add_u32 s64, s63, 8
    s_and_b32 s64, s64, 15
    s_and_b32 s100, s64, 3
    s_lshl_b32 s100, s100, 6
    s_lshr_b32 s101, s64, 3
    s_lshl_b32 s101, s101, 5
    s_or_b32 s100, s100, s101
    s_lshl_b32 s64, s64, 10
    s_add_u32 m0, s61, s64
    v_xor_b32 v52, s100, v5
    s_add_u32 s64, s64, s62
    buffer_load_dwordx4 v52, s[36:39], s64 offen nt lds
    s_add_u32 s64, s63, 9
    s_and_b32 s64, s64, 15
    s_and_b32 s100, s64, 3
    s_lshl_b32 s100, s100, 6
    s_lshr_b32 s101, s64, 3
    s_lshl_b32 s101, s101, 5
    s_or_b32 s100, s100, s101
    s_lshl_b32 s64, s64, 10
    s_add_u32 m0, s61, s64
    v_xor_b32 v53, s100, v5
    s_add_u32 s64, s64, s62
    buffer_load_dwordx4 v53, s[36:39], s64 offen nt lds
    s_add_u32 s64, s63, 10
    s_and_b32 s64, s64, 15
    s_and_b32 s100, s64, 3
    s_lshl_b32 s100, s100, 6
    s_lshr_b32 s101, s64, 3
    s_lshl_b32 s101, s101, 5
    s_or_b32 s100, s100, s101
    s_lshl_b32 s64, s64, 10
    s_add_u32 m0, s61, s64
    v_xor_b32 v52, s100, v5
    s_add_u32 s64, s64, s62
    buffer_load_dwordx4 v52, s[36:39], s64 offen nt lds
    s_add_u32 s64, s63, 11
    s_and_b32 s64, s64, 15
    s_and_b32 s100, s64, 3
    s_lshl_b32 s100, s100, 6
    s_lshr_b32 s101, s64, 3
    s_lshl_b32 s101, s101, 5
    s_or_b32 s100, s100, s101
    s_lshl_b32 s64, s64, 10
    s_add_u32 m0, s61, s64
    v_xor_b32 v53, s100, v5
    s_add_u32 s64, s64, s62
    buffer_load_dwordx4 v53, s[36:39], s64 offen nt lds
    s_add_u32 s64, s63, 12
    s_and_b32 s64, s64, 15
    s_and_b32 s100, s64, 3
    s_lshl_b32 s100, s100, 6
    s_lshr_b32 s101, s64, 3
    s_lshl_b32 s101, s101, 5
    s_or_b32 s100, s100, s101
    s_lshl_b32 s64, s64, 10
    s_add_u32 m0, s61, s64
    v_xor_b32 v52, s100, v5
    s_add_u32 s64, s64, s62
    buffer_load_dwordx4 v52, s[36:39], s64 offen nt lds
    s_add_u32 s64, s63, 13
    s_and_b32 s64, s64, 15
    s_and_b32 s100, s64, 3
    s_lshl_b32 s100, s100, 6
    s_lshr_b32 s101, s64, 3
    s_lshl_b32 s101, s101, 5
    s_or_b32 s100, s100, s101
    s_lshl_b32 s64, s64, 10
    s_add_u32 m0, s61, s64
    v_xor_b32 v53, s100, v5
    s_add_u32 s64, s64, s62
    buffer_load_dwordx4 v53, s[36:39], s64 offen nt lds
    s_add_u32 s64, s63, 14
    s_and_b32 s64, s64, 15
    s_and_b32 s100, s64, 3
    s_lshl_b32 s100, s100, 6
    s_lshr_b32 s101, s64, 3
    s_lshl_b32 s101, s101, 5
    s_or_b32 s100, s100, s101
    s_lshl_b32 s64, s64, 10
    s_add_u32 m0, s61, s64
    v_xor_b32 v52, s100, v5
    s_add_u32 s64, s64, s62
    buffer_load_dwordx4 v52, s[36:39], s64 offen nt lds
    s_add_u32 s64, s63, 15
    s_and_b32 s64, s64, 15
    s_and_b32 s100, s64, 3
    s_lshl_b32 s100, s100, 6
    s_lshr_b32 s101, s64, 3
    s_lshl_b32 s101, s101, 5
    s_or_b32 s100, s100, s101
    s_lshl_b32 s64, s64, 10
    s_add_u32 m0, s61, s64
    v_xor_b32 v53, s100, v5
    s_add_u32 s64, s64, s62
    buffer_load_dwordx4 v53, s[36:39], s64 offen nt lds
    s_waitcnt vmcnt(0)
    s_barrier
    v_lshrrev_b32 v40, 2, v3
    v_and_b32 v41, 1, v2
    v_lshlrev_b32 v42, 2, v40
    v_lshl_or_b32 v42, v41, 1, v42
    v_lshl_add_u32 v43, v2, 3, v40
    v_lshlrev_b32 v43, 10, v43
    v_and_b32 v44, 1, v3
    v_lshl_add_u32 v43, v44, 3, v43
    v_bfe_u32 v44, v3, 1, 1
    s_lshl_b32 s61, s56, 3
    s_add_u32 s62, s61, 0
    v_add_u32 v45, s62, v44
    v_xor_b32 v45, v45, v42
    v_lshl_add_u32 v48, v45, 4, v43
    s_add_u32 s62, s61, 2
    v_add_u32 v45, s62, v44
    v_xor_b32 v45, v45, v42
    v_lshl_add_u32 v49, v45, 4, v43
    s_add_u32 s62, s61, 4
    v_add_u32 v45, s62, v44
    v_xor_b32 v45, v45, v42
    v_lshl_add_u32 v50, v45, 4, v43
    s_add_u32 s62, s61, 6
    v_add_u32 v45, s62, v44
    v_xor_b32 v45, v45, v42
    v_lshl_add_u32 v51, v45, 4, v43
    ds_read_b64_tr_b16 v[128:129], v48 offset:0
    ds_read_b64_tr_b16 v[130:131], v48 offset:4096
    ds_read_b64_tr_b16 v[144:145], v49 offset:0
    ds_read_b64_tr_b16 v[146:147], v49 offset:4096
    ds_read_b64_tr_b16 v[160:161], v50 offset:0
    ds_read_b64_tr_b16 v[162:163], v50 offset:4096
    ds_read_b64_tr_b16 v[176:177], v51 offset:0
    ds_read_b64_tr_b16 v[178:179], v51 offset:4096
    s_waitcnt lgkmcnt(0)
    ds_read_b64_tr_b16 v[132:133], v48 offset:32768
    ds_read_b64_tr_b16 v[134:135], v48 offset:36864
    ds_read_b64_tr_b16 v[148:149], v49 offset:32768
    ds_read_b64_tr_b16 v[150:151], v49 offset:36864
    ds_read_b64_tr_b16 v[164:165], v50 offset:32768
    ds_read_b64_tr_b16 v[166:167], v50 offset:36864
    ds_read_b64_tr_b16 v[180:181], v51 offset:32768
    ds_read_b64_tr_b16 v[182:183], v51 offset:36864
    s_waitcnt lgkmcnt(0)
    v_add_u32 v48, 0x10000, v48
    v_add_u32 v49, 0x10000, v49
    v_add_u32 v50, 0x10000, v50
    v_add_u32 v51, 0x10000, v51
    ds_read_b64_tr_b16 v[136:137], v48 offset:0
    ds_read_b64_tr_b16 v[138:139], v48 offset:4096
    ds_read_b64_tr_b16 v[152:153], v49 offset:0
    ds_read_b64_tr_b16 v[154:155], v49 offset:4096
    ds_read_b64_tr_b16 v[168:169], v50 offset:0
    ds_read_b64_tr_b16 v[170:171], v50 offset:4096
    ds_read_b64_tr_b16 v[184:185], v51 offset:0
    ds_read_b64_tr_b16 v[186:187], v51 offset:4096
    s_waitcnt lgkmcnt(0)
    ds_read_b64_tr_b16 v[140:141], v48 offset:32768
    ds_read_b64_tr_b16 v[142:143], v48 offset:36864
    ds_read_b64_tr_b16 v[156:157], v49 offset:32768
    ds_read_b64_tr_b16 v[158:159], v49 offset:36864
    ds_read_b64_tr_b16 v[172:173], v50 offset:32768
    ds_read_b64_tr_b16 v[174:175], v50 offset:36864
    ds_read_b64_tr_b16 v[188:189], v51 offset:32768
    ds_read_b64_tr_b16 v[190:191], v51 offset:36864
    s_waitcnt lgkmcnt(0)
L_t2_head:
    v_lshrrev_b32 v40, 5, v1
    v_lshlrev_b32 v41, 12, v40
    v_and_b32 v42, 31, v1
    v_lshl_add_u32 v41, v42, 4, v41
    v_add_u32 v41, 512, v41
    v_lshlrev_b32 v43, 7, v40
    s_lshl_b32 s61, s56, 9
    s_add_u32 s61, s61, 131072
    v_lshlrev_b32 v46, 3, v1
    v_add_u32 v46, s61, v46
    v_and_b32 v47, 1, v3
    v_lshlrev_b32 v47, 8, v47
    v_lshl_add_u32 v47, v2, 4, v47
    v_add_u32 v47, s61, v47
    s_mov_b32 s70, 1040356334
    v_lshlrev_b32 v48, 4, v1
    v_add_u32 v48, 135168, v48
    v_lshlrev_b32 v49, 3, v40
    v_add_u32 v49, 143360, v49
    s_cmp_ge_u32 s56, 6
    s_cbranch_scc1 Lhnp_71
    s_mov_b32 s62, s56
    s_lshl_b32 s63, s62, 9
    s_add_u32 s63, s63, s93
    s_lshl_b32 s64, s62, 4
    s_add_u32 s64, s64, s93
    s_mov_b32 s92, 0
Lpoll_72:
    buffer_load_dwordx4 v[64:67], v41, s[32:35], s63 offen sc0 sc1
    buffer_load_dwordx2 v[68:69], v43, s[32:35], s64 offen offset:128 sc0 sc1
    s_waitcnt vmcnt(0)
    v_mov_b32 v45, v64
    v_max3_u32 v45, v45, v65, v66
    v_max3_u32 v45, v45, v67, v68
    v_max_u32 v45, v45, v69
    v_cmpx_eq_u32 vcc, -1, v45
    s_cbranch_execz Lpolld_73
    s_sleep 1
    s_add_u32 s92, s92, 1
    s_cmp_lt_u32 s92, 400000
    s_cbranch_scc1 Lpoll_72
Lpolld_73:
    s_mov_b64 exec, -1
    s_lshl_b32 s62, s56, 10
    v_add_u32 v44, s62, v48
    ds_write_b128 v44, v[64:67]
    s_lshl_b32 s62, s56, 4
    v_add_u32 v44, s62, v49
    ds_write_b64 v44, v[68:69]
    s_waitcnt lgkmcnt(0)
Lhnp_71:
    s_barrier
    ds_read_b64 v[88:89], v49 offset:0
    ds_read_b64 v[90:91], v49 offset:16
    ds_read_b64 v[92:93], v49 offset:32
    ds_read_b64 v[94:95], v49 offset:48
    ds_read_b64 v[96:97], v49 offset:64
    ds_read_b64 v[98:99], v49 offset:80
    ds_read_b128 v[64:67], v48 offset:0
    ds_read_b128 v[68:71], v48 offset:1024
    ds_read_b128 v[72:75], v48 offset:2048
    ds_read_b128 v[76:79], v48 offset:3072
    ds_read_b128 v[80:83], v48 offset:4096
    ds_read_b128 v[84:87], v48 offset:5120
    s_waitcnt lgkmcnt(6)
    v_max3_f32 v45, v88, v90, v92
    v_max3_f32 v45, v45, v94, v96
    v_max_f32 v45, v45, v98
    v_mul_f32 v44, s70, v45
    v_fma_f32 v88, v88, s70, -v44
    v_fma_f32 v90, v90, s70, -v44
    v_fma_f32 v92, v92, s70, -v44
    v_fma_f32 v94, v94, s70, -v44
    v_fma_f32 v96, v96, s70, -v44
    v_fma_f32 v98, v98, s70, -v44
    v_exp_f32 v88, v88
    v_exp_f32 v90, v90
    v_exp_f32 v92, v92
    v_exp_f32 v94, v94
    v_exp_f32 v96, v96
    v_exp_f32 v98, v98
    s_nop 0
    v_mul_f32 v45, v88, v89
    v_fmac_f32 v45, v90, v91
    v_fmac_f32 v45, v92, v93
    v_fmac_f32 v45, v94, v95
    v_fmac_f32 v45, v96, v97
    v_fmac_f32 v45, v98, v99
    v_rcp_f32 v45, v45
    s_waitcnt lgkmcnt(0)
    v_mul_f32 v64, v64, v88
    v_mul_f32 v65, v65, v88
    v_mul_f32 v66, v66, v88
    v_mul_f32 v67, v67, v88
    v_fmac_f32 v64, v68, v90
    v_fmac_f32 v65, v69, v90
    v_fmac_f32 v66, v70, v90
    v_fmac_f32 v67, v71, v90
    v_fmac_f32 v64, v72, v92
    v_fmac_f32 v65, v73, v92
    v_fmac_f32 v66, v74, v92
    v_fmac_f32 v67, v75, v92
    v_fmac_f32 v64, v76, v94
    v_fmac_f32 v65, v77, v94
    v_fmac_f32 v66, v78, v94
    v_fmac_f32 v67, v79, v94
    v_fmac_f32 v64, v80, v96
    v_fmac_f32 v65, v81, v96
    v_fmac_f32 v66, v82, v96
    v_fmac_f32 v67, v83, v96
    v_fmac_f32 v64, v84, v98
    v_fmac_f32 v65, v85, v98
    v_fmac_f32 v66, v86, v98
    v_fmac_f32 v67, v87, v98
    v_mul_f32 v64, v64, v45
    v_mul_f32 v65, v65, v45
    v_mul_f32 v66, v66, v45
    v_mul_f32 v67, v67, v45
    v_cvt_pk_bf16_f32 v64, v64, v65
    v_cvt_pk_bf16_f32 v65, v66, v67
    ds_write_b64 v46, v[64:65]
    s_waitcnt lgkmcnt(0)
    ds_read_b128 v[24:27], v47 offset:0
    ds_read_b128 v[28:31], v47 offset:64
    ds_read_b128 v[32:35], v47 offset:128
    ds_read_b128 v[36:39], v47 offset:192
    v_and_b32 v40, 1, v1
    v_lshlrev_b32 v40, 19, v40
    v_lshl_add_u32 v40, v2, 4, v40
    s_lshl_b32 s61, s56, 16
    s_lshl_b32 s62, s65, 6
    s_add_u32 s61, s61, s62
    s_add_u32 s61, s61, 8704
    s_waitcnt lgkmcnt(3)
    v_mfma_f32_16x16x32_bf16 v[8:11], v[128:131], v[24:27], 0
    v_mfma_f32_16x16x32_bf16 v[12:15], v[144:147], v[24:27], 0
    v_mfma_f32_16x16x32_bf16 v[16:19], v[160:163], v[24:27], 0
    v_mfma_f32_16x16x32_bf16 v[20:23], v[176:179], v[24:27], 0
    s_waitcnt lgkmcnt(2)
    v_mfma_f32_16x16x32_bf16 v[8:11], v[132:135], v[28:31], v[8:11]
    v_mfma_f32_16x16x32_bf16 v[12:15], v[148:151], v[28:31], v[12:15]
    v_mfma_f32_16x16x32_bf16 v[16:19], v[164:167], v[28:31], v[16:19]
    v_mfma_f32_16x16x32_bf16 v[20:23], v[180:183], v[28:31], v[20:23]
    s_waitcnt lgkmcnt(1)
    v_mfma_f32_16x16x32_bf16 v[8:11], v[136:139], v[32:35], v[8:11]
    v_mfma_f32_16x16x32_bf16 v[12:15], v[152:155], v[32:35], v[12:15]
    v_mfma_f32_16x16x32_bf16 v[16:19], v[168:171], v[32:35], v[16:19]
    v_mfma_f32_16x16x32_bf16 v[20:23], v[184:187], v[32:35], v[20:23]
    s_waitcnt lgkmcnt(0)
    v_mfma_f32_16x16x32_bf16 v[8:11], v[140:143], v[36:39], v[8:11]
    v_mfma_f32_16x16x32_bf16 v[12:15], v[156:159], v[36:39], v[12:15]
    v_mfma_f32_16x16x32_bf16 v[16:19], v[172:175], v[36:39], v[16:19]
    v_mfma_f32_16x16x32_bf16 v[20:23], v[188:191], v[36:39], v[20:23]
    s_mov_b32 exec_lo, 0x00030003
    s_mov_b32 exec_hi, 0x00030003
    s_nop 2
    s_nop 1
    buffer_store_dwordx4 v[8:11], v40, s[32:35], s61 offen sc0 sc1
    s_add_u32 s61, s61, 16384
    buffer_store_dwordx4 v[12:15], v40, s[32:35], s61 offen sc0 sc1
    s_add_u32 s61, s61, 16384
    buffer_store_dwordx4 v[16:19], v40, s[32:35], s61 offen sc0 sc1
    s_add_u32 s61, s61, 16384
    s_nop 3
    buffer_store_dwordx4 v[20:23], v40, s[32:35], s61 offen sc0 sc1
    s_mov_b64 exec, -1
    s_branch L_final
L_roleT1:
    s_mov_b32 s65, s75
    s_mov_b32 s44, s10
    s_mov_b32 s45, s11
    s_and_b32 s45, s45, 0xffff
    s_mov_b32 s46, 4194304
    s_mov_b32 s47, 0x00020000
    s_cmp_eq_u32 s56, 7
    s_cbranch_scc1 Lt1s_74
    s_lshl_b32 s85, s56, 19
    s_lshl_b32 s86, s65, 8
    s_add_u32 s85, s85, s86
    buffer_load_dwordx4 v[128:131], v4, s[44:47], s85 offen nt
    s_add_u32 s85, s85, 8192
    buffer_load_dwordx4 v[132:135], v4, s[44:47], s85 offen nt
    s_add_u32 s85, s85, 8192
    buffer_load_dwordx4 v[136:139], v4, s[44:47], s85 offen nt
    s_add_u32 s85, s85, 8192
    buffer_load_dwordx4 v[140:143], v4, s[44:47], s85 offen nt
    s_add_u32 s85, s85, 8192
    s_waitcnt vmcnt(4)
    v_perm_b32 v232, v196, v192, s68
    v_perm_b32 v233, v196, v192, s69
    v_perm_b32 v234, v197, v193, s68
    v_perm_b32 v235, v197, v193, s69
    v_perm_b32 v236, v198, v194, s68
    v_perm_b32 v237, v198, v194, s69
    v_perm_b32 v238, v199, v195, s68
    v_perm_b32 v239, v199, v195, s69
    v_dot2_f32_bf16 v212, v232, v208, 0
    v_dot2_f32_bf16 v213, v233, v208, 0
    v_dot2_f32_bf16 v214, v234, v208, 0
    v_dot2_f32_bf16 v215, v235, v208, 0
    v_dot2_f32_bf16 v216, v236, v208, 0
    v_dot2_f32_bf16 v217, v237, v208, 0
    v_dot2_f32_bf16 v218, v238, v208, 0
    v_dot2_f32_bf16 v219, v239, v208, 0
    v_dot2_f32_bf16 v220, v232, v210, 0
    v_dot2_f32_bf16 v221, v233, v210, 0
    v_dot2_f32_bf16 v222, v234, v210, 0
    v_dot2_f32_bf16 v223, v235, v210, 0
    v_dot2_f32_bf16 v224, v236, v210, 0
    v_dot2_f32_bf16 v225, v237, v210, 0
    v_dot2_f32_bf16 v226, v238, v210, 0
    v_dot2_f32_bf16 v227, v239, v210, 0
    v_perm_b32 v232, v204, v200, s68
    v_perm_b32 v233, v204, v200, s69
    v_perm_b32 v234, v205, v201, s68
    v_perm_b32 v235, v205, v201, s69
    v_perm_b32 v236, v206, v202, s68
    v_perm_b32 v237, v206, v202, s69
    v_perm_b32 v238, v207, v203, s68
    v_perm_b32 v239, v207, v203, s69
    v_dot2_f32_bf16 v212, v232, v209, v212
    v_dot2_f32_bf16 v213, v233, v209, v213
    v_dot2_f32_bf16 v214, v234, v209, v214
    v_dot2_f32_bf16 v215, v235, v209, v215
    v_dot2_f32_bf16 v216, v236, v209, v216
    v_dot2_f32_bf16 v217, v237, v209, v217
    v_dot2_f32_bf16 v218, v238, v209, v218
    v_dot2_f32_bf16 v219, v239, v209, v219
    v_dot2_f32_bf16 v220, v232, v211, v220
    v_dot2_f32_bf16 v221, v233, v211, v221
    v_dot2_f32_bf16 v222, v234, v211, v222
    v_dot2_f32_bf16 v223, v235, v211, v223
    v_dot2_f32_bf16 v224, v236, v211, v224
    v_dot2_f32_bf16 v225, v237, v211, v225
    v_dot2_f32_bf16 v226, v238, v211, v226
    v_dot2_f32_bf16 v227, v239, v211, v227
    s_nop 2
    v_permlane32_swap_b32 v212, v220
    v_permlane32_swap_b32 v213, v221
    v_permlane32_swap_b32 v214, v222
    v_permlane32_swap_b32 v215, v223
    v_permlane32_swap_b32 v216, v224
    v_permlane32_swap_b32 v217, v225
    v_permlane32_swap_b32 v218, v226
    v_permlane32_swap_b32 v219, v227
    s_nop 1
    v_add_f32 v212, v212, v220
    v_add_f32 v213, v213, v221
    v_add_f32 v214, v214, v222
    v_add_f32 v215, v215, v223
    v_add_f32 v216, v216, v224
    v_add_f32 v217, v217, v225
    v_add_f32 v218, v218, v226
    v_add_f32 v219, v219, v227
    s_nop 1
    v_permlane16_swap_b32 v212, v216
    v_permlane16_swap_b32 v213, v217
    v_permlane16_swap_b32 v214, v218
    v_permlane16_swap_b32 v215, v219
    s_nop 1
    v_add_f32 v212, v212, v216
    v_add_f32 v213, v213, v217
    v_add_f32 v214, v214, v218
    v_add_f32 v215, v215, v219
    s_nop 1
    v_add_f32_dpp v212, v212, v212 row_ror:8 row_mask:0xf bank_mask:0xf
    v_add_f32_dpp v213, v213, v213 row_ror:8 row_mask:0xf bank_mask:0xf
    v_add_f32_dpp v214, v214, v214 row_ror:8 row_mask:0xf bank_mask:0xf
    v_add_f32_dpp v215, v215, v215 row_ror:8 row_mask:0xf bank_mask:0xf
    v_lshrrev_b32 v232, 5, v228
    v_lshlrev_b32 v232, 8, v232
    v_bfe_u32 v233, v228, 4, 1
    v_lshl_add_u32 v232, v233, 4, v232
    v_lshl_add_u32 v232, v230, 5, v232
    s_lshl_b32 s61, s56, 9
    s_add_u32 s61, s61, 131072
    v_add_u32 v232, s61, v232
    ds_write_b128 v232, v[212:215]
    s_waitcnt lgkmcnt(0)
    s_barrier
    s_waitcnt vmcnt(4)
    buffer_load_dwordx4 v[144:147], v4, s[44:47], s85 offen nt
    s_add_u32 s85, s85, 8192
    s_waitcnt vmcnt(4)
    buffer_load_dwordx4 v[148:151], v4, s[44:47], s85 offen nt
    s_add_u32 s85, s85, 8192
    s_waitcnt vmcnt(4)
    buffer_load_dwordx4 v[152:155], v4, s[44:47], s85 offen nt
    s_add_u32 s85, s85, 8192
    s_waitcnt vmcnt(4)
    buffer_load_dwordx4 v[156:159], v4, s[44:47], s85 offen nt
    s_add_u32 s85, s85, 8192
    s_waitcnt vmcnt(4)
    buffer_load_dwordx4 v[160:163], v4, s[44:47], s85 offen nt
    s_add_u32 s85, s85, 8192
    s_waitcnt vmcnt(4)
    buffer_load_dwordx4 v[164:167], v4, s[44:47], s85 offen nt
    s_add_u32 s85, s85, 8192
    s_waitcnt vmcnt(4)
    buffer_load_dwordx4 v[168:171], v4, s[44:47], s85 offen nt
    s_add_u32 s85, s85, 8192
    s_waitcnt vmcnt(4)
    buffer_load_dwordx4 v[172:175], v4, s[44:47], s85 offen nt
    s_add_u32 s85, s85, 8192
    s_waitcnt vmcnt(4)
    buffer_load_dwordx4 v[176:179], v4, s[44:47], s85 offen nt
    s_add_u32 s85, s85, 8192
    s_waitcnt vmcnt(4)
    buffer_load_dwordx4 v[180:183], v4, s[44:47], s85 offen nt
    s_add_u32 s85, s85, 8192
    s_waitcnt vmcnt(4)
    buffer_load_dwordx4 v[184:187], v4, s[44:47], s85 offen nt
    s_add_u32 s85, s85, 8192
    s_waitcnt vmcnt(4)
    buffer_load_dwordx4 v[188:191], v4, s[44:47], s85 offen nt
    s_branch Lt1j_75
Lt1s_74:
    s_setprio 3
    s_waitcnt vmcnt(0)
    v_perm_b32 v232, v196, v192, s68
    v_perm_b32 v233, v196, v192, s69
    v_perm_b32 v234, v197, v193, s68
    v_perm_b32 v235, v197, v193, s69
    v_perm_b32 v236, v198, v194, s68
    v_perm_b32 v237, v198, v194, s69
    v_perm_b32 v238, v199, v195, s68
    v_perm_b32 v239, v199, v195, s69
    v_dot2_f32_bf16 v212, v232, v208, 0
    v_dot2_f32_bf16 v213, v233, v208, 0
    v_dot2_f32_bf16 v214, v234, v208, 0
    v_dot2_f32_bf16 v215, v235, v208, 0
    v_dot2_f32_bf16 v216, v236, v208, 0
    v_dot2_f32_bf16 v217, v237, v208, 0
    v_dot2_f32_bf16 v218, v238, v208, 0
    v_dot2_f32_bf16 v219, v239, v208, 0
    v_dot2_f32_bf16 v220, v232, v210, 0
    v_dot2_f32_bf16 v221, v233, v210, 0
    v_dot2_f32_bf16 v222, v234, v210, 0
    v_dot2_f32_bf16 v223, v235, v210, 0
    v_dot2_f32_bf16 v224, v236, v210, 0
    v_dot2_f32_bf16 v225, v237, v210, 0
    v_dot2_f32_bf16 v226, v238, v210, 0
    v_dot2_f32_bf16 v227, v239, v210, 0
    v_perm_b32 v232, v204, v200, s68
    v_perm_b32 v233, v204, v200, s69
    v_perm_b32 v234, v205, v201, s68
    v_perm_b32 v235, v205, v201, s69
    v_perm_b32 v236, v206, v202, s68
    v_perm_b32 v237, v206, v202, s69
    v_perm_b32 v238, v207, v203, s68
    v_perm_b32 v239, v207, v203, s69
    v_dot2_f32_bf16 v212, v232, v209, v212
    v_dot2_f32_bf16 v213, v233, v209, v213
    v_dot2_f32_bf16 v214, v234, v209, v214
    v_dot2_f32_bf16 v215, v235, v209, v215
    v_dot2_f32_bf16 v216, v236, v209, v216
    v_dot2_f32_bf16 v217, v237, v209, v217
    v_dot2_f32_bf16 v218, v238, v209, v218
    v_dot2_f32_bf16 v219, v239, v209, v219
    v_dot2_f32_bf16 v220, v232, v211, v220
    v_dot2_f32_bf16 v221, v233, v211, v221
    v_dot2_f32_bf16 v222, v234, v211, v222
    v_dot2_f32_bf16 v223, v235, v211, v223
    v_dot2_f32_bf16 v224, v236, v211, v224
    v_dot2_f32_bf16 v225, v237, v211, v225
    v_dot2_f32_bf16 v226, v238, v211, v226
    v_dot2_f32_bf16 v227, v239, v211, v227
    s_nop 2
    v_permlane32_swap_b32 v212, v220
    v_permlane32_swap_b32 v213, v221
    v_permlane32_swap_b32 v214, v222
    v_permlane32_swap_b32 v215, v223
    v_permlane32_swap_b32 v216, v224
    v_permlane32_swap_b32 v217, v225
    v_permlane32_swap_b32 v218, v226
    v_permlane32_swap_b32 v219, v227
    s_nop 1
    v_add_f32 v212, v212, v220
    v_add_f32 v213, v213, v221
    v_add_f32 v214, v214, v222
    v_add_f32 v215, v215, v223
    v_add_f32 v216, v216, v224
    v_add_f32 v217, v217, v225
    v_add_f32 v218, v218, v226
    v_add_f32 v219, v219, v227
    s_nop 1
    v_permlane16_swap_b32 v212, v216
    v_permlane16_swap_b32 v213, v217
    v_permlane16_swap_b32 v214, v218
    v_permlane16_swap_b32 v215, v219
    s_nop 1
    v_add_f32 v212, v212, v216
    v_add_f32 v213, v213, v217
    v_add_f32 v214, v214, v218
    v_add_f32 v215, v215, v219
    s_nop 1
    v_add_f32_dpp v212, v212, v212 row_ror:8 row_mask:0xf bank_mask:0xf
    v_add_f32_dpp v213, v213, v213 row_ror:8 row_mask:0xf bank_mask:0xf
    v_add_f32_dpp v214, v214, v214 row_ror:8 row_mask:0xf bank_mask:0xf
    v_add_f32_dpp v215, v215, v215 row_ror:8 row_mask:0xf bank_mask:0xf
    v_lshrrev_b32 v232, 5, v228
    v_lshlrev_b32 v232, 8, v232
    v_bfe_u32 v233, v228, 4, 1
    v_lshl_add_u32 v232, v233, 4, v232
    v_lshl_add_u32 v232, v230, 5, v232
    s_lshl_b32 s61, s56, 9
    s_add_u32 s61, s61, 131072
    v_add_u32 v232, s61, v232
    ds_write_b128 v232, v[212:215]
    s_waitcnt lgkmcnt(0)
    s_barrier
    v_mov_b32 v48, 1
    v_mov_b32 v49, 0
    s_mov_b64 exec, 1
    buffer_atomic_add v48, v49, s[52:55], 0 offen offset:128 sc1
    s_mov_b64 exec, -1
    v_mov_b32 v234, 0
    buffer_load_dword v235, v234, s[52:55], s91 offen offset:0 sc0 sc1
    v_and_b32 v232, 31, v228
    v_lshlrev_b32 v233, 4, v232
    v_add_u32 v233, 131072, v233
    ds_read_b128 v[192:195], v233 offset:0
    ds_read_b128 v[196:199], v233 offset:512
    ds_read_b128 v[200:203], v233 offset:1024
    ds_read_b128 v[204:207], v233 offset:1536
    ds_read_b128 v[208:211], v233 offset:2048
    ds_read_b128 v[212:215], v233 offset:2560
    ds_read_b128 v[216:219], v233 offset:3072
    ds_read_b128 v[220:223], v233 offset:3584
    s_waitcnt lgkmcnt(6)
    v_add_f32 v192, v192, v196
    v_add_f32 v193, v193, v197
    v_add_f32 v194, v194, v198
    v_add_f32 v195, v195, v199
    s_waitcnt lgkmcnt(5)
    v_add_f32 v192, v192, v200
    v_add_f32 v193, v193, v201
    v_add_f32 v194, v194, v202
    v_add_f32 v195, v195, v203
    s_waitcnt lgkmcnt(4)
    v_add_f32 v192, v192, v204
    v_add_f32 v193, v193, v205
    v_add_f32 v194, v194, v206
    v_add_f32 v195, v195, v207
    s_waitcnt lgkmcnt(3)
    v_add_f32 v192, v192, v208
    v_add_f32 v193, v193, v209
    v_add_f32 v194, v194, v210
    v_add_f32 v195, v195, v211
    s_waitcnt lgkmcnt(2)
    v_add_f32 v192, v192, v212
    v_add_f32 v193, v193, v213
    v_add_f32 v194, v194, v214
    v_add_f32 v195, v195, v215
    s_waitcnt lgkmcnt(1)
    v_add_f32 v192, v192, v216
    v_add_f32 v193, v193, v217
    v_add_f32 v194, v194, v218
    v_add_f32 v195, v195, v219
    s_waitcnt lgkmcnt(0)
    v_add_f32 v192, v192, v220
    v_add_f32 v193, v193, v221
    v_add_f32 v194, v194, v222
    v_add_f32 v195, v195, v223
    v_lshrrev_b32 v233, 4, v232
    v_lshlrev_b32 v233, 10, v233
    v_and_b32 v232, 15, v232
    v_lshl_add_u32 v233, v232, 4, v233
    s_waitcnt vmcnt(0)
    s_mov_b32 s92, 0
Lcf_76:
    v_readfirstlane_b32 s57, v235
    s_nop 3
    s_cmp_lg_u32 s57, 0
    s_cbranch_scc1 Lcfd_77
    s_sleep 2
    buffer_load_dword v235, v234, s[52:55], s91 offen offset:0 sc0 sc1
    s_waitcnt vmcnt(0)
    s_add_u32 s92, s92, 1
    s_cmp_lt_u32 s92, 400000
    s_cbranch_scc1 Lcf_76
Lcfd_77:
    s_mov_b64 exec, 0xffffffff
    buffer_store_dwordx4 v[192:195], v233, s[32:35], s3 offen sc0 sc1
    s_mov_b64 exec, -1
    s_lshl_b32 s85, s56, 19
    s_lshl_b32 s86, s65, 8
    s_add_u32 s85, s85, s86
    buffer_load_dwordx4 v[128:131], v4, s[44:47], s85 offen nt
    s_add_u32 s85, s85, 8192
    buffer_load_dwordx4 v[132:135], v4, s[44:47], s85 offen nt
    s_add_u32 s85, s85, 8192
    buffer_load_dwordx4 v[136:139], v4, s[44:47], s85 offen nt
    s_add_u32 s85, s85, 8192
    buffer_load_dwordx4 v[140:143], v4, s[44:47], s85 offen nt
    s_add_u32 s85, s85, 8192
    buffer_load_dwordx4 v[144:147], v4, s[44:47], s85 offen nt
    s_add_u32 s85, s85, 8192
    buffer_load_dwordx4 v[148:151], v4, s[44:47], s85 offen nt
    s_add_u32 s85, s85, 8192
    buffer_load_dwordx4 v[152:155], v4, s[44:47], s85 offen nt
    s_add_u32 s85, s85, 8192
    buffer_load_dwordx4 v[156:159], v4, s[44:47], s85 offen nt
    s_add_u32 s85, s85, 8192
    buffer_load_dwordx4 v[160:163], v4, s[44:47], s85 offen nt
    s_add_u32 s85, s85, 8192
    buffer_load_dwordx4 v[164:167], v4, s[44:47], s85 offen nt
    s_add_u32 s85, s85, 8192
    buffer_load_dwordx4 v[168:171], v4, s[44:47], s85 offen nt
    s_add_u32 s85, s85, 8192
    buffer_load_dwordx4 v[172:175], v4, s[44:47], s85 offen nt
    s_add_u32 s85, s85, 8192
    buffer_load_dwordx4 v[176:179], v4, s[44:47], s85 offen nt
    s_add_u32 s85, s85, 8192
    buffer_load_dwordx4 v[180:183], v4, s[44:47], s85 offen nt
    s_add_u32 s85, s85, 8192
    buffer_load_dwordx4 v[184:187], v4, s[44:47], s85 offen nt
    s_add_u32 s85, s85, 8192
    buffer_load_dwordx4 v[188:191], v4, s[44:47], s85 offen nt
    v_mov_b32 v7, 0
    buffer_load_dword v6, v7, s[52:55], 0 offen offset:128 sc0 sc1
    v_lshlrev_b32 v40, 4, v1
    s_lshl_b32 s61, s65, 11
    s_add_u32 s61, s61, 1310720
    s_mov_b32 s92, 0
Lpoll_78:
    buffer_load_dwordx4 v[24:27], v40, s[32:35], s61 offen offset:0 sc0 sc1
    buffer_load_dwordx4 v[32:35], v40, s[32:35], s61 offen offset:1024 sc0 sc1
    s_waitcnt vmcnt(0)
    v_mov_b32 v41, v24
    v_max3_u32 v41, v41, v25, v26
    v_max3_u32 v41, v41, v27, v32
    v_max3_u32 v41, v41, v33, v34
    v_max_u32 v41, v41, v35
    v_cmpx_eq_u32 vcc, -1, v41
    s_cbranch_execz Lpolld_79
    s_sleep 4
    s_add_u32 s92, s92, 1
    s_cmp_lt_u32 s92, 400000
    s_cbranch_scc1 Lpoll_78
Lpolld_79:
    s_mov_b64 exec, -1
    v_mov_b32 v28, v24
    v_mov_b32 v29, v25
    v_mov_b32 v30, v26
    v_mov_b32 v31, v27
    v_mov_b32 v36, v32
    v_mov_b32 v37, v33
    v_mov_b32 v38, v34
    v_mov_b32 v39, v35
    s_nop 1
    v_permlane32_swap_b32 v24, v28
    v_permlane32_swap_b32 v25, v29
    v_permlane32_swap_b32 v26, v30
    v_permlane32_swap_b32 v27, v31
    v_permlane32_swap_b32 v32, v36
    v_permlane32_swap_b32 v33, v37
    v_permlane32_swap_b32 v34, v38
    v_permlane32_swap_b32 v35, v39
    s_nop 1
    v_add_f32 v24, v24, v28
    v_add_f32 v25, v25, v29
    v_add_f32 v26, v26, v30
    v_add_f32 v27, v27, v31
    v_cvt_pk_bf16_f32 v24, v24, v25
    v_cvt_pk_bf16_f32 v25, v26, v27
    v_add_f32 v32, v32, v36
    v_add_f32 v33, v33, v37
    v_add_f32 v34, v34, v38
    v_add_f32 v35, v35, v39
    v_cvt_pk_bf16_f32 v32, v32, v33
    v_cvt_pk_bf16_f32 v33, v34, v35
    s_mov_b32 s92, 0
Lcf_80:
    v_readfirstlane_b32 s57, v6
    s_nop 3
    s_cmp_ge_u32 s57, 64
    s_cbranch_scc1 Lcfd_81
    s_sleep 8
    v_mov_b32 v7, 0
    buffer_load_dword v6, v7, s[52:55], 0 offen offset:128 sc0 sc1
    s_waitcnt vmcnt(0)
    s_add_u32 s92, s92, 1
    s_cmp_lt_u32 s92, 400000
    s_cbranch_scc1 Lcf_80
Lcfd_81:
    v_and_b32 v42, 31, v1
    v_lshlrev_b32 v42, 3, v42
    v_add_u32 v42, 135168, v42
    ds_write_b64 v42, v[24:25] offset:0
    ds_write_b64 v42, v[32:33] offset:256
    s_waitcnt lgkmcnt(0)
    s_setprio 0
Lt1j_75:
    s_barrier
    v_lshlrev_b32 v40, 4, v3
    v_add_u32 v40, 135168, v40
    ds_read_b128 v[56:59], v40
    ds_read_b128 v[60:63], v40 offset:256
    s_waitcnt lgkmcnt(0)
    s_waitcnt vmcnt(15)
    v_dot2_f32_bf16 v192, v128, v56, 0
    v_dot2_f32_bf16 v192, v129, v57, v192
    v_dot2_f32_bf16 v192, v130, v58, v192
    v_dot2_f32_bf16 v192, v131, v59, v192
    v_dot2_f32_bf16 v208, v128, v60, 0
    v_dot2_f32_bf16 v208, v129, v61, v208
    v_dot2_f32_bf16 v208, v130, v62, v208
    v_dot2_f32_bf16 v208, v131, v63, v208
    s_waitcnt vmcnt(14)
    v_dot2_f32_bf16 v193, v132, v56, 0
    v_dot2_f32_bf16 v193, v133, v57, v193
    v_dot2_f32_bf16 v193, v134, v58, v193
    v_dot2_f32_bf16 v193, v135, v59, v193
    v_dot2_f32_bf16 v209, v132, v60, 0
    v_dot2_f32_bf16 v209, v133, v61, v209
    v_dot2_f32_bf16 v209, v134, v62, v209
    v_dot2_f32_bf16 v209, v135, v63, v209
    s_waitcnt vmcnt(13)
    v_dot2_f32_bf16 v194, v136, v56, 0
    v_dot2_f32_bf16 v194, v137, v57, v194
    v_dot2_f32_bf16 v194, v138, v58, v194
    v_dot2_f32_bf16 v194, v139, v59, v194
    v_dot2_f32_bf16 v210, v136, v60, 0
    v_dot2_f32_bf16 v210, v137, v61, v210
    v_dot2_f32_bf16 v210, v138, v62, v210
    v_dot2_f32_bf16 v210, v139, v63, v210
    s_waitcnt vmcnt(12)
    v_dot2_f32_bf16 v195, v140, v56, 0
    v_dot2_f32_bf16 v195, v141, v57, v195
    v_dot2_f32_bf16 v195, v142, v58, v195
    v_dot2_f32_bf16 v195, v143, v59, v195
    v_dot2_f32_bf16 v211, v140, v60, 0
    v_dot2_f32_bf16 v211, v141, v61, v211
    v_dot2_f32_bf16 v211, v142, v62, v211
    v_dot2_f32_bf16 v211, v143, v63, v211
    s_waitcnt vmcnt(11)
    v_dot2_f32_bf16 v196, v144, v56, 0
    v_dot2_f32_bf16 v196, v145, v57, v196
    v_dot2_f32_bf16 v196, v146, v58, v196
    v_dot2_f32_bf16 v196, v147, v59, v196
    v_dot2_f32_bf16 v212, v144, v60, 0
    v_dot2_f32_bf16 v212, v145, v61, v212
    v_dot2_f32_bf16 v212, v146, v62, v212
    v_dot2_f32_bf16 v212, v147, v63, v212
    s_waitcnt vmcnt(10)
    v_dot2_f32_bf16 v197, v148, v56, 0
    v_dot2_f32_bf16 v197, v149, v57, v197
    v_dot2_f32_bf16 v197, v150, v58, v197
    v_dot2_f32_bf16 v197, v151, v59, v197
    v_dot2_f32_bf16 v213, v148, v60, 0
    v_dot2_f32_bf16 v213, v149, v61, v213
    v_dot2_f32_bf16 v213, v150, v62, v213
    v_dot2_f32_bf16 v213, v151, v63, v213
    s_waitcnt vmcnt(9)
    v_dot2_f32_bf16 v198, v152, v56, 0
    v_dot2_f32_bf16 v198, v153, v57, v198
    v_dot2_f32_bf16 v198, v154, v58, v198
    v_dot2_f32_bf16 v198, v155, v59, v198
    v_dot2_f32_bf16 v214, v152, v60, 0
    v_dot2_f32_bf16 v214, v153, v61, v214
    v_dot2_f32_bf16 v214, v154, v62, v214
    v_dot2_f32_bf16 v214, v155, v63, v214
    s_waitcnt vmcnt(8)
    v_dot2_f32_bf16 v199, v156, v56, 0
    v_dot2_f32_bf16 v199, v157, v57, v199
    v_dot2_f32_bf16 v199, v158, v58, v199
    v_dot2_f32_bf16 v199, v159, v59, v199
    v_dot2_f32_bf16 v215, v156, v60, 0
    v_dot2_f32_bf16 v215, v157, v61, v215
    v_dot2_f32_bf16 v215, v158, v62, v215
    v_dot2_f32_bf16 v215, v159, v63, v215
    s_waitcnt vmcnt(7)
    v_dot2_f32_bf16 v200, v160, v56, 0
    v_dot2_f32_bf16 v200, v161, v57, v200
    v_dot2_f32_bf16 v200, v162, v58, v200
    v_dot2_f32_bf16 v200, v163, v59, v200
    v_dot2_f32_bf16 v216, v160, v60, 0
    v_dot2_f32_bf16 v216, v161, v61, v216
    v_dot2_f32_bf16 v216, v162, v62, v216
    v_dot2_f32_bf16 v216, v163, v63, v216
    s_waitcnt vmcnt(6)
    v_dot2_f32_bf16 v201, v164, v56, 0
    v_dot2_f32_bf16 v201, v165, v57, v201
    v_dot2_f32_bf16 v201, v166, v58, v201
    v_dot2_f32_bf16 v201, v167, v59, v201
    v_dot2_f32_bf16 v217, v164, v60, 0
    v_dot2_f32_bf16 v217, v165, v61, v217
    v_dot2_f32_bf16 v217, v166, v62, v217
    v_dot2_f32_bf16 v217, v167, v63, v217
    s_waitcnt vmcnt(5)
    v_dot2_f32_bf16 v202, v168, v56, 0
    v_dot2_f32_bf16 v202, v169, v57, v202
    v_dot2_f32_bf16 v202, v170, v58, v202
    v_dot2_f32_bf16 v202, v171, v59, v202
    v_dot2_f32_bf16 v218, v168, v60, 0
    v_dot2_f32_bf16 v218, v169, v61, v218
    v_dot2_f32_bf16 v218, v170, v62, v218
    v_dot2_f32_bf16 v218, v171, v63, v218
    s_waitcnt vmcnt(4)
    v_dot2_f32_bf16 v203, v172, v56, 0
    v_dot2_f32_bf16 v203, v173, v57, v203
    v_dot2_f32_bf16 v203, v174, v58, v203
    v_dot2_f32_bf16 v203, v175, v59, v203
    v_dot2_f32_bf16 v219, v172, v60, 0
    v_dot2_f32_bf16 v219, v173, v61, v219
    v_dot2_f32_bf16 v219, v174, v62, v219
    v_dot2_f32_bf16 v219, v175, v63, v219
    s_waitcnt vmcnt(3)
    v_dot2_f32_bf16 v204, v176, v56, 0
    v_dot2_f32_bf16 v204, v177, v57, v204
    v_dot2_f32_bf16 v204, v178, v58, v204
    v_dot2_f32_bf16 v204, v179, v59, v204
    v_dot2_f32_bf16 v220, v176, v60, 0
    v_dot2_f32_bf16 v220, v177, v61, v220
    v_dot2_f32_bf16 v220, v178, v62, v220
    v_dot2_f32_bf16 v220, v179, v63, v220
    s_waitcnt vmcnt(2)
    v_dot2_f32_bf16 v205, v180, v56, 0
    v_dot2_f32_bf16 v205, v181, v57, v205
    v_dot2_f32_bf16 v205, v182, v58, v205
    v_dot2_f32_bf16 v205, v183, v59, v205
    v_dot2_f32_bf16 v221, v180, v60, 0
    v_dot2_f32_bf16 v221, v181, v61, v221
    v_dot2_f32_bf16 v221, v182, v62, v221
    v_dot2_f32_bf16 v221, v183, v63, v221
    s_waitcnt vmcnt(1)
    v_dot2_f32_bf16 v206, v184, v56, 0
    v_dot2_f32_bf16 v206, v185, v57, v206
    v_dot2_f32_bf16 v206, v186, v58, v206
    v_dot2_f32_bf16 v206, v187, v59, v206
    v_dot2_f32_bf16 v222, v184, v60, 0
    v_dot2_f32_bf16 v222, v185, v61, v222
    v_dot2_f32_bf16 v222, v186, v62, v222
    v_dot2_f32_bf16 v222, v187, v63, v222
    s_waitcnt vmcnt(0)
    v_dot2_f32_bf16 v207, v188, v56, 0
    v_dot2_f32_bf16 v207, v189, v57, v207
    v_dot2_f32_bf16 v207, v190, v58, v207
    v_dot2_f32_bf16 v207, v191, v59, v207
    v_dot2_f32_bf16 v223, v188, v60, 0
    v_dot2_f32_bf16 v223, v189, v61, v223
    v_dot2_f32_bf16 v223, v190, v62, v223
    v_dot2_f32_bf16 v223, v191, v63, v223
    s_nop 2
    v_add_f32_dpp v192, v192, v192 row_ror:8 row_mask:0xf bank_mask:0xf
    v_add_f32_dpp v193, v193, v193 row_ror:8 row_mask:0xf bank_mask:0xf
    v_add_f32_dpp v194, v194, v194 row_ror:8 row_mask:0xf bank_mask:0xf
    v_add_f32_dpp v195, v195, v195 row_ror:8 row_mask:0xf bank_mask:0xf
    v_add_f32_dpp v196, v196, v196 row_ror:8 row_mask:0xf bank_mask:0xf
    v_add_f32_dpp v197, v197, v197 row_ror:8 row_mask:0xf bank_mask:0xf
    v_add_f32_dpp v198, v198, v198 row_ror:8 row_mask:0xf bank_mask:0xf
    v_add_f32_dpp v199, v199, v199 row_ror:8 row_mask:0xf bank_mask:0xf
    v_add_f32_dpp v200, v200, v200 row_ror:8 row_mask:0xf bank_mask:0xf
    v_add_f32_dpp v201, v201, v201 row_ror:8 row_mask:0xf bank_mask:0xf
    v_add_f32_dpp v202, v202, v202 row_ror:8 row_mask:0xf bank_mask:0xf
    v_add_f32_dpp v203, v203, v203 row_ror:8 row_mask:0xf bank_mask:0xf
    v_add_f32_dpp v204, v204, v204 row_ror:8 row_mask:0xf bank_mask:0xf
    v_add_f32_dpp v205, v205, v205 row_ror:8 row_mask:0xf bank_mask:0xf
    v_add_f32_dpp v206, v206, v206 row_ror:8 row_mask:0xf bank_mask:0xf
    v_add_f32_dpp v207, v207, v207 row_ror:8 row_mask:0xf bank_mask:0xf
    v_add_f32_dpp v208, v208, v208 row_ror:8 row_mask:0xf bank_mask:0xf
    v_add_f32_dpp v209, v209, v209 row_ror:8 row_mask:0xf bank_mask:0xf
    v_add_f32_dpp v210, v210, v210 row_ror:8 row_mask:0xf bank_mask:0xf
    v_add_f32_dpp v211, v211, v211 row_ror:8 row_mask:0xf bank_mask:0xf
    v_add_f32_dpp v212, v212, v212 row_ror:8 row_mask:0xf bank_mask:0xf
    v_add_f32_dpp v213, v213, v213 row_ror:8 row_mask:0xf bank_mask:0xf
    v_add_f32_dpp v214, v214, v214 row_ror:8 row_mask:0xf bank_mask:0xf
    v_add_f32_dpp v215, v215, v215 row_ror:8 row_mask:0xf bank_mask:0xf
    v_add_f32_dpp v216, v216, v216 row_ror:8 row_mask:0xf bank_mask:0xf
    v_add_f32_dpp v217, v217, v217 row_ror:8 row_mask:0xf bank_mask:0xf
    v_add_f32_dpp v218, v218, v218 row_ror:8 row_mask:0xf bank_mask:0xf
    v_add_f32_dpp v219, v219, v219 row_ror:8 row_mask:0xf bank_mask:0xf
    v_add_f32_dpp v220, v220, v220 row_ror:8 row_mask:0xf bank_mask:0xf
    v_add_f32_dpp v221, v221, v221 row_ror:8 row_mask:0xf bank_mask:0xf
    v_add_f32_dpp v222, v222, v222 row_ror:8 row_mask:0xf bank_mask:0xf
    v_add_f32_dpp v223, v223, v223 row_ror:8 row_mask:0xf bank_mask:0xf
    v_add_f32_dpp v192, v192, v192 row_ror:4 row_mask:0xf bank_mask:0xf
    v_add_f32_dpp v193, v193, v193 row_ror:4 row_mask:0xf bank_mask:0xf
    v_add_f32_dpp v194, v194, v194 row_ror:4 row_mask:0xf bank_mask:0xf
    v_add_f32_dpp v195, v195, v195 row_ror:4 row_mask:0xf bank_mask:0xf
    v_add_f32_dpp v196, v196, v196 row_ror:4 row_mask:0xf bank_mask:0xf
    v_add_f32_dpp v197, v197, v197 row_ror:4 row_mask:0xf bank_mask:0xf
    v_add_f32_dpp v198, v198, v198 row_ror:4 row_mask:0xf bank_mask:0xf
    v_add_f32_dpp v199, v199, v199 row_ror:4 row_mask:0xf bank_mask:0xf
    v_add_f32_dpp v200, v200, v200 row_ror:4 row_mask:0xf bank_mask:0xf
    v_add_f32_dpp v201, v201, v201 row_ror:4 row_mask:0xf bank_mask:0xf
    v_add_f32_dpp v202, v202, v202 row_ror:4 row_mask:0xf bank_mask:0xf
    v_add_f32_dpp v203, v203, v203 row_ror:4 row_mask:0xf bank_mask:0xf
    v_add_f32_dpp v204, v204, v204 row_ror:4 row_mask:0xf bank_mask:0xf
    v_add_f32_dpp v205, v205, v205 row_ror:4 row_mask:0xf bank_mask:0xf
    v_add_f32_dpp v206, v206, v206 row_ror:4 row_mask:0xf bank_mask:0xf
    v_add_f32_dpp v207, v207, v207 row_ror:4 row_mask:0xf bank_mask:0xf
    v_add_f32_dpp v208, v208, v208 row_ror:4 row_mask:0xf bank_mask:0xf
    v_add_f32_dpp v209, v209, v209 row_ror:4 row_mask:0xf bank_mask:0xf
    v_add_f32_dpp v210, v210, v210 row_ror:4 row_mask:0xf bank_mask:0xf
    v_add_f32_dpp v211, v211, v211 row_ror:4 row_mask:0xf bank_mask:0xf
    v_add_f32_dpp v212, v212, v212 row_ror:4 row_mask:0xf bank_mask:0xf
    v_add_f32_dpp v213, v213, v213 row_ror:4 row_mask:0xf bank_mask:0xf
    v_add_f32_dpp v214, v214, v214 row_ror:4 row_mask:0xf bank_mask:0xf
    v_add_f32_dpp v215, v215, v215 row_ror:4 row_mask:0xf bank_mask:0xf
    v_add_f32_dpp v216, v216, v216 row_ror:4 row_mask:0xf bank_mask:0xf
    v_add_f32_dpp v217, v217, v217 row_ror:4 row_mask:0xf bank_mask:0xf
    v_add_f32_dpp v218, v218, v218 row_ror:4 row_mask:0xf bank_mask:0xf
    v_add_f32_dpp v219, v219, v219 row_ror:4 row_mask:0xf bank_mask:0xf
    v_add_f32_dpp v220, v220, v220 row_ror:4 row_mask:0xf bank_mask:0xf
    v_add_f32_dpp v221, v221, v221 row_ror:4 row_mask:0xf bank_mask:0xf
    v_add_f32_dpp v222, v222, v222 row_ror:4 row_mask:0xf bank_mask:0xf
    v_add_f32_dpp v223, v223, v223 row_ror:4 row_mask:0xf bank_mask:0xf
    v_add_f32_dpp v192, v192, v192 row_ror:2 row_mask:0xf bank_mask:0xf
    v_add_f32_dpp v193, v193, v193 row_ror:2 row_mask:0xf bank_mask:0xf
    v_add_f32_dpp v194, v194, v194 row_ror:2 row_mask:0xf bank_mask:0xf
    v_add_f32_dpp v195, v195, v195 row_ror:2 row_mask:0xf bank_mask:0xf
    v_add_f32_dpp v196, v196, v196 row_ror:2 row_mask:0xf bank_mask:0xf
    v_add_f32_dpp v197, v197, v197 row_ror:2 row_mask:0xf bank_mask:0xf
    v_add_f32_dpp v198, v198, v198 row_ror:2 row_mask:0xf bank_mask:0xf
    v_add_f32_dpp v199, v199, v199 row_ror:2 row_mask:0xf bank_mask:0xf
    v_add_f32_dpp v200, v200, v200 row_ror:2 row_mask:0xf bank_mask:0xf
    v_add_f32_dpp v201, v201, v201 row_ror:2 row_mask:0xf bank_mask:0xf
    v_add_f32_dpp v202, v202, v202 row_ror:2 row_mask:0xf bank_mask:0xf
    v_add_f32_dpp v203, v203, v203 row_ror:2 row_mask:0xf bank_mask:0xf
    v_add_f32_dpp v204, v204, v204 row_ror:2 row_mask:0xf bank_mask:0xf
    v_add_f32_dpp v205, v205, v205 row_ror:2 row_mask:0xf bank_mask:0xf
    v_add_f32_dpp v206, v206, v206 row_ror:2 row_mask:0xf bank_mask:0xf
    v_add_f32_dpp v207, v207, v207 row_ror:2 row_mask:0xf bank_mask:0xf
    v_add_f32_dpp v208, v208, v208 row_ror:2 row_mask:0xf bank_mask:0xf
    v_add_f32_dpp v209, v209, v209 row_ror:2 row_mask:0xf bank_mask:0xf
    v_add_f32_dpp v210, v210, v210 row_ror:2 row_mask:0xf bank_mask:0xf
    v_add_f32_dpp v211, v211, v211 row_ror:2 row_mask:0xf bank_mask:0xf
    v_add_f32_dpp v212, v212, v212 row_ror:2 row_mask:0xf bank_mask:0xf
    v_add_f32_dpp v213, v213, v213 row_ror:2 row_mask:0xf bank_mask:0xf
    v_add_f32_dpp v214, v214, v214 row_ror:2 row_mask:0xf bank_mask:0xf
    v_add_f32_dpp v215, v215, v215 row_ror:2 row_mask:0xf bank_mask:0xf
    v_add_f32_dpp v216, v216, v216 row_ror:2 row_mask:0xf bank_mask:0xf
    v_add_f32_dpp v217, v217, v217 row_ror:2 row_mask:0xf bank_mask:0xf
    v_add_f32_dpp v218, v218, v218 row_ror:2 row_mask:0xf bank_mask:0xf
    v_add_f32_dpp v219, v219, v219 row_ror:2 row_mask:0xf bank_mask:0xf
    v_add_f32_dpp v220, v220, v220 row_ror:2 row_mask:0xf bank_mask:0xf
    v_add_f32_dpp v221, v221, v221 row_ror:2 row_mask:0xf bank_mask:0xf
    v_add_f32_dpp v222, v222, v222 row_ror:2 row_mask:0xf bank_mask:0xf
    v_add_f32_dpp v223, v223, v223 row_ror:2 row_mask:0xf bank_mask:0xf
    v_add_f32_dpp v192, v192, v192 row_ror:1 row_mask:0xf bank_mask:0xf
    v_add_f32_dpp v193, v193, v193 row_ror:1 row_mask:0xf bank_mask:0xf
    v_add_f32_dpp v194, v194, v194 row_ror:1 row_mask:0xf bank_mask:0xf
    v_add_f32_dpp v195, v195, v195 row_ror:1 row_mask:0xf bank_mask:0xf
    v_add_f32_dpp v196, v196, v196 row_ror:1 row_mask:0xf bank_mask:0xf
    v_add_f32_dpp v197, v197, v197 row_ror:1 row_mask:0xf bank_mask:0xf
    v_add_f32_dpp v198, v198, v198 row_ror:1 row_mask:0xf bank_mask:0xf
    v_add_f32_dpp v199, v199, v199 row_ror:1 row_mask:0xf bank_mask:0xf
    v_add_f32_dpp v200, v200, v200 row_ror:1 row_mask:0xf bank_mask:0xf
    v_add_f32_dpp v201, v201, v201 row_ror:1 row_mask:0xf bank_mask:0xf
    v_add_f32_dpp v202, v202, v202 row_ror:1 row_mask:0xf bank_mask:0xf
    v_add_f32_dpp v203, v203, v203 row_ror:1 row_mask:0xf bank_mask:0xf
    v_add_f32_dpp v204, v204, v204 row_ror:1 row_mask:0xf bank_mask:0xf
    v_add_f32_dpp v205, v205, v205 row_ror:1 row_mask:0xf bank_mask:0xf
    v_add_f32_dpp v206, v206, v206 row_ror:1 row_mask:0xf bank_mask:0xf
    v_add_f32_dpp v207, v207, v207 row_ror:1 row_mask:0xf bank_mask:0xf
    v_add_f32_dpp v208, v208, v208 row_ror:1 row_mask:0xf bank_mask:0xf
    v_add_f32_dpp v209, v209, v209 row_ror:1 row_mask:0xf bank_mask:0xf
    v_add_f32_dpp v210, v210, v210 row_ror:1 row_mask:0xf bank_mask:0xf
    v_add_f32_dpp v211, v211, v211 row_ror:1 row_mask:0xf bank_mask:0xf
    v_add_f32_dpp v212, v212, v212 row_ror:1 row_mask:0xf bank_mask:0xf
    v_add_f32_dpp v213, v213, v213 row_ror:1 row_mask:0xf bank_mask:0xf
    v_add_f32_dpp v214, v214, v214 row_ror:1 row_mask:0xf bank_mask:0xf
    v_add_f32_dpp v215, v215, v215 row_ror:1 row_mask:0xf bank_mask:0xf
    v_add_f32_dpp v216, v216, v216 row_ror:1 row_mask:0xf bank_mask:0xf
    v_add_f32_dpp v217, v217, v217 row_ror:1 row_mask:0xf bank_mask:0xf
    v_add_f32_dpp v218, v218, v218 row_ror:1 row_mask:0xf bank_mask:0xf
    v_add_f32_dpp v219, v219, v219 row_ror:1 row_mask:0xf bank_mask:0xf
    v_add_f32_dpp v220, v220, v220 row_ror:1 row_mask:0xf bank_mask:0xf
    v_add_f32_dpp v221, v221, v221 row_ror:1 row_mask:0xf bank_mask:0xf
    v_add_f32_dpp v222, v222, v222 row_ror:1 row_mask:0xf bank_mask:0xf
    v_add_f32_dpp v223, v223, v223 row_ror:1 row_mask:0xf bank_mask:0xf
    s_mov_b32 s70, 1040356334
    v_mul_f32 v192, s70, v192
    v_mul_f32 v193, s70, v193
    v_mul_f32 v194, s70, v194
    v_mul_f32 v195, s70, v195
    v_mul_f32 v196, s70, v196
    v_mul_f32 v197, s70, v197
    v_mul_f32 v198, s70, v198
    v_mul_f32 v199, s70, v199
    v_mul_f32 v200, s70, v200
    v_mul_f32 v201, s70, v201
    v_mul_f32 v202, s70, v202
    v_mul_f32 v203, s70, v203
    v_mul_f32 v204, s70, v204
    v_mul_f32 v205, s70, v205
    v_mul_f32 v206, s70, v206
    v_mul_f32 v207, s70, v207
    v_mul_f32 v208, s70, v208
    v_mul_f32 v209, s70, v209
    v_mul_f32 v210, s70, v210
    v_mul_f32 v211, s70, v211
    v_mul_f32 v212, s70, v212
    v_mul_f32 v213, s70, v213
    v_mul_f32 v214, s70, v214
    v_mul_f32 v215, s70, v215
    v_mul_f32 v216, s70, v216
    v_mul_f32 v217, s70, v217
    v_mul_f32 v218, s70, v218
    v_mul_f32 v219, s70, v219
    v_mul_f32 v220, s70, v220
    v_mul_f32 v221, s70, v221
    v_mul_f32 v222, s70, v222
    v_mul_f32 v223, s70, v223
    s_lshl_b32 s61, s56, 8
    s_add_u32 s61, s61, 139264
    v_lshlrev_b32 v40, 6, v2
    v_add_u32 v40, s61, v40
    s_mov_b64 s[94:95], exec
    s_mov_b32 exec_lo, 0x00010001
    s_mov_b32 exec_hi, 0x00010001
    ds_write_b128 v40, v[192:195] offset:0
    ds_write_b128 v40, v[196:199] offset:16
    ds_write_b128 v40, v[200:203] offset:32
    ds_write_b128 v40, v[204:207] offset:48
    ds_write_b128 v40, v[208:211] offset:2048
    ds_write_b128 v40, v[212:215] offset:2064
    ds_write_b128 v40, v[216:219] offset:2080
    ds_write_b128 v40, v[220:223] offset:2096
    s_mov_b64 exec, s[94:95]
    s_waitcnt lgkmcnt(0)
    s_barrier
    s_cmp_eq_u32 s56, 0
    s_cbranch_scc1 Lqa0_82
    s_barrier
    s_mov_b32 s44, s12
    s_mov_b32 s45, s13
    s_and_b32 s45, s45, 0xffff
    s_mov_b32 s46, 4194304
    s_mov_b32 s47, 0x00020000
    s_lshl_b32 s61, s56, 19
    s_lshl_b32 s62, s65, 8
    s_add_u32 s61, s61, s62
    buffer_load_dwordx4 v[64:67], v4, s[44:47], s61 offen nt
    s_add_u32 s61, s61, 8192
    buffer_load_dwordx4 v[68:71], v4, s[44:47], s61 offen nt
    s_add_u32 s61, s61, 8192
    buffer_load_dwordx4 v[72:75], v4, s[44:47], s61 offen nt
    s_add_u32 s61, s61, 8192
    buffer_load_dwordx4 v[76:79], v4, s[44:47], s61 offen nt
    s_add_u32 s61, s61, 8192
    buffer_load_dwordx4 v[80:83], v4, s[44:47], s61 offen nt
    s_add_u32 s61, s61, 8192
    buffer_load_dwordx4 v[84:87], v4, s[44:47], s61 offen nt
    s_add_u32 s61, s61, 8192
    buffer_load_dwordx4 v[88:91], v4, s[44:47], s61 offen nt
    s_add_u32 s61, s61, 8192
    buffer_load_dwordx4 v[92:95], v4, s[44:47], s61 offen nt
    s_add_u32 s61, s61, 8192
    buffer_load_dwordx4 v[96:99], v4, s[44:47], s61 offen nt
    s_add_u32 s61, s61, 8192
    buffer_load_dwordx4 v[100:103], v4, s[44:47], s61 offen nt
    s_add_u32 s61, s61, 8192
    buffer_load_dwordx4 v[104:107], v4, s[44:47], s61 offen nt
    s_add_u32 s61, s61, 8192
    buffer_load_dwordx4 v[108:111], v4, s[44:47], s61 offen nt
    s_add_u32 s61, s61, 8192
    buffer_load_dwordx4 v[112:115], v4, s[44:47], s61 offen nt
    s_add_u32 s61, s61, 8192
    buffer_load_dwordx4 v[116:119], v4, s[44:47], s61 offen nt
    s_add_u32 s61, s61, 8192
    buffer_load_dwordx4 v[120:123], v4, s[44:47], s61 offen nt
    s_add_u32 s61, s61, 8192
    buffer_load_dwordx4 v[124:127], v4, s[44:47], s61 offen nt
    s_mov_b32 s36, s14
    s_mov_b32 s37, s15
    s_and_b32 s37, s37, 0xffff
    s_mov_b32 s38, 4194304
    s_mov_b32 s39, 0x00020000
    s_lshl_b32 s61, s56, 14
    s_lshl_b32 s62, s65, 17
    s_add_u32 s62, s62, s61
    s_mul_i32 s63, s65, 5
    s_lshl_b32 s64, s56, 1
    s_add_u32 s63, s63, s64
    s_add_u32 s64, s63, 0
    s_and_b32 s64, s64, 15
    s_and_b32 s100, s64, 3
    s_lshl_b32 s100, s100, 6
    s_lshr_b32 s101, s64, 3
    s_lshl_b32 s101, s101, 5
    s_or_b32 s100, s100, s101
    s_lshl_b32 s64, s64, 10
    s_add_u32 m0, s61, s64
    v_xor_b32 v52, s100, v5
    s_add_u32 s64, s64, s62
    buffer_load_dwordx4 v52, s[36:39], s64 offen nt lds
    s_add_u32 s64, s63, 1
    s_and_b32 s64, s64, 15
    s_and_b32 s100, s64, 3
    s_lshl_b32 s100, s100, 6
    s_lshr_b32 s101, s64, 3
    s_lshl_b32 s101, s101, 5
    s_or_b32 s100, s100, s101
    s_lshl_b32 s64, s64, 10
    s_add_u32 m0, s61, s64
    v_xor_b32 v53, s100, v5
    s_add_u32 s64, s64, s62
    buffer_load_dwordx4 v53, s[36:39], s64 offen nt lds
    s_add_u32 s64, s63, 2
    s_and_b32 s64, s64, 15
    s_and_b32 s100, s64, 3
    s_lshl_b32 s100, s100, 6
    s_lshr_b32 s101, s64, 3
    s_lshl_b32 s101, s101, 5
    s_or_b32 s100, s100, s101
    s_lshl_b32 s64, s64, 10
    s_add_u32 m0, s61, s64
    v_xor_b32 v52, s100, v5
    s_add_u32 s64, s64, s62
    buffer_load_dwordx4 v52, s[36:39], s64 offen nt lds
    s_add_u32 s64, s63, 3
    s_and_b32 s64, s64, 15
    s_and_b32 s100, s64, 3
    s_lshl_b32 s100, s100, 6
    s_lshr_b32 s101, s64, 3
    s_lshl_b32 s101, s101, 5
    s_or_b32 s100, s100, s101
    s_lshl_b32 s64, s64, 10
    s_add_u32 m0, s61, s64
    v_xor_b32 v53, s100, v5
    s_add_u32 s64, s64, s62
    buffer_load_dwordx4 v53, s[36:39], s64 offen nt lds
    s_add_u32 s64, s63, 4
    s_and_b32 s64, s64, 15
    s_and_b32 s100, s64, 3
    s_lshl_b32 s100, s100, 6
    s_lshr_b32 s101, s64, 3
    s_lshl_b32 s101, s101, 5
    s_or_b32 s100, s100, s101
    s_lshl_b32 s64, s64, 10
    s_add_u32 m0, s61, s64
    v_xor_b32 v52, s100, v5
    s_add_u32 s64, s64, s62
    buffer_load_dwordx4 v52, s[36:39], s64 offen nt lds
    s_add_u32 s64, s63, 5
    s_and_b32 s64, s64, 15
    s_and_b32 s100, s64, 3
    s_lshl_b32 s100, s100, 6
    s_lshr_b32 s101, s64, 3
    s_lshl_b32 s101, s101, 5
    s_or_b32 s100, s100, s101
    s_lshl_b32 s64, s64, 10
    s_add_u32 m0, s61, s64
    v_xor_b32 v53, s100, v5
    s_add_u32 s64, s64, s62
    buffer_load_dwordx4 v53, s[36:39], s64 offen nt lds
    s_add_u32 s64, s63, 6
    s_and_b32 s64, s64, 15
    s_and_b32 s100, s64, 3
    s_lshl_b32 s100, s100, 6
    s_lshr_b32 s101, s64, 3
    s_lshl_b32 s101, s101, 5
    s_or_b32 s100, s100, s101
    s_lshl_b32 s64, s64, 10
    s_add_u32 m0, s61, s64
    v_xor_b32 v52, s100, v5
    s_add_u32 s64, s64, s62
    buffer_load_dwordx4 v52, s[36:39], s64 offen nt lds
    s_add_u32 s64, s63, 7
    s_and_b32 s64, s64, 15
    s_and_b32 s100, s64, 3
    s_lshl_b32 s100, s100, 6
    s_lshr_b32 s101, s64, 3
    s_lshl_b32 s101, s101, 5
    s_or_b32 s100, s100, s101
    s_lshl_b32 s64, s64, 10
    s_add_u32 m0, s61, s64
    v_xor_b32 v53, s100, v5
    s_add_u32 s64, s64, s62
    buffer_load_dwordx4 v53, s[36:39], s64 offen nt lds
    s_add_u32 s64, s63, 8
    s_and_b32 s64, s64, 15
    s_and_b32 s100, s64, 3
    s_lshl_b32 s100, s100, 6
    s_lshr_b32 s101, s64, 3
    s_lshl_b32 s101, s101, 5
    s_or_b32 s100, s100, s101
    s_lshl_b32 s64, s64, 10
    s_add_u32 m0, s61, s64
    v_xor_b32 v52, s100, v5
    s_add_u32 s64, s64, s62
    buffer_load_dwordx4 v52, s[36:39], s64 offen nt lds
    s_add_u32 s64, s63, 9
    s_and_b32 s64, s64, 15
    s_and_b32 s100, s64, 3
    s_lshl_b32 s100, s100, 6
    s_lshr_b32 s101, s64, 3
    s_lshl_b32 s101, s101, 5
    s_or_b32 s100, s100, s101
    s_lshl_b32 s64, s64, 10
    s_add_u32 m0, s61, s64
    v_xor_b32 v53, s100, v5
    s_add_u32 s64, s64, s62
    buffer_load_dwordx4 v53, s[36:39], s64 offen nt lds
    s_add_u32 s64, s63, 10
    s_and_b32 s64, s64, 15
    s_and_b32 s100, s64, 3
    s_lshl_b32 s100, s100, 6
    s_lshr_b32 s101, s64, 3
    s_lshl_b32 s101, s101, 5
    s_or_b32 s100, s100, s101
    s_lshl_b32 s64, s64, 10
    s_add_u32 m0, s61, s64
    v_xor_b32 v52, s100, v5
    s_add_u32 s64, s64, s62
    buffer_load_dwordx4 v52, s[36:39], s64 offen nt lds
    s_add_u32 s64, s63, 11
    s_and_b32 s64, s64, 15
    s_and_b32 s100, s64, 3
    s_lshl_b32 s100, s100, 6
    s_lshr_b32 s101, s64, 3
    s_lshl_b32 s101, s101, 5
    s_or_b32 s100, s100, s101
    s_lshl_b32 s64, s64, 10
    s_add_u32 m0, s61, s64
    v_xor_b32 v53, s100, v5
    s_add_u32 s64, s64, s62
    buffer_load_dwordx4 v53, s[36:39], s64 offen nt lds
    s_add_u32 s64, s63, 12
    s_and_b32 s64, s64, 15
    s_and_b32 s100, s64, 3
    s_lshl_b32 s100, s100, 6
    s_lshr_b32 s101, s64, 3
    s_lshl_b32 s101, s101, 5
    s_or_b32 s100, s100, s101
    s_lshl_b32 s64, s64, 10
    s_add_u32 m0, s61, s64
    v_xor_b32 v52, s100, v5
    s_add_u32 s64, s64, s62
    buffer_load_dwordx4 v52, s[36:39], s64 offen nt lds
    s_add_u32 s64, s63, 13
    s_and_b32 s64, s64, 15
    s_and_b32 s100, s64, 3
    s_lshl_b32 s100, s100, 6
    s_lshr_b32 s101, s64, 3
    s_lshl_b32 s101, s101, 5
    s_or_b32 s100, s100, s101
    s_lshl_b32 s64, s64, 10
    s_add_u32 m0, s61, s64
    v_xor_b32 v53, s100, v5
    s_add_u32 s64, s64, s62
    buffer_load_dwordx4 v53, s[36:39], s64 offen nt lds
    s_add_u32 s64, s63, 14
    s_and_b32 s64, s64, 15
    s_and_b32 s100, s64, 3
    s_lshl_b32 s100, s100, 6
    s_lshr_b32 s101, s64, 3
    s_lshl_b32 s101, s101, 5
    s_or_b32 s100, s100, s101
    s_lshl_b32 s64, s64, 10
    s_add_u32 m0, s61, s64
    v_xor_b32 v52, s100, v5
    s_add_u32 s64, s64, s62
    buffer_load_dwordx4 v52, s[36:39], s64 offen nt lds
    s_add_u32 s64, s63, 15
    s_and_b32 s64, s64, 15
    s_and_b32 s100, s64, 3
    s_lshl_b32 s100, s100, 6
    s_lshr_b32 s101, s64, 3
    s_lshl_b32 s101, s101, 5
    s_or_b32 s100, s100, s101
    s_lshl_b32 s64, s64, 10
    s_add_u32 m0, s61, s64
    v_xor_b32 v53, s100, v5
    s_add_u32 s64, s64, s62
    buffer_load_dwordx4 v53, s[36:39], s64 offen nt lds
    s_branch Lqaj_83
Lqa0_82:
    v_lshlrev_b32 v40, 5, v1
    v_add_u32 v40, 139264, v40
    ds_read_b128 v[192:195], v40 offset:0
    ds_read_b128 v[196:199], v40 offset:16
    ds_read_b128 v[200:203], v40 offset:2048
    ds_read_b128 v[204:207], v40 offset:2064
    s_waitcnt lgkmcnt(0)
    s_lshl_b32 s61, s65, 10
    s_add_u32 s61, s61, 1146880
    v_cvt_pk_bf16_f32 v208, v192, v193
    v_cvt_pk_bf16_f32 v209, v194, v195
    v_cvt_pk_bf16_f32 v210, v196, v197
    v_cvt_pk_bf16_f32 v211, v198, v199
    buffer_store_dwordx4 v[208:211], v5, s[32:35], s61 offen sc0 sc1
    s_add_u32 s61, s61, 32768
    v_cvt_pk_bf16_f32 v212, v200, v201
    v_cvt_pk_bf16_f32 v213, v202, v203
    v_cvt_pk_bf16_f32 v214, v204, v205
    v_cvt_pk_bf16_f32 v215, v206, v207
    buffer_store_dwordx4 v[212:215], v5, s[32:35], s61 offen sc0 sc1
    s_barrier
    s_mov_b32 s44, s12
    s_mov_b32 s45, s13
    s_and_b32 s45, s45, 0xffff
    s_mov_b32 s46, 4194304
    s_mov_b32 s47, 0x00020000
    s_lshl_b32 s61, s56, 19
    s_lshl_b32 s62, s65, 8
    s_add_u32 s61, s61, s62
    buffer_load_dwordx4 v[64:67], v4, s[44:47], s61 offen nt
    s_add_u32 s61, s61, 8192
    buffer_load_dwordx4 v[68:71], v4, s[44:47], s61 offen nt
    s_add_u32 s61, s61, 8192
    buffer_load_dwordx4 v[72:75], v4, s[44:47], s61 offen nt
    s_add_u32 s61, s61, 8192
    buffer_load_dwordx4 v[76:79], v4, s[44:47], s61 offen nt
    s_add_u32 s61, s61, 8192
    buffer_load_dwordx4 v[80:83], v4, s[44:47], s61 offen nt
    s_add_u32 s61, s61, 8192
    buffer_load_dwordx4 v[84:87], v4, s[44:47], s61 offen nt
    s_add_u32 s61, s61, 8192
    buffer_load_dwordx4 v[88:91], v4, s[44:47], s61 offen nt
    s_add_u32 s61, s61, 8192
    buffer_load_dwordx4 v[92:95], v4, s[44:47], s61 offen nt
    s_add_u32 s61, s61, 8192
    buffer_load_dwordx4 v[96:99], v4, s[44:47], s61 offen nt
    s_add_u32 s61, s61, 8192
    buffer_load_dwordx4 v[100:103], v4, s[44:47], s61 offen nt
    s_add_u32 s61, s61, 8192
    buffer_load_dwordx4 v[104:107], v4, s[44:47], s61 offen nt
    s_add_u32 s61, s61, 8192
    buffer_load_dwordx4 v[108:111], v4, s[44:47], s61 offen nt
    s_add_u32 s61, s61, 8192
    buffer_load_dwordx4 v[112:115], v4, s[44:47], s61 offen nt
    s_add_u32 s61, s61, 8192
    buffer_load_dwordx4 v[116:119], v4, s[44:47], s61 offen nt
    s_add_u32 s61, s61, 8192
    buffer_load_dwordx4 v[120:123], v4, s[44:47], s61 offen nt
    s_add_u32 s61, s61, 8192
    buffer_load_dwordx4 v[124:127], v4, s[44:47], s61 offen nt
    s_mov_b32 s36, s14
    s_mov_b32 s37, s15
    s_and_b32 s37, s37, 0xffff
    s_mov_b32 s38, 4194304
    s_mov_b32 s39, 0x00020000
    s_lshl_b32 s61, s56, 14
    s_lshl_b32 s62, s65, 17
    s_add_u32 s62, s62, s61
    s_mul_i32 s63, s65, 5
    s_lshl_b32 s64, s56, 1
    s_add_u32 s63, s63, s64
    s_add_u32 s64, s63, 0
    s_and_b32 s64, s64, 15
    s_and_b32 s100, s64, 3
    s_lshl_b32 s100, s100, 6
    s_lshr_b32 s101, s64, 3
    s_lshl_b32 s101, s101, 5
    s_or_b32 s100, s100, s101
    s_lshl_b32 s64, s64, 10
    s_add_u32 m0, s61, s64
    v_xor_b32 v52, s100, v5
    s_add_u32 s64, s64, s62
    buffer_load_dwordx4 v52, s[36:39], s64 offen nt lds
    s_add_u32 s64, s63, 1
    s_and_b32 s64, s64, 15
    s_and_b32 s100, s64, 3
    s_lshl_b32 s100, s100, 6
    s_lshr_b32 s101, s64, 3
    s_lshl_b32 s101, s101, 5
    s_or_b32 s100, s100, s101
    s_lshl_b32 s64, s64, 10
    s_add_u32 m0, s61, s64
    v_xor_b32 v53, s100, v5
    s_add_u32 s64, s64, s62
    buffer_load_dwordx4 v53, s[36:39], s64 offen nt lds
    s_add_u32 s64, s63, 2
    s_and_b32 s64, s64, 15
    s_and_b32 s100, s64, 3
    s_lshl_b32 s100, s100, 6
    s_lshr_b32 s101, s64, 3
    s_lshl_b32 s101, s101, 5
    s_or_b32 s100, s100, s101
    s_lshl_b32 s64, s64, 10
    s_add_u32 m0, s61, s64
    v_xor_b32 v52, s100, v5
    s_add_u32 s64, s64, s62
    buffer_load_dwordx4 v52, s[36:39], s64 offen nt lds
    s_add_u32 s64, s63, 3
    s_and_b32 s64, s64, 15
    s_and_b32 s100, s64, 3
    s_lshl_b32 s100, s100, 6
    s_lshr_b32 s101, s64, 3
    s_lshl_b32 s101, s101, 5
    s_or_b32 s100, s100, s101
    s_lshl_b32 s64, s64, 10
    s_add_u32 m0, s61, s64
    v_xor_b32 v53, s100, v5
    s_add_u32 s64, s64, s62
    buffer_load_dwordx4 v53, s[36:39], s64 offen nt lds
    s_add_u32 s64, s63, 4
    s_and_b32 s64, s64, 15
    s_and_b32 s100, s64, 3
    s_lshl_b32 s100, s100, 6
    s_lshr_b32 s101, s64, 3
    s_lshl_b32 s101, s101, 5
    s_or_b32 s100, s100, s101
    s_lshl_b32 s64, s64, 10
    s_add_u32 m0, s61, s64
    v_xor_b32 v52, s100, v5
    s_add_u32 s64, s64, s62
    buffer_load_dwordx4 v52, s[36:39], s64 offen nt lds
    s_add_u32 s64, s63, 5
    s_and_b32 s64, s64, 15
    s_and_b32 s100, s64, 3
    s_lshl_b32 s100, s100, 6
    s_lshr_b32 s101, s64, 3
    s_lshl_b32 s101, s101, 5
    s_or_b32 s100, s100, s101
    s_lshl_b32 s64, s64, 10
    s_add_u32 m0, s61, s64
    v_xor_b32 v53, s100, v5
    s_add_u32 s64, s64, s62
    buffer_load_dwordx4 v53, s[36:39], s64 offen nt lds
    s_add_u32 s64, s63, 6
    s_and_b32 s64, s64, 15
    s_and_b32 s100, s64, 3
    s_lshl_b32 s100, s100, 6
    s_lshr_b32 s101, s64, 3
    s_lshl_b32 s101, s101, 5
    s_or_b32 s100, s100, s101
    s_lshl_b32 s64, s64, 10
    s_add_u32 m0, s61, s64
    v_xor_b32 v52, s100, v5
    s_add_u32 s64, s64, s62
    buffer_load_dwordx4 v52, s[36:39], s64 offen nt lds
    s_add_u32 s64, s63, 7
    s_and_b32 s64, s64, 15
    s_and_b32 s100, s64, 3
    s_lshl_b32 s100, s100, 6
    s_lshr_b32 s101, s64, 3
    s_lshl_b32 s101, s101, 5
    s_or_b32 s100, s100, s101
    s_lshl_b32 s64, s64, 10
    s_add_u32 m0, s61, s64
    v_xor_b32 v53, s100, v5
    s_add_u32 s64, s64, s62
    buffer_load_dwordx4 v53, s[36:39], s64 offen nt lds
    s_add_u32 s64, s63, 8
    s_and_b32 s64, s64, 15
    s_and_b32 s100, s64, 3
    s_lshl_b32 s100, s100, 6
    s_lshr_b32 s101, s64, 3
    s_lshl_b32 s101, s101, 5
    s_or_b32 s100, s100, s101
    s_lshl_b32 s64, s64, 10
    s_add_u32 m0, s61, s64
    v_xor_b32 v52, s100, v5
    s_add_u32 s64, s64, s62
    buffer_load_dwordx4 v52, s[36:39], s64 offen nt lds
    s_add_u32 s64, s63, 9
    s_and_b32 s64, s64, 15
    s_and_b32 s100, s64, 3
    s_lshl_b32 s100, s100, 6
    s_lshr_b32 s101, s64, 3
    s_lshl_b32 s101, s101, 5
    s_or_b32 s100, s100, s101
    s_lshl_b32 s64, s64, 10
    s_add_u32 m0, s61, s64
    v_xor_b32 v53, s100, v5
    s_add_u32 s64, s64, s62
    buffer_load_dwordx4 v53, s[36:39], s64 offen nt lds
    s_add_u32 s64, s63, 10
    s_and_b32 s64, s64, 15
    s_and_b32 s100, s64, 3
    s_lshl_b32 s100, s100, 6
    s_lshr_b32 s101, s64, 3
    s_lshl_b32 s101, s101, 5
    s_or_b32 s100, s100, s101
    s_lshl_b32 s64, s64, 10
    s_add_u32 m0, s61, s64
    v_xor_b32 v52, s100, v5
    s_add_u32 s64, s64, s62
    buffer_load_dwordx4 v52, s[36:39], s64 offen nt lds
    s_add_u32 s64, s63, 11
    s_and_b32 s64, s64, 15
    s_and_b32 s100, s64, 3
    s_lshl_b32 s100, s100, 6
    s_lshr_b32 s101, s64, 3
    s_lshl_b32 s101, s101, 5
    s_or_b32 s100, s100, s101
    s_lshl_b32 s64, s64, 10
    s_add_u32 m0, s61, s64
    v_xor_b32 v53, s100, v5
    s_add_u32 s64, s64, s62
    buffer_load_dwordx4 v53, s[36:39], s64 offen nt lds
    s_add_u32 s64, s63, 12
    s_and_b32 s64, s64, 15
    s_and_b32 s100, s64, 3
    s_lshl_b32 s100, s100, 6
    s_lshr_b32 s101, s64, 3
    s_lshl_b32 s101, s101, 5
    s_or_b32 s100, s100, s101
    s_lshl_b32 s64, s64, 10
    s_add_u32 m0, s61, s64
    v_xor_b32 v52, s100, v5
    s_add_u32 s64, s64, s62
    buffer_load_dwordx4 v52, s[36:39], s64 offen nt lds
    s_add_u32 s64, s63, 13
    s_and_b32 s64, s64, 15
    s_and_b32 s100, s64, 3
    s_lshl_b32 s100, s100, 6
    s_lshr_b32 s101, s64, 3
    s_lshl_b32 s101, s101, 5
    s_or_b32 s100, s100, s101
    s_lshl_b32 s64, s64, 10
    s_add_u32 m0, s61, s64
    v_xor_b32 v53, s100, v5
    s_add_u32 s64, s64, s62
    buffer_load_dwordx4 v53, s[36:39], s64 offen nt lds
    s_add_u32 s64, s63, 14
    s_and_b32 s64, s64, 15
    s_and_b32 s100, s64, 3
    s_lshl_b32 s100, s100, 6
    s_lshr_b32 s101, s64, 3
    s_lshl_b32 s101, s101, 5
    s_or_b32 s100, s100, s101
    s_lshl_b32 s64, s64, 10
    s_add_u32 m0, s61, s64
    v_xor_b32 v52, s100, v5
    s_add_u32 s64, s64, s62
    buffer_load_dwordx4 v52, s[36:39], s64 offen nt lds
    s_add_u32 s64, s63, 15
    s_and_b32 s64, s64, 15
    s_and_b32 s100, s64, 3
    s_lshl_b32 s100, s100, 6
    s_lshr_b32 s101, s64, 3
    s_lshl_b32 s101, s101, 5
    s_or_b32 s100, s100, s101
    s_lshl_b32 s64, s64, 10
    s_add_u32 m0, s61, s64
    v_xor_b32 v53, s100, v5
    s_add_u32 s64, s64, s62
    buffer_load_dwordx4 v53, s[36:39], s64 offen nt lds
Lqaj_83:
    s_waitcnt vmcnt(0)
    s_barrier
    v_lshrrev_b32 v40, 2, v3
    v_and_b32 v41, 1, v2
    v_lshlrev_b32 v42, 2, v40
    v_lshl_or_b32 v42, v41, 1, v42
    v_lshl_add_u32 v43, v2, 3, v40
    v_lshlrev_b32 v43, 10, v43
    v_and_b32 v44, 1, v3
    v_lshl_add_u32 v43, v44, 3, v43
    v_bfe_u32 v44, v3, 1, 1
    s_lshl_b32 s61, s56, 3
    s_add_u32 s62, s61, 0
    v_add_u32 v45, s62, v44
    v_xor_b32 v45, v45, v42
    v_lshl_add_u32 v48, v45, 4, v43
    s_add_u32 s62, s61, 2
    v_add_u32 v45, s62, v44
    v_xor_b32 v45, v45, v42
    v_lshl_add_u32 v49, v45, 4, v43
    s_add_u32 s62, s61, 4
    v_add_u32 v45, s62, v44
    v_xor_b32 v45, v45, v42
    v_lshl_add_u32 v50, v45, 4, v43
    s_add_u32 s62, s61, 6
    v_add_u32 v45, s62, v44
    v_xor_b32 v45, v45, v42
    v_lshl_add_u32 v51, v45, 4, v43
    ds_read_b64_tr_b16 v[128:129], v48 offset:0
    ds_read_b64_tr_b16 v[130:131], v48 offset:4096
    ds_read_b64_tr_b16 v[144:145], v49 offset:0
    ds_read_b64_tr_b16 v[146:147], v49 offset:4096
    ds_read_b64_tr_b16 v[160:161], v50 offset:0
    ds_read_b64_tr_b16 v[162:163], v50 offset:4096
    ds_read_b64_tr_b16 v[176:177], v51 offset:0
    ds_read_b64_tr_b16 v[178:179], v51 offset:4096
    s_waitcnt lgkmcnt(0)
    ds_read_b64_tr_b16 v[132:133], v48 offset:32768
    ds_read_b64_tr_b16 v[134:135], v48 offset:36864
    ds_read_b64_tr_b16 v[148:149], v49 offset:32768
    ds_read_b64_tr_b16 v[150:151], v49 offset:36864
    ds_read_b64_tr_b16 v[164:165], v50 offset:32768
    ds_read_b64_tr_b16 v[166:167], v50 offset:36864
    ds_read_b64_tr_b16 v[180:181], v51 offset:32768
    ds_read_b64_tr_b16 v[182:183], v51 offset:36864
    s_waitcnt lgkmcnt(0)
    v_add_u32 v48, 0x10000, v48
    v_add_u32 v49, 0x10000, v49
    v_add_u32 v50, 0x10000, v50
    v_add_u32 v51, 0x10000, v51
    ds_read_b64_tr_b16 v[136:137], v48 offset:0
    ds_read_b64_tr_b16 v[138:139], v48 offset:4096
    ds_read_b64_tr_b16 v[152:153], v49 offset:0
    ds_read_b64_tr_b16 v[154:155], v49 offset:4096
    ds_read_b64_tr_b16 v[168:169], v50 offset:0
    ds_read_b64_tr_b16 v[170:171], v50 offset:4096
    ds_read_b64_tr_b16 v[184:185], v51 offset:0
    ds_read_b64_tr_b16 v[186:187], v51 offset:4096
    s_waitcnt lgkmcnt(0)
    ds_read_b64_tr_b16 v[140:141], v48 offset:32768
    ds_read_b64_tr_b16 v[142:143], v48 offset:36864
    ds_read_b64_tr_b16 v[156:157], v49 offset:32768
    ds_read_b64_tr_b16 v[158:159], v49 offset:36864
    ds_read_b64_tr_b16 v[172:173], v50 offset:32768
    ds_read_b64_tr_b16 v[174:175], v50 offset:36864
    ds_read_b64_tr_b16 v[188:189], v51 offset:32768
    ds_read_b64_tr_b16 v[190:191], v51 offset:36864
    s_waitcnt lgkmcnt(0)
    s_barrier
    s_cmp_lg_u32 s56, 0
    s_cbranch_scc1 Lwf_84
    v_lshlrev_b32 v40, 2, v1
    s_mov_b64 exec, 0xffffffff
    s_mov_b32 s92, 0
Lpoll_85:
    buffer_load_dword v41, v40, s[32:35], s93 offen offset:0 sc0 sc1
    s_waitcnt vmcnt(0)
    v_mov_b32 v42, v41
    v_cmpx_eq_u32 vcc, -1, v42
    s_cbranch_execz Lpolld_86
    s_sleep 8
    s_add_u32 s92, s92, 1
    s_cmp_lt_u32 s92, 400000
    s_cbranch_scc1 Lpoll_85
Lpolld_86:
    s_mov_b64 exec, -1
Lwf_84:
    s_barrier
    s_lshr_b32 s66, s56, 2
    s_and_b32 s63, s56, 3
    s_lshl_b32 s61, s56, 17
    s_lshl_b32 s62, s65, 10
    s_add_u32 s61, s61, s62
    s_add_u32 s61, s61, 2097152
    v_lshlrev_b32 v40, 3, v3
    s_lshl_b32 s62, s65, 8
    s_lshl_b32 s64, s66, 7
    s_add_u32 s62, s62, s64
    s_add_u32 s62, s62, 1245184
    buffer_load_dwordx2 v[42:43], v40, s[32:35], s62 offen sc0 sc1
    buffer_load_dwordx4 v[192:195], v5, s[32:35], s61 offen sc0 sc1
    s_add_u32 s61, s61, 32768
    buffer_load_dwordx4 v[196:199], v5, s[32:35], s61 offen sc0 sc1
    s_add_u32 s61, s61, 32768
    buffer_load_dwordx4 v[200:203], v5, s[32:35], s61 offen sc0 sc1
    s_add_u32 s61, s61, 32768
    buffer_load_dwordx4 v[204:207], v5, s[32:35], s61 offen sc0 sc1
    s_waitcnt vmcnt(4)
    v_mov_b32 v44, v42
    s_nop 1
    v_max_f32_dpp v44, v44, v44 row_ror:8 row_mask:0xf bank_mask:0xf
    s_nop 1
    v_max_f32_dpp v44, v44, v44 row_ror:4 row_mask:0xf bank_mask:0xf
    s_nop 1
    v_max_f32_dpp v44, v44, v44 row_ror:2 row_mask:0xf bank_mask:0xf
    s_nop 1
    v_max_f32_dpp v44, v44, v44 row_ror:1 row_mask:0xf bank_mask:0xf
    v_sub_f32 v42, v42, v44
    v_exp_f32 v42, v42
    s_nop 0
    v_mul_f32 v43, v43, v42
    s_nop 1
    v_add_f32_dpp v43, v43, v43 row_ror:8 row_mask:0xf bank_mask:0xf
    s_nop 1
    v_add_f32_dpp v43, v43, v43 row_ror:4 row_mask:0xf bank_mask:0xf
    s_nop 1
    v_add_f32_dpp v43, v43, v43 row_ror:2 row_mask:0xf bank_mask:0xf
    s_nop 1
    v_add_f32_dpp v43, v43, v43 row_ror:1 row_mask:0xf bank_mask:0xf
    v_rcp_f32 v43, v43
    s_nop 0
    v_mul_f32 v42, v42, v43
    s_lshl_b32 s63, s63, 2
    s_nop 1
    s_add_u32 s64, s63, 0
    v_readlane_b32 s76, v42, s64
    s_add_u32 s64, s63, 1
    v_readlane_b32 s77, v42, s64
    s_add_u32 s64, s63, 2
    v_readlane_b32 s78, v42, s64
    s_add_u32 s64, s63, 3
    v_readlane_b32 s79, v42, s64
    s_nop 1
    s_waitcnt vmcnt(3)
    v_lshlrev_b32 v48, 16, v192
    v_and_b32 v49, 0xffff0000, v192
    v_lshlrev_b32 v50, 16, v193
    v_and_b32 v51, 0xffff0000, v193
    v_lshlrev_b32 v52, 16, v194
    v_and_b32 v53, 0xffff0000, v194
    v_lshlrev_b32 v54, 16, v195
    v_and_b32 v55, 0xffff0000, v195
    v_mul_f32 v24, s76, v48
    v_mul_f32 v25, s76, v49
    v_mul_f32 v26, s76, v50
    v_mul_f32 v27, s76, v51
    v_mul_f32 v28, s76, v52
    v_mul_f32 v29, s76, v53
    v_mul_f32 v30, s76, v54
    v_mul_f32 v31, s76, v55
    s_waitcnt vmcnt(2)
    v_lshlrev_b32 v48, 16, v196
    v_and_b32 v49, 0xffff0000, v196
    v_lshlrev_b32 v50, 16, v197
    v_and_b32 v51, 0xffff0000, v197
    v_lshlrev_b32 v52, 16, v198
    v_and_b32 v53, 0xffff0000, v198
    v_lshlrev_b32 v54, 16, v199
    v_and_b32 v55, 0xffff0000, v199
    v_fmac_f32 v24, s77, v48
    v_fmac_f32 v25, s77, v49
    v_fmac_f32 v26, s77, v50
    v_fmac_f32 v27, s77, v51
    v_fmac_f32 v28, s77, v52
    v_fmac_f32 v29, s77, v53
    v_fmac_f32 v30, s77, v54
    v_fmac_f32 v31, s77, v55
    s_waitcnt vmcnt(1)
    v_lshlrev_b32 v48, 16, v200
    v_and_b32 v49, 0xffff0000, v200
    v_lshlrev_b32 v50, 16, v201
    v_and_b32 v51, 0xffff0000, v201
    v_lshlrev_b32 v52, 16, v202
    v_and_b32 v53, 0xffff0000, v202
    v_lshlrev_b32 v54, 16, v203
    v_and_b32 v55, 0xffff0000, v203
    v_fmac_f32 v24, s78, v48
    v_fmac_f32 v25, s78, v49
    v_fmac_f32 v26, s78, v50
    v_fmac_f32 v27, s78, v51
    v_fmac_f32 v28, s78, v52
    v_fmac_f32 v29, s78, v53
    v_fmac_f32 v30, s78, v54
    v_fmac_f32 v31, s78, v55
    s_waitcnt vmcnt(0)
    v_lshlrev_b32 v48, 16, v204
    v_and_b32 v49, 0xffff0000, v204
    v_lshlrev_b32 v50, 16, v205
    v_and_b32 v51, 0xffff0000, v205
    v_lshlrev_b32 v52, 16, v206
    v_and_b32 v53, 0xffff0000, v206
    v_lshlrev_b32 v54, 16, v207
    v_and_b32 v55, 0xffff0000, v207
    v_fmac_f32 v24, s79, v48
    v_fmac_f32 v25, s79, v49
    v_fmac_f32 v26, s79, v50
    v_fmac_f32 v27, s79, v51
    v_fmac_f32 v28, s79, v52
    v_fmac_f32 v29, s79, v53
    v_fmac_f32 v30, s79, v54
    v_fmac_f32 v31, s79, v55
    s_lshl_b32 s61, s56, 11
    v_lshlrev_b32 v40, 5, v1
    v_add_u32 v40, s61, v40
    ds_write_b128 v40, v[24:27] offset:16384
    ds_write_b128 v40, v[28:31] offset:16400
    s_waitcnt lgkmcnt(0)
    s_barrier
    v_and_b32 v40, 255, v0
    v_lshlrev_b32 v40, 3, v40
    s_lshl_b32 s61, s66, 13
    v_add_u32 v40, s61, v40
    ds_read_b64 v[24:25], v40 offset:16384
    ds_read_b64 v[26:27], v40 offset:18432
    ds_read_b64 v[28:29], v40 offset:20480
    ds_read_b64 v[30:31], v40 offset:22528
    s_waitcnt lgkmcnt(0)
    v_add_f32 v24, v24, v26
    v_add_f32 v25, v25, v27
    v_add_f32 v24, v24, v28
    v_add_f32 v25, v25, v29
    v_add_f32 v24, v24, v30
    v_add_f32 v25, v25, v31
    v_cvt_pk_bf16_f32 v24, v24, v25
    v_lshlrev_b32 v40, 2, v0
    ds_write_b32 v40, v24 offset:32768
    s_waitcnt lgkmcnt(0)
    s_barrier
    s_lshl_b32 s61, s56, 7
    v_lshlrev_b32 v40, 5, v2
    v_add_u32 v40, s61, v40
    ds_read_b128 v[8:11], v40 offset:32768
    ds_read_b128 v[12:15], v40 offset:32784
    ds_read_b128 v[16:19], v40 offset:33792
    ds_read_b128 v[20:23], v40 offset:33808
    s_waitcnt lgkmcnt(0)
    v_mov_b32 v24, 0
    v_mov_b32 v25, 0
    v_mov_b32 v26, 0
    v_mov_b32 v27, 0
    v_mov_b32 v28, 0
    v_mov_b32 v29, 0
    v_mov_b32 v30, 0
    v_mov_b32 v31, 0
    v_mov_b32 v32, 0
    v_mov_b32 v33, 0
    v_mov_b32 v34, 0
    v_mov_b32 v35, 0
    v_mov_b32 v36, 0
    v_mov_b32 v37, 0
    v_mov_b32 v38, 0
    v_mov_b32 v39, 0
    v_perm_b32 v40, v68, v64, s68
    v_perm_b32 v41, v68, v64, s69
    v_perm_b32 v42, v69, v65, s68
    v_perm_b32 v43, v69, v65, s69
    v_perm_b32 v44, v70, v66, s68
    v_perm_b32 v45, v70, v66, s69
    v_perm_b32 v46, v71, v67, s68
    v_perm_b32 v47, v71, v67, s69
    v_dot2_f32_bf16 v24, v40, v8, v24
    v_dot2_f32_bf16 v25, v41, v8, v25
    v_dot2_f32_bf16 v26, v42, v8, v26
    v_dot2_f32_bf16 v27, v43, v8, v27
    v_dot2_f32_bf16 v28, v44, v8, v28
    v_dot2_f32_bf16 v29, v45, v8, v29
    v_dot2_f32_bf16 v30, v46, v8, v30
    v_dot2_f32_bf16 v31, v47, v8, v31
    v_dot2_f32_bf16 v32, v40, v16, v32
    v_dot2_f32_bf16 v33, v41, v16, v33
    v_dot2_f32_bf16 v34, v42, v16, v34
    v_dot2_f32_bf16 v35, v43, v16, v35
    v_dot2_f32_bf16 v36, v44, v16, v36
    v_dot2_f32_bf16 v37, v45, v16, v37
    v_dot2_f32_bf16 v38, v46, v16, v38
    v_dot2_f32_bf16 v39, v47, v16, v39
    v_perm_b32 v40, v76, v72, s68
    v_perm_b32 v41, v76, v72, s69
    v_perm_b32 v42, v77, v73, s68
    v_perm_b32 v43, v77, v73, s69
    v_perm_b32 v44, v78, v74, s68
    v_perm_b32 v45, v78, v74, s69
    v_perm_b32 v46, v79, v75, s68
    v_perm_b32 v47, v79, v75, s69
    v_dot2_f32_bf16 v24, v40, v9, v24
    v_dot2_f32_bf16 v25, v41, v9, v25
    v_dot2_f32_bf16 v26, v42, v9, v26
    v_dot2_f32_bf16 v27, v43, v9, v27
    v_dot2_f32_bf16 v28, v44, v9, v28
    v_dot2_f32_bf16 v29, v45, v9, v29
    v_dot2_f32_bf16 v30, v46, v9, v30
    v_dot2_f32_bf16 v31, v47, v9, v31
    v_dot2_f32_bf16 v32, v40, v17, v32
    v_dot2_f32_bf16 v33, v41, v17, v33
    v_dot2_f32_bf16 v34, v42, v17, v34
    v_dot2_f32_bf16 v35, v43, v17, v35
    v_dot2_f32_bf16 v36, v44, v17, v36
    v_dot2_f32_bf16 v37, v45, v17, v37
    v_dot2_f32_bf16 v38, v46, v17, v38
    v_dot2_f32_bf16 v39, v47, v17, v39
    v_perm_b32 v40, v84, v80, s68
    v_perm_b32 v41, v84, v80, s69
    v_perm_b32 v42, v85, v81, s68
    v_perm_b32 v43, v85, v81, s69
    v_perm_b32 v44, v86, v82, s68
    v_perm_b32 v45, v86, v82, s69
    v_perm_b32 v46, v87, v83, s68
    v_perm_b32 v47, v87, v83, s69
    v_dot2_f32_bf16 v24, v40, v10, v24
    v_dot2_f32_bf16 v25, v41, v10, v25
    v_dot2_f32_bf16 v26, v42, v10, v26
    v_dot2_f32_bf16 v27, v43, v10, v27
    v_dot2_f32_bf16 v28, v44, v10, v28
    v_dot2_f32_bf16 v29, v45, v10, v29
    v_dot2_f32_bf16 v30, v46, v10, v30
    v_dot2_f32_bf16 v31, v47, v10, v31
    v_dot2_f32_bf16 v32, v40, v18, v32
    v_dot2_f32_bf16 v33, v41, v18, v33
    v_dot2_f32_bf16 v34, v42, v18, v34
    v_dot2_f32_bf16 v35, v43, v18, v35
    v_dot2_f32_bf16 v36, v44, v18, v36
    v_dot2_f32_bf16 v37, v45, v18, v37
    v_dot2_f32_bf16 v38, v46, v18, v38
    v_dot2_f32_bf16 v39, v47, v18, v39
    v_perm_b32 v40, v92, v88, s68
    v_perm_b32 v41, v92, v88, s69
    v_perm_b32 v42, v93, v89, s68
    v_perm_b32 v43, v93, v89, s69
    v_perm_b32 v44, v94, v90, s68
    v_perm_b32 v45, v94, v90, s69
    v_perm_b32 v46, v95, v91, s68
    v_perm_b32 v47, v95, v91, s69
    v_dot2_f32_bf16 v24, v40, v11, v24
    v_dot2_f32_bf16 v25, v41, v11, v25
    v_dot2_f32_bf16 v26, v42, v11, v26
    v_dot2_f32_bf16 v27, v43, v11, v27
    v_dot2_f32_bf16 v28, v44, v11, v28
    v_dot2_f32_bf16 v29, v45, v11, v29
    v_dot2_f32_bf16 v30, v46, v11, v30
    v_dot2_f32_bf16 v31, v47, v11, v31
    v_dot2_f32_bf16 v32, v40, v19, v32
    v_dot2_f32_bf16 v33, v41, v19, v33
    v_dot2_f32_bf16 v34, v42, v19, v34
    v_dot2_f32_bf16 v35, v43, v19, v35
    v_dot2_f32_bf16 v36, v44, v19, v36
    v_dot2_f32_bf16 v37, v45, v19, v37
    v_dot2_f32_bf16 v38, v46, v19, v38
    v_dot2_f32_bf16 v39, v47, v19, v39
    v_perm_b32 v40, v100, v96, s68
    v_perm_b32 v41, v100, v96, s69
    v_perm_b32 v42, v101, v97, s68
    v_perm_b32 v43, v101, v97, s69
    v_perm_b32 v44, v102, v98, s68
    v_perm_b32 v45, v102, v98, s69
    v_perm_b32 v46, v103, v99, s68
    v_perm_b32 v47, v103, v99, s69
    v_dot2_f32_bf16 v24, v40, v12, v24
    v_dot2_f32_bf16 v25, v41, v12, v25
    v_dot2_f32_bf16 v26, v42, v12, v26
    v_dot2_f32_bf16 v27, v43, v12, v27
    v_dot2_f32_bf16 v28, v44, v12, v28
    v_dot2_f32_bf16 v29, v45, v12, v29
    v_dot2_f32_bf16 v30, v46, v12, v30
    v_dot2_f32_bf16 v31, v47, v12, v31
    v_dot2_f32_bf16 v32, v40, v20, v32
    v_dot2_f32_bf16 v33, v41, v20, v33
    v_dot2_f32_bf16 v34, v42, v20, v34
    v_dot2_f32_bf16 v35, v43, v20, v35
    v_dot2_f32_bf16 v36, v44, v20, v36
    v_dot2_f32_bf16 v37, v45, v20, v37
    v_dot2_f32_bf16 v38, v46, v20, v38
    v_dot2_f32_bf16 v39, v47, v20, v39
    v_perm_b32 v40, v108, v104, s68
    v_perm_b32 v41, v108, v104, s69
    v_perm_b32 v42, v109, v105, s68
    v_perm_b32 v43, v109, v105, s69
    v_perm_b32 v44, v110, v106, s68
    v_perm_b32 v45, v110, v106, s69
    v_perm_b32 v46, v111, v107, s68
    v_perm_b32 v47, v111, v107, s69
    v_dot2_f32_bf16 v24, v40, v13, v24
    v_dot2_f32_bf16 v25, v41, v13, v25
    v_dot2_f32_bf16 v26, v42, v13, v26
    v_dot2_f32_bf16 v27, v43, v13, v27
    v_dot2_f32_bf16 v28, v44, v13, v28
    v_dot2_f32_bf16 v29, v45, v13, v29
    v_dot2_f32_bf16 v30, v46, v13, v30
    v_dot2_f32_bf16 v31, v47, v13, v31
    v_dot2_f32_bf16 v32, v40, v21, v32
    v_dot2_f32_bf16 v33, v41, v21, v33
    v_dot2_f32_bf16 v34, v42, v21, v34
    v_dot2_f32_bf16 v35, v43, v21, v35
    v_dot2_f32_bf16 v36, v44, v21, v36
    v_dot2_f32_bf16 v37, v45, v21, v37
    v_dot2_f32_bf16 v38, v46, v21, v38
    v_dot2_f32_bf16 v39, v47, v21, v39
    v_perm_b32 v40, v116, v112, s68
    v_perm_b32 v41, v116, v112, s69
    v_perm_b32 v42, v117, v113, s68
    v_perm_b32 v43, v117, v113, s69
    v_perm_b32 v44, v118, v114, s68
    v_perm_b32 v45, v118, v114, s69
    v_perm_b32 v46, v119, v115, s68
    v_perm_b32 v47, v119, v115, s69
    v_dot2_f32_bf16 v24, v40, v14, v24
    v_dot2_f32_bf16 v25, v41, v14, v25
    v_dot2_f32_bf16 v26, v42, v14, v26
    v_dot2_f32_bf16 v27, v43, v14, v27
    v_dot2_f32_bf16 v28, v44, v14, v28
    v_dot2_f32_bf16 v29, v45, v14, v29
    v_dot2_f32_bf16 v30, v46, v14, v30
    v_dot2_f32_bf16 v31, v47, v14, v31
    v_dot2_f32_bf16 v32, v40, v22, v32
    v_dot2_f32_bf16 v33, v41, v22, v33
    v_dot2_f32_bf16 v34, v42, v22, v34
    v_dot2_f32_bf16 v35, v43, v22, v35
    v_dot2_f32_bf16 v36, v44, v22, v36
    v_dot2_f32_bf16 v37, v45, v22, v37
    v_dot2_f32_bf16 v38, v46, v22, v38
    v_dot2_f32_bf16 v39, v47, v22, v39
    v_perm_b32 v40, v124, v120, s68
    v_perm_b32 v41, v124, v120, s69
    v_perm_b32 v42, v125, v121, s68
    v_perm_b32 v43, v125, v121, s69
    v_perm_b32 v44, v126, v122, s68
    v_perm_b32 v45, v126, v122, s69
    v_perm_b32 v46, v127, v123, s68
    v_perm_b32 v47, v127, v123, s69
    v_dot2_f32_bf16 v24, v40, v15, v24
    v_dot2_f32_bf16 v25, v41, v15, v25
    v_dot2_f32_bf16 v26, v42, v15, v26
    v_dot2_f32_bf16 v27, v43, v15, v27
    v_dot2_f32_bf16 v28, v44, v15, v28
    v_dot2_f32_bf16 v29, v45, v15, v29
    v_dot2_f32_bf16 v30, v46, v15, v30
    v_dot2_f32_bf16 v31, v47, v15, v31
    v_dot2_f32_bf16 v32, v40, v23, v32
    v_dot2_f32_bf16 v33, v41, v23, v33
    v_dot2_f32_bf16 v34, v42, v23, v34
    v_dot2_f32_bf16 v35, v43, v23, v35
    v_dot2_f32_bf16 v36, v44, v23, v36
    v_dot2_f32_bf16 v37, v45, v23, v37
    v_dot2_f32_bf16 v38, v46, v23, v38
    v_dot2_f32_bf16 v39, v47, v23, v39
    s_nop 2
    v_permlane32_swap_b32 v24, v28
    v_permlane32_swap_b32 v25, v29
    v_permlane32_swap_b32 v26, v30
    v_permlane32_swap_b32 v27, v31
    v_permlane32_swap_b32 v32, v36
    v_permlane32_swap_b32 v33, v37
    v_permlane32_swap_b32 v34, v38
    v_permlane32_swap_b32 v35, v39
    s_nop 1
    v_add_f32 v24, v24, v28
    v_add_f32 v25, v25, v29
    v_add_f32 v26, v26, v30
    v_add_f32 v27, v27, v31
    v_add_f32 v32, v32, v36
    v_add_f32 v33, v33, v37
    v_add_f32 v34, v34, v38
    v_add_f32 v35, v35, v39
    s_nop 1
    v_permlane16_swap_b32 v24, v26
    v_permlane16_swap_b32 v25, v27
    v_permlane16_swap_b32 v32, v34
    v_permlane16_swap_b32 v33, v35
    s_nop 1
    v_add_f32 v24, v24, v26
    v_add_f32 v25, v25, v27
    v_add_f32 v32, v32, v34
    v_add_f32 v33, v33, v35
    v_lshlrev_b32 v48, 5, v3
    v_lshl_add_u32 v48, v2, 3, v48
    s_lshl_b32 s61, s56, 9
    v_add_u32 v49, s61, v48
    ds_write_b64 v49, v[24:25] offset:0
    ds_write_b64 v49, v[32:33] offset:4096
    s_waitcnt lgkmcnt(0)
    s_barrier
    v_lshrrev_b32 v40, 5, v1
    v_lshlrev_b32 v40, 12, v40
    v_and_b32 v41, 31, v1
    v_lshl_add_u32 v40, v41, 4, v40
    ds_read_b128 v[192:195], v40 offset:0
    ds_read_b128 v[196:199], v40 offset:512
    ds_read_b128 v[200:203], v40 offset:1024
    ds_read_b128 v[204:207], v40 offset:1536
    ds_read_b128 v[208:211], v40 offset:2048
    ds_read_b128 v[212:215], v40 offset:2560
    ds_read_b128 v[216:219], v40 offset:3072
    ds_read_b128 v[220:223], v40 offset:3584
    s_lshl_b32 s61, s56, 9
    s_add_u32 s61, s61, 131072
    v_lshlrev_b32 v46, 3, v1
    v_add_u32 v46, s61, v46
    v_and_b32 v47, 1, v3
    v_lshlrev_b32 v47, 8, v47
    v_lshl_add_u32 v47, v2, 4, v47
    v_add_u32 v47, s61, v47
    s_waitcnt lgkmcnt(6)
    v_add_f32 v192, v192, v196
    v_add_f32 v193, v193, v197
    v_add_f32 v194, v194, v198
    v_add_f32 v195, v195, v199
    s_waitcnt lgkmcnt(5)
    v_add_f32 v192, v192, v200
    v_add_f32 v193, v193, v201
    v_add_f32 v194, v194, v202
    v_add_f32 v195, v195, v203
    s_waitcnt lgkmcnt(4)
    v_add_f32 v192, v192, v204
    v_add_f32 v193, v193, v205
    v_add_f32 v194, v194, v206
    v_add_f32 v195, v195, v207
    s_waitcnt lgkmcnt(3)
    v_add_f32 v192, v192, v208
    v_add_f32 v193, v193, v209
    v_add_f32 v194, v194, v210
    v_add_f32 v195, v195, v211
    s_waitcnt lgkmcnt(2)
    v_add_f32 v192, v192, v212
    v_add_f32 v193, v193, v213
    v_add_f32 v194, v194, v214
    v_add_f32 v195, v195, v215
    s_waitcnt lgkmcnt(1)
    v_add_f32 v192, v192, v216
    v_add_f32 v193, v193, v217
    v_add_f32 v194, v194, v218
    v_add_f32 v195, v195, v219
    s_waitcnt lgkmcnt(0)
    v_add_f32 v192, v192, v220
    v_add_f32 v193, v193, v221
    v_add_f32 v194, v194, v222
    v_add_f32 v195, v195, v223
    v_cvt_pk_bf16_f32 v192, v192, v193
    v_cvt_pk_bf16_f32 v193, v194, v195
    ds_write_b64 v46, v[192:193]
    s_waitcnt lgkmcnt(0)
    ds_read_b128 v[24:27], v47 offset:0
    ds_read_b128 v[28:31], v47 offset:64
    ds_read_b128 v[32:35], v47 offset:128
    ds_read_b128 v[36:39], v47 offset:192
    v_and_b32 v40, 1, v1
    v_lshlrev_b32 v40, 19, v40
    v_lshl_add_u32 v40, v2, 4, v40
    s_lshl_b32 s61, s56, 16
    s_lshl_b32 s62, s65, 6
    s_add_u32 s61, s61, s62
    s_add_u32 s61, s61, 10752
    s_waitcnt lgkmcnt(3)
    v_mfma_f32_16x16x32_bf16 v[8:11], v[128:131], v[24:27], 0
    v_mfma_f32_16x16x32_bf16 v[12:15], v[144:147], v[24:27], 0
    v_mfma_f32_16x16x32_bf16 v[16:19], v[160:163], v[24:27], 0
    v_mfma_f32_16x16x32_bf16 v[20:23], v[176:179], v[24:27], 0
    s_waitcnt lgkmcnt(2)
    v_mfma_f32_16x16x32_bf16 v[8:11], v[132:135], v[28:31], v[8:11]
    v_mfma_f32_16x16x32_bf16 v[12:15], v[148:151], v[28:31], v[12:15]
    v_mfma_f32_16x16x32_bf16 v[16:19], v[164:167], v[28:31], v[16:19]
    v_mfma_f32_16x16x32_bf16 v[20:23], v[180:183], v[28:31], v[20:23]
    s_waitcnt lgkmcnt(1)
    v_mfma_f32_16x16x32_bf16 v[8:11], v[136:139], v[32:35], v[8:11]
    v_mfma_f32_16x16x32_bf16 v[12:15], v[152:155], v[32:35], v[12:15]
    v_mfma_f32_16x16x32_bf16 v[16:19], v[168:171], v[32:35], v[16:19]
    v_mfma_f32_16x16x32_bf16 v[20:23], v[184:187], v[32:35], v[20:23]
    s_waitcnt lgkmcnt(0)
    v_mfma_f32_16x16x32_bf16 v[8:11], v[140:143], v[36:39], v[8:11]
    v_mfma_f32_16x16x32_bf16 v[12:15], v[156:159], v[36:39], v[12:15]
    v_mfma_f32_16x16x32_bf16 v[16:19], v[172:175], v[36:39], v[16:19]
    v_mfma_f32_16x16x32_bf16 v[20:23], v[188:191], v[36:39], v[20:23]
    s_mov_b32 exec_lo, 0x00030003
    s_mov_b32 exec_hi, 0x00030003
    s_nop 2
    s_nop 1
    buffer_store_dwordx4 v[8:11], v40, s[32:35], s61 offen sc0 sc1
    s_add_u32 s61, s61, 16384
    buffer_store_dwordx4 v[12:15], v40, s[32:35], s61 offen sc0 sc1
    s_add_u32 s61, s61, 16384
    buffer_store_dwordx4 v[16:19], v40, s[32:35], s61 offen sc0 sc1
    s_add_u32 s61, s61, 16384
    s_nop 3
    buffer_store_dwordx4 v[20:23], v40, s[32:35], s61 offen sc0 sc1
    s_mov_b64 exec, -1
    s_branch L_final
L_final:
    s_cmp_ge_u32 s56, 2
    s_cbranch_scc1 L_end
    s_lshr_b32 s66, s75, 5
    s_and_b32 s64, s75, 31
    v_lshlrev_b32 v8, 5, v1
    s_lshl_b32 s61, s56, 11
    s_add_u32 s61, s61, 8704
    s_add_u32 s61, s61, s93
    v_and_b32 v6, 1, v1
    v_lshlrev_b32 v6, 4, v6
    v_lshl_add_u32 v6, v2, 2, v6
    s_lshl_b32 s59, s66, 11
    s_lshl_b32 s60, s64, 5
    s_add_u32 s59, s59, s60
    s_xor_b32 s60, s56, 1
    s_lshl_b32 s60, s60, 10
    s_add_u32 s59, s59, s60
    s_mov_b32 s36, s26
    s_mov_b32 s37, s27
    s_and_b32 s37, s37, 0xffff
    s_mov_b32 s38, 4096
    s_mov_b32 s39, 0x00020000
    s_mov_b32 s92, 0
Lpoll_89:
    buffer_load_dwordx4 v[12:15], v8, s[32:35], s61 offen sc0 sc1
    buffer_load_dwordx4 v[16:19], v8, s[32:35], s61 offen offset:16 sc0 sc1
    s_waitcnt vmcnt(0)
    v_mov_b32 v22, v12
    v_max3_u32 v22, v22, v13, v14
    v_max3_u32 v22, v22, v15, v16
    v_max3_u32 v22, v22, v17, v18
    v_max_u32 v22, v22, v19
    v_cmpx_eq_u32 vcc, -1, v22
    s_cbranch_execz Lpolld_90
    s_sleep 2
    s_add_u32 s92, s92, 1
    s_cmp_lt_u32 s92, 400000
    s_cbranch_scc1 Lpoll_89
Lpolld_90:
    s_mov_b64 exec, -1
Lfsk_87:
    s_nop 1
    v_permlane32_swap_b32 v12, v16
    v_permlane32_swap_b32 v13, v17
    v_permlane32_swap_b32 v14, v18
    v_permlane32_swap_b32 v15, v19
    s_nop 1
    v_add_f32 v12, v12, v16
    v_add_f32 v13, v13, v17
    v_add_f32 v14, v14, v18
    v_add_f32 v15, v15, v19
    s_nop 1
    v_permlane16_swap_b32 v12, v14
    v_permlane16_swap_b32 v13, v15
    s_nop 1
    v_add_f32 v12, v12, v14
    v_add_f32 v13, v13, v15
    s_nop 0
    v_add_f32_dpp v12, v12, v12 row_ror:8 row_mask:0xf bank_mask:0xf
    v_add_f32_dpp v13, v13, v13 row_ror:8 row_mask:0xf bank_mask:0xf
    s_nop 0
    v_add_f32_dpp v12, v12, v12 row_ror:4 row_mask:0xf bank_mask:0xf
    v_add_f32_dpp v13, v13, v13 row_ror:4 row_mask:0xf bank_mask:0xf
    s_nop 0
    v_add_f32_dpp v12, v12, v12 quad_perm:[2,3,0,1] row_mask:0xf bank_mask:0xf
    v_add_f32_dpp v13, v13, v13 quad_perm:[2,3,0,1] row_mask:0xf bank_mask:0xf
    v_cvt_pk_bf16_f32 v12, v12, v13
    s_mov_b32 exec_lo, 0x00030003
    s_mov_b32 exec_hi, 0x00030003
    buffer_store_dword v12, v6, s[36:39], s59 offen
    s_mov_b64 exec, -1
    s_branch L_end
L_end:
    s_endpgm
.section .rodata,"a"
.p2align 6
.amdhsa_kernel concat_heads__compressed_kv_cla__gqa_block_cached__decode_kernel
  .amdhsa_next_free_vgpr 256
  .amdhsa_next_free_sgpr 102
  .amdhsa_accum_offset 256
  .amdhsa_group_segment_fixed_size 0
  .amdhsa_kernarg_size 112
  .amdhsa_user_sgpr_count 2
  .amdhsa_user_sgpr_kernarg_segment_ptr 1
  .amdhsa_system_sgpr_workgroup_id_x 1
.end_amdhsa_kernel
```
